```python
import torch

def _softmax(x, axis=-1):
    return torch.softmax(x, dim=axis)
def _gelu(x):
    return torch.nn.functional.gelu(x, approximate="tanh")
def _silu(x):
    return torch.nn.functional.silu(x)
def _sigmoid(x):
    return torch.sigmoid(x)
def _layernorm(x, axis=-1, eps=1e-5):
    m = x.mean(dim=axis, keepdim=True)
    v = x.var(dim=axis, keepdim=True, unbiased=False)
    return (x - m) / torch.sqrt(v + eps)
def _scatter_add(tgt, idx, src, axis=0):
    return tgt.clone().index_add_(axis, idx, src)
def _segment_sum(src, seg, n):
    out = torch.zeros((n,) + src.shape[1:], dtype=src.dtype)
    return out.index_add_(0, seg, src)
def _pad(x, pw):
    flat = tuple(v for pair in reversed(pw) for v in pair)
    return torch.nn.functional.pad(x, flat)

kernel_name = 'sequential_preLN__ssm_conv_s4d__dense_activation_squared_relu__prompt'

def setup_inputs():

    _w = (lambda a: (lambda t: t.to(torch.bfloat16) if t.is_floating_point() else t)(torch.as_tensor(a)))
    def _A_setup():
        Bsz, L, D, N = 1, 2048, 576, 128
        return {
            "u": _w((lambda *s: torch.randn(*s, dtype=torch.bfloat16) * 0.05)(Bsz, L, D)),
            "log_A_real": _w((lambda *s: torch.randn(*s, dtype=torch.bfloat16) * 3.2)(D, N) * 0.5),
            "A_imag": _w((lambda *s: torch.randn(*s, dtype=torch.bfloat16) * 0.05)(D, N) * 3.14),
            "C_real": _w((lambda *s: torch.randn(*s, dtype=torch.bfloat16) * 0.1)(D, N) / N ** 0.5),
            "C_imag": _w((lambda *s: torch.randn(*s, dtype=torch.bfloat16) * 0.1)(D, N) / N ** 0.5),
            "log_dt": _w((lambda *s: torch.randn(*s, dtype=torch.bfloat16) * 0.05)(D) * 0.5 - 4.0),
            "D_skip": _w((lambda *s: torch.randn(*s, dtype=torch.bfloat16) * 0.05)(D)),
        }
    _A_in = _A_setup()

    def _B_setup():
        B, S, D, F = 1, 2048, 576, 4608
        return {
            "x": _w((lambda *s: torch.randn(*s, dtype=torch.bfloat16) * 0.05)(B, S, D)),
            "w1": _w((lambda *s: torch.randn(*s, dtype=torch.bfloat16) * 0.05)(D, F)),
            "b1": _w((lambda *s: torch.randn(*s, dtype=torch.bfloat16) * 0.2)(F)),
            "w2": _w((lambda *s: torch.randn(*s, dtype=torch.bfloat16) * 0.05)(F, D)),
            "b2": _w((lambda *s: torch.randn(*s, dtype=torch.bfloat16) * 1.6)(D)),
        }
    _B_in = _B_setup()

    return {
        "A_u": _A_in["u"],
        "A_log_A_real": _A_in["log_A_real"],
        "A_A_imag": _A_in["A_imag"],
        "A_C_real": _A_in["C_real"],
        "A_C_imag": _A_in["C_imag"],
        "A_log_dt": _A_in["log_dt"],
        "A_D_skip": _A_in["D_skip"],
        "B_x": _B_in["x"],
        "B_w1": _B_in["w1"],
        "B_b1": _B_in["b1"],
        "B_w2": _B_in["w2"],
        "B_b2": _B_in["b2"],
    }

def reference(A_u, A_log_A_real, A_A_imag, A_C_real, A_C_imag, A_log_dt, A_D_skip, B_x, B_w1, B_b1, B_w2, B_b2):
    def _A_ref(u, log_A_real, A_imag, C_real, C_imag, log_dt, D_skip):
        L = u.shape[1]
        dt = torch.exp(log_dt)
        A = -torch.exp(log_A_real) + 1j * A_imag
        C = (C_real + 1j * C_imag) * dt[:, None]
        pos = (lambda x, dt: x.to(dt))(torch.arange(L), log_dt.dtype)
        P = torch.exp((A * dt[:, None])[:, :, None] * pos[None, None, :])
        K = 2.0 * torch.einsum("dn,dnl->dl", C, P).real
        L2 = 2 * L
        u_t = (lambda x, *d: x.permute(*d))(u, 0, 2, 1)
        Kf = (lambda x, *a, **k: torch.fft.rfft(x.float(), *a, **k))(K, L2)
        Uf = (lambda x, *a, **k: torch.fft.rfft(x.float(), *a, **k))(u_t, L2)
        y = (lambda x, *a, **k: torch.fft.irfft(x, *a, **k).to(torch.bfloat16))(Uf * Kf[None, :, :], L2)[:, :, :L]
        y = (lambda x, *d: x.permute(*d))(y, 0, 2, 1)
        return y + u * D_skip[None, None, :]

    def _B_ref(x, w1, b1, w2, b2):
        h = torch.einsum("bsd,df->bsf", x, w1) + b1
        zero = torch.zeros_like(h)
        r = torch.where(h > zero, h, zero)
        h = r * r
        out = torch.einsum("bsf,fd->bsd", h, w2) + b2
        return out

    x = A_u
    h = x + _A_ref(_layernorm(x, axis=-1), A_log_A_real, A_A_imag, A_C_real, A_C_imag, A_log_dt, A_D_skip)
    h2 = h + _B_ref(_layernorm(h, axis=-1), B_w1, B_b1, B_w2, B_b2)
    return h2
```

```asm
; @launch grid=(256,1,1) block=(256,1,1) lds=163840
.amdgcn_target "amdgcn-amd-amdhsa--gfx950"
.text
.globl sequential_preLN__ssm_conv_s4d__dense_activation_squared_relu__prompt_kernel
.p2align 8
.type sequential_preLN__ssm_conv_s4d__dense_activation_squared_relu__prompt_kernel,@function
sequential_preLN__ssm_conv_s4d__dense_activation_squared_relu__prompt_kernel:
s_cmp_ge_u32 s2, 256
s_cbranch_scc1 KF_end
s_load_dwordx16 s[16:31], s[0:1], 0
s_load_dwordx2 s[8:9], s[0:1], 112
s_load_dwordx4 s[48:51], s[0:1], 64
s_load_dwordx2 s[52:53], s[0:1], 80
s_load_dwordx4 s[56:59], s[0:1], 88
s_getpc_b64 s[40:41]
v_lshlrev_b32 v59, 6, v0
global_load_dword v58, v59, s[40:41] offset:512
v_lshrrev_b32 v2, 5, v0
v_and_b32 v3, 31, v0
v_lshrrev_b32 v4, 6, v0
v_and_b32 v1, 63, v0
s_and_b32 s32, s2, 7
s_lshl_b32 s32, s32, 5
s_lshr_b32 s6, s2, 3
s_add_u32 s32, s32, s6
s_mul_i32 s6, s32, 9216
v_mul_u32_u24 v5, 1152, v2
v_lshl_add_u32 v5, v3, 2, v5
v_add_u32 v5, s6, v5
v_readfirstlane_b32 s7, v4
s_and_b32 s3, s2, 7
s_mul_i32 s3, s3, 18
s_lshr_b32 s6, s2, 3
s_add_u32 s3, s3, s6
s_lshl_b32 s13, s3, 2
s_add_u32 s13, s13, s7
s_min_u32 s13, s13, 575
s_lshl_b32 s6, s13, 8
v_lshl_add_u32 v6, v1, 2, s6
s_lshl_b32 s6, s13, 1
v_mov_b32 v7, s6
s_waitcnt lgkmcnt(0)
global_load_dword v10, v5, s[16:17] offset:0
global_load_dword v11, v5, s[16:17] offset:128
global_load_dword v12, v5, s[16:17] offset:256
global_load_dword v13, v5, s[16:17] offset:384
global_load_dword v14, v5, s[16:17] offset:512
global_load_dword v15, v5, s[16:17] offset:640
global_load_dword v16, v5, s[16:17] offset:768
global_load_dword v17, v5, s[16:17] offset:896
global_load_dword v18, v5, s[16:17] offset:1024
s_mov_b32 s10, 67108864
s_mov_b32 s11, 0x20000
s_mov_b32 s12, 0xffff0000
s_mov_b32 s6, 4718592
s_load_dword s14, s[8:9], s6
v_mul_u32_u24 v8, 1216, v2
v_lshl_add_u32 v8, v3, 2, v8
v_add_u32 v8, 124672, v8
v_bfe_u32 v44, v0, 2, 2
v_bfe_u32 v40, v0, 5, 1
v_lshl_add_u32 v9, v40, 3, v44
v_mul_u32_u24 v9, 1216, v9
v_and_b32 v41, 3, v0
v_lshl_add_u32 v9, v41, 3, v9
v_and_b32 v42, 16, v0
v_lshl_add_u32 v9, v42, 1, v9
v_lshl_add_u32 v9, v4, 6, v9
v_add_u32 v9, 124672, v9
v_lshl_add_u32 v45, v40, 2, v41
s_bfe_u32 s6, s32, 0x30001
v_xor_b32 v45, s6, v45
v_lshrrev_b32 v43, 2, v3
v_lshl_add_u32 v43, v4, 3, v43
v_lshlrev_b32 v43, 7, v43
v_lshl_add_u32 v43, v45, 4, v43
s_mul_i32 s15, s32, 18432
v_mov_b32 v52, 0
s_lshl_b32 s43, s2, 4
s_add_u32 s43, s43, 4784128
v_lshlrev_b32 v250, 4, v0
v_lshlrev_b32 v251, 4, v1
v_lshlrev_b32 v53, 12, v0
v_and_b32 v223, 0x7000, v53
v_bfe_u32 v44, v0, 2, 2
s_mul_i32 s36, s7, 30144
s_mul_i32 s35, s7, 1600
s_add_u32 s35, s35, 81168
v_and_b32 v46, 15, v1
v_lshrrev_b32 v47, 4, v1
v_lshl_add_u32 v239, v1, 3, s36
v_mul_u32_u24 v48, 528, v46
v_lshl_add_u32 v48, v42, 4, v48
v_lshl_add_u32 v48, v40, 7, v48
v_add_u32 v240, s36, v48
s_mul_i32 s36, s7, 8256
s_add_u32 s36, s36, 87552
v_lshl_add_u32 v255, v46, 2, s36
v_lshlrev_b32 v48, 5, v47
v_sub_u32 v48, v255, v48
v_add_u32 v224, 104, v48
v_add_u32 v225, 1128, v48
v_add_u32 v226, 2152, v48
v_add_u32 v227, 3176, v48
v_add_u32 v228, 4200, v48
v_lshlrev_b32 v48, 4, v47
v_sub_u32 v48, v255, v48
v_add_u32 v229, 4472, v48
v_lshl_add_u32 v48, v46, 1, v47
v_add_u32 v49, 30, v48
v_bfe_u32 v50, v49, 1, 3
v_xor_b32 v50, s7, v50
v_lshlrev_b32 v49, 7, v49
v_lshl_add_u32 v49, v50, 4, v49
v_add_u32 v232, 118528, v49
v_add_u32 v49, 26, v48
v_bfe_u32 v50, v49, 1, 3
v_xor_b32 v50, s7, v50
v_lshlrev_b32 v49, 7, v49
v_lshl_add_u32 v49, v50, 4, v49
v_add_u32 v233, 118528, v49
v_add_u32 v49, 22, v48
v_bfe_u32 v50, v49, 1, 3
v_xor_b32 v50, s7, v50
v_lshlrev_b32 v49, 7, v49
v_lshl_add_u32 v49, v50, 4, v49
v_add_u32 v234, 118528, v49
v_add_u32 v49, 18, v48
v_bfe_u32 v50, v49, 1, 3
v_xor_b32 v50, s7, v50
v_lshlrev_b32 v49, 7, v49
v_lshl_add_u32 v49, v50, 4, v49
v_add_u32 v235, 118528, v49
v_add_u32 v49, 29, v48
v_bfe_u32 v50, v49, 1, 3
v_xor_b32 v50, s7, v50
v_lshlrev_b32 v49, 7, v49
v_lshl_add_u32 v49, v50, 4, v49
v_add_u32 v230, 118528, v49
v_lshl_add_u32 v49, v46, 1, v40
v_and_b32 v50, 7, v46
v_xor_b32 v50, s7, v50
v_xor_b32 v50, 4, v50
v_lshlrev_b32 v49, 7, v49
v_lshl_add_u32 v49, v50, 4, v49
v_and_b32 v50, 1, v47
v_lshl_add_u32 v49, v50, 3, v49
v_add_u32 v237, 124672, v49
v_lshlrev_b32 v49, 5, v46
v_lshl_add_u32 v49, v47, 3, v49
v_add_u32 v238, s36, v49
v_lshlrev_b32 v49, 8, v40
v_lshl_add_u32 v49, v46, 4, v49
v_lshl_add_u32 v49, v50, 3, v49
v_add_u32 v241, s35, v49
v_lshl_add_u32 v49, v47, 7, s35
v_cmp_lt_u32 vcc, 31, v1
v_lshlrev_b32 v50, 3, v46
v_lshlrev_b32 v51, 2, v46
v_cndmask_b32 v50, v50, v51, vcc
v_add_u32 v242, v50, v49
v_mov_b32 v50, 4
v_mov_b32 v51, 64
v_cndmask_b32 v50, v50, v51, vcc
v_add_u32 v243, v50, v242
v_lshl_add_u32 v244, v46, 1, v49
s_sub_u32 s6, s35, 4
v_mov_b32 v254, s6
v_lshl_add_u32 v245, v1, 3, s6
v_lshl_add_u32 v246, v1, 2, s6
v_lshl_add_u32 v247, v1, 4, s36
v_lshlrev_b32 v250, 4, v0
v_lshlrev_b32 v251, 4, v1
v_mul_u32_u24 v49, 8256, v44
v_add_u32 v49, 87552, v49
v_lshl_add_u32 v49, v41, 3, v49
v_lshl_add_u32 v49, v47, 6, v49
v_lshl_add_u32 v252, v4, 10, v49
v_mul_u32_u24 v49, 36864, v47
v_lshl_add_u32 v253, v46, 4, v49
s_lshl_b32 s42, s3, 8
s_mul_i32 s6, s7, 589824
s_add_u32 s42, s42, s6
s_add_u32 s42, s42, 5767168
v_lshrrev_b32 v49, 3, v1
v_mul_u32_u24 v49, 18304, v49
v_add_u32 v236, v49, v251
s_lshl_b32 s38, s3, 7
s_mul_i32 s39, s7, 1179648
s_add_u32 s38, s38, s39
s_lshl_b32 s39, s7, 13
s_add_u32 s39, s39, 124672
s_and_b32 s34, s2, 7
s_lshl_b32 s34, s34, 12
s_add_u32 s34, s34, 4784128
v_lshrrev_b32 v49, 1, v1
v_lshl_add_u32 v248, v49, 2, s35
v_lshl_add_u32 v249, v1, 2, s36
v_lshl_add_u32 v231, v40, 8, v249
v_mov_b32 v56, 0x100
s_movk_i32 s65, 0x202
v_mov_b32 v184, 0x0c0c0c0c
v_mov_b32 v49, 0x01000100
v_cmp_gt_u32 vcc, 5, v1
s_mov_b32 s6, 0x01000c0c
v_mov_b32 v185, 0x07060302
v_cndmask_b32 v184, v184, v49, vcc
v_mov_b32 v186, 0x05040100
v_writelane_b32 v184, s6, 5
s_mov_b32 s6, 0x0c0c0302
v_writelane_b32 v185, s6, 0
s_mov_b32 s6, 0x0c0c0100
v_writelane_b32 v186, s6, 0
v_and_b32 v49, 1, v1
v_lshlrev_b32 v49, 3, v49
v_mov_b32 v50, 0xa540
v_mov_b32 v51, 0x29500
v_lshrrev_b32 v50, v49, v50
v_lshrrev_b32 v51, v49, v51
v_and_b32 v51, 3, v51
v_mad_u32_u24 v51, v51, s65, v56
v_bfe_u32 v57, v50, 0, 2
v_mad_u32_u24 v57, v57, s65, v56
v_lshl_or_b32 v188, v51, 16, v57
v_mov_b32 v51, v57
v_bfe_u32 v57, v50, 2, 2
v_mad_u32_u24 v57, v57, s65, v56
v_lshl_or_b32 v189, v51, 16, v57
v_mov_b32 v51, v57
v_bfe_u32 v57, v50, 4, 2
v_mad_u32_u24 v57, v57, s65, v56
v_lshl_or_b32 v190, v51, 16, v57
v_mov_b32 v51, v57
v_bfe_u32 v57, v50, 6, 2
v_mad_u32_u24 v57, v57, s65, v56
v_lshl_or_b32 v191, v51, 16, v57
v_mov_b32 v51, v57
s_mov_b32 s44, 0x07060100
s_mov_b32 s45, 0x01000100
s_mov_b32 s46, 0x03020302
v_mov_b32 v52, 0
v_mov_b32 v53, 0
v_mov_b32 v54, 0
v_mov_b32 v55, 0
v_add_u32 v49, 120576, v250
ds_write_b128 v49, v[52:55]
v_mov_b32 v56, 0x3c00
v_mov_b32 v57, 0x3c00
ds_write_b64 v239, v[56:57] offset:8448
global_load_ushort v60, v7, s[26:27]
global_load_dword v61, v6, s[18:19]
global_load_dword v62, v6, s[20:21]
global_load_dword v63, v6, s[22:23]
global_load_dword v64, v6, s[24:25]
s_waitcnt vmcnt(13)
ds_write_b32 v8, v10 offset:9728
v_lshlrev_b32 v20, 16, v10
v_and_b32 v21, s12, v10
s_waitcnt vmcnt(12)
ds_write_b32 v8, v11 offset:9856
v_lshlrev_b32 v22, 16, v11
v_and_b32 v23, s12, v11
v_pk_add_f32 v[44:45], v[20:21], v[22:23]
s_waitcnt vmcnt(11)
ds_write_b32 v8, v12 offset:9984
v_lshlrev_b32 v24, 16, v12
v_and_b32 v25, s12, v12
v_pk_add_f32 v[44:45], v[44:45], v[24:25]
s_waitcnt vmcnt(10)
ds_write_b32 v8, v13 offset:10112
v_lshlrev_b32 v26, 16, v13
v_and_b32 v27, s12, v13
v_pk_add_f32 v[44:45], v[44:45], v[26:27]
s_waitcnt vmcnt(9)
ds_write_b32 v8, v14 offset:10240
v_lshlrev_b32 v28, 16, v14
v_and_b32 v29, s12, v14
v_pk_add_f32 v[44:45], v[44:45], v[28:29]
s_waitcnt vmcnt(8)
ds_write_b32 v8, v15 offset:10368
v_lshlrev_b32 v30, 16, v15
v_and_b32 v31, s12, v15
v_pk_add_f32 v[44:45], v[44:45], v[30:31]
s_waitcnt vmcnt(7)
ds_write_b32 v8, v16 offset:10496
v_lshlrev_b32 v32, 16, v16
v_and_b32 v33, s12, v16
v_pk_add_f32 v[44:45], v[44:45], v[32:33]
s_waitcnt vmcnt(6)
ds_write_b32 v8, v17 offset:10624
v_lshlrev_b32 v34, 16, v17
v_and_b32 v35, s12, v17
v_pk_add_f32 v[44:45], v[44:45], v[34:35]
s_waitcnt vmcnt(5)
ds_write_b32 v8, v18 offset:10752
v_lshlrev_b32 v36, 16, v18
v_and_b32 v37, s12, v18
v_pk_add_f32 v[44:45], v[44:45], v[36:37]
v_add_f32 v44, v44, v45
s_nop 1
v_add_f32_dpp v44, v44, v44 row_ror:8 row_mask:0xf bank_mask:0xf
s_nop 1
v_add_f32_dpp v44, v44, v44 row_ror:4 row_mask:0xf bank_mask:0xf
s_nop 1
v_add_f32_dpp v44, v44, v44 row_ror:2 row_mask:0xf bank_mask:0xf
s_nop 1
v_add_f32_dpp v44, v44, v44 row_ror:1 row_mask:0xf bank_mask:0xf
v_mov_b32 v45, v44
s_nop 1
v_permlane16_swap_b32 v44, v45
v_add_f32 v44, v44, v45
v_mul_f32 v44, 0xbae38e39, v44
v_pk_add_f32 v[80:81], v[20:21], v[44:45] op_sel_hi:[1,0]
v_pk_add_f32 v[82:83], v[22:23], v[44:45] op_sel_hi:[1,0]
v_pk_add_f32 v[84:85], v[24:25], v[44:45] op_sel_hi:[1,0]
v_pk_add_f32 v[86:87], v[26:27], v[44:45] op_sel_hi:[1,0]
v_pk_add_f32 v[88:89], v[28:29], v[44:45] op_sel_hi:[1,0]
v_pk_add_f32 v[90:91], v[30:31], v[44:45] op_sel_hi:[1,0]
v_pk_add_f32 v[92:93], v[32:33], v[44:45] op_sel_hi:[1,0]
v_pk_add_f32 v[94:95], v[34:35], v[44:45] op_sel_hi:[1,0]
v_pk_add_f32 v[96:97], v[36:37], v[44:45] op_sel_hi:[1,0]
v_pk_mul_f32 v[46:47], v[80:81], v[80:81]
v_pk_fma_f32 v[46:47], v[82:83], v[82:83], v[46:47]
v_pk_fma_f32 v[46:47], v[84:85], v[84:85], v[46:47]
v_pk_fma_f32 v[46:47], v[86:87], v[86:87], v[46:47]
v_pk_fma_f32 v[46:47], v[88:89], v[88:89], v[46:47]
v_pk_fma_f32 v[46:47], v[90:91], v[90:91], v[46:47]
v_pk_fma_f32 v[46:47], v[92:93], v[92:93], v[46:47]
v_pk_fma_f32 v[46:47], v[94:95], v[94:95], v[46:47]
v_pk_fma_f32 v[46:47], v[96:97], v[96:97], v[46:47]
v_add_f32 v46, v46, v47
v_cvt_pk_bf16_f32 v44, v44, v44
v_and_b32 v44, s12, v44
v_add_f32_dpp v46, v46, v46 row_ror:8 row_mask:0xf bank_mask:0xf
v_pk_add_f32 v[20:21], v[20:21], v[44:45] op_sel_hi:[1,0]
v_pk_add_f32 v[22:23], v[22:23], v[44:45] op_sel_hi:[1,0]
v_add_f32_dpp v46, v46, v46 row_ror:4 row_mask:0xf bank_mask:0xf
v_pk_add_f32 v[24:25], v[24:25], v[44:45] op_sel_hi:[1,0]
v_pk_add_f32 v[26:27], v[26:27], v[44:45] op_sel_hi:[1,0]
v_add_f32_dpp v46, v46, v46 row_ror:2 row_mask:0xf bank_mask:0xf
v_pk_add_f32 v[28:29], v[28:29], v[44:45] op_sel_hi:[1,0]
v_pk_add_f32 v[30:31], v[30:31], v[44:45] op_sel_hi:[1,0]
v_add_f32_dpp v46, v46, v46 row_ror:1 row_mask:0xf bank_mask:0xf
v_pk_add_f32 v[32:33], v[32:33], v[44:45] op_sel_hi:[1,0]
v_pk_add_f32 v[34:35], v[34:35], v[44:45] op_sel_hi:[1,0]
v_mov_b32 v47, v46
v_pk_add_f32 v[36:37], v[36:37], v[44:45] op_sel_hi:[1,0]
v_cvt_pk_bf16_f32 v21, v20, v21
v_permlane16_swap_b32 v46, v47
v_cvt_pk_bf16_f32 v23, v22, v23
v_cvt_pk_bf16_f32 v25, v24, v25
v_add_f32 v46, v46, v47
v_cvt_pk_bf16_f32 v27, v26, v27
v_cvt_pk_bf16_f32 v29, v28, v29
v_mul_f32 v46, 0x3ae38e39, v46
v_cvt_pk_bf16_f32 v31, v30, v31
v_cvt_pk_bf16_f32 v33, v32, v33
v_cvt_pk_bf16_f32 v46, v46, v46
v_cvt_pk_bf16_f32 v35, v34, v35
v_cvt_pk_bf16_f32 v37, v36, v37
v_and_b32 v46, s12, v46
v_lshlrev_b32 v20, 16, v21
v_and_b32 v21, s12, v21
v_add_f32 v46, 0x3727c5ac, v46
v_lshlrev_b32 v22, 16, v23
v_and_b32 v23, s12, v23
v_cvt_pk_bf16_f32 v46, v46, v46
v_lshlrev_b32 v24, 16, v25
v_and_b32 v25, s12, v25
v_and_b32 v46, s12, v46
v_lshlrev_b32 v26, 16, v27
v_and_b32 v27, s12, v27
v_sqrt_f32 v46, v46
v_lshlrev_b32 v28, 16, v29
v_and_b32 v29, s12, v29
v_cvt_pk_bf16_f32 v46, v46, v46
v_lshlrev_b32 v30, 16, v31
v_and_b32 v31, s12, v31
v_and_b32 v46, s12, v46
v_lshlrev_b32 v32, 16, v33
v_and_b32 v33, s12, v33
v_rcp_f32 v46, v46
v_lshlrev_b32 v34, 16, v35
v_and_b32 v35, s12, v35
v_lshlrev_b32 v36, 16, v37
v_and_b32 v37, s12, v37
v_pk_mul_f32 v[20:21], v[20:21], v[46:47] op_sel_hi:[1,0]
v_pk_mul_f32 v[22:23], v[22:23], v[46:47] op_sel_hi:[1,0]
v_pk_mul_f32 v[24:25], v[24:25], v[46:47] op_sel_hi:[1,0]
v_pk_mul_f32 v[26:27], v[26:27], v[46:47] op_sel_hi:[1,0]
v_pk_mul_f32 v[28:29], v[28:29], v[46:47] op_sel_hi:[1,0]
v_pk_mul_f32 v[30:31], v[30:31], v[46:47] op_sel_hi:[1,0]
v_pk_mul_f32 v[32:33], v[32:33], v[46:47] op_sel_hi:[1,0]
v_pk_mul_f32 v[34:35], v[34:35], v[46:47] op_sel_hi:[1,0]
v_pk_mul_f32 v[36:37], v[36:37], v[46:47] op_sel_hi:[1,0]
v_cvt_pk_bf16_f32 v20, v20, v21
ds_write_b32 v8, v20 offset:0
v_cvt_pk_bf16_f32 v22, v22, v23
ds_write_b32 v8, v22 offset:128
v_cvt_pk_bf16_f32 v24, v24, v25
ds_write_b32 v8, v24 offset:256
v_cvt_pk_bf16_f32 v26, v26, v27
ds_write_b32 v8, v26 offset:384
v_cvt_pk_bf16_f32 v28, v28, v29
ds_write_b32 v8, v28 offset:512
v_cvt_pk_bf16_f32 v30, v30, v31
ds_write_b32 v8, v30 offset:640
v_cvt_pk_bf16_f32 v32, v32, v33
ds_write_b32 v8, v32 offset:768
v_cvt_pk_bf16_f32 v34, v34, v35
ds_write_b32 v8, v34 offset:896
v_cvt_pk_bf16_f32 v36, v36, v37
ds_write_b32 v8, v36 offset:1024
s_waitcnt lgkmcnt(0)
s_barrier
ds_read_b64_tr_b16 v[20:21], v9 offset:0
ds_read_b64_tr_b16 v[22:23], v9 offset:4864
ds_read_b64_tr_b16 v[24:25], v9 offset:256
ds_read_b64_tr_b16 v[26:27], v9 offset:5120
ds_read_b64_tr_b16 v[28:29], v9 offset:512
ds_read_b64_tr_b16 v[30:31], v9 offset:5376
ds_read_b64_tr_b16 v[32:33], v9 offset:768
ds_read_b64_tr_b16 v[34:35], v9 offset:5632
ds_read_b64_tr_b16 v[36:37], v9 offset:1024
ds_read_b64_tr_b16 v[38:39], v9 offset:5888
s_waitcnt lgkmcnt(8)
buffer_store_dwordx4 v[20:23], v43, s[8:11], s15 offen sc1
s_add_u32 s15, s15, 4096
s_waitcnt lgkmcnt(6)
buffer_store_dwordx4 v[24:27], v43, s[8:11], s15 offen sc1
s_add_u32 s15, s15, 4096
s_waitcnt lgkmcnt(4)
buffer_store_dwordx4 v[28:31], v43, s[8:11], s15 offen sc1
s_add_u32 s15, s15, 4096
s_waitcnt lgkmcnt(2)
buffer_store_dwordx4 v[32:35], v43, s[8:11], s15 offen sc1
s_add_u32 s15, s15, 4096
s_cmp_ge_u32 s7, 2
s_cbranch_scc1 KF_ln4
s_waitcnt lgkmcnt(0)
buffer_store_dwordx4 v[36:39], v43, s[8:11], s15 offen sc1
KF_ln4:
s_cmp_ge_u32 s2, 144
s_cbranch_scc1 KF_aux
s_waitcnt vmcnt(4) lgkmcnt(0)
v_lshlrev_b32 v60, 16, v60
v_lshlrev_b32 v66, 16, v61
v_and_b32 v67, s12, v61
v_mul_f32 v60, 1069066811, v60
v_lshlrev_b32 v70, 16, v63
v_lshlrev_b32 v71, 16, v64
v_and_b32 v72, s12, v63
v_and_b32 v73, s12, v64
v_mul_f32 v66, 1069066811, v66
v_mul_f32 v67, 1069066811, v67
v_max3_f32 v74, |v70|, |v71|, |v72|
v_exp_f32 v60, v60
v_max_f32 v74, v74, |v73|
v_exp_f32 v66, v66
v_exp_f32 v67, v67
v_max_f32_dpp v74, v74, v74 row_ror:8 row_mask:0xf bank_mask:0xf
v_cvt_pk_bf16_f32 v60, v60, v60
v_cvt_pk_bf16_f32 v67, v66, v67
v_max_f32_dpp v74, v74, v74 row_ror:4 row_mask:0xf bank_mask:0xf
v_lshlrev_b32 v68, 16, v62
v_and_b32 v69, s12, v62
v_max_f32_dpp v74, v74, v74 row_ror:2 row_mask:0xf bank_mask:0xf
v_and_b32 v60, s12, v60
v_lshlrev_b32 v66, 16, v67
v_max_f32_dpp v74, v74, v74 row_ror:1 row_mask:0xf bank_mask:0xf
v_and_b32 v67, s12, v67
v_mov_b32 v75, v74
v_mul_f32 v66, v60, v66
v_mul_f32 v67, v60, v67
v_permlane16_swap_b32 v74, v75
v_max_f32 v74, v74, v75
v_mov_b32 v75, v74
v_mul_f32 v68, v60, v68
v_mul_f32 v69, v60, v69
v_permlane32_swap_b32 v74, v75
v_max_f32 v74, v74, v75
v_mul_f32 v66, 3216550459, v66
v_mul_f32 v67, 3216550459, v67
v_mul_f32 v68, 0.15915494, v68
v_mul_f32 v69, 0.15915494, v69
v_frexp_exp_i32_f32 v74, v74
v_sub_u32 v75, 14, v74
v_ldexp_f32 v70, v70, v75
v_ldexp_f32 v71, -v71, v75
v_ldexp_f32 v72, v72, v75
v_ldexp_f32 v73, -v73, v75
v_subrev_u32 v74, 13, v74
v_ldexp_f32 v60, v60, v74
v_mul_f32 v169, 0x41000000, v66
v_mul_f32 v170, 0x43000000, v66
v_mul_f32 v81, 0xc1000000, v68
v_mul_f32 v85, 0x43000000, v68
v_fract_f32 v77, v68
v_exp_f32 v168, v66
v_exp_f32 v169, v169
v_exp_f32 v170, v170
v_fract_f32 v81, v81
v_fract_f32 v85, v85
v_mul_f32 v173, 0x41000000, v67
v_mul_f32 v174, 0x43000000, v67
v_mul_f32 v83, 0xc1000000, v69
v_mul_f32 v87, 0x43000000, v69
v_fract_f32 v79, v69
v_exp_f32 v172, v67
v_exp_f32 v173, v173
v_exp_f32 v174, v174
v_fract_f32 v83, v83
v_fract_f32 v87, v87
v_cos_f32 v76, v77
v_sin_f32 v77, v77
v_cos_f32 v80, v81
v_sin_f32 v81, v81
v_cos_f32 v84, v85
v_sin_f32 v85, v85
v_cos_f32 v78, v79
v_sin_f32 v79, v79
v_cos_f32 v82, v83
v_sin_f32 v83, v83
v_cos_f32 v86, v87
v_sin_f32 v87, v87
v_mul_f32 v76, v76, v168
v_mul_f32 v77, v77, v168
v_mul_f32 v80, v80, v169
v_mul_f32 v81, v81, v169
v_mul_f32 v84, v84, v170
v_mul_f32 v85, v85, v170
v_mul_f32 v78, v78, v172
v_mul_f32 v79, v79, v172
v_mul_f32 v82, v82, v173
v_mul_f32 v83, v83, v173
v_mul_f32 v86, v86, v174
v_mul_f32 v87, v87, v174
v_cvt_pk_f16_f32 v10, v70, v71
v_cvt_pk_f16_f32 v11, v72, v73
ds_write_b64 v239, v[10:11] offset:0
v_cvt_pk_f16_f32 v12, v76, v77
v_cvt_pk_f16_f32 v13, v78, v79
v_cvt_pk_f16_f32 v14, v84, v85
v_cvt_pk_f16_f32 v15, v86, v87
v_cvt_pk_f16_f32 v16, v80, v81
ds_write_b64 v239, v[12:13] offset:8976
v_cvt_pk_f16_f32 v17, v82, v83
v_pk_mul_f16 v168, v10, v16 op_sel:[0,0] op_sel_hi:[0,1]
v_pk_mul_f16 v169, v11, v17 op_sel:[0,0] op_sel_hi:[0,1]
v_pk_mul_f16 v170, v14, v12 op_sel:[0,0] op_sel_hi:[0,1]
v_pk_mul_f16 v171, v15, v13 op_sel:[0,0] op_sel_hi:[0,1]
ds_write_b64 v239, v[14:15] offset:12672
v_pk_fma_f16 v168, v10, v16, v168 op_sel:[1,1,0] op_sel_hi:[1,0,1] neg_lo:[1,0,0]
v_pk_fma_f16 v169, v11, v17, v169 op_sel:[1,1,0] op_sel_hi:[1,0,1] neg_lo:[1,0,0]
v_pk_fma_f16 v170, v14, v12, v170 op_sel:[1,1,0] op_sel_hi:[1,0,1] neg_lo:[1,0,0]
v_pk_fma_f16 v171, v15, v13, v171 op_sel:[1,1,0] op_sel_hi:[1,0,1] neg_lo:[1,0,0]
v_pk_mul_f32 v[88:89], v[76:77], v[76:77] op_sel:[0,0] op_sel_hi:[0,1]
ds_write_b64 v239, v[168:169] offset:528
v_pk_mul_f32 v[90:91], v[78:79], v[78:79] op_sel:[0,0] op_sel_hi:[0,1]
v_pk_mul_f32 v[92:93], v[80:81], v[80:81] op_sel:[0,0] op_sel_hi:[0,1]
v_pk_mul_f32 v[94:95], v[82:83], v[82:83] op_sel:[0,0] op_sel_hi:[0,1]
v_pk_mul_f32 v[96:97], v[84:85], v[84:85] op_sel:[0,0] op_sel_hi:[0,1]
v_pk_mul_f32 v[98:99], v[86:87], v[86:87] op_sel:[0,0] op_sel_hi:[0,1]
ds_write_b64 v239, v[170:171] offset:13200
v_pk_fma_f32 v[88:89], v[76:77], v[76:77], v[88:89] op_sel:[1,1,0] op_sel_hi:[1,0,1] neg_lo:[1,0,0]
v_pk_fma_f32 v[90:91], v[78:79], v[78:79], v[90:91] op_sel:[1,1,0] op_sel_hi:[1,0,1] neg_lo:[1,0,0]
v_pk_fma_f32 v[92:93], v[80:81], v[80:81], v[92:93] op_sel:[1,1,0] op_sel_hi:[1,0,1] neg_lo:[1,0,0]
v_pk_fma_f32 v[94:95], v[82:83], v[82:83], v[94:95] op_sel:[1,1,0] op_sel_hi:[1,0,1] neg_lo:[1,0,0]
v_pk_fma_f32 v[96:97], v[84:85], v[84:85], v[96:97] op_sel:[1,1,0] op_sel_hi:[1,0,1] neg_lo:[1,0,0]
v_pk_fma_f32 v[98:99], v[86:87], v[86:87], v[98:99] op_sel:[1,1,0] op_sel_hi:[1,0,1] neg_lo:[1,0,0]
v_cvt_pk_f16_f32 v18, v88, v89
v_cvt_pk_f16_f32 v19, v90, v91
ds_write_b64 v239, v[18:19] offset:9504
v_cvt_pk_f16_f32 v20, v92, v93
v_cvt_pk_f16_f32 v21, v94, v95
v_cvt_pk_f16_f32 v22, v96, v97
v_cvt_pk_f16_f32 v23, v98, v99
v_pk_mul_f16 v172, v10, v20 op_sel:[0,0] op_sel_hi:[0,1]
ds_write_b64 v239, v[22:23] offset:16896
v_pk_mul_f16 v173, v11, v21 op_sel:[0,0] op_sel_hi:[0,1]
v_pk_mul_f16 v174, v14, v18 op_sel:[0,0] op_sel_hi:[0,1]
v_pk_mul_f16 v175, v15, v19 op_sel:[0,0] op_sel_hi:[0,1]
v_pk_mul_f16 v176, v22, v18 op_sel:[0,0] op_sel_hi:[0,1]
v_pk_mul_f16 v177, v23, v19 op_sel:[0,0] op_sel_hi:[0,1]
v_pk_fma_f16 v172, v10, v20, v172 op_sel:[1,1,0] op_sel_hi:[1,0,1] neg_lo:[1,0,0]
v_pk_fma_f16 v173, v11, v21, v173 op_sel:[1,1,0] op_sel_hi:[1,0,1] neg_lo:[1,0,0]
ds_write_b64 v239, v[172:173] offset:1056
v_pk_fma_f16 v174, v14, v18, v174 op_sel:[1,1,0] op_sel_hi:[1,0,1] neg_lo:[1,0,0]
v_pk_fma_f16 v175, v15, v19, v175 op_sel:[1,1,0] op_sel_hi:[1,0,1] neg_lo:[1,0,0]
v_pk_fma_f16 v176, v22, v18, v176 op_sel:[1,1,0] op_sel_hi:[1,0,1] neg_lo:[1,0,0]
v_pk_fma_f16 v177, v23, v19, v177 op_sel:[1,1,0] op_sel_hi:[1,0,1] neg_lo:[1,0,0]
v_pk_mul_f32 v[100:101], v[88:89], v[76:77] op_sel:[0,0] op_sel_hi:[0,1]
ds_write_b64 v239, v[174:175] offset:13728
v_pk_mul_f32 v[102:103], v[90:91], v[78:79] op_sel:[0,0] op_sel_hi:[0,1]
v_pk_mul_f32 v[104:105], v[88:89], v[88:89] op_sel:[0,0] op_sel_hi:[0,1]
v_pk_mul_f32 v[106:107], v[90:91], v[90:91] op_sel:[0,0] op_sel_hi:[0,1]
v_pk_mul_f32 v[108:109], v[92:93], v[80:81] op_sel:[0,0] op_sel_hi:[0,1]
v_pk_mul_f32 v[110:111], v[94:95], v[82:83] op_sel:[0,0] op_sel_hi:[0,1]
ds_write_b64 v239, v[176:177] offset:17424
v_pk_mul_f32 v[112:113], v[92:93], v[92:93] op_sel:[0,0] op_sel_hi:[0,1]
v_pk_mul_f32 v[114:115], v[94:95], v[94:95] op_sel:[0,0] op_sel_hi:[0,1]
v_pk_mul_f32 v[116:117], v[96:97], v[84:85] op_sel:[0,0] op_sel_hi:[0,1]
v_pk_mul_f32 v[118:119], v[98:99], v[86:87] op_sel:[0,0] op_sel_hi:[0,1]
v_pk_mul_f32 v[120:121], v[96:97], v[96:97] op_sel:[0,0] op_sel_hi:[0,1]
v_pk_mul_f32 v[122:123], v[98:99], v[98:99] op_sel:[0,0] op_sel_hi:[0,1]
v_pk_fma_f32 v[100:101], v[88:89], v[76:77], v[100:101] op_sel:[1,1,0] op_sel_hi:[1,0,1] neg_lo:[1,0,0]
v_pk_fma_f32 v[102:103], v[90:91], v[78:79], v[102:103] op_sel:[1,1,0] op_sel_hi:[1,0,1] neg_lo:[1,0,0]
v_pk_fma_f32 v[104:105], v[88:89], v[88:89], v[104:105] op_sel:[1,1,0] op_sel_hi:[1,0,1] neg_lo:[1,0,0]
v_pk_fma_f32 v[106:107], v[90:91], v[90:91], v[106:107] op_sel:[1,1,0] op_sel_hi:[1,0,1] neg_lo:[1,0,0]
v_pk_fma_f32 v[108:109], v[92:93], v[80:81], v[108:109] op_sel:[1,1,0] op_sel_hi:[1,0,1] neg_lo:[1,0,0]
v_pk_fma_f32 v[110:111], v[94:95], v[82:83], v[110:111] op_sel:[1,1,0] op_sel_hi:[1,0,1] neg_lo:[1,0,0]
v_pk_fma_f32 v[112:113], v[92:93], v[92:93], v[112:113] op_sel:[1,1,0] op_sel_hi:[1,0,1] neg_lo:[1,0,0]
v_pk_fma_f32 v[114:115], v[94:95], v[94:95], v[114:115] op_sel:[1,1,0] op_sel_hi:[1,0,1] neg_lo:[1,0,0]
v_pk_fma_f32 v[116:117], v[96:97], v[84:85], v[116:117] op_sel:[1,1,0] op_sel_hi:[1,0,1] neg_lo:[1,0,0]
v_pk_fma_f32 v[118:119], v[98:99], v[86:87], v[118:119] op_sel:[1,1,0] op_sel_hi:[1,0,1] neg_lo:[1,0,0]
v_pk_fma_f32 v[120:121], v[96:97], v[96:97], v[120:121] op_sel:[1,1,0] op_sel_hi:[1,0,1] neg_lo:[1,0,0]
v_pk_fma_f32 v[122:123], v[98:99], v[98:99], v[122:123] op_sel:[1,1,0] op_sel_hi:[1,0,1] neg_lo:[1,0,0]
v_cvt_pk_f16_f32 v24, v100, v101
s_waitcnt vmcnt(0)
s_mul_i32 s14, s14, 0x9e3779b1
s_add_u32 s14, s14, 0x7f4a7c15
s_mov_b32 s99, s14
v_mov_b32 v2, s14
s_barrier
s_cmp_lg_u32 s7, 0
s_cbranch_scc1 KF_f1
buffer_store_dword v2, v223, s[8:11], s43 offen sc1
KF_f1:
global_load_ushort v65, v7, s[28:29]
v_cvt_pk_f16_f32 v25, v102, v103
ds_write_b64 v239, v[24:25] offset:10032
v_cvt_pk_f16_f32 v26, v104, v105
v_cvt_pk_f16_f32 v27, v106, v107
v_cvt_pk_f16_f32 v28, v108, v109
v_cvt_pk_f16_f32 v29, v110, v111
v_cvt_pk_f16_f32 v30, v116, v117
ds_write_b64 v239, v[26:27] offset:10560
v_cvt_pk_f16_f32 v31, v118, v119
v_cvt_pk_f16_f32 v32, v120, v121
v_cvt_pk_f16_f32 v33, v122, v123
v_pk_mul_f16 v178, v10, v28 op_sel:[0,0] op_sel_hi:[0,1]
v_pk_mul_f16 v179, v11, v29 op_sel:[0,0] op_sel_hi:[0,1]
ds_write_b64 v239, v[30:31] offset:19008
v_pk_mul_f16 v180, v32, v14 op_sel:[0,0] op_sel_hi:[0,1]
v_pk_mul_f16 v181, v33, v15 op_sel:[0,0] op_sel_hi:[0,1]
v_pk_mul_f16 v182, v32, v22 op_sel:[0,0] op_sel_hi:[0,1]
v_pk_mul_f16 v183, v33, v23 op_sel:[0,0] op_sel_hi:[0,1]
v_pk_mul_f16 v192, v32, v30 op_sel:[0,0] op_sel_hi:[0,1]
ds_write_b64 v239, v[32:33] offset:21120
v_pk_mul_f16 v193, v33, v31 op_sel:[0,0] op_sel_hi:[0,1]
v_pk_mul_f16 v194, v14, v24 op_sel:[0,0] op_sel_hi:[0,1]
v_pk_mul_f16 v195, v15, v25 op_sel:[0,0] op_sel_hi:[0,1]
v_pk_mul_f16 v196, v14, v26 op_sel:[0,0] op_sel_hi:[0,1]
v_pk_mul_f16 v197, v15, v27 op_sel:[0,0] op_sel_hi:[0,1]
v_pk_mul_f16 v198, v22, v26 op_sel:[0,0] op_sel_hi:[0,1]
v_pk_mul_f16 v199, v23, v27 op_sel:[0,0] op_sel_hi:[0,1]
v_pk_mul_f16 v200, v30, v18 op_sel:[0,0] op_sel_hi:[0,1]
v_pk_mul_f16 v201, v31, v19 op_sel:[0,0] op_sel_hi:[0,1]
v_pk_fma_f16 v178, v10, v28, v178 op_sel:[1,1,0] op_sel_hi:[1,0,1] neg_lo:[1,0,0]
v_pk_fma_f16 v179, v11, v29, v179 op_sel:[1,1,0] op_sel_hi:[1,0,1] neg_lo:[1,0,0]
ds_write_b64 v239, v[178:179] offset:1584
v_pk_fma_f16 v180, v32, v14, v180 op_sel:[1,1,0] op_sel_hi:[1,0,1] neg_lo:[1,0,0]
v_pk_fma_f16 v181, v33, v15, v181 op_sel:[1,1,0] op_sel_hi:[1,0,1] neg_lo:[1,0,0]
v_pk_fma_f16 v182, v32, v22, v182 op_sel:[1,1,0] op_sel_hi:[1,0,1] neg_lo:[1,0,0]
v_pk_fma_f16 v183, v33, v23, v183 op_sel:[1,1,0] op_sel_hi:[1,0,1] neg_lo:[1,0,0]
v_pk_fma_f16 v192, v32, v30, v192 op_sel:[1,1,0] op_sel_hi:[1,0,1] neg_lo:[1,0,0]
ds_write_b64 v239, v[180:181] offset:22176
v_pk_fma_f16 v193, v33, v31, v193 op_sel:[1,1,0] op_sel_hi:[1,0,1] neg_lo:[1,0,0]
v_pk_fma_f16 v194, v14, v24, v194 op_sel:[1,1,0] op_sel_hi:[1,0,1] neg_lo:[1,0,0]
v_pk_fma_f16 v195, v15, v25, v195 op_sel:[1,1,0] op_sel_hi:[1,0,1] neg_lo:[1,0,0]
v_pk_fma_f16 v196, v14, v26, v196 op_sel:[1,1,0] op_sel_hi:[1,0,1] neg_lo:[1,0,0]
v_pk_fma_f16 v197, v15, v27, v197 op_sel:[1,1,0] op_sel_hi:[1,0,1] neg_lo:[1,0,0]
ds_write_b64 v239, v[182:183] offset:23232
v_pk_fma_f16 v198, v22, v26, v198 op_sel:[1,1,0] op_sel_hi:[1,0,1] neg_lo:[1,0,0]
v_pk_fma_f16 v199, v23, v27, v199 op_sel:[1,1,0] op_sel_hi:[1,0,1] neg_lo:[1,0,0]
v_pk_fma_f16 v200, v30, v18, v200 op_sel:[1,1,0] op_sel_hi:[1,0,1] neg_lo:[1,0,0]
v_pk_fma_f16 v201, v31, v19, v201 op_sel:[1,1,0] op_sel_hi:[1,0,1] neg_lo:[1,0,0]
v_pk_mul_f32 v[124:125], v[104:105], v[76:77] op_sel:[0,0] op_sel_hi:[0,1]
ds_write_b64 v239, v[192:193] offset:24288
v_pk_mul_f32 v[126:127], v[106:107], v[78:79] op_sel:[0,0] op_sel_hi:[0,1]
v_pk_mul_f32 v[128:129], v[104:105], v[88:89] op_sel:[0,0] op_sel_hi:[0,1]
v_pk_mul_f32 v[130:131], v[106:107], v[90:91] op_sel:[0,0] op_sel_hi:[0,1]
v_pk_mul_f32 v[132:133], v[104:105], v[100:101] op_sel:[0,0] op_sel_hi:[0,1]
v_pk_mul_f32 v[134:135], v[106:107], v[102:103] op_sel:[0,0] op_sel_hi:[0,1]
ds_write_b64 v239, v[194:195] offset:14256
v_pk_mul_f32 v[136:137], v[70:71], v[112:113] op_sel:[0,0] op_sel_hi:[0,1]
v_pk_mul_f32 v[138:139], v[72:73], v[114:115] op_sel:[0,0] op_sel_hi:[0,1]
v_pk_mul_f32 v[140:141], v[120:121], v[120:121] op_sel:[0,0] op_sel_hi:[0,1]
v_pk_mul_f32 v[142:143], v[122:123], v[122:123] op_sel:[0,0] op_sel_hi:[0,1]
v_pk_mul_f32 v[144:145], v[120:121], v[104:105] op_sel:[0,0] op_sel_hi:[0,1]
ds_write_b64 v239, v[196:197] offset:14784
v_pk_mul_f32 v[146:147], v[122:123], v[106:107] op_sel:[0,0] op_sel_hi:[0,1]
v_pk_fma_f32 v[124:125], v[104:105], v[76:77], v[124:125] op_sel:[1,1,0] op_sel_hi:[1,0,1] neg_lo:[1,0,0]
v_pk_fma_f32 v[126:127], v[106:107], v[78:79], v[126:127] op_sel:[1,1,0] op_sel_hi:[1,0,1] neg_lo:[1,0,0]
v_pk_fma_f32 v[128:129], v[104:105], v[88:89], v[128:129] op_sel:[1,1,0] op_sel_hi:[1,0,1] neg_lo:[1,0,0]
v_pk_fma_f32 v[130:131], v[106:107], v[90:91], v[130:131] op_sel:[1,1,0] op_sel_hi:[1,0,1] neg_lo:[1,0,0]
ds_write_b64 v239, v[198:199] offset:17952
v_pk_fma_f32 v[132:133], v[104:105], v[100:101], v[132:133] op_sel:[1,1,0] op_sel_hi:[1,0,1] neg_lo:[1,0,0]
v_pk_fma_f32 v[134:135], v[106:107], v[102:103], v[134:135] op_sel:[1,1,0] op_sel_hi:[1,0,1] neg_lo:[1,0,0]
v_pk_fma_f32 v[136:137], v[70:71], v[112:113], v[136:137] op_sel:[1,1,0] op_sel_hi:[1,0,1] neg_lo:[1,0,0]
v_pk_fma_f32 v[138:139], v[72:73], v[114:115], v[138:139] op_sel:[1,1,0] op_sel_hi:[1,0,1] neg_lo:[1,0,0]
v_pk_fma_f32 v[140:141], v[120:121], v[120:121], v[140:141] op_sel:[1,1,0] op_sel_hi:[1,0,1] neg_lo:[1,0,0]
ds_write_b64 v239, v[200:201] offset:19536
v_pk_fma_f32 v[142:143], v[122:123], v[122:123], v[142:143] op_sel:[1,1,0] op_sel_hi:[1,0,1] neg_lo:[1,0,0]
v_pk_fma_f32 v[144:145], v[120:121], v[104:105], v[144:145] op_sel:[1,1,0] op_sel_hi:[1,0,1] neg_lo:[1,0,0]
v_pk_fma_f32 v[146:147], v[122:123], v[106:107], v[146:147] op_sel:[1,1,0] op_sel_hi:[1,0,1] neg_lo:[1,0,0]
v_cvt_pk_f16_f32 v34, v124, v125
v_cvt_pk_f16_f32 v35, v126, v127
ds_write_b64 v239, v[34:35] offset:11088
v_cvt_pk_f16_f32 v36, v128, v129
v_cvt_pk_f16_f32 v37, v130, v131
v_cvt_pk_f16_f32 v38, v132, v133
v_cvt_pk_f16_f32 v39, v134, v135
v_cvt_pk_f16_f32 v40, v136, v137
ds_write_b64 v239, v[36:37] offset:11616
v_cvt_pk_f16_f32 v41, v138, v139
v_cvt_pk_f16_f32 v42, v140, v141
v_cvt_pk_f16_f32 v43, v142, v143
v_cvt_pk_f16_f32 v44, v144, v145
v_cvt_pk_f16_f32 v45, v146, v147
ds_write_b64 v239, v[38:39] offset:12144
v_pk_mul_f16 v202, v40, v16 op_sel:[0,0] op_sel_hi:[0,1]
v_pk_mul_f16 v203, v41, v17 op_sel:[0,0] op_sel_hi:[0,1]
v_pk_mul_f16 v204, v40, v20 op_sel:[0,0] op_sel_hi:[0,1]
v_pk_mul_f16 v205, v41, v21 op_sel:[0,0] op_sel_hi:[0,1]
v_pk_mul_f16 v206, v40, v28 op_sel:[0,0] op_sel_hi:[0,1]
ds_write_b64 v239, v[40:41] offset:2112
v_pk_mul_f16 v207, v41, v29 op_sel:[0,0] op_sel_hi:[0,1]
v_pk_mul_f16 v208, v42, v14 op_sel:[0,0] op_sel_hi:[0,1]
v_pk_mul_f16 v209, v43, v15 op_sel:[0,0] op_sel_hi:[0,1]
v_pk_mul_f16 v210, v42, v22 op_sel:[0,0] op_sel_hi:[0,1]
v_pk_mul_f16 v211, v43, v23 op_sel:[0,0] op_sel_hi:[0,1]
ds_write_b64 v239, v[42:43] offset:25344
v_pk_mul_f16 v212, v42, v30 op_sel:[0,0] op_sel_hi:[0,1]
v_pk_mul_f16 v213, v43, v31 op_sel:[0,0] op_sel_hi:[0,1]
v_pk_mul_f16 v214, v14, v34 op_sel:[0,0] op_sel_hi:[0,1]
v_pk_mul_f16 v215, v15, v35 op_sel:[0,0] op_sel_hi:[0,1]
v_pk_mul_f16 v216, v14, v36 op_sel:[0,0] op_sel_hi:[0,1]
ds_write_b64 v239, v[44:45] offset:21648
v_pk_mul_f16 v217, v15, v37 op_sel:[0,0] op_sel_hi:[0,1]
v_pk_fma_f16 v202, v40, v16, v202 op_sel:[1,1,0] op_sel_hi:[1,0,1] neg_lo:[1,0,0]
v_pk_fma_f16 v203, v41, v17, v203 op_sel:[1,1,0] op_sel_hi:[1,0,1] neg_lo:[1,0,0]
v_pk_fma_f16 v204, v40, v20, v204 op_sel:[1,1,0] op_sel_hi:[1,0,1] neg_lo:[1,0,0]
v_pk_fma_f16 v205, v41, v21, v205 op_sel:[1,1,0] op_sel_hi:[1,0,1] neg_lo:[1,0,0]
ds_write_b64 v239, v[202:203] offset:2640
v_pk_fma_f16 v206, v40, v28, v206 op_sel:[1,1,0] op_sel_hi:[1,0,1] neg_lo:[1,0,0]
v_pk_fma_f16 v207, v41, v29, v207 op_sel:[1,1,0] op_sel_hi:[1,0,1] neg_lo:[1,0,0]
v_pk_fma_f16 v208, v42, v14, v208 op_sel:[1,1,0] op_sel_hi:[1,0,1] neg_lo:[1,0,0]
v_pk_fma_f16 v209, v43, v15, v209 op_sel:[1,1,0] op_sel_hi:[1,0,1] neg_lo:[1,0,0]
v_pk_fma_f16 v210, v42, v22, v210 op_sel:[1,1,0] op_sel_hi:[1,0,1] neg_lo:[1,0,0]
ds_write_b64 v239, v[204:205] offset:3168
v_pk_fma_f16 v211, v43, v23, v211 op_sel:[1,1,0] op_sel_hi:[1,0,1] neg_lo:[1,0,0]
v_pk_fma_f16 v212, v42, v30, v212 op_sel:[1,1,0] op_sel_hi:[1,0,1] neg_lo:[1,0,0]
v_pk_fma_f16 v213, v43, v31, v213 op_sel:[1,1,0] op_sel_hi:[1,0,1] neg_lo:[1,0,0]
v_pk_fma_f16 v214, v14, v34, v214 op_sel:[1,1,0] op_sel_hi:[1,0,1] neg_lo:[1,0,0]
v_pk_fma_f16 v215, v15, v35, v215 op_sel:[1,1,0] op_sel_hi:[1,0,1] neg_lo:[1,0,0]
ds_write_b64 v239, v[206:207] offset:3696
v_pk_fma_f16 v216, v14, v36, v216 op_sel:[1,1,0] op_sel_hi:[1,0,1] neg_lo:[1,0,0]
v_pk_fma_f16 v217, v15, v37, v217 op_sel:[1,1,0] op_sel_hi:[1,0,1] neg_lo:[1,0,0]
v_pk_mul_f32 v[148:149], v[136:137], v[112:113] op_sel:[0,0] op_sel_hi:[0,1]
v_pk_mul_f32 v[150:151], v[138:139], v[114:115] op_sel:[0,0] op_sel_hi:[0,1]
v_pk_mul_f32 v[152:153], v[140:141], v[120:121] op_sel:[0,0] op_sel_hi:[0,1]
ds_write_b64 v239, v[208:209] offset:25872
v_pk_mul_f32 v[154:155], v[142:143], v[122:123] op_sel:[0,0] op_sel_hi:[0,1]
v_pk_mul_f32 v[156:157], v[140:141], v[140:141] op_sel:[0,0] op_sel_hi:[0,1]
v_pk_mul_f32 v[158:159], v[142:143], v[142:143] op_sel:[0,0] op_sel_hi:[0,1]
v_pk_fma_f32 v[148:149], v[136:137], v[112:113], v[148:149] op_sel:[1,1,0] op_sel_hi:[1,0,1] neg_lo:[1,0,0]
v_pk_fma_f32 v[150:151], v[138:139], v[114:115], v[150:151] op_sel:[1,1,0] op_sel_hi:[1,0,1] neg_lo:[1,0,0]
ds_write_b64 v239, v[210:211] offset:26400
v_pk_fma_f32 v[152:153], v[140:141], v[120:121], v[152:153] op_sel:[1,1,0] op_sel_hi:[1,0,1] neg_lo:[1,0,0]
v_pk_fma_f32 v[154:155], v[142:143], v[122:123], v[154:155] op_sel:[1,1,0] op_sel_hi:[1,0,1] neg_lo:[1,0,0]
v_pk_fma_f32 v[156:157], v[140:141], v[140:141], v[156:157] op_sel:[1,1,0] op_sel_hi:[1,0,1] neg_lo:[1,0,0]
v_pk_fma_f32 v[158:159], v[142:143], v[142:143], v[158:159] op_sel:[1,1,0] op_sel_hi:[1,0,1] neg_lo:[1,0,0]
v_cvt_pk_f16_f32 v46, v148, v149
ds_write_b64 v239, v[212:213] offset:26928
v_cvt_pk_f16_f32 v47, v150, v151
v_cvt_pk_f16_f32 v48, v152, v153
v_cvt_pk_f16_f32 v49, v154, v155
v_cvt_pk_f16_f32 v50, v156, v157
v_cvt_pk_f16_f32 v51, v158, v159
ds_write_b64 v239, v[214:215] offset:15312
v_pk_mul_f16 v218, v46, v16 op_sel:[0,0] op_sel_hi:[0,1]
v_pk_mul_f16 v219, v47, v17 op_sel:[0,0] op_sel_hi:[0,1]
v_pk_mul_f16 v220, v46, v20 op_sel:[0,0] op_sel_hi:[0,1]
v_pk_mul_f16 v221, v47, v21 op_sel:[0,0] op_sel_hi:[0,1]
v_pk_mul_f16 v168, v46, v28 op_sel:[0,0] op_sel_hi:[0,1]
ds_write_b64 v239, v[216:217] offset:15840
v_pk_mul_f16 v169, v47, v29 op_sel:[0,0] op_sel_hi:[0,1]
v_pk_mul_f16 v170, v48, v14 op_sel:[0,0] op_sel_hi:[0,1]
v_pk_mul_f16 v171, v49, v15 op_sel:[0,0] op_sel_hi:[0,1]
v_pk_mul_f16 v172, v48, v22 op_sel:[0,0] op_sel_hi:[0,1]
v_pk_mul_f16 v173, v49, v23 op_sel:[0,0] op_sel_hi:[0,1]
ds_write_b64 v239, v[46:47] offset:4224
v_pk_mul_f16 v174, v48, v30 op_sel:[0,0] op_sel_hi:[0,1]
v_pk_mul_f16 v175, v49, v31 op_sel:[0,0] op_sel_hi:[0,1]
v_pk_mul_f16 v176, v14, v38 op_sel:[0,0] op_sel_hi:[0,1]
v_pk_mul_f16 v177, v15, v39 op_sel:[0,0] op_sel_hi:[0,1]
v_pk_mul_f16 v178, v22, v36 op_sel:[0,0] op_sel_hi:[0,1]
ds_write_b64 v239, v[48:49] offset:27456
v_pk_mul_f16 v179, v23, v37 op_sel:[0,0] op_sel_hi:[0,1]
v_pk_fma_f16 v218, v46, v16, v218 op_sel:[1,1,0] op_sel_hi:[1,0,1] neg_lo:[1,0,0]
v_pk_fma_f16 v219, v47, v17, v219 op_sel:[1,1,0] op_sel_hi:[1,0,1] neg_lo:[1,0,0]
v_pk_fma_f16 v220, v46, v20, v220 op_sel:[1,1,0] op_sel_hi:[1,0,1] neg_lo:[1,0,0]
v_pk_fma_f16 v221, v47, v21, v221 op_sel:[1,1,0] op_sel_hi:[1,0,1] neg_lo:[1,0,0]
ds_write_b64 v239, v[50:51] offset:29568
v_pk_fma_f16 v168, v46, v28, v168 op_sel:[1,1,0] op_sel_hi:[1,0,1] neg_lo:[1,0,0]
v_pk_fma_f16 v169, v47, v29, v169 op_sel:[1,1,0] op_sel_hi:[1,0,1] neg_lo:[1,0,0]
v_pk_fma_f16 v170, v48, v14, v170 op_sel:[1,1,0] op_sel_hi:[1,0,1] neg_lo:[1,0,0]
v_pk_fma_f16 v171, v49, v15, v171 op_sel:[1,1,0] op_sel_hi:[1,0,1] neg_lo:[1,0,0]
v_pk_fma_f16 v172, v48, v22, v172 op_sel:[1,1,0] op_sel_hi:[1,0,1] neg_lo:[1,0,0]
ds_write_b64 v239, v[218:219] offset:4752
v_pk_fma_f16 v173, v49, v23, v173 op_sel:[1,1,0] op_sel_hi:[1,0,1] neg_lo:[1,0,0]
v_pk_fma_f16 v174, v48, v30, v174 op_sel:[1,1,0] op_sel_hi:[1,0,1] neg_lo:[1,0,0]
v_pk_fma_f16 v175, v49, v31, v175 op_sel:[1,1,0] op_sel_hi:[1,0,1] neg_lo:[1,0,0]
v_pk_fma_f16 v176, v14, v38, v176 op_sel:[1,1,0] op_sel_hi:[1,0,1] neg_lo:[1,0,0]
v_pk_fma_f16 v177, v15, v39, v177 op_sel:[1,1,0] op_sel_hi:[1,0,1] neg_lo:[1,0,0]
ds_write_b64 v239, v[220:221] offset:5280
v_pk_fma_f16 v178, v22, v36, v178 op_sel:[1,1,0] op_sel_hi:[1,0,1] neg_lo:[1,0,0]
v_pk_fma_f16 v179, v23, v37, v179 op_sel:[1,1,0] op_sel_hi:[1,0,1] neg_lo:[1,0,0]
v_pk_mul_f32 v[160:161], v[148:149], v[112:113] op_sel:[0,0] op_sel_hi:[0,1]
v_pk_mul_f32 v[162:163], v[150:151], v[114:115] op_sel:[0,0] op_sel_hi:[0,1]
v_pk_fma_f32 v[160:161], v[148:149], v[112:113], v[160:161] op_sel:[1,1,0] op_sel_hi:[1,0,1] neg_lo:[1,0,0]
ds_write_b64 v239, v[168:169] offset:5808
v_pk_fma_f32 v[162:163], v[150:151], v[114:115], v[162:163] op_sel:[1,1,0] op_sel_hi:[1,0,1] neg_lo:[1,0,0]
v_cvt_pk_f16_f32 v164, v160, v161
v_cvt_pk_f16_f32 v165, v162, v163
v_pk_mul_f16 v180, v164, v16 op_sel:[0,0] op_sel_hi:[0,1]
v_pk_mul_f16 v181, v165, v17 op_sel:[0,0] op_sel_hi:[0,1]
ds_write_b64 v239, v[170:171] offset:27984
v_pk_mul_f16 v182, v164, v20 op_sel:[0,0] op_sel_hi:[0,1]
v_pk_mul_f16 v183, v165, v21 op_sel:[0,0] op_sel_hi:[0,1]
v_pk_mul_f16 v192, v164, v28 op_sel:[0,0] op_sel_hi:[0,1]
v_pk_mul_f16 v193, v165, v29 op_sel:[0,0] op_sel_hi:[0,1]
v_pk_mul_f16 v194, v30, v26 op_sel:[0,0] op_sel_hi:[0,1]
ds_write_b64 v239, v[172:173] offset:28512
v_pk_mul_f16 v195, v31, v27 op_sel:[0,0] op_sel_hi:[0,1]
v_pk_fma_f16 v180, v164, v16, v180 op_sel:[1,1,0] op_sel_hi:[1,0,1] neg_lo:[1,0,0]
v_pk_fma_f16 v181, v165, v17, v181 op_sel:[1,1,0] op_sel_hi:[1,0,1] neg_lo:[1,0,0]
v_pk_fma_f16 v182, v164, v20, v182 op_sel:[1,1,0] op_sel_hi:[1,0,1] neg_lo:[1,0,0]
v_pk_fma_f16 v183, v165, v21, v183 op_sel:[1,1,0] op_sel_hi:[1,0,1] neg_lo:[1,0,0]
ds_write_b64 v239, v[174:175] offset:29040
v_pk_fma_f16 v192, v164, v28, v192 op_sel:[1,1,0] op_sel_hi:[1,0,1] neg_lo:[1,0,0]
v_pk_fma_f16 v193, v165, v29, v193 op_sel:[1,1,0] op_sel_hi:[1,0,1] neg_lo:[1,0,0]
v_pk_fma_f16 v194, v30, v26, v194 op_sel:[1,1,0] op_sel_hi:[1,0,1] neg_lo:[1,0,0]
v_pk_fma_f16 v195, v31, v27, v195 op_sel:[1,1,0] op_sel_hi:[1,0,1] neg_lo:[1,0,0]
v_pk_mul_f16 v196, v30, v36 op_sel:[0,0] op_sel_hi:[0,1]
ds_write_b64 v239, v[176:177] offset:16368
v_pk_mul_f16 v197, v31, v37 op_sel:[0,0] op_sel_hi:[0,1]
v_pk_mul_f16 v198, v44, v14 op_sel:[0,0] op_sel_hi:[0,1]
v_pk_mul_f16 v199, v45, v15 op_sel:[0,0] op_sel_hi:[0,1]
v_pk_mul_f16 v200, v44, v22 op_sel:[0,0] op_sel_hi:[0,1]
v_pk_mul_f16 v201, v45, v23 op_sel:[0,0] op_sel_hi:[0,1]
ds_write_b64 v239, v[178:179] offset:18480
v_pk_mul_f16 v202, v44, v30 op_sel:[0,0] op_sel_hi:[0,1]
v_pk_mul_f16 v203, v45, v31 op_sel:[0,0] op_sel_hi:[0,1]
v_pk_fma_f16 v196, v30, v36, v196 op_sel:[1,1,0] op_sel_hi:[1,0,1] neg_lo:[1,0,0]
v_pk_fma_f16 v197, v31, v37, v197 op_sel:[1,1,0] op_sel_hi:[1,0,1] neg_lo:[1,0,0]
v_pk_fma_f16 v198, v44, v14, v198 op_sel:[1,1,0] op_sel_hi:[1,0,1] neg_lo:[1,0,0]
ds_write_b64 v239, v[164:165] offset:6336
v_pk_fma_f16 v199, v45, v15, v199 op_sel:[1,1,0] op_sel_hi:[1,0,1] neg_lo:[1,0,0]
v_pk_fma_f16 v200, v44, v22, v200 op_sel:[1,1,0] op_sel_hi:[1,0,1] neg_lo:[1,0,0]
v_pk_fma_f16 v201, v45, v23, v201 op_sel:[1,1,0] op_sel_hi:[1,0,1] neg_lo:[1,0,0]
v_pk_fma_f16 v202, v44, v30, v202 op_sel:[1,1,0] op_sel_hi:[1,0,1] neg_lo:[1,0,0]
v_pk_fma_f16 v203, v45, v31, v203 op_sel:[1,1,0] op_sel_hi:[1,0,1] neg_lo:[1,0,0]
ds_write_b64 v239, v[180:181] offset:6864
ds_write_b64 v239, v[182:183] offset:7392
ds_write_b64 v239, v[192:193] offset:7920
ds_write_b64 v239, v[194:195] offset:20064
ds_write_b64 v239, v[196:197] offset:20592
ds_write_b64 v239, v[198:199] offset:22704
ds_write_b64 v239, v[200:201] offset:23760
ds_write_b64 v239, v[202:203] offset:24816
buffer_load_dword v4, v250, s[8:11], s34 offen sc1
s_waitcnt lgkmcnt(0)
ds_read_b128 a[0:3], v240 offset:0
ds_read_b128 a[32:35], v240 offset:8448
ds_read_b128 a[4:7], v240 offset:16
ds_read_b128 a[36:39], v240 offset:8464
ds_read_b128 a[8:11], v240 offset:32
ds_read_b128 a[40:43], v240 offset:8480
ds_read_b128 a[12:15], v240 offset:48
ds_read_b128 a[44:47], v240 offset:8496
ds_read_b128 a[16:19], v240 offset:64
ds_read_b128 a[48:51], v240 offset:8512
ds_read_b128 a[20:23], v240 offset:80
ds_read_b128 a[52:55], v240 offset:8528
ds_read_b128 a[24:27], v240 offset:96
ds_read_b128 a[56:59], v240 offset:8544
s_waitcnt vmcnt(1)
v_lshlrev_b32 v10, 16, v65
v_cmp_eq_u32 vcc, 0, v1
s_nop 1
v_cndmask_b32 v10, 0, v10, vcc
s_waitcnt lgkmcnt(12)
v_mfma_f32_16x16x32_f16 v[80:83], a[32:35], a[0:3], 0
ds_read_b128 a[28:31], v240 offset:112
ds_read_b128 a[60:63], v240 offset:8560
s_waitcnt lgkmcnt(12)
v_mfma_f32_16x16x32_f16 v[80:83], a[36:39], a[4:7], v[80:83]
ds_read_b128 a[64:67], v240 offset:16896
ds_read_b128 a[68:71], v240 offset:16912
s_waitcnt lgkmcnt(12)
v_mfma_f32_16x16x32_f16 v[80:83], a[40:43], a[8:11], v[80:83]
ds_read_b128 a[72:75], v240 offset:16928
ds_read_b128 a[76:79], v240 offset:16944
s_waitcnt lgkmcnt(12)
v_mfma_f32_16x16x32_f16 v[80:83], a[44:47], a[12:15], v[80:83]
ds_read_b128 a[80:83], v240 offset:16960
ds_read_b128 a[84:87], v240 offset:16976
s_waitcnt lgkmcnt(12)
v_mfma_f32_16x16x32_f16 v[80:83], a[48:51], a[16:19], v[80:83]
ds_read_b128 a[88:91], v240 offset:16992
ds_read_b128 a[92:95], v240 offset:17008
s_waitcnt lgkmcnt(12)
v_mfma_f32_16x16x32_f16 v[80:83], a[52:55], a[20:23], v[80:83]
ds_read_b128 a[96:99], v240 offset:25344
ds_read_b128 a[100:103], v240 offset:25360
s_waitcnt lgkmcnt(12)
v_mfma_f32_16x16x32_f16 v[80:83], a[56:59], a[24:27], v[80:83]
ds_read_b128 a[104:107], v240 offset:25376
ds_read_b128 a[108:111], v240 offset:25392
s_waitcnt lgkmcnt(12)
v_mfma_f32_16x16x32_f16 v[80:83], a[60:63], a[28:31], v[80:83]
ds_read_b128 a[112:115], v240 offset:25408
ds_read_b128 a[116:119], v240 offset:25424
s_waitcnt lgkmcnt(13)
v_mfma_f32_16x16x32_f16 v[84:87], a[64:67], a[0:3], 0
ds_read_b128 a[120:123], v240 offset:25440
s_waitcnt lgkmcnt(13)
v_mfma_f32_16x16x32_f16 v[84:87], a[68:71], a[4:7], v[84:87]
ds_read_b128 a[124:127], v240 offset:25456
s_waitcnt lgkmcnt(13)
v_mfma_f32_16x16x32_f16 v[84:87], a[72:75], a[8:11], v[84:87]
s_waitcnt lgkmcnt(12)
v_mfma_f32_16x16x32_f16 v[84:87], a[76:79], a[12:15], v[84:87]
s_waitcnt lgkmcnt(11)
v_mfma_f32_16x16x32_f16 v[84:87], a[80:83], a[16:19], v[84:87]
s_waitcnt lgkmcnt(10)
v_mfma_f32_16x16x32_f16 v[84:87], a[84:87], a[20:23], v[84:87]
v_fma_f32 v80, v60, v80, v10
v_mul_f32 v81, v60, v81
s_waitcnt lgkmcnt(9)
v_mfma_f32_16x16x32_f16 v[84:87], a[88:91], a[24:27], v[84:87]
v_mul_f32 v82, v60, v82
v_mul_f32 v83, v60, v83
s_waitcnt lgkmcnt(8)
v_mfma_f32_16x16x32_f16 v[84:87], a[92:95], a[28:31], v[84:87]
v_cvt_pk_bf16_f32 v80, v80, v81
v_cvt_pk_bf16_f32 v81, v82, v83
s_waitcnt lgkmcnt(7)
v_mfma_f32_16x16x32_f16 v[88:91], a[96:99], a[0:3], 0
s_waitcnt lgkmcnt(6)
v_mfma_f32_16x16x32_f16 v[88:91], a[100:103], a[4:7], v[88:91]
s_waitcnt lgkmcnt(5)
v_mfma_f32_16x16x32_f16 v[88:91], a[104:107], a[8:11], v[88:91]
s_waitcnt lgkmcnt(4)
v_mfma_f32_16x16x32_f16 v[88:91], a[108:111], a[12:15], v[88:91]
s_waitcnt lgkmcnt(3)
v_mfma_f32_16x16x32_f16 v[88:91], a[112:115], a[16:19], v[88:91]
s_waitcnt lgkmcnt(2)
v_mfma_f32_16x16x32_f16 v[88:91], a[116:119], a[20:23], v[88:91]
v_mul_f32 v84, v60, v84
v_mul_f32 v85, v60, v85
s_waitcnt lgkmcnt(1)
v_mfma_f32_16x16x32_f16 v[88:91], a[120:123], a[24:27], v[88:91]
v_mul_f32 v86, v60, v86
v_mul_f32 v87, v60, v87
s_waitcnt lgkmcnt(0)
v_mfma_f32_16x16x32_f16 v[88:91], a[124:127], a[28:31], v[88:91]
v_cvt_pk_bf16_f32 v84, v84, v85
v_cvt_pk_bf16_f32 v85, v86, v87
s_mov_b32 s37, 0
KF_poll:
s_waitcnt vmcnt(0)
v_cmp_ne_u32 vcc, s14, v4
s_add_u32 s37, s37, 1
s_cbranch_vccz KF_pok
s_cmp_gt_u32 s37, 20000
s_cbranch_scc1 KF_pok
s_sleep 2
buffer_load_dword v4, v250, s[8:11], s34 offen sc1
s_branch KF_poll
KF_pok:
s_mov_b32 m0, s39
s_barrier
buffer_load_dwordx4 v236, s[8:11], s38 offen offset:0 sc1 lds
s_add_u32 s38, s38, 146432
buffer_load_dwordx4 v236, s[8:11], s38 offen offset:1024 sc1 lds
ds_write_b32 v254, v52
ds_write_b32 v255, v52
ds_write_b64 v241, v[80:81]
ds_write_b32 v242, v84 offset:512
ds_write_b32 v243, v85 offset:512
ds_read_b32 v24, v245
ds_read2_b32 v[26:27], v245 offset0:1 offset1:2
ds_read_b32 v25, v246 offset:512
ds_read2_b32 v[28:29], v246 offset0:129 offset1:130
s_add_u32 s38, s38, 146432
buffer_load_dwordx4 v236, s[8:11], s38 offen offset:2048 sc1 lds
v_cmp_eq_u32 vcc, 0, v1
v_mul_f32 v88, v60, v88
v_mul_f32 v89, v60, v89
v_mul_f32 v90, v60, v90
v_mul_f32 v91, v60, v91
v_cvt_pk_bf16_f32 v88, v88, v89
v_cvt_pk_bf16_f32 v89, v90, v91
ds_write_b16 v244, v88 offset:1024
ds_write_b16_d16_hi v244, v88 offset:1056
ds_write_b16 v244, v89 offset:1088
ds_write_b16_d16_hi v244, v89 offset:1120
ds_read2_b32 v[30:31], v248 offset0:192 offset1:193
ds_read2_b32 v[32:33], v248 offset0:224 offset1:225
ds_read_b32 v34, v254 offset:1028
ds_read_b32 v35, v246 offset:1024
ds_read_b32 v36, v246 offset:1028
ds_read_b32 v37, v246 offset:1032
s_add_u32 s38, s38, 146432
buffer_load_dwordx4 v236, s[8:11], s38 offen offset:3072 sc1 lds
s_waitcnt lgkmcnt(10)
v_perm_b32 v44, v24, v26, s44
v_alignbit_b32 v45, v26, v26, 16
v_perm_b32 v46, v26, v27, s44
v_alignbit_b32 v47, v27, v27, 16
ds_write_b128 v247, v[44:47] offset:64
v_perm_b32 v49, v28, v28, s45
v_perm_b32 v48, v25, v28, s44
v_alignbit_b32 v50, v28, v28, 16
v_perm_b32 v51, v28, v29, s44
v_cndmask_b32 v48, v49, v48, vcc
ds_write_b128 v247, v[48:51] offset:1088
s_add_u32 m0, m0, 4096
s_add_u32 s38, s38, 150528
buffer_load_dwordx4 v236, s[8:11], s38 offen offset:0 sc1 lds
s_waitcnt lgkmcnt(7)
v_perm_b32 v92, v31, v30, v188
v_perm_b32 v93, v31, v30, v189
v_perm_b32 v94, v31, v30, v190
v_perm_b32 v95, v31, v30, v191
ds_write_b128 v247, v[92:95] offset:2112
s_add_u32 s38, s38, 146432
buffer_load_dwordx4 v236, s[8:11], s38 offen offset:1024 sc1 lds
s_add_u32 s38, s38, 146432
buffer_load_dwordx4 v236, s[8:11], s38 offen offset:2048 sc1 lds
s_waitcnt lgkmcnt(7)
v_perm_b32 v96, v33, v32, v188
v_perm_b32 v97, v33, v32, v189
v_perm_b32 v98, v33, v32, v190
v_perm_b32 v99, v33, v32, v191
ds_write_b128 v247, v[96:99] offset:3136
s_add_u32 s38, s38, 146432
buffer_load_dwordx4 v236, s[8:11], s38 offen offset:3072 sc1 lds
s_waitcnt lgkmcnt(4)
v_perm_b32 v38, v34, v34, v184
v_perm_b32 v39, v35, v36, v185
v_perm_b32 v40, v36, v37, v186
ds_write_b32 v249, v38 offset:4160
ds_write_b32 v231, v52 offset:4416
ds_write_b32 v249, v39 offset:4544
ds_write_b32 v249, v40 offset:4928
ds_read2_b32 a[0:1], v224 offset0:6 offset1:4
ds_read2_b32 a[2:3], v224 offset0:2 offset1:0
ds_read2_b32 a[4:5], v225 offset0:6 offset1:4
ds_read2_b32 a[6:7], v225 offset0:2 offset1:0
ds_read2_b32 a[8:9], v226 offset0:6 offset1:4
ds_read2_b32 a[10:11], v226 offset0:2 offset1:0
ds_read2_b32 a[12:13], v227 offset0:6 offset1:4
ds_read2_b32 a[14:15], v227 offset0:2 offset1:0
ds_read2_b32 a[240:241], v228 offset0:6 offset1:4
ds_read2_b32 a[242:243], v228 offset0:2 offset1:0
ds_read2_b32 a[48:49], v224 offset0:38 offset1:36
ds_read2_b32 a[50:51], v224 offset0:34 offset1:32
ds_read2_b32 a[52:53], v225 offset0:38 offset1:36
ds_read2_b32 a[54:55], v225 offset0:34 offset1:32
ds_read2_b32 a[56:57], v226 offset0:38 offset1:36
ds_read2_b32 a[58:59], v226 offset0:34 offset1:32
ds_read2_b32 a[60:61], v227 offset0:38 offset1:36
ds_read2_b32 a[62:63], v227 offset0:34 offset1:32
v_and_b32 v5, 15, v1
v_lshrrev_b32 v6, 1, v1
v_and_b32 v6, 24, v6
s_movk_i32 s60, 0x3f80
s_mov_b32 s61, 0x3f800000
v_mov_b32 v7, 4064
v_lshlrev_b32 v7, v5, v7
v_lshrrev_b32 v7, v6, v7
v_bfe_i32 v8, v7, 0, 1
v_bfe_i32 v9, v7, 1, 1
v_and_b32 v8, s60, v8
v_and_or_b32 v176, v9, s61, v8
v_bfe_i32 v8, v7, 2, 1
v_bfe_i32 v9, v7, 3, 1
v_and_b32 v8, s60, v8
v_and_or_b32 v177, v9, s61, v8
v_bfe_i32 v8, v7, 4, 1
v_bfe_i32 v9, v7, 5, 1
v_and_b32 v8, s60, v8
v_and_or_b32 v178, v9, s61, v8
v_bfe_i32 v8, v7, 6, 1
v_bfe_i32 v9, v7, 7, 1
v_and_b32 v8, s60, v8
v_and_or_b32 v179, v9, s61, v8
v_mov_b32 v7, 8176
v_lshlrev_b32 v7, v5, v7
v_lshrrev_b32 v7, v6, v7
v_bfe_i32 v8, v7, 0, 1
v_bfe_i32 v9, v7, 1, 1
v_and_b32 v8, s60, v8
v_and_or_b32 v180, v9, s61, v8
v_bfe_i32 v8, v7, 2, 1
v_bfe_i32 v9, v7, 3, 1
v_and_b32 v8, s60, v8
v_and_or_b32 v181, v9, s61, v8
v_bfe_i32 v8, v7, 4, 1
v_bfe_i32 v9, v7, 5, 1
v_and_b32 v8, s60, v8
v_and_or_b32 v182, v9, s61, v8
v_bfe_i32 v8, v7, 6, 1
v_bfe_i32 v9, v7, 7, 1
v_and_b32 v8, s60, v8
v_and_or_b32 v183, v9, s61, v8
ds_read2_b32 a[208:209], v229 offset0:18 offset1:16
ds_read2_b32 a[210:211], v229 offset0:2 offset1:0
ds_read2_b32 a[212:213], v229 offset0:34 offset1:32
ds_read2_b32 a[214:215], v229 offset0:18 offset1:16
ds_read2_b32 a[216:217], v229 offset0:50 offset1:48
ds_read2_b32 a[218:219], v229 offset0:34 offset1:32
ds_read2_b32 a[220:221], v229 offset0:66 offset1:64
ds_read2_b32 a[222:223], v229 offset0:50 offset1:48
ds_read2_b32 a[224:225], v229 offset0:114 offset1:112
ds_read2_b32 a[226:227], v229 offset0:98 offset1:96
ds_read2_b32 a[228:229], v229 offset0:130 offset1:128
ds_read2_b32 a[230:231], v229 offset0:114 offset1:112
ds_read2_b32 a[232:233], v229 offset0:146 offset1:144
ds_read2_b32 a[234:235], v229 offset0:130 offset1:128
ds_read2_b32 a[236:237], v229 offset0:162 offset1:160
ds_read2_b32 a[238:239], v229 offset0:146 offset1:144
s_and_b32 s47, s2, 3
s_lshl_b32 s47, s47, 1
s_bfe_u32 s54, s2, 0x10002
s_add_u32 s47, s47, s54
s_mul_i32 s47, s47, 663552
s_lshr_b32 s54, s2, 3
s_lshl_b32 s54, s54, 15
v_lshlrev_b32 v59, 7, v0
s_add_u32 s47, s47, s54
s_mov_b32 s54, 5308416
s_mov_b32 s55, 0x20000
s_waitcnt vmcnt(0)
s_barrier
ds_read_b128 a[16:19], v232 offset:2048
ds_read_b128 a[20:23], v232 offset:6144
ds_read_b128 a[24:27], v232 offset:10240
ds_read_b128 a[28:31], v232 offset:14336
ds_read_b128 a[32:35], v232 offset:18432
ds_read_b128 a[36:39], v232 offset:22528
ds_read_b128 a[40:43], v232 offset:26624
ds_read_b128 a[44:47], v232 offset:30720
s_cmp_lg_u32 s2, 0
s_cbranch_scc1 KF_nb
s_mov_b32 s6, 4718592
buffer_store_dword v2, v52, s[8:11], s6 offen
KF_nb:
s_waitcnt lgkmcnt(7)
v_mfma_f32_16x16x32_bf16 v[192:195], a[0:3], a[16:19], 0
ds_read_b128 a[64:67], v233 offset:2048
s_waitcnt lgkmcnt(7)
v_mfma_f32_16x16x32_bf16 v[196:199], a[0:3], a[20:23], 0
ds_read_b128 a[68:71], v233 offset:6144
v_mfma_f32_16x16x32_bf16 v[196:199], a[4:7], a[16:19], v[196:199]
ds_read_b128 a[72:75], v233 offset:10240
s_waitcnt lgkmcnt(8)
v_mfma_f32_16x16x32_bf16 v[200:203], a[0:3], a[24:27], 0
ds_read_b128 a[76:79], v233 offset:14336
v_mfma_f32_16x16x32_bf16 v[200:203], a[4:7], a[20:23], v[200:203]
ds_read_b128 a[80:83], v233 offset:18432
v_mfma_f32_16x16x32_bf16 v[200:203], a[8:11], a[16:19], v[200:203]
ds_read_b128 a[84:87], v233 offset:22528
s_waitcnt lgkmcnt(8)
v_mfma_f32_16x16x32_bf16 v[204:207], a[0:3], a[28:31], 0
ds_read_b128 a[88:91], v233 offset:26624
v_mfma_f32_16x16x32_bf16 v[204:207], a[4:7], a[24:27], v[204:207]
ds_read_b128 a[92:95], v233 offset:30720
v_mfma_f32_16x16x32_bf16 v[204:207], a[8:11], a[20:23], v[204:207]
ds_read_b128 a[192:195], v230 offset:2048
global_load_dword v55, v251, s[56:57]
v_mfma_f32_16x16x32_bf16 v[204:207], a[12:15], a[16:19], v[204:207]
ds_read_b128 a[196:199], v230 offset:6144
v_mfma_f32_16x16x32_bf16 v[208:211], a[0:3], a[32:35], 0
ds_read_b128 a[200:203], v230 offset:10240
v_mfma_f32_16x16x32_bf16 v[208:211], a[4:7], a[28:31], v[208:211]
ds_read_b128 a[204:207], v230 offset:14336
v_mfma_f32_16x16x32_bf16 v[208:211], a[8:11], a[24:27], v[208:211]
ds_read_b64 v[32:33], v237 offset:0
v_mfma_f32_16x16x32_bf16 v[208:211], a[12:15], a[20:23], v[208:211]
ds_read_b64 v[34:35], v237 offset:4096
v_mfma_f32_16x16x32_bf16 v[208:211], a[240:243], a[16:19], v[208:211]
ds_read_b64 v[36:37], v237 offset:8192
v_mfma_f32_16x16x32_bf16 v[212:215], a[0:3], a[36:39], 0
ds_read_b64 v[38:39], v237 offset:12288
v_mfma_f32_16x16x32_bf16 v[212:215], a[4:7], a[32:35], v[212:215]
ds_read_b64 v[40:41], v237 offset:16384
v_mfma_f32_16x16x32_bf16 v[212:215], a[8:11], a[28:31], v[212:215]
ds_read_b64 v[42:43], v237 offset:20480
v_mfma_f32_16x16x32_bf16 v[212:215], a[12:15], a[24:27], v[212:215]
ds_read_b64 v[44:45], v237 offset:24576
v_mfma_f32_16x16x32_bf16 v[212:215], a[240:243], a[20:23], v[212:215]
ds_read_b64 v[46:47], v237 offset:28672
s_waitcnt lgkmcnt(8)
v_mfma_f32_16x16x32_bf16 v[216:219], a[0:3], a[40:43], 0
ds_read_b128 a[112:115], v234 offset:2048
v_mfma_f32_16x16x32_bf16 v[216:219], a[4:7], a[36:39], v[216:219]
ds_read2_b32 a[96:97], v224 offset0:70 offset1:68
v_mfma_f32_16x16x32_bf16 v[216:219], a[8:11], a[32:35], v[216:219]
ds_read2_b32 a[98:99], v224 offset0:66 offset1:64
v_mfma_f32_16x16x32_bf16 v[216:219], a[12:15], a[28:31], v[216:219]
ds_read_b128 a[116:119], v234 offset:6144
v_mfma_f32_16x16x32_bf16 v[216:219], a[240:243], a[24:27], v[216:219]
ds_read2_b32 a[100:101], v225 offset0:70 offset1:68
v_mfma_f32_16x16x32_bf16 v[220:223], a[0:3], a[44:47], 0
ds_read2_b32 a[102:103], v225 offset0:66 offset1:64
v_mfma_f32_16x16x32_bf16 v[220:223], a[4:7], a[40:43], v[220:223]
ds_read_b128 a[120:123], v234 offset:10240
v_mfma_f32_16x16x32_bf16 v[220:223], a[8:11], a[36:39], v[220:223]
ds_read2_b32 a[104:105], v226 offset0:70 offset1:68
v_mfma_f32_16x16x32_bf16 v[220:223], a[12:15], a[32:35], v[220:223]
ds_read2_b32 a[106:107], v226 offset0:66 offset1:64
v_mfma_f32_16x16x32_bf16 v[220:223], a[240:243], a[28:31], v[220:223]
ds_read_b128 a[124:127], v234 offset:14336
v_mfma_f32_16x16x32_bf16 v[192:195], a[48:51], a[64:67], v[192:195]
ds_read2_b32 a[108:109], v227 offset0:70 offset1:68
v_mfma_f32_16x16x32_bf16 v[196:199], a[48:51], a[68:71], v[196:199]
ds_read2_b32 a[110:111], v227 offset0:66 offset1:64
v_mfma_f32_16x16x32_bf16 v[196:199], a[52:55], a[64:67], v[196:199]
ds_read_b128 a[128:131], v234 offset:18432
v_mfma_f32_16x16x32_bf16 v[200:203], a[48:51], a[72:75], v[200:203]
ds_read_b128 a[132:135], v234 offset:22528
v_mfma_f32_16x16x32_bf16 v[200:203], a[52:55], a[68:71], v[200:203]
ds_read_b128 a[136:139], v234 offset:26624
v_mfma_f32_16x16x32_bf16 v[200:203], a[56:59], a[64:67], v[200:203]
ds_read_b128 a[140:143], v234 offset:30720
v_mfma_f32_16x16x32_bf16 v[204:207], a[48:51], a[76:79], v[204:207]
ds_read_b128 a[160:163], v235 offset:2048
v_mfma_f32_16x16x32_bf16 v[204:207], a[52:55], a[72:75], v[204:207]
ds_read2_b32 a[144:145], v224 offset0:102 offset1:100
v_mfma_f32_16x16x32_bf16 v[204:207], a[56:59], a[68:71], v[204:207]
ds_read2_b32 a[146:147], v224 offset0:98 offset1:96
v_mfma_f32_16x16x32_bf16 v[204:207], a[60:63], a[64:67], v[204:207]
ds_read_b128 a[164:167], v235 offset:6144
v_mfma_f32_16x16x32_bf16 v[208:211], a[48:51], a[80:83], v[208:211]
ds_read2_b32 a[148:149], v225 offset0:102 offset1:100
v_mfma_f32_16x16x32_bf16 v[208:211], a[52:55], a[76:79], v[208:211]
ds_read2_b32 a[150:151], v225 offset0:98 offset1:96
v_mfma_f32_16x16x32_bf16 v[208:211], a[56:59], a[72:75], v[208:211]
ds_read_b128 a[168:171], v235 offset:10240
v_mfma_f32_16x16x32_bf16 v[208:211], a[60:63], a[68:71], v[208:211]
ds_read2_b32 a[152:153], v226 offset0:102 offset1:100
v_mfma_f32_16x16x32_bf16 v[212:215], a[48:51], a[84:87], v[212:215]
ds_read2_b32 a[154:155], v226 offset0:98 offset1:96
v_mfma_f32_16x16x32_bf16 v[212:215], a[52:55], a[80:83], v[212:215]
ds_read_b128 a[172:175], v235 offset:14336
v_mfma_f32_16x16x32_bf16 v[212:215], a[56:59], a[76:79], v[212:215]
ds_read2_b32 a[156:157], v227 offset0:102 offset1:100
v_mfma_f32_16x16x32_bf16 v[212:215], a[60:63], a[72:75], v[212:215]
ds_read2_b32 a[158:159], v227 offset0:98 offset1:96
v_mfma_f32_16x16x32_bf16 v[216:219], a[48:51], a[88:91], v[216:219]
ds_read_b128 a[176:179], v235 offset:18432
v_mfma_f32_16x16x32_bf16 v[216:219], a[52:55], a[84:87], v[216:219]
ds_read_b128 a[180:183], v235 offset:22528
v_mfma_f32_16x16x32_bf16 v[216:219], a[56:59], a[80:83], v[216:219]
ds_read_b128 a[184:187], v235 offset:26624
v_mfma_f32_16x16x32_bf16 v[216:219], a[60:63], a[76:79], v[216:219]
ds_read_b128 a[188:191], v235 offset:30720
v_mfma_f32_16x16x32_bf16 v[220:223], a[48:51], a[92:95], v[220:223]
v_mfma_f32_16x16x32_bf16 v[220:223], a[52:55], a[88:91], v[220:223]
v_mfma_f32_16x16x32_bf16 v[220:223], a[56:59], a[84:87], v[220:223]
v_mfma_f32_16x16x32_bf16 v[220:223], a[60:63], a[80:83], v[220:223]
v_mfma_f32_16x16x32_bf16 v[128:131], a[16:19], v[176:179], 0
v_mfma_f32_16x16x32_bf16 v[132:135], a[20:23], v[176:179], 0
v_mfma_f32_16x16x32_bf16 v[136:139], a[24:27], v[176:179], 0
v_mfma_f32_16x16x32_bf16 v[140:143], a[28:31], v[176:179], 0
ds_read_b128 a[16:19], v232 offset:0
v_mfma_f32_16x16x32_bf16 v[144:147], a[192:195], v[180:183], 0
ds_read2_b32 a[0:1], v224 offset0:134 offset1:132
v_mfma_f32_16x16x32_bf16 v[148:151], a[196:199], v[180:183], 0
ds_read2_b32 a[2:3], v224 offset0:130 offset1:128
v_mfma_f32_16x16x32_bf16 v[152:155], a[200:203], v[180:183], 0
ds_read_b128 a[20:23], v232 offset:4096
v_mfma_f32_16x16x32_bf16 v[156:159], a[204:207], v[180:183], 0
ds_read2_b32 a[4:5], v225 offset0:134 offset1:132
s_waitcnt lgkmcnt(8)
v_mfma_f32_16x16x32_bf16 v[192:195], a[96:99], a[112:115], v[192:195]
ds_read2_b32 a[6:7], v225 offset0:130 offset1:128
v_mfma_f32_16x16x32_bf16 v[196:199], a[96:99], a[116:119], v[196:199]
v_mfma_f32_16x16x32_bf16 v[196:199], a[100:103], a[112:115], v[196:199]
ds_read_b128 a[24:27], v232 offset:8192
v_cvt_pk_bf16_f32 v160, v128, v129
v_mfma_f32_16x16x32_bf16 v[200:203], a[96:99], a[120:123], v[200:203]
ds_read2_b32 a[8:9], v226 offset0:134 offset1:132
v_cvt_pk_bf16_f32 v161, v130, v131
v_mfma_f32_16x16x32_bf16 v[200:203], a[100:103], a[116:119], v[200:203]
ds_read2_b32 a[10:11], v226 offset0:130 offset1:128
v_cvt_pk_bf16_f32 v162, v132, v133
v_mfma_f32_16x16x32_bf16 v[200:203], a[104:107], a[112:115], v[200:203]
ds_read_b128 a[28:31], v232 offset:12288
v_cvt_pk_bf16_f32 v163, v134, v135
v_mfma_f32_16x16x32_bf16 v[204:207], a[96:99], a[124:127], v[204:207]
v_cvt_pk_bf16_f32 v164, v136, v137
v_cvt_pk_bf16_f32 v165, v138, v139
v_mfma_f32_16x16x32_bf16 v[204:207], a[100:103], a[120:123], v[204:207]
ds_read2_b32 a[12:13], v227 offset0:134 offset1:132
v_cvt_pk_bf16_f32 v166, v140, v141
v_mfma_f32_16x16x32_bf16 v[204:207], a[104:107], a[116:119], v[204:207]
ds_read2_b32 a[14:15], v227 offset0:130 offset1:128
v_cvt_pk_bf16_f32 v167, v142, v143
v_mfma_f32_16x16x32_bf16 v[204:207], a[108:111], a[112:115], v[204:207]
ds_read_b128 a[32:35], v232 offset:16384
v_cvt_pk_bf16_f32 v168, v144, v145
v_mfma_f32_16x16x32_bf16 v[208:211], a[96:99], a[128:131], v[208:211]
ds_read_b128 a[36:39], v232 offset:20480
v_cvt_pk_bf16_f32 v169, v146, v147
v_mfma_f32_16x16x32_bf16 v[208:211], a[100:103], a[124:127], v[208:211]
v_cvt_pk_bf16_f32 v170, v148, v149
v_cvt_pk_bf16_f32 v171, v150, v151
v_mfma_f32_16x16x32_bf16 v[208:211], a[104:107], a[120:123], v[208:211]
ds_read_b128 a[40:43], v232 offset:24576
v_cvt_pk_bf16_f32 v172, v152, v153
v_mfma_f32_16x16x32_bf16 v[208:211], a[108:111], a[116:119], v[208:211]
ds_read_b128 a[44:47], v232 offset:28672
v_cvt_pk_bf16_f32 v173, v154, v155
v_mfma_f32_16x16x32_bf16 v[212:215], a[96:99], a[132:135], v[212:215]
ds_read_b128 a[64:67], v233 offset:0
v_cvt_pk_bf16_f32 v174, v156, v157
v_mfma_f32_16x16x32_bf16 v[212:215], a[100:103], a[128:131], v[212:215]
ds_read2_b32 a[48:49], v224 offset0:166 offset1:164
v_cvt_pk_bf16_f32 v175, v158, v159
v_mfma_f32_16x16x32_bf16 v[212:215], a[104:107], a[124:127], v[212:215]
v_mfma_f32_16x16x32_bf16 v[212:215], a[108:111], a[120:123], v[212:215]
ds_read2_b32 a[50:51], v224 offset0:162 offset1:160
v_mfma_f32_16x16x32_bf16 v[216:219], a[96:99], a[136:139], v[216:219]
ds_read_b128 a[68:71], v233 offset:4096
v_mfma_f32_16x16x32_bf16 v[216:219], a[100:103], a[132:135], v[216:219]
ds_read2_b32 a[52:53], v225 offset0:166 offset1:164
v_mfma_f32_16x16x32_bf16 v[216:219], a[104:107], a[128:131], v[216:219]
ds_read2_b32 a[54:55], v225 offset0:162 offset1:160
v_mfma_f32_16x16x32_bf16 v[216:219], a[108:111], a[124:127], v[216:219]
v_mfma_f32_16x16x32_bf16 v[220:223], a[96:99], a[140:143], v[220:223]
ds_read_b128 a[72:75], v233 offset:8192
v_mfma_f32_16x16x32_bf16 v[220:223], a[100:103], a[136:139], v[220:223]
ds_read2_b32 a[56:57], v226 offset0:166 offset1:164
v_mfma_f32_16x16x32_bf16 v[220:223], a[104:107], a[132:135], v[220:223]
ds_read2_b32 a[58:59], v226 offset0:162 offset1:160
v_mfma_f32_16x16x32_bf16 v[220:223], a[108:111], a[128:131], v[220:223]
ds_read_b128 a[76:79], v233 offset:12288
v_mfma_f32_16x16x32_bf16 v[192:195], a[144:147], a[160:163], v[192:195]
v_lshlrev_b32 v96, 16, v32
v_and_b32 v97, s12, v32
v_mfma_f32_16x16x32_bf16 v[196:199], a[144:147], a[164:167], v[196:199]
ds_read2_b32 a[60:61], v227 offset0:166 offset1:164
v_lshlrev_b32 v98, 16, v33
v_mfma_f32_16x16x32_bf16 v[196:199], a[148:151], a[160:163], v[196:199]
ds_read2_b32 a[62:63], v227 offset0:162 offset1:160
v_and_b32 v99, s12, v33
v_mfma_f32_16x16x32_bf16 v[200:203], a[144:147], a[168:171], v[200:203]
ds_read_b128 a[80:83], v233 offset:16384
v_lshlrev_b32 v100, 16, v34
v_mfma_f32_16x16x32_bf16 v[200:203], a[148:151], a[164:167], v[200:203]
ds_read_b128 a[84:87], v233 offset:20480
v_and_b32 v101, s12, v34
v_mfma_f32_16x16x32_bf16 v[200:203], a[152:155], a[160:163], v[200:203]
v_lshlrev_b32 v102, 16, v35
v_and_b32 v103, s12, v35
v_mfma_f32_16x16x32_bf16 v[204:207], a[144:147], a[172:175], v[204:207]
ds_read_b128 a[88:91], v233 offset:24576
v_lshlrev_b32 v104, 16, v36
v_mfma_f32_16x16x32_bf16 v[204:207], a[148:151], a[168:171], v[204:207]
ds_read_b128 a[92:95], v233 offset:28672
v_and_b32 v105, s12, v36
v_mfma_f32_16x16x32_bf16 v[204:207], a[152:155], a[164:167], v[204:207]
ds_read_b128 a[112:115], v234 offset:0
v_lshlrev_b32 v106, 16, v37
v_mfma_f32_16x16x32_bf16 v[204:207], a[156:159], a[160:163], v[204:207]
ds_read2_b32 a[96:97], v224 offset0:198 offset1:196
v_and_b32 v107, s12, v37
v_mfma_f32_16x16x32_bf16 v[208:211], a[144:147], a[176:179], v[208:211]
v_lshlrev_b32 v108, 16, v38
v_and_b32 v109, s12, v38
v_mfma_f32_16x16x32_bf16 v[208:211], a[148:151], a[172:175], v[208:211]
ds_read2_b32 a[98:99], v224 offset0:194 offset1:192
v_lshlrev_b32 v110, 16, v39
v_mfma_f32_16x16x32_bf16 v[208:211], a[152:155], a[168:171], v[208:211]
ds_read_b128 a[116:119], v234 offset:4096
v_and_b32 v111, s12, v39
v_mfma_f32_16x16x32_bf16 v[208:211], a[156:159], a[164:167], v[208:211]
ds_read2_b32 a[100:101], v225 offset0:198 offset1:196
v_lshlrev_b32 v112, 16, v40
s_waitcnt lgkmcnt(8)
v_mfma_f32_16x16x32_bf16 v[212:215], a[144:147], a[180:183], v[212:215]
ds_read2_b32 a[102:103], v225 offset0:194 offset1:192
v_and_b32 v113, s12, v40
v_mfma_f32_16x16x32_bf16 v[212:215], a[148:151], a[176:179], v[212:215]
v_lshlrev_b32 v114, 16, v41
v_and_b32 v115, s12, v41
v_mfma_f32_16x16x32_bf16 v[212:215], a[152:155], a[172:175], v[212:215]
ds_read_b128 a[120:123], v234 offset:8192
v_lshlrev_b32 v116, 16, v42
v_mfma_f32_16x16x32_bf16 v[212:215], a[156:159], a[168:171], v[212:215]
ds_read2_b32 a[104:105], v226 offset0:198 offset1:196
v_and_b32 v117, s12, v42
v_mfma_f32_16x16x32_bf16 v[216:219], a[144:147], a[184:187], v[216:219]
ds_read2_b32 a[106:107], v226 offset0:194 offset1:192
v_lshlrev_b32 v118, 16, v43
v_mfma_f32_16x16x32_bf16 v[216:219], a[148:151], a[180:183], v[216:219]
ds_read_b128 a[124:127], v234 offset:12288
v_and_b32 v119, s12, v43
v_mfma_f32_16x16x32_bf16 v[216:219], a[152:155], a[176:179], v[216:219]
v_lshlrev_b32 v120, 16, v44
v_and_b32 v121, s12, v44
v_mfma_f32_16x16x32_bf16 v[216:219], a[156:159], a[172:175], v[216:219]
ds_read2_b32 a[108:109], v227 offset0:198 offset1:196
v_lshlrev_b32 v122, 16, v45
v_mfma_f32_16x16x32_bf16 v[220:223], a[144:147], a[188:191], v[220:223]
ds_read2_b32 a[110:111], v227 offset0:194 offset1:192
v_and_b32 v123, s12, v45
v_mfma_f32_16x16x32_bf16 v[220:223], a[148:151], a[184:187], v[220:223]
ds_read_b128 a[128:131], v234 offset:16384
v_lshlrev_b32 v124, 16, v46
v_mfma_f32_16x16x32_bf16 v[220:223], a[152:155], a[180:183], v[220:223]
ds_read_b128 a[132:135], v234 offset:20480
v_and_b32 v125, s12, v46
v_mfma_f32_16x16x32_bf16 v[220:223], a[156:159], a[176:179], v[220:223]
v_lshlrev_b32 v126, 16, v47
v_and_b32 v127, s12, v47
v_mfma_f32_16x16x32_bf16 v[208:211], v[160:163], a[208:211], v[208:211]
ds_read_b128 a[136:139], v234 offset:24576
v_mfma_f32_16x16x32_bf16 v[208:211], v[168:171], a[224:227], v[208:211]
ds_read_b128 a[140:143], v234 offset:28672
v_mfma_f32_16x16x32_bf16 v[212:215], v[160:163], a[212:215], v[212:215]
ds_read_b128 a[160:163], v235 offset:0
v_mfma_f32_16x16x32_bf16 v[212:215], v[168:171], a[228:231], v[212:215]
ds_read2_b32 a[144:145], v224 offset0:230 offset1:228
v_mfma_f32_16x16x32_bf16 v[216:219], v[160:163], a[216:219], v[216:219]
v_mfma_f32_16x16x32_bf16 v[216:219], v[168:171], a[232:235], v[216:219]
ds_read2_b32 a[146:147], v224 offset0:226 offset1:224
v_mfma_f32_16x16x32_bf16 v[216:219], v[164:167], a[208:211], v[216:219]
ds_read_b128 a[164:167], v235 offset:4096
v_mfma_f32_16x16x32_bf16 v[216:219], v[172:175], a[224:227], v[216:219]
ds_read2_b32 a[148:149], v225 offset0:230 offset1:228
v_mfma_f32_16x16x32_bf16 v[220:223], v[160:163], a[220:223], v[220:223]
ds_read2_b32 a[150:151], v225 offset0:226 offset1:224
v_mfma_f32_16x16x32_bf16 v[220:223], v[168:171], a[236:239], v[220:223]
v_mfma_f32_16x16x32_bf16 v[220:223], v[164:167], a[212:215], v[220:223]
ds_read_b128 a[168:171], v235 offset:8192
v_mfma_f32_16x16x32_bf16 v[220:223], v[172:175], a[228:231], v[220:223]
ds_read2_b32 a[152:153], v226 offset0:230 offset1:228
v_mfma_f32_16x16x32_bf16 v[192:195], a[0:3], a[16:19], v[192:195]
ds_read2_b32 a[154:155], v226 offset0:226 offset1:224
v_mfma_f32_16x16x32_bf16 v[196:199], a[0:3], a[20:23], v[196:199]
ds_read_b128 a[172:175], v235 offset:12288
v_mfma_f32_16x16x32_bf16 v[196:199], a[4:7], a[16:19], v[196:199]
v_mfma_f32_16x16x32_bf16 v[200:203], a[0:3], a[24:27], v[200:203]
ds_read2_b32 a[156:157], v227 offset0:230 offset1:228
v_mfma_f32_16x16x32_bf16 v[200:203], a[4:7], a[20:23], v[200:203]
ds_read2_b32 a[158:159], v227 offset0:226 offset1:224
v_mfma_f32_16x16x32_bf16 v[200:203], a[8:11], a[16:19], v[200:203]
ds_read_b128 a[176:179], v235 offset:16384
v_mfma_f32_16x16x32_bf16 v[204:207], a[0:3], a[28:31], v[204:207]
ds_read_b128 a[180:183], v235 offset:20480
v_mfma_f32_16x16x32_bf16 v[204:207], a[4:7], a[24:27], v[204:207]
v_mfma_f32_16x16x32_bf16 v[204:207], a[8:11], a[20:23], v[204:207]
ds_read_b128 a[184:187], v235 offset:24576
v_mfma_f32_16x16x32_bf16 v[204:207], a[12:15], a[16:19], v[204:207]
ds_read_b128 a[188:191], v235 offset:28672
v_mfma_f32_16x16x32_bf16 v[208:211], a[0:3], a[32:35], v[208:211]
v_mfma_f32_16x16x32_bf16 v[208:211], a[4:7], a[28:31], v[208:211]
v_mfma_f32_16x16x32_bf16 v[208:211], a[8:11], a[24:27], v[208:211]
v_mfma_f32_16x16x32_bf16 v[208:211], a[12:15], a[20:23], v[208:211]
v_mfma_f32_16x16x32_bf16 v[212:215], a[0:3], a[36:39], v[212:215]
v_mfma_f32_16x16x32_bf16 v[212:215], a[4:7], a[32:35], v[212:215]
v_mfma_f32_16x16x32_bf16 v[212:215], a[8:11], a[28:31], v[212:215]
v_mfma_f32_16x16x32_bf16 v[212:215], a[12:15], a[24:27], v[212:215]
v_mfma_f32_16x16x32_bf16 v[216:219], a[0:3], a[40:43], v[216:219]
v_mfma_f32_16x16x32_bf16 v[216:219], a[4:7], a[36:39], v[216:219]
v_mfma_f32_16x16x32_bf16 v[216:219], a[8:11], a[32:35], v[216:219]
v_mfma_f32_16x16x32_bf16 v[216:219], a[12:15], a[28:31], v[216:219]
v_mfma_f32_16x16x32_bf16 v[220:223], a[0:3], a[44:47], v[220:223]
v_mfma_f32_16x16x32_bf16 v[220:223], a[4:7], a[40:43], v[220:223]
v_mfma_f32_16x16x32_bf16 v[220:223], a[8:11], a[36:39], v[220:223]
v_mfma_f32_16x16x32_bf16 v[220:223], a[12:15], a[32:35], v[220:223]
v_mfma_f32_16x16x32_bf16 v[192:195], a[48:51], a[64:67], v[192:195]
v_mfma_f32_16x16x32_bf16 v[196:199], a[48:51], a[68:71], v[196:199]
v_mfma_f32_16x16x32_bf16 v[196:199], a[52:55], a[64:67], v[196:199]
v_mfma_f32_16x16x32_bf16 v[200:203], a[48:51], a[72:75], v[200:203]
v_mfma_f32_16x16x32_bf16 v[200:203], a[52:55], a[68:71], v[200:203]
v_mfma_f32_16x16x32_bf16 v[200:203], a[56:59], a[64:67], v[200:203]
v_mfma_f32_16x16x32_bf16 v[204:207], a[48:51], a[76:79], v[204:207]
v_mfma_f32_16x16x32_bf16 v[204:207], a[52:55], a[72:75], v[204:207]
v_mfma_f32_16x16x32_bf16 v[204:207], a[56:59], a[68:71], v[204:207]
v_mfma_f32_16x16x32_bf16 v[204:207], a[60:63], a[64:67], v[204:207]
v_mfma_f32_16x16x32_bf16 v[208:211], a[48:51], a[80:83], v[208:211]
v_mfma_f32_16x16x32_bf16 v[208:211], a[52:55], a[76:79], v[208:211]
v_mfma_f32_16x16x32_bf16 v[208:211], a[56:59], a[72:75], v[208:211]
v_mfma_f32_16x16x32_bf16 v[208:211], a[60:63], a[68:71], v[208:211]
s_waitcnt lgkmcnt(8)
v_mfma_f32_16x16x32_bf16 v[212:215], a[48:51], a[84:87], v[212:215]
v_mfma_f32_16x16x32_bf16 v[212:215], a[52:55], a[80:83], v[212:215]
v_mfma_f32_16x16x32_bf16 v[212:215], a[56:59], a[76:79], v[212:215]
v_mfma_f32_16x16x32_bf16 v[212:215], a[60:63], a[72:75], v[212:215]
v_mfma_f32_16x16x32_bf16 v[216:219], a[48:51], a[88:91], v[216:219]
v_mfma_f32_16x16x32_bf16 v[216:219], a[52:55], a[84:87], v[216:219]
v_mfma_f32_16x16x32_bf16 v[216:219], a[56:59], a[80:83], v[216:219]
v_mfma_f32_16x16x32_bf16 v[216:219], a[60:63], a[76:79], v[216:219]
v_mfma_f32_16x16x32_bf16 v[220:223], a[48:51], a[92:95], v[220:223]
v_mfma_f32_16x16x32_bf16 v[220:223], a[52:55], a[88:91], v[220:223]
v_mfma_f32_16x16x32_bf16 v[220:223], a[56:59], a[84:87], v[220:223]
v_mfma_f32_16x16x32_bf16 v[220:223], a[60:63], a[80:83], v[220:223]
v_mfma_f32_16x16x32_bf16 v[192:195], a[96:99], a[112:115], v[192:195]
v_mfma_f32_16x16x32_bf16 v[192:195], a[144:147], a[160:163], v[192:195]
v_mfma_f32_16x16x32_bf16 v[196:199], a[96:99], a[116:119], v[196:199]
v_mfma_f32_16x16x32_bf16 v[196:199], a[100:103], a[112:115], v[196:199]
v_mfma_f32_16x16x32_bf16 v[196:199], a[144:147], a[164:167], v[196:199]
v_mfma_f32_16x16x32_bf16 v[196:199], a[148:151], a[160:163], v[196:199]
v_mfma_f32_16x16x32_bf16 v[200:203], a[96:99], a[120:123], v[200:203]
v_mfma_f32_16x16x32_bf16 v[200:203], a[100:103], a[116:119], v[200:203]
s_nop 1
v_pk_add_f32 v[128:129], v[192:193], v[96:97]
v_pk_add_f32 v[130:131], v[194:195], v[98:99]
v_mfma_f32_16x16x32_bf16 v[200:203], a[104:107], a[112:115], v[200:203]
v_cvt_pk_bf16_f32 v132, v128, v129
v_cvt_pk_bf16_f32 v133, v130, v131
v_mfma_f32_16x16x32_bf16 v[200:203], a[144:147], a[168:171], v[200:203]
ds_write_b64 v238, v[132:133] offset:0
v_mfma_f32_16x16x32_bf16 v[200:203], a[148:151], a[164:167], v[200:203]
s_waitcnt lgkmcnt(8)
v_mfma_f32_16x16x32_bf16 v[200:203], a[152:155], a[160:163], v[200:203]
v_pk_add_f32 v[136:137], v[196:197], v[100:101]
v_pk_add_f32 v[138:139], v[198:199], v[102:103]
v_mfma_f32_16x16x32_bf16 v[204:207], a[96:99], a[124:127], v[204:207]
v_cvt_pk_bf16_f32 v140, v136, v137
v_cvt_pk_bf16_f32 v141, v138, v139
v_mfma_f32_16x16x32_bf16 v[204:207], a[100:103], a[120:123], v[204:207]
ds_write_b64 v238, v[140:141] offset:512
v_mfma_f32_16x16x32_bf16 v[204:207], a[104:107], a[116:119], v[204:207]
v_mfma_f32_16x16x32_bf16 v[204:207], a[108:111], a[112:115], v[204:207]
s_waitcnt lgkmcnt(8)
v_mfma_f32_16x16x32_bf16 v[204:207], a[144:147], a[172:175], v[204:207]
v_mfma_f32_16x16x32_bf16 v[204:207], a[148:151], a[168:171], v[204:207]
v_pk_add_f32 v[144:145], v[200:201], v[104:105]
v_pk_add_f32 v[146:147], v[202:203], v[106:107]
v_mfma_f32_16x16x32_bf16 v[204:207], a[152:155], a[164:167], v[204:207]
v_cvt_pk_bf16_f32 v148, v144, v145
v_cvt_pk_bf16_f32 v149, v146, v147
s_waitcnt lgkmcnt(6)
v_mfma_f32_16x16x32_bf16 v[204:207], a[156:159], a[160:163], v[204:207]
ds_write_b64 v238, v[148:149] offset:1024
v_mfma_f32_16x16x32_bf16 v[208:211], a[96:99], a[128:131], v[208:211]
v_mfma_f32_16x16x32_bf16 v[208:211], a[100:103], a[124:127], v[208:211]
v_mfma_f32_16x16x32_bf16 v[208:211], a[104:107], a[120:123], v[208:211]
v_mfma_f32_16x16x32_bf16 v[208:211], a[108:111], a[116:119], v[208:211]
s_waitcnt lgkmcnt(6)
v_mfma_f32_16x16x32_bf16 v[208:211], a[144:147], a[176:179], v[208:211]
v_mfma_f32_16x16x32_bf16 v[208:211], a[148:151], a[172:175], v[208:211]
v_pk_add_f32 v[152:153], v[204:205], v[108:109]
v_pk_add_f32 v[154:155], v[206:207], v[110:111]
v_mfma_f32_16x16x32_bf16 v[208:211], a[152:155], a[168:171], v[208:211]
v_cvt_pk_bf16_f32 v156, v152, v153
v_cvt_pk_bf16_f32 v157, v154, v155
v_mfma_f32_16x16x32_bf16 v[208:211], a[156:159], a[164:167], v[208:211]
ds_write_b64 v238, v[156:157] offset:1536
v_mfma_f32_16x16x32_bf16 v[212:215], a[96:99], a[132:135], v[212:215]
v_mfma_f32_16x16x32_bf16 v[212:215], a[100:103], a[128:131], v[212:215]
v_mfma_f32_16x16x32_bf16 v[212:215], a[104:107], a[124:127], v[212:215]
v_mfma_f32_16x16x32_bf16 v[212:215], a[108:111], a[120:123], v[212:215]
s_waitcnt lgkmcnt(6)
v_mfma_f32_16x16x32_bf16 v[212:215], a[144:147], a[180:183], v[212:215]
v_mfma_f32_16x16x32_bf16 v[212:215], a[148:151], a[176:179], v[212:215]
v_pk_add_f32 v[160:161], v[208:209], v[112:113]
v_pk_add_f32 v[162:163], v[210:211], v[114:115]
v_mfma_f32_16x16x32_bf16 v[212:215], a[152:155], a[172:175], v[212:215]
v_cvt_pk_bf16_f32 v164, v160, v161
v_cvt_pk_bf16_f32 v165, v162, v163
v_mfma_f32_16x16x32_bf16 v[212:215], a[156:159], a[168:171], v[212:215]
ds_write_b64 v238, v[164:165] offset:2048
v_mfma_f32_16x16x32_bf16 v[216:219], a[96:99], a[136:139], v[216:219]
v_mfma_f32_16x16x32_bf16 v[216:219], a[100:103], a[132:135], v[216:219]
v_mfma_f32_16x16x32_bf16 v[216:219], a[104:107], a[128:131], v[216:219]
v_mfma_f32_16x16x32_bf16 v[216:219], a[108:111], a[124:127], v[216:219]
s_waitcnt lgkmcnt(6)
v_mfma_f32_16x16x32_bf16 v[216:219], a[144:147], a[184:187], v[216:219]
v_mfma_f32_16x16x32_bf16 v[216:219], a[148:151], a[180:183], v[216:219]
v_pk_add_f32 v[168:169], v[212:213], v[116:117]
v_pk_add_f32 v[170:171], v[214:215], v[118:119]
v_mfma_f32_16x16x32_bf16 v[216:219], a[152:155], a[176:179], v[216:219]
v_cvt_pk_bf16_f32 v172, v168, v169
v_cvt_pk_bf16_f32 v173, v170, v171
v_mfma_f32_16x16x32_bf16 v[216:219], a[156:159], a[172:175], v[216:219]
ds_write_b64 v238, v[172:173] offset:2560
v_mfma_f32_16x16x32_bf16 v[220:223], a[96:99], a[140:143], v[220:223]
v_mfma_f32_16x16x32_bf16 v[220:223], a[100:103], a[136:139], v[220:223]
v_mfma_f32_16x16x32_bf16 v[220:223], a[104:107], a[132:135], v[220:223]
v_mfma_f32_16x16x32_bf16 v[220:223], a[108:111], a[128:131], v[220:223]
s_waitcnt lgkmcnt(6)
v_mfma_f32_16x16x32_bf16 v[220:223], a[144:147], a[188:191], v[220:223]
v_mfma_f32_16x16x32_bf16 v[220:223], a[148:151], a[184:187], v[220:223]
v_pk_add_f32 v[176:177], v[216:217], v[120:121]
v_pk_add_f32 v[178:179], v[218:219], v[122:123]
v_mfma_f32_16x16x32_bf16 v[220:223], a[152:155], a[180:183], v[220:223]
v_cvt_pk_bf16_f32 v180, v176, v177
v_cvt_pk_bf16_f32 v181, v178, v179
v_mfma_f32_16x16x32_bf16 v[220:223], a[156:159], a[176:179], v[220:223]
ds_write_b64 v238, v[180:181] offset:3072
s_nop 6
v_pk_add_f32 v[184:185], v[220:221], v[124:125]
v_pk_add_f32 v[186:187], v[222:223], v[126:127]
v_cvt_pk_bf16_f32 v188, v184, v185
v_cvt_pk_bf16_f32 v189, v186, v187
ds_write_b64 v238, v[188:189] offset:3584
s_waitcnt lgkmcnt(0)
s_barrier
ds_read_b64_tr_b16 v[32:33], v252 offset:0
ds_read_b64_tr_b16 v[34:35], v252 offset:32
ds_read_b64_tr_b16 v[36:37], v252 offset:256
ds_read_b64_tr_b16 v[38:39], v252 offset:288
ds_read_b64_tr_b16 v[40:41], v252 offset:512
ds_read_b64_tr_b16 v[42:43], v252 offset:544
ds_read_b64_tr_b16 v[44:45], v252 offset:768
ds_read_b64_tr_b16 v[46:47], v252 offset:800
s_waitcnt lgkmcnt(6)
buffer_store_dwordx4 v[32:35], v253, s[8:11], s42 offen sc1
s_add_u32 s42, s42, 147456
s_waitcnt lgkmcnt(4)
buffer_store_dwordx4 v[36:39], v253, s[8:11], s42 offen sc1
s_add_u32 s42, s42, 147456
s_waitcnt lgkmcnt(2)
buffer_store_dwordx4 v[40:43], v253, s[8:11], s42 offen sc1
s_add_u32 s42, s42, 147456
s_waitcnt lgkmcnt(0)
buffer_store_dwordx4 v[44:47], v253, s[8:11], s42 offen sc1
s_branch K3_entry
KF_aux:
s_sub_u32 s3, s2, 144
v_mov_b32 v108, 0
s_waitcnt vmcnt(0) lgkmcnt(0)
s_mul_i32 s14, s14, 0x9e3779b1
s_add_u32 s14, s14, 0x7f4a7c15
s_mov_b32 s99, s14
v_mov_b32 v109, s14
s_barrier
s_cmp_lg_u32 s7, 0
s_cbranch_scc1 KF_f2
buffer_store_dword v109, v223, s[8:11], s43 offen sc1
KF_f2:
s_barrier
v_mov_b32 v53, 0
v_mov_b32 v54, 0
v_mov_b32 v55, 0
s_lshr_b32 s3, s3, 3
s_lshr_b32 s6, s7, 1
s_lshl_b32 s13, s3, 1
s_add_u32 s13, s13, s6
s_mul_i32 s14, s13, 43
s_lshr_b32 s14, s14, 7
s_mul_i32 s15, s14, 3
s_sub_u32 s15, s13, s15
s_and_b32 s6, s2, 3
s_mul_i32 s6, s6, 18
s_add_u32 s14, s14, s6
s_bfe_u32 s6, s2, 0x10002
s_mul_i32 s6, s6, 9
s_add_u32 s14, s14, s6
s_cmp_lt_u32 s13, 27
s_cselect_b32 s18, 5308416, 0
s_cselect_b32 s22, 4849664, s10
s_mov_b32 s16, s48
s_mov_b32 s17, s49
s_mov_b32 s19, 0x20000
v_bfe_u32 v3, v0, 3, 4
v_and_b32 v2, 7, v0
v_mul_u32_u24 v3, 9216, v3
v_lshl_add_u32 v3, v2, 4, v3
s_lshl_b32 s20, s14, 7
s_min_u32 s21, s20, 9088
v_lshl_add_u32 v4, v1, 1, s21
s_mul_i32 s21, s15, 1769472
s_add_u32 s20, s20, s21
s_mov_b32 s21, 147456
global_load_ushort v5, v4, s[50:51]
buffer_load_dwordx4 v[16:19], v3, s[16:19], s20 offen
s_add_u32 s20, s20, s21
buffer_load_dwordx4 v[20:23], v3, s[16:19], s20 offen
s_add_u32 s20, s20, s21
buffer_load_dwordx4 v[24:27], v3, s[16:19], s20 offen
s_add_u32 s20, s20, s21
buffer_load_dwordx4 v[28:31], v3, s[16:19], s20 offen
s_add_u32 s20, s20, s21
buffer_load_dwordx4 v[32:35], v3, s[16:19], s20 offen
s_add_u32 s20, s20, s21
buffer_load_dwordx4 v[36:39], v3, s[16:19], s20 offen
s_add_u32 s20, s20, s21
buffer_load_dwordx4 v[40:43], v3, s[16:19], s20 offen
s_add_u32 s20, s20, s21
buffer_load_dwordx4 v[44:47], v3, s[16:19], s20 offen
s_add_u32 s20, s20, s21
buffer_load_dwordx4 v[48:51], v3, s[16:19], s20 offen
s_add_u32 s20, s20, s21
buffer_load_dwordx4 v[52:55], v3, s[16:19], s20 offen
s_add_u32 s20, s20, s21
buffer_load_dwordx4 v[56:59], v3, s[16:19], s20 offen
s_add_u32 s20, s20, s21
buffer_load_dwordx4 v[60:63], v3, s[16:19], s20 offen
s_add_u32 s20, s20, s21
v_min_u32 v102, 47, v0
v_lshlrev_b32 v102, 7, v102
s_mul_i32 s6, s3, 6144
s_add_u32 s6, s6, 0x3800
v_add_u32 v103, s6, v102
global_load_dword v110, v103, s[40:41]
global_load_dword v111, v251, s[56:57]
s_and_b32 s47, s2, 3
s_lshl_b32 s47, s47, 1
s_bfe_u32 s54, s2, 0x10002
s_add_u32 s47, s47, s54
s_mul_i32 s47, s47, 663552
s_lshr_b32 s54, s2, 3
s_mul_i32 s54, s54, 5376
s_add_u32 s54, s54, 493056
s_add_u32 s47, s47, s54
s_mov_b32 s54, 5308416
s_mov_b32 s55, 0x20000
buffer_load_dword v112, v102, s[52:55], s47 offen
s_waitcnt vmcnt(14)
v_lshlrev_b32 v8, 16, v16
v_and_b32 v9, s12, v16
v_lshlrev_b32 v10, 16, v17
v_and_b32 v11, s12, v17
v_lshlrev_b32 v12, 16, v18
v_and_b32 v13, s12, v18
v_lshlrev_b32 v14, 16, v19
v_and_b32 v15, s12, v19
s_waitcnt vmcnt(13)
v_lshlrev_b32 v90, 16, v20
v_and_b32 v91, s12, v20
v_lshlrev_b32 v92, 16, v21
v_and_b32 v93, s12, v21
v_lshlrev_b32 v94, 16, v22
v_and_b32 v95, s12, v22
v_lshlrev_b32 v96, 16, v23
v_and_b32 v97, s12, v23
v_pk_add_f32 v[8:9], v[8:9], v[90:91]
v_pk_add_f32 v[10:11], v[10:11], v[92:93]
v_pk_add_f32 v[12:13], v[12:13], v[94:95]
v_pk_add_f32 v[14:15], v[14:15], v[96:97]
s_waitcnt vmcnt(12)
v_lshlrev_b32 v90, 16, v24
v_and_b32 v91, s12, v24
v_lshlrev_b32 v92, 16, v25
v_and_b32 v93, s12, v25
v_lshlrev_b32 v94, 16, v26
v_and_b32 v95, s12, v26
v_lshlrev_b32 v96, 16, v27
v_and_b32 v97, s12, v27
v_pk_add_f32 v[8:9], v[8:9], v[90:91]
v_pk_add_f32 v[10:11], v[10:11], v[92:93]
v_pk_add_f32 v[12:13], v[12:13], v[94:95]
v_pk_add_f32 v[14:15], v[14:15], v[96:97]
s_waitcnt vmcnt(11)
v_lshlrev_b32 v90, 16, v28
v_and_b32 v91, s12, v28
v_lshlrev_b32 v92, 16, v29
v_and_b32 v93, s12, v29
v_lshlrev_b32 v94, 16, v30
v_and_b32 v95, s12, v30
v_lshlrev_b32 v96, 16, v31
v_and_b32 v97, s12, v31
v_pk_add_f32 v[8:9], v[8:9], v[90:91]
v_pk_add_f32 v[10:11], v[10:11], v[92:93]
v_pk_add_f32 v[12:13], v[12:13], v[94:95]
v_pk_add_f32 v[14:15], v[14:15], v[96:97]
s_waitcnt vmcnt(10)
v_lshlrev_b32 v90, 16, v32
v_and_b32 v91, s12, v32
v_lshlrev_b32 v92, 16, v33
v_and_b32 v93, s12, v33
v_lshlrev_b32 v94, 16, v34
v_and_b32 v95, s12, v34
v_lshlrev_b32 v96, 16, v35
v_and_b32 v97, s12, v35
v_pk_add_f32 v[8:9], v[8:9], v[90:91]
v_pk_add_f32 v[10:11], v[10:11], v[92:93]
v_pk_add_f32 v[12:13], v[12:13], v[94:95]
v_pk_add_f32 v[14:15], v[14:15], v[96:97]
s_waitcnt vmcnt(9)
v_lshlrev_b32 v90, 16, v36
v_and_b32 v91, s12, v36
v_lshlrev_b32 v92, 16, v37
v_and_b32 v93, s12, v37
v_lshlrev_b32 v94, 16, v38
v_and_b32 v95, s12, v38
v_lshlrev_b32 v96, 16, v39
v_and_b32 v97, s12, v39
v_pk_add_f32 v[8:9], v[8:9], v[90:91]
v_pk_add_f32 v[10:11], v[10:11], v[92:93]
v_pk_add_f32 v[12:13], v[12:13], v[94:95]
v_pk_add_f32 v[14:15], v[14:15], v[96:97]
s_waitcnt vmcnt(8)
v_lshlrev_b32 v90, 16, v40
v_and_b32 v91, s12, v40
v_lshlrev_b32 v92, 16, v41
v_and_b32 v93, s12, v41
v_lshlrev_b32 v94, 16, v42
v_and_b32 v95, s12, v42
v_lshlrev_b32 v96, 16, v43
v_and_b32 v97, s12, v43
v_pk_add_f32 v[8:9], v[8:9], v[90:91]
v_pk_add_f32 v[10:11], v[10:11], v[92:93]
v_pk_add_f32 v[12:13], v[12:13], v[94:95]
v_pk_add_f32 v[14:15], v[14:15], v[96:97]
s_waitcnt vmcnt(7)
v_lshlrev_b32 v90, 16, v44
v_and_b32 v91, s12, v44
v_lshlrev_b32 v92, 16, v45
v_and_b32 v93, s12, v45
v_lshlrev_b32 v94, 16, v46
v_and_b32 v95, s12, v46
v_lshlrev_b32 v96, 16, v47
v_and_b32 v97, s12, v47
v_pk_add_f32 v[8:9], v[8:9], v[90:91]
v_pk_add_f32 v[10:11], v[10:11], v[92:93]
v_pk_add_f32 v[12:13], v[12:13], v[94:95]
v_pk_add_f32 v[14:15], v[14:15], v[96:97]
s_waitcnt vmcnt(6)
v_lshlrev_b32 v90, 16, v48
v_and_b32 v91, s12, v48
v_lshlrev_b32 v92, 16, v49
v_and_b32 v93, s12, v49
v_lshlrev_b32 v94, 16, v50
v_and_b32 v95, s12, v50
v_lshlrev_b32 v96, 16, v51
v_and_b32 v97, s12, v51
v_pk_add_f32 v[8:9], v[8:9], v[90:91]
v_pk_add_f32 v[10:11], v[10:11], v[92:93]
v_pk_add_f32 v[12:13], v[12:13], v[94:95]
v_pk_add_f32 v[14:15], v[14:15], v[96:97]
s_waitcnt vmcnt(5)
v_lshlrev_b32 v90, 16, v52
v_and_b32 v91, s12, v52
v_lshlrev_b32 v92, 16, v53
v_and_b32 v93, s12, v53
v_lshlrev_b32 v94, 16, v54
v_and_b32 v95, s12, v54
v_lshlrev_b32 v96, 16, v55
v_and_b32 v97, s12, v55
v_pk_add_f32 v[8:9], v[8:9], v[90:91]
v_pk_add_f32 v[10:11], v[10:11], v[92:93]
v_pk_add_f32 v[12:13], v[12:13], v[94:95]
v_pk_add_f32 v[14:15], v[14:15], v[96:97]
s_waitcnt vmcnt(4)
v_lshlrev_b32 v90, 16, v56
v_and_b32 v91, s12, v56
v_lshlrev_b32 v92, 16, v57
v_and_b32 v93, s12, v57
v_lshlrev_b32 v94, 16, v58
v_and_b32 v95, s12, v58
v_lshlrev_b32 v96, 16, v59
v_and_b32 v97, s12, v59
v_pk_add_f32 v[8:9], v[8:9], v[90:91]
v_pk_add_f32 v[10:11], v[10:11], v[92:93]
v_pk_add_f32 v[12:13], v[12:13], v[94:95]
v_pk_add_f32 v[14:15], v[14:15], v[96:97]
s_waitcnt vmcnt(3)
v_lshlrev_b32 v90, 16, v60
v_and_b32 v91, s12, v60
v_lshlrev_b32 v92, 16, v61
v_and_b32 v93, s12, v61
v_lshlrev_b32 v94, 16, v62
v_and_b32 v95, s12, v62
v_lshlrev_b32 v96, 16, v63
v_and_b32 v97, s12, v63
v_pk_add_f32 v[8:9], v[8:9], v[90:91]
v_pk_add_f32 v[10:11], v[10:11], v[92:93]
v_pk_add_f32 v[12:13], v[12:13], v[94:95]
v_pk_add_f32 v[14:15], v[14:15], v[96:97]
v_add_f32_dpp v8, v8, v8 row_ror:8 row_mask:0xf bank_mask:0xf
v_add_f32_dpp v9, v9, v9 row_ror:8 row_mask:0xf bank_mask:0xf
v_add_f32_dpp v10, v10, v10 row_ror:8 row_mask:0xf bank_mask:0xf
v_add_f32_dpp v11, v11, v11 row_ror:8 row_mask:0xf bank_mask:0xf
v_add_f32_dpp v12, v12, v12 row_ror:8 row_mask:0xf bank_mask:0xf
v_add_f32_dpp v13, v13, v13 row_ror:8 row_mask:0xf bank_mask:0xf
v_add_f32_dpp v14, v14, v14 row_ror:8 row_mask:0xf bank_mask:0xf
v_add_f32_dpp v15, v15, v15 row_ror:8 row_mask:0xf bank_mask:0xf
v_lshrrev_b32 v3, 4, v0
v_lshlrev_b32 v3, 8, v3
v_lshl_add_u32 v3, v2, 5, v3
s_lshl_b32 s6, s7, 10
v_lshl_add_u32 v2, v1, 2, s6
ds_write_b128 v3, v[8:11]
ds_write_b128 v3, v[12:15] offset:16
s_waitcnt lgkmcnt(0)
s_barrier
s_bitcmp1_b32 s7, 0
s_cbranch_scc1 KF_fin
ds_read2st64_b32 v[16:17], v2 offset0:0 offset1:1
ds_read2st64_b32 v[18:19], v2 offset0:2 offset1:3
ds_read2st64_b32 v[20:21], v2 offset0:4 offset1:5
ds_read2st64_b32 v[22:23], v2 offset0:6 offset1:7
s_lshl_b32 s13, s14, 10
s_add_u32 s13, s13, s22
s_lshl_b32 s6, s15, 8
s_add_u32 s6, s6, s13
s_waitcnt lgkmcnt(0)
v_lshrrev_b32 v3, 4, v1
v_and_b32 v4, 0xf0, v251
v_lshl_add_u32 v3, v3, 2, v4
v_pk_add_f32 v[16:17], v[16:17], v[20:21]
v_pk_add_f32 v[18:19], v[18:19], v[22:23]
v_pk_add_f32 v[16:17], v[16:17], v[18:19]
v_add_f32 v16, v16, v17
v_cvt_pk_bf16_f32 v17, v16, v16
v_and_b32 v18, s12, v17
v_sub_f32 v18, v16, v18
v_cvt_pk_bf16_f32 v17, v16, v18
buffer_store_dword v17, v3, s[8:11], s6 offen sc1
s_cmp_lg_u32 s15, 0
s_cbranch_scc1 KF_nb1
buffer_store_dword v5, v3, s[8:11], s13 offen offset:768 sc1
KF_nb1:
KF_fin:
s_add_u32 s43, s43, 4294934528
s_waitcnt vmcnt(0) lgkmcnt(0)
s_barrier
s_cmp_lg_u32 s7, 0
s_cbranch_scc1 KF_f3
buffer_store_dword v109, v223, s[8:11], s43 offen sc1
s_waitcnt vmcnt(0)
KF_f3:
s_barrier
s_and_b32 s47, s2, 3
s_lshl_b32 s47, s47, 1
s_bfe_u32 s54, s2, 0x10002
s_xor_b32 s54, s54, 0
s_add_u32 s47, s47, s54
s_mul_i32 s47, s47, 663552
s_mul_i32 s54, s3, 47616
s_add_u32 s47, s47, s54
s_mov_b32 s54, 5308416
s_mov_b32 s55, 0x20000
v_lshlrev_b32 v74, 7, v0
buffer_load_dword v76, v74, s[52:55], s47 offen
s_add_u32 s47, s47, 32768
s_cmp_ge_u32 s7, 2
s_cbranch_scc1 KF_t30
buffer_load_dword v77, v74, s[52:55], s47 offen
KF_t30:
s_branch K3_entry
KF_end:
s_endpgm
K3_entry:
s_lshl_b32 s3, s2, 4
s_add_u32 s33, s3, 4751360
v_lshlrev_b32 v60, 12, v0
v_and_b32 v60, 0x7000, v60
v_mov_b32 v61, s99
s_load_dwordx2 s[8:9], s[0:1], 112
s_load_dwordx2 s[12:13], s[0:1], 64
s_load_dwordx4 s[16:19], s[0:1], 80
s_load_dwordx2 s[20:21], s[0:1], 96
v_lshrrev_b32 v22, 6, v0
v_and_b32 v0, 63, v0
s_and_b32 s24, s2, 3
v_readfirstlane_b32 s27, v22
s_bfe_u32 s25, s2, 0x10002
s_lshl_b32 s25, s25, 3
s_lshr_b32 s3, s2, 5
s_add_u32 s25, s25, s3
s_bfe_u32 s26, s2, 0x20003
v_lshrrev_b32 v23, 3, v0
v_lshl_add_u32 v23, v22, 4, v23
v_lshrrev_b32 v48, 4, v0
v_lshlrev_b32 v49, 1, v48
v_and_b32 v50, 7, v0
v_xor_b32 v49, v49, v50
v_lshlrev_b32 v49, 4, v49
v_mul_u32_u24 v2, 9216, v23
v_add_u32 v2, v2, v49
v_add_u32 v3, 72704, v2
v_lshlrev_b32 v1, 4, v0
s_mul_i32 s28, s24, 1152
s_mul_i32 s3, s26, 320
s_add_u32 s28, s28, s3
s_lshl_b32 s29, s28, 1
s_lshl_b32 s30, s27, 11
s_lshl_b32 s31, s25, 2
s_add_u32 s31, s31, s27
s_mul_i32 s32, s31, 36864
s_add_u32 s32, s32, 5767168
s_mov_b32 s10, 67108864
s_mov_b32 s11, 0x20000
s_mov_b32 s14, 5308416
s_mov_b32 s15, 0x20000
s_mov_b32 s3, 4718592
s_waitcnt lgkmcnt(0)
s_mov_b32 s52, s99
v_mov_b32 v15, s99
s_add_u32 m0, s30, 0
s_add_u32 s6, s29, 0
buffer_load_dwordx4 v2, s[12:15], s6 offen offset:0 lds
buffer_load_dwordx4 v3, s[12:15], s6 offen offset:1024 lds
s_add_u32 m0, s30, 8192
s_add_u32 s6, s29, 589824
buffer_load_dwordx4 v2, s[12:15], s6 offen offset:0 lds
buffer_load_dwordx4 v3, s[12:15], s6 offen offset:1024 lds
s_bfe_u32 s62, s2, 0x20003
s_cmp_eq_u32 s62, 3
s_cbranch_scc1 PWC3
PWB3:
s_cmp_lg_u32 s7, 0
s_cbranch_scc1 PWB3_0
s_call_b64 s[62:63], PSB_0
s_call_b64 s[62:63], PSB_4
PWB3_0:
s_cmp_lg_u32 s7, 1
s_cbranch_scc1 PWB3_1
s_call_b64 s[62:63], PSB_1
s_call_b64 s[62:63], PSB_5
PWB3_1:
s_cmp_lg_u32 s7, 2
s_cbranch_scc1 PWB3_2
s_call_b64 s[62:63], PSB_2
s_call_b64 s[62:63], PSB_6
PWB3_2:
s_cmp_lg_u32 s7, 3
s_cbranch_scc1 PWB3_3
s_call_b64 s[62:63], PSB_3
s_call_b64 s[62:63], PSB_7
PWB3_3:
s_branch PWE3
PWC3:
s_cmp_lg_u32 s7, 0
s_cbranch_scc1 PWC3_0
s_call_b64 s[62:63], PSC_0
s_call_b64 s[62:63], PSC_4
PWC3_0:
s_cmp_lg_u32 s7, 1
s_cbranch_scc1 PWC3_1
s_call_b64 s[62:63], PSC_1
s_call_b64 s[62:63], PSC_5
PWC3_1:
s_cmp_lg_u32 s7, 2
s_cbranch_scc1 PWC3_2
s_call_b64 s[62:63], PSC_2
s_call_b64 s[62:63], PSC_6
PWC3_2:
s_cmp_lg_u32 s7, 3
s_cbranch_scc1 PWC3_3
s_call_b64 s[62:63], PSC_3
s_call_b64 s[62:63], PSC_7
PWC3_3:
PWE3:
s_waitcnt vmcnt(4)
s_barrier
s_cmp_lg_u32 s27, 0
s_cbranch_scc1 K3_nf
s_cmp_ge_u32 s2, 144
s_cbranch_scc1 K3_nf
buffer_store_dword v61, v60, s[8:11], s33 offen sc1
K3_nf:
s_add_u32 m0, s30, 16384
s_add_u32 s6, s29, 1179648
buffer_load_dwordx4 v2, s[12:15], s6 offen offset:0 lds
buffer_load_dwordx4 v3, s[12:15], s6 offen offset:1024 lds
s_add_u32 m0, s30, 24576
s_add_u32 s6, s29, 1769472
buffer_load_dwordx4 v2, s[12:15], s6 offen offset:0 lds
buffer_load_dwordx4 v3, s[12:15], s6 offen offset:1024 lds
s_add_u32 m0, s30, 32768
s_add_u32 s6, s29, 2359296
buffer_load_dwordx4 v2, s[12:15], s6 offen offset:0 lds
buffer_load_dwordx4 v3, s[12:15], s6 offen offset:1024 lds
s_add_u32 m0, s30, 40960
s_add_u32 s6, s29, 2949120
buffer_load_dwordx4 v2, s[12:15], s6 offen offset:0 lds
buffer_load_dwordx4 v3, s[12:15], s6 offen offset:1024 lds
s_add_u32 m0, s30, 49152
s_add_u32 s6, s29, 3538944
buffer_load_dwordx4 v2, s[12:15], s6 offen offset:0 lds
buffer_load_dwordx4 v3, s[12:15], s6 offen offset:1024 lds
s_add_u32 m0, s30, 57344
s_add_u32 s6, s29, 4128768
buffer_load_dwordx4 v2, s[12:15], s6 offen offset:0 lds
buffer_load_dwordx4 v3, s[12:15], s6 offen offset:1024 lds
s_add_u32 m0, s30, 65536
s_add_u32 s6, s29, 4718592
buffer_load_dwordx4 v2, s[12:15], s6 offen offset:0 lds
buffer_load_dwordx4 v3, s[12:15], s6 offen offset:1024 lds
s_mov_b32 s4, s18
s_mov_b32 s5, s19
v_lshl_add_u32 v56, v22, 10, v1
s_mov_b32 s18, 5308416
s_mov_b32 s19, 0x20000
s_mov_b32 s22, 2359296
s_mov_b32 s23, 0x20000
v_mul_u32_u24 v4, 1152, v23
v_add_u32 v4, v4, v49
v_add_u32 v5, 8192, v4
v_lshrrev_b32 v51, 2, v0
v_and_b32 v52, 3, v0
v_lshlrev_b32 v53, 3, v52
v_lshl_add_u32 v53, v51, 7, v53
v_bfe_u32 v54, v0, 3, 2
v_lshl_add_u32 v6, v54, 5, v53
s_and_b32 s3, s24, 1
s_lshl_b32 s40, s3, 6
v_add_u32 v53, 49152, v6
v_xor_b32 v10, s40, v53
v_xor_b32 v7, 32, v6
v_xor_b32 v11, 32, v10
v_xor_b32 v8, 64, v6
v_xor_b32 v12, 64, v10
v_xor_b32 v9, 96, v6
v_xor_b32 v13, 96, v10
s_lshl_b32 s33, s28, 4
s_add_u32 s33, s33, 4849664
s_nop 0
s_lshl_b32 s34, s25, 2
s_add_u32 s34, s34, s24
s_mul_i32 s34, s34, 84
s_add_u32 s34, s34, s27
s_lshl_b32 s34, s34, 12
s_add_u32 s34, s34, 8388608
s_mul_i32 s35, s24, 1327104
s_lshl_b32 s3, s26, 8
s_add_u32 s35, s35, s3
s_lshl_b32 s36, s31, 2
s_add_u32 s36, s36, s24
s_lshl_b32 s36, s36, 10
s_add_u32 s36, s36, 4980736
s_lshl_b32 s37, s26, 2
s_add_u32 s37, s37, s36
s_mov_b32 s53, 0
s_mov_b32 s39, 0xffff0000
s_lshr_b32 s54, s24, 1
s_lshl_b32 s54, s54, 7
s_add_u32 s54, s54, s35
s_xor_b32 s55, s54, 128
v_lshlrev_b32 v17, 2, v0
v_add_u32 v19, 0x4000, v17
v_mov_b32 v144, 0x3f803f80
v_mov_b32 v145, 0x3f803f80
v_mov_b32 v146, 0x3f803f80
v_mov_b32 v147, 0x3f803f80
v_mov_b32 v224, 0
v_mov_b32 v225, 0
v_mov_b32 v227, 0
v_mov_b32 v228, 0
v_mov_b32 v229, 0
v_mov_b32 v230, 0
v_mov_b32 v232, 0
v_mov_b32 v233, 0
v_mov_b32 v235, 0
v_mov_b32 v236, 0
v_mov_b32 v237, 0
v_mov_b32 v238, 0
v_mov_b32 v240, 0
v_mov_b32 v241, 0
s_waitcnt lgkmcnt(0)
v_mov_b32 v15, s52
s_cmp_eq_u32 s26, 3
s_cbranch_scc1 K3_C
s_add_u32 s41, s26, 1
s_cmp_eq_u32 s41, 3
s_cselect_b32 s41, 0, s41
s_add_u32 s42, s41, 1
s_cmp_eq_u32 s42, 3
s_cselect_b32 s42, 0, s42
s_mul_i32 s3, s26, 368640
s_add_u32 s43, s54, s3
s_add_u32 s96, s55, s3
s_mul_i32 s3, s26, 98304
s_add_u32 s47, s34, s3
s_mul_i32 s3, s41, 368640
s_add_u32 s44, s54, s3
s_add_u32 s97, s55, s3
s_mul_i32 s3, s41, 98304
s_add_u32 s48, s34, s3
s_mul_i32 s3, s42, 368640
s_add_u32 s45, s54, s3
s_add_u32 s98, s55, s3
s_mul_i32 s3, s42, 98304
s_add_u32 s49, s34, s3
s_lshl_b32 s38, s25, 2
s_add_u32 s38, s38, s26
s_mul_i32 s38, s38, 196608
s_lshl_b32 s3, s27, 12
s_add_u32 s38, s38, s3
s_mul_i32 s46, s24, 49152
s_add_u32 s46, s46, s38
s_xor_b32 s3, s24, 1
s_mul_i32 s3, s3, 49152
s_add_u32 s3, s3, s38
s_add_u32 s64, s3, 30408704
s_add_u32 s67, s46, 30408704
s_xor_b32 s3, s24, 2
s_mul_i32 s3, s3, 49152
s_add_u32 s3, s3, s38
s_add_u32 s65, s3, 30425088
s_add_u32 s68, s46, 30425088
s_xor_b32 s3, s24, 3
s_mul_i32 s3, s3, 49152
s_add_u32 s3, s3, s38
s_add_u32 s66, s3, 30441472
s_add_u32 s69, s46, 30441472
s_mul_i32 s3, s31, 36864
s_lshl_b32 s28, s26, 8
s_lshl_b32 s31, s24, 6
s_add_u32 s28, s28, s31
s_lshl_b32 s31, s24, 5
s_add_u32 s31, s31, 1024
s_add_u32 s38, s28, s3
s_add_u32 s46, s31, s3
s_lshl_b32 s25, s28, 5
s_add_u32 s25, s25, s32
s_lshl_b32 s26, s31, 5
s_add_u32 s26, s26, s32
s_lshl_b32 s42, s27, 12
v_add_u32 v23, s42, v1
v_add_u32 v23, 98304, v23
v_add_u32 v242, 8, v23
s_and_b32 s3, s2, 7
s_lshl_b32 s3, s3, 12
s_add_u32 s3, s3, 4751360
s_mov_b32 s50, 0
s_cmp_lt_u32 s2, 144
s_cbranch_scc1 K3B_pl
s_cmp_lg_u32 s27, 0
s_cbranch_scc1 K3B_qk
s_sub_u32 s56, s2, 144
s_lshl_b32 s56, s56, 4
s_add_u32 s56, s56, s3
K3B_ql:
buffer_load_dword v57, off, s[8:11], s56 sc1
s_add_u32 s50, s50, 1
s_waitcnt vmcnt(0)
v_cmp_ne_u32 vcc, s52, v57
s_cbranch_vccz K3B_qk
s_sleep 4
s_cmp_lt_u32 s50, 20000
s_cbranch_scc1 K3B_ql
K3B_qk:
s_barrier
K3B_pl:
buffer_load_dword v60, v56, s[8:11], s3 offen sc1
s_add_u32 s50, s50, 1
s_waitcnt vmcnt(0)
v_cmp_ne_u32 vcc, s52, v60
s_cbranch_vccz K3B_pk
s_sleep 2
s_cmp_lt_u32 s50, 20000
s_cbranch_scc1 K3B_pl
K3B_pk:
s_barrier
s_add_u32 m0, s42, 98304
s_add_u32 s7, s32, 0
buffer_load_dwordx4 v1, s[8:11], s7 offen offset:0 sc1 lds
buffer_load_dwordx4 v1, s[8:11], s7 offen offset:1024 sc1 lds
buffer_load_dwordx4 v1, s[8:11], s7 offen offset:2048 sc1 lds
buffer_load_dwordx4 v1, s[8:11], s7 offen offset:3072 sc1 lds
s_add_u32 m0, s42, 114688
s_add_u32 s7, s32, 4096
buffer_load_dwordx4 v1, s[8:11], s7 offen offset:0 sc1 lds
buffer_load_dwordx4 v1, s[8:11], s7 offen offset:1024 sc1 lds
buffer_load_dwordx4 v1, s[8:11], s7 offen offset:2048 sc1 lds
buffer_load_dwordx4 v1, s[8:11], s7 offen offset:3072 sc1 lds
s_add_u32 m0, s42, 131072
s_add_u32 s7, s32, 8192
buffer_load_dwordx4 v1, s[8:11], s7 offen offset:0 sc1 lds
buffer_load_dwordx4 v1, s[8:11], s7 offen offset:1024 sc1 lds
buffer_load_dwordx4 v1, s[8:11], s7 offen offset:2048 sc1 lds
buffer_load_dwordx4 v1, s[8:11], s7 offen offset:3072 sc1 lds
s_add_u32 s50, s33, 4096
s_mov_b32 s0, s52
s_mov_b32 s1, s52
s_branch PGB_0
.p2align 12
PSB_0:
s_setpc_b64 s[62:63]
PGB_0:
ds_read_b64_tr_b16 v[24:25], v6 offset:0
ds_read_b64_tr_b16 v[26:27], v6 offset:2048
ds_read_b64_tr_b16 v[28:29], v7 offset:0
ds_read_b64_tr_b16 v[30:31], v7 offset:2048
ds_read_b64_tr_b16 v[32:33], v8 offset:0
ds_read_b64_tr_b16 v[34:35], v8 offset:2048
ds_read_b64_tr_b16 v[36:37], v9 offset:0
ds_read_b64_tr_b16 v[38:39], v9 offset:2048
ds_read_b64_tr_b16 v[40:41], v6 offset:4096
ds_read_b64_tr_b16 v[42:43], v6 offset:6144
ds_read_b64_tr_b16 v[44:45], v7 offset:4096
ds_read_b64_tr_b16 v[46:47], v7 offset:6144
s_waitcnt vmcnt(10)
ds_read2st64_b64 a[0:3], v23 offset0:0 offset1:2
ds_read2st64_b64 a[4:7], v242 offset0:0 offset1:2
s_waitcnt lgkmcnt(0)
v_mfma_f32_16x16x32_bf16 v[160:163], v[24:27], a[0:3], 0
ds_read_b64_tr_b16 v[248:249], v8 offset:4096
v_mfma_f32_16x16x32_bf16 v[168:171], v[24:27], a[4:7], 0
ds_read_b64_tr_b16 v[250:251], v8 offset:6144
v_mfma_f32_16x16x32_bf16 v[128:131], v[144:147], a[0:3], 0
s_add_u32 m0, s42, 147456
s_add_u32 s7, s32, 12288
buffer_load_dwordx4 v1, s[8:11], s7 offen offset:0 sc1 lds
s_waitcnt vmcnt(9)
v_mfma_f32_16x16x32_bf16 v[164:167], v[28:31], a[0:3], 0
buffer_load_dwordx4 v1, s[8:11], s7 offen offset:1024 sc1 lds
ds_read_b64_tr_b16 v[252:253], v9 offset:4096
v_mfma_f32_16x16x32_bf16 v[172:175], v[28:31], a[4:7], 0
ds_read_b64_tr_b16 v[254:255], v9 offset:6144
ds_read2st64_b64 a[8:11], v23 offset0:4 offset1:6
ds_read2st64_b64 a[12:15], v242 offset0:4 offset1:6
v_mfma_f32_16x16x32_bf16 v[132:135], v[144:147], a[4:7], 0
buffer_load_dwordx4 v1, s[8:11], s7 offen offset:2048 sc1 lds
v_mfma_f32_16x16x32_bf16 v[176:179], v[32:35], a[0:3], 0
buffer_load_dwordx4 v1, s[8:11], s7 offen offset:3072 sc1 lds
ds_read_b64_tr_b16 v[24:25], v6 offset:8192
v_mfma_f32_16x16x32_bf16 v[184:187], v[32:35], a[4:7], 0
ds_read_b64_tr_b16 v[26:27], v6 offset:10240
v_mfma_f32_16x16x32_bf16 v[136:139], a[0:3], a[0:3], 0
s_add_u32 m0, s42, 98304
s_add_u32 s7, s32, 16384
buffer_load_dwordx4 v1, s[8:11], s7 offen offset:0 sc1 lds
v_mfma_f32_16x16x32_bf16 v[180:183], v[36:39], a[0:3], 0
ds_read_b64_tr_b16 v[28:29], v7 offset:8192
v_mfma_f32_16x16x32_bf16 v[188:191], v[36:39], a[4:7], 0
ds_read_b64_tr_b16 v[30:31], v7 offset:10240
v_mfma_f32_16x16x32_bf16 v[140:143], a[4:7], a[4:7], 0
s_waitcnt lgkmcnt(4)
v_mfma_f32_16x16x32_bf16 v[160:163], v[40:43], a[8:11], v[160:163]
buffer_load_dwordx4 v1, s[8:11], s7 offen offset:1024 sc1 lds
ds_read_b64_tr_b16 v[32:33], v8 offset:8192
v_mfma_f32_16x16x32_bf16 v[168:171], v[40:43], a[12:15], v[168:171]
ds_read_b64_tr_b16 v[34:35], v8 offset:10240
v_mfma_f32_16x16x32_bf16 v[128:131], v[144:147], a[8:11], v[128:131]
s_waitcnt vmcnt(12)
v_mfma_f32_16x16x32_bf16 v[164:167], v[44:47], a[8:11], v[164:167]
buffer_load_dwordx4 v1, s[8:11], s7 offen offset:2048 sc1 lds
ds_read_b64_tr_b16 v[36:37], v9 offset:8192
v_mfma_f32_16x16x32_bf16 v[172:175], v[44:47], a[12:15], v[172:175]
ds_read_b64_tr_b16 v[38:39], v9 offset:10240
ds_read2st64_b64 a[16:19], v23 offset0:32 offset1:34
ds_read2st64_b64 a[20:23], v242 offset0:32 offset1:34
v_mfma_f32_16x16x32_bf16 v[132:135], v[144:147], a[12:15], v[132:135]
v_mfma_f32_16x16x32_bf16 v[176:179], v[248:251], a[8:11], v[176:179]
buffer_load_dwordx4 v1, s[8:11], s7 offen offset:3072 sc1 lds
ds_read_b64_tr_b16 v[40:41], v6 offset:12288
v_mfma_f32_16x16x32_bf16 v[184:187], v[248:251], a[12:15], v[184:187]
ds_read_b64_tr_b16 v[42:43], v6 offset:14336
v_mfma_f32_16x16x32_bf16 v[136:139], a[8:11], a[8:11], v[136:139]
v_mfma_f32_16x16x32_bf16 v[180:183], v[252:255], a[8:11], v[180:183]
buffer_load_dwordx4 v[244:247], v1, s[8:11], s33 offen offset:0 sc1
ds_read_b64_tr_b16 v[44:45], v7 offset:12288
v_mfma_f32_16x16x32_bf16 v[188:191], v[252:255], a[12:15], v[188:191]
ds_read_b64_tr_b16 v[46:47], v7 offset:14336
v_mfma_f32_16x16x32_bf16 v[140:143], a[12:15], a[12:15], v[140:143]
s_waitcnt lgkmcnt(4)
v_mfma_f32_16x16x32_bf16 v[160:163], v[24:27], a[16:19], v[160:163]
ds_read_b64_tr_b16 v[248:249], v8 offset:12288
v_mfma_f32_16x16x32_bf16 v[168:171], v[24:27], a[20:23], v[168:171]
ds_read_b64_tr_b16 v[250:251], v8 offset:14336
v_mfma_f32_16x16x32_bf16 v[128:131], v[144:147], a[16:19], v[128:131]
s_add_u32 m0, s42, 114688
s_add_u32 s7, s32, 20480
buffer_load_dwordx4 v1, s[8:11], s7 offen offset:0 sc1 lds
s_waitcnt vmcnt(14)
v_mfma_f32_16x16x32_bf16 v[164:167], v[28:31], a[16:19], v[164:167]
ds_read_b64_tr_b16 v[252:253], v9 offset:12288
v_mfma_f32_16x16x32_bf16 v[172:175], v[28:31], a[20:23], v[172:175]
ds_read_b64_tr_b16 v[254:255], v9 offset:14336
ds_read2st64_b64 a[24:27], v23 offset0:36 offset1:38
ds_read2st64_b64 a[28:31], v242 offset0:36 offset1:38
v_mfma_f32_16x16x32_bf16 v[132:135], v[144:147], a[20:23], v[132:135]
buffer_load_dwordx4 v1, s[8:11], s7 offen offset:1024 sc1 lds
v_mfma_f32_16x16x32_bf16 v[176:179], v[32:35], a[16:19], v[176:179]
ds_read_b64_tr_b16 v[24:25], v6 offset:16384
v_mfma_f32_16x16x32_bf16 v[184:187], v[32:35], a[20:23], v[184:187]
ds_read_b64_tr_b16 v[26:27], v6 offset:18432
v_mfma_f32_16x16x32_bf16 v[136:139], a[16:19], a[16:19], v[136:139]
v_mfma_f32_16x16x32_bf16 v[180:183], v[36:39], a[16:19], v[180:183]
ds_read_b64_tr_b16 v[28:29], v7 offset:16384
v_mfma_f32_16x16x32_bf16 v[188:191], v[36:39], a[20:23], v[188:191]
ds_read_b64_tr_b16 v[30:31], v7 offset:18432
v_mfma_f32_16x16x32_bf16 v[140:143], a[20:23], a[20:23], v[140:143]
s_waitcnt lgkmcnt(4)
v_mfma_f32_16x16x32_bf16 v[160:163], v[40:43], a[24:27], v[160:163]
ds_read_b64_tr_b16 v[32:33], v8 offset:16384
v_mfma_f32_16x16x32_bf16 v[168:171], v[40:43], a[28:31], v[168:171]
ds_read_b64_tr_b16 v[34:35], v8 offset:18432
v_mfma_f32_16x16x32_bf16 v[128:131], v[144:147], a[24:27], v[128:131]
s_waitcnt vmcnt(13)
v_mfma_f32_16x16x32_bf16 v[164:167], v[44:47], a[24:27], v[164:167]
ds_read_b64_tr_b16 v[36:37], v9 offset:16384
v_mfma_f32_16x16x32_bf16 v[172:175], v[44:47], a[28:31], v[172:175]
ds_read_b64_tr_b16 v[38:39], v9 offset:18432
ds_read2st64_b64 a[32:35], v23 offset0:64 offset1:66
ds_read2st64_b64 a[36:39], v242 offset0:64 offset1:66
v_mfma_f32_16x16x32_bf16 v[132:135], v[144:147], a[28:31], v[132:135]
v_mfma_f32_16x16x32_bf16 v[176:179], v[248:251], a[24:27], v[176:179]
ds_read_b64_tr_b16 v[40:41], v6 offset:20480
v_mfma_f32_16x16x32_bf16 v[184:187], v[248:251], a[28:31], v[184:187]
ds_read_b64_tr_b16 v[42:43], v6 offset:22528
v_mfma_f32_16x16x32_bf16 v[136:139], a[24:27], a[24:27], v[136:139]
buffer_load_dwordx4 v1, s[8:11], s7 offen offset:2048 sc1 lds
v_mfma_f32_16x16x32_bf16 v[180:183], v[252:255], a[24:27], v[180:183]
ds_read_b64_tr_b16 v[44:45], v7 offset:20480
v_mfma_f32_16x16x32_bf16 v[188:191], v[252:255], a[28:31], v[188:191]
ds_read_b64_tr_b16 v[46:47], v7 offset:22528
v_mfma_f32_16x16x32_bf16 v[140:143], a[28:31], a[28:31], v[140:143]
s_waitcnt lgkmcnt(4)
v_mfma_f32_16x16x32_bf16 v[160:163], v[24:27], a[32:35], v[160:163]
ds_read_b64_tr_b16 v[248:249], v8 offset:20480
v_mfma_f32_16x16x32_bf16 v[168:171], v[24:27], a[36:39], v[168:171]
ds_read_b64_tr_b16 v[250:251], v8 offset:22528
v_mfma_f32_16x16x32_bf16 v[128:131], v[144:147], a[32:35], v[128:131]
buffer_load_dwordx4 v1, s[8:11], s7 offen offset:3072 sc1 lds
s_waitcnt vmcnt(13)
v_mfma_f32_16x16x32_bf16 v[164:167], v[28:31], a[32:35], v[164:167]
ds_read_b64_tr_b16 v[252:253], v9 offset:20480
v_mfma_f32_16x16x32_bf16 v[172:175], v[28:31], a[36:39], v[172:175]
ds_read_b64_tr_b16 v[254:255], v9 offset:22528
ds_read2st64_b64 a[40:43], v23 offset0:68 offset1:70
ds_read2st64_b64 a[44:47], v242 offset0:68 offset1:70
v_mfma_f32_16x16x32_bf16 v[132:135], v[144:147], a[36:39], v[132:135]
v_mfma_f32_16x16x32_bf16 v[176:179], v[32:35], a[32:35], v[176:179]
v_mfma_f32_16x16x32_bf16 v[184:187], v[32:35], a[36:39], v[184:187]
s_barrier
ds_read_b64_tr_b16 v[24:25], v6 offset:24576
ds_read_b64_tr_b16 v[26:27], v6 offset:26624
v_mfma_f32_16x16x32_bf16 v[136:139], a[32:35], a[32:35], v[136:139]
s_add_u32 m0, s42, 131072
s_add_u32 s7, s32, 24576
buffer_load_dwordx4 v1, s[8:11], s7 offen offset:0 sc1 lds
v_mfma_f32_16x16x32_bf16 v[180:183], v[36:39], a[32:35], v[180:183]
ds_read_b64_tr_b16 v[28:29], v7 offset:24576
v_mfma_f32_16x16x32_bf16 v[188:191], v[36:39], a[36:39], v[188:191]
ds_read_b64_tr_b16 v[30:31], v7 offset:26624
v_mfma_f32_16x16x32_bf16 v[140:143], a[36:39], a[36:39], v[140:143]
s_waitcnt lgkmcnt(4)
v_mfma_f32_16x16x32_bf16 v[160:163], v[40:43], a[40:43], v[160:163]
buffer_load_dwordx4 v1, s[8:11], s7 offen offset:1024 sc1 lds
ds_read_b64_tr_b16 v[32:33], v8 offset:24576
v_mfma_f32_16x16x32_bf16 v[168:171], v[40:43], a[44:47], v[168:171]
ds_read_b64_tr_b16 v[34:35], v8 offset:26624
v_mfma_f32_16x16x32_bf16 v[128:131], v[144:147], a[40:43], v[128:131]
s_waitcnt vmcnt(13)
v_mfma_f32_16x16x32_bf16 v[164:167], v[44:47], a[40:43], v[164:167]
buffer_load_dwordx4 v1, s[8:11], s7 offen offset:2048 sc1 lds
ds_read_b64_tr_b16 v[36:37], v9 offset:24576
v_mfma_f32_16x16x32_bf16 v[172:175], v[44:47], a[44:47], v[172:175]
ds_read_b64_tr_b16 v[38:39], v9 offset:26624
ds_read2st64_b64 a[48:51], v23 offset0:96 offset1:98
ds_read2st64_b64 a[52:55], v242 offset0:96 offset1:98
v_mfma_f32_16x16x32_bf16 v[132:135], v[144:147], a[44:47], v[132:135]
v_mfma_f32_16x16x32_bf16 v[176:179], v[248:251], a[40:43], v[176:179]
buffer_load_dwordx4 v1, s[8:11], s7 offen offset:3072 sc1 lds
ds_read_b64_tr_b16 v[40:41], v6 offset:28672
v_mfma_f32_16x16x32_bf16 v[184:187], v[248:251], a[44:47], v[184:187]
ds_read_b64_tr_b16 v[42:43], v6 offset:30720
v_mfma_f32_16x16x32_bf16 v[136:139], a[40:43], a[40:43], v[136:139]
s_add_u32 m0, s30, 73728
s_add_u32 s6, s29, 128
v_mfma_f32_16x16x32_bf16 v[180:183], v[252:255], a[40:43], v[180:183]
buffer_load_dwordx4 v2, s[12:15], s6 offen offset:0 lds
ds_read_b64_tr_b16 v[44:45], v7 offset:28672
v_mfma_f32_16x16x32_bf16 v[188:191], v[252:255], a[44:47], v[188:191]
ds_read_b64_tr_b16 v[46:47], v7 offset:30720
v_mfma_f32_16x16x32_bf16 v[140:143], a[44:47], a[44:47], v[140:143]
s_waitcnt lgkmcnt(4)
v_mfma_f32_16x16x32_bf16 v[160:163], v[24:27], a[48:51], v[160:163]
ds_read_b64_tr_b16 v[248:249], v8 offset:28672
v_mfma_f32_16x16x32_bf16 v[168:171], v[24:27], a[52:55], v[168:171]
ds_read_b64_tr_b16 v[250:251], v8 offset:30720
v_mfma_f32_16x16x32_bf16 v[128:131], v[144:147], a[48:51], v[128:131]
s_add_u32 m0, s42, 147456
s_add_u32 s7, s32, 28672
buffer_load_dwordx4 v1, s[8:11], s7 offen offset:0 sc1 lds
s_waitcnt vmcnt(15)
v_mfma_f32_16x16x32_bf16 v[164:167], v[28:31], a[48:51], v[164:167]
ds_read_b64_tr_b16 v[252:253], v9 offset:28672
v_mfma_f32_16x16x32_bf16 v[172:175], v[28:31], a[52:55], v[172:175]
ds_read_b64_tr_b16 v[254:255], v9 offset:30720
ds_read2st64_b64 a[56:59], v23 offset0:100 offset1:102
ds_read2st64_b64 a[60:63], v242 offset0:100 offset1:102
v_mfma_f32_16x16x32_bf16 v[132:135], v[144:147], a[52:55], v[132:135]
buffer_load_dwordx4 v1, s[8:11], s7 offen offset:1024 sc1 lds
v_mfma_f32_16x16x32_bf16 v[176:179], v[32:35], a[48:51], v[176:179]
ds_read_b64_tr_b16 v[24:25], v6 offset:32768
v_mfma_f32_16x16x32_bf16 v[184:187], v[32:35], a[52:55], v[184:187]
ds_read_b64_tr_b16 v[26:27], v6 offset:34816
v_mfma_f32_16x16x32_bf16 v[136:139], a[48:51], a[48:51], v[136:139]
s_add_u32 m0, s30, 73728
s_nop 0
buffer_load_dwordx4 v3, s[12:15], s6 offen offset:1024 lds
v_mfma_f32_16x16x32_bf16 v[180:183], v[36:39], a[48:51], v[180:183]
ds_read_b64_tr_b16 v[28:29], v7 offset:32768
v_mfma_f32_16x16x32_bf16 v[188:191], v[36:39], a[52:55], v[188:191]
ds_read_b64_tr_b16 v[30:31], v7 offset:34816
v_mfma_f32_16x16x32_bf16 v[140:143], a[52:55], a[52:55], v[140:143]
s_add_u32 m0, s30, 81920
s_add_u32 s6, s29, 589952
s_waitcnt lgkmcnt(4)
v_mfma_f32_16x16x32_bf16 v[160:163], v[40:43], a[56:59], v[160:163]
buffer_load_dwordx4 v2, s[12:15], s6 offen offset:0 lds
ds_read_b64_tr_b16 v[32:33], v8 offset:32768
v_mfma_f32_16x16x32_bf16 v[168:171], v[40:43], a[60:63], v[168:171]
ds_read_b64_tr_b16 v[34:35], v8 offset:34816
v_mfma_f32_16x16x32_bf16 v[128:131], v[144:147], a[56:59], v[128:131]
s_waitcnt vmcnt(16)
v_mfma_f32_16x16x32_bf16 v[164:167], v[44:47], a[56:59], v[164:167]
ds_read_b64_tr_b16 v[36:37], v9 offset:32768
v_mfma_f32_16x16x32_bf16 v[172:175], v[44:47], a[60:63], v[172:175]
ds_read_b64_tr_b16 v[38:39], v9 offset:34816
ds_read2st64_b64 a[64:67], v23 offset0:0 offset1:2
ds_read2st64_b64 a[68:71], v242 offset0:0 offset1:2
v_mfma_f32_16x16x32_bf16 v[132:135], v[144:147], a[60:63], v[132:135]
v_mfma_f32_16x16x32_bf16 v[176:179], v[248:251], a[56:59], v[176:179]
ds_read_b64_tr_b16 v[40:41], v6 offset:36864
v_mfma_f32_16x16x32_bf16 v[184:187], v[248:251], a[60:63], v[184:187]
ds_read_b64_tr_b16 v[42:43], v6 offset:38912
v_mfma_f32_16x16x32_bf16 v[136:139], a[56:59], a[56:59], v[136:139]
s_add_u32 m0, s42, 147456
s_nop 0
buffer_load_dwordx4 v1, s[8:11], s7 offen offset:2048 sc1 lds
v_mfma_f32_16x16x32_bf16 v[180:183], v[252:255], a[56:59], v[180:183]
ds_read_b64_tr_b16 v[44:45], v7 offset:36864
v_mfma_f32_16x16x32_bf16 v[188:191], v[252:255], a[60:63], v[188:191]
ds_read_b64_tr_b16 v[46:47], v7 offset:38912
v_mfma_f32_16x16x32_bf16 v[140:143], a[60:63], a[60:63], v[140:143]
s_waitcnt lgkmcnt(4)
v_mfma_f32_16x16x32_bf16 v[160:163], v[24:27], a[64:67], v[160:163]
ds_read_b64_tr_b16 v[248:249], v8 offset:36864
v_mfma_f32_16x16x32_bf16 v[168:171], v[24:27], a[68:71], v[168:171]
ds_read_b64_tr_b16 v[250:251], v8 offset:38912
v_mfma_f32_16x16x32_bf16 v[128:131], v[144:147], a[64:67], v[128:131]
buffer_load_dwordx4 v1, s[8:11], s7 offen offset:3072 sc1 lds
s_waitcnt vmcnt(16)
v_mfma_f32_16x16x32_bf16 v[164:167], v[28:31], a[64:67], v[164:167]
ds_read_b64_tr_b16 v[252:253], v9 offset:36864
v_mfma_f32_16x16x32_bf16 v[172:175], v[28:31], a[68:71], v[172:175]
ds_read_b64_tr_b16 v[254:255], v9 offset:38912
ds_read2st64_b64 a[72:75], v23 offset0:4 offset1:6
ds_read2st64_b64 a[76:79], v242 offset0:4 offset1:6
v_mfma_f32_16x16x32_bf16 v[132:135], v[144:147], a[68:71], v[132:135]
v_mfma_f32_16x16x32_bf16 v[176:179], v[32:35], a[64:67], v[176:179]
ds_read_b64_tr_b16 v[24:25], v6 offset:40960
v_mfma_f32_16x16x32_bf16 v[184:187], v[32:35], a[68:71], v[184:187]
ds_read_b64_tr_b16 v[26:27], v6 offset:43008
v_mfma_f32_16x16x32_bf16 v[136:139], a[64:67], a[64:67], v[136:139]
s_add_u32 s7, s32, 32768
buffer_load_dwordx4 v[48:51], v1, s[8:11], s7 offen offset:0 sc1
v_mfma_f32_16x16x32_bf16 v[180:183], v[36:39], a[64:67], v[180:183]
ds_read_b64_tr_b16 v[28:29], v7 offset:40960
v_mfma_f32_16x16x32_bf16 v[188:191], v[36:39], a[68:71], v[188:191]
ds_read_b64_tr_b16 v[30:31], v7 offset:43008
v_mfma_f32_16x16x32_bf16 v[140:143], a[68:71], a[68:71], v[140:143]
s_waitcnt lgkmcnt(4)
v_mfma_f32_16x16x32_bf16 v[160:163], v[40:43], a[72:75], v[160:163]
ds_read_b64_tr_b16 v[32:33], v8 offset:40960
v_mfma_f32_16x16x32_bf16 v[168:171], v[40:43], a[76:79], v[168:171]
ds_read_b64_tr_b16 v[34:35], v8 offset:43008
v_mfma_f32_16x16x32_bf16 v[128:131], v[144:147], a[72:75], v[128:131]
buffer_load_dwordx4 v[52:55], v1, s[8:11], s7 offen offset:1024 sc1
s_waitcnt vmcnt(15)
v_mfma_f32_16x16x32_bf16 v[164:167], v[44:47], a[72:75], v[164:167]
ds_read_b64_tr_b16 v[36:37], v9 offset:40960
v_mfma_f32_16x16x32_bf16 v[172:175], v[44:47], a[76:79], v[172:175]
ds_read_b64_tr_b16 v[38:39], v9 offset:43008
ds_read2st64_b64 a[80:83], v23 offset0:32 offset1:34
ds_read2st64_b64 a[84:87], v242 offset0:32 offset1:34
v_mfma_f32_16x16x32_bf16 v[132:135], v[144:147], a[76:79], v[132:135]
v_mfma_f32_16x16x32_bf16 v[176:179], v[248:251], a[72:75], v[176:179]
ds_read_b64_tr_b16 v[40:41], v6 offset:45056
v_mfma_f32_16x16x32_bf16 v[184:187], v[248:251], a[76:79], v[184:187]
ds_read_b64_tr_b16 v[42:43], v6 offset:47104
v_mfma_f32_16x16x32_bf16 v[136:139], a[72:75], a[72:75], v[136:139]
buffer_load_dwordx4 v[56:59], v1, s[8:11], s7 offen offset:2048 sc1
v_mfma_f32_16x16x32_bf16 v[180:183], v[252:255], a[72:75], v[180:183]
ds_read_b64_tr_b16 v[44:45], v7 offset:45056
v_mfma_f32_16x16x32_bf16 v[188:191], v[252:255], a[76:79], v[188:191]
ds_read_b64_tr_b16 v[46:47], v7 offset:47104
v_mfma_f32_16x16x32_bf16 v[140:143], a[76:79], a[76:79], v[140:143]
s_waitcnt lgkmcnt(4)
v_mfma_f32_16x16x32_bf16 v[160:163], v[24:27], a[80:83], v[160:163]
buffer_load_dwordx4 v[60:63], v1, s[8:11], s7 offen offset:3072 sc1
ds_read_b64_tr_b16 v[248:249], v8 offset:45056
v_mfma_f32_16x16x32_bf16 v[168:171], v[24:27], a[84:87], v[168:171]
ds_read_b64_tr_b16 v[250:251], v8 offset:47104
v_mfma_f32_16x16x32_bf16 v[128:131], v[144:147], a[80:83], v[128:131]
s_add_u32 m0, s30, 81920
s_nop 0
buffer_load_dwordx4 v3, s[12:15], s6 offen offset:1024 lds
s_waitcnt vmcnt(16)
v_mfma_f32_16x16x32_bf16 v[164:167], v[28:31], a[80:83], v[164:167]
ds_read_b64_tr_b16 v[252:253], v9 offset:45056
v_mfma_f32_16x16x32_bf16 v[172:175], v[28:31], a[84:87], v[172:175]
ds_read_b64_tr_b16 v[254:255], v9 offset:47104
ds_read2st64_b64 a[88:91], v23 offset0:36 offset1:38
ds_read2st64_b64 a[92:95], v242 offset0:36 offset1:38
v_mfma_f32_16x16x32_bf16 v[132:135], v[144:147], a[84:87], v[132:135]
v_mfma_f32_16x16x32_bf16 v[176:179], v[32:35], a[80:83], v[176:179]
v_mfma_f32_16x16x32_bf16 v[184:187], v[32:35], a[84:87], v[184:187]
s_barrier
v_add_u32 v6, 49152, v6
ds_read_b64_tr_b16 v[24:25], v6 offset:0
ds_read_b64_tr_b16 v[26:27], v6 offset:2048
v_mfma_f32_16x16x32_bf16 v[136:139], a[80:83], a[80:83], v[136:139]
s_add_u32 m0, s30, 90112
s_add_u32 s6, s29, 1179776
buffer_load_dwordx4 v2, s[12:15], s6 offen offset:0 lds
v_mfma_f32_16x16x32_bf16 v[180:183], v[36:39], a[80:83], v[180:183]
buffer_load_dwordx4 v3, s[12:15], s6 offen offset:1024 lds
v_add_u32 v7, 49152, v7
ds_read_b64_tr_b16 v[28:29], v7 offset:0
v_mfma_f32_16x16x32_bf16 v[188:191], v[36:39], a[84:87], v[188:191]
ds_read_b64_tr_b16 v[30:31], v7 offset:2048
v_mfma_f32_16x16x32_bf16 v[140:143], a[84:87], a[84:87], v[140:143]
s_waitcnt lgkmcnt(4)
v_mfma_f32_16x16x32_bf16 v[160:163], v[40:43], a[88:91], v[160:163]
v_add_u32 v8, 49152, v8
ds_read_b64_tr_b16 v[32:33], v8 offset:0
v_mfma_f32_16x16x32_bf16 v[168:171], v[40:43], a[92:95], v[168:171]
ds_read_b64_tr_b16 v[34:35], v8 offset:2048
v_mfma_f32_16x16x32_bf16 v[128:131], v[144:147], a[88:91], v[128:131]
s_waitcnt vmcnt(16)
v_mfma_f32_16x16x32_bf16 v[164:167], v[44:47], a[88:91], v[164:167]
v_add_u32 v9, 49152, v9
ds_read_b64_tr_b16 v[36:37], v9 offset:0
v_mfma_f32_16x16x32_bf16 v[172:175], v[44:47], a[92:95], v[172:175]
ds_read_b64_tr_b16 v[38:39], v9 offset:2048
ds_read2st64_b64 a[96:99], v23 offset0:64 offset1:66
ds_read2st64_b64 a[100:103], v242 offset0:64 offset1:66
v_mfma_f32_16x16x32_bf16 v[132:135], v[144:147], a[92:95], v[132:135]
v_mfma_f32_16x16x32_bf16 v[176:179], v[248:251], a[88:91], v[176:179]
ds_read_b64_tr_b16 v[40:41], v6 offset:4096
v_mfma_f32_16x16x32_bf16 v[184:187], v[248:251], a[92:95], v[184:187]
ds_read_b64_tr_b16 v[42:43], v6 offset:6144
v_mfma_f32_16x16x32_bf16 v[136:139], a[88:91], a[88:91], v[136:139]
v_mfma_f32_16x16x32_bf16 v[180:183], v[252:255], a[88:91], v[180:183]
ds_read_b64_tr_b16 v[44:45], v7 offset:4096
v_mfma_f32_16x16x32_bf16 v[188:191], v[252:255], a[92:95], v[188:191]
ds_read_b64_tr_b16 v[46:47], v7 offset:6144
v_mfma_f32_16x16x32_bf16 v[140:143], a[92:95], a[92:95], v[140:143]
s_waitcnt lgkmcnt(4)
v_mfma_f32_16x16x32_bf16 v[160:163], v[24:27], a[96:99], v[160:163]
ds_read_b64_tr_b16 v[248:249], v8 offset:4096
v_mfma_f32_16x16x32_bf16 v[168:171], v[24:27], a[100:103], v[168:171]
ds_read_b64_tr_b16 v[250:251], v8 offset:6144
v_mfma_f32_16x16x32_bf16 v[128:131], v[144:147], a[96:99], v[128:131]
s_waitcnt vmcnt(14)
v_mfma_f32_16x16x32_bf16 v[164:167], v[28:31], a[96:99], v[164:167]
ds_read_b64_tr_b16 v[252:253], v9 offset:4096
v_mfma_f32_16x16x32_bf16 v[172:175], v[28:31], a[100:103], v[172:175]
ds_read_b64_tr_b16 v[254:255], v9 offset:6144
ds_read2st64_b64 a[104:107], v23 offset0:68 offset1:70
ds_read2st64_b64 a[108:111], v242 offset0:68 offset1:70
v_mfma_f32_16x16x32_bf16 v[132:135], v[144:147], a[100:103], v[132:135]
v_mfma_f32_16x16x32_bf16 v[176:179], v[32:35], a[96:99], v[176:179]
ds_read_b64_tr_b16 v[24:25], v6 offset:8192
v_mfma_f32_16x16x32_bf16 v[184:187], v[32:35], a[100:103], v[184:187]
ds_read_b64_tr_b16 v[26:27], v6 offset:10240
v_mfma_f32_16x16x32_bf16 v[136:139], a[96:99], a[96:99], v[136:139]
v_mfma_f32_16x16x32_bf16 v[180:183], v[36:39], a[96:99], v[180:183]
ds_read_b64_tr_b16 v[28:29], v7 offset:8192
v_mfma_f32_16x16x32_bf16 v[188:191], v[36:39], a[100:103], v[188:191]
ds_read_b64_tr_b16 v[30:31], v7 offset:10240
v_mfma_f32_16x16x32_bf16 v[140:143], a[100:103], a[100:103], v[140:143]
s_waitcnt lgkmcnt(4)
v_mfma_f32_16x16x32_bf16 v[160:163], v[40:43], a[104:107], v[160:163]
ds_read_b64_tr_b16 v[32:33], v8 offset:8192
v_mfma_f32_16x16x32_bf16 v[168:171], v[40:43], a[108:111], v[168:171]
ds_read_b64_tr_b16 v[34:35], v8 offset:10240
v_mfma_f32_16x16x32_bf16 v[128:131], v[144:147], a[104:107], v[128:131]
s_waitcnt vmcnt(11)
v_mfma_f32_16x16x32_bf16 v[164:167], v[44:47], a[104:107], v[164:167]
ds_read_b64_tr_b16 v[36:37], v9 offset:8192
v_mfma_f32_16x16x32_bf16 v[172:175], v[44:47], a[108:111], v[172:175]
ds_read_b64_tr_b16 v[38:39], v9 offset:10240
ds_read2st64_b64 a[112:115], v23 offset0:96 offset1:98
ds_read2st64_b64 a[116:119], v242 offset0:96 offset1:98
v_mfma_f32_16x16x32_bf16 v[132:135], v[144:147], a[108:111], v[132:135]
v_mfma_f32_16x16x32_bf16 v[176:179], v[248:251], a[104:107], v[176:179]
ds_read_b64_tr_b16 v[40:41], v6 offset:12288
v_mfma_f32_16x16x32_bf16 v[184:187], v[248:251], a[108:111], v[184:187]
ds_read_b64_tr_b16 v[42:43], v6 offset:14336
v_mfma_f32_16x16x32_bf16 v[136:139], a[104:107], a[104:107], v[136:139]
v_mfma_f32_16x16x32_bf16 v[180:183], v[252:255], a[104:107], v[180:183]
ds_read_b64_tr_b16 v[44:45], v7 offset:12288
v_mfma_f32_16x16x32_bf16 v[188:191], v[252:255], a[108:111], v[188:191]
ds_read_b64_tr_b16 v[46:47], v7 offset:14336
v_mfma_f32_16x16x32_bf16 v[140:143], a[108:111], a[108:111], v[140:143]
s_waitcnt lgkmcnt(4)
v_mfma_f32_16x16x32_bf16 v[160:163], v[24:27], a[112:115], v[160:163]
ds_read_b64_tr_b16 v[248:249], v8 offset:12288
v_mfma_f32_16x16x32_bf16 v[168:171], v[24:27], a[116:119], v[168:171]
ds_read_b64_tr_b16 v[250:251], v8 offset:14336
v_mfma_f32_16x16x32_bf16 v[128:131], v[144:147], a[112:115], v[128:131]
s_waitcnt vmcnt(7)
v_mfma_f32_16x16x32_bf16 v[164:167], v[28:31], a[112:115], v[164:167]
ds_read_b64_tr_b16 v[252:253], v9 offset:12288
v_mfma_f32_16x16x32_bf16 v[172:175], v[28:31], a[116:119], v[172:175]
ds_read_b64_tr_b16 v[254:255], v9 offset:14336
ds_read2st64_b64 a[120:123], v23 offset0:100 offset1:102
ds_read2st64_b64 a[124:127], v242 offset0:100 offset1:102
v_mfma_f32_16x16x32_bf16 v[132:135], v[144:147], a[116:119], v[132:135]
v_mfma_f32_16x16x32_bf16 v[176:179], v[32:35], a[112:115], v[176:179]
ds_read_b64_tr_b16 v[24:25], v6 offset:16384
v_mfma_f32_16x16x32_bf16 v[184:187], v[32:35], a[116:119], v[184:187]
ds_read_b64_tr_b16 v[26:27], v6 offset:18432
v_mfma_f32_16x16x32_bf16 v[136:139], a[112:115], a[112:115], v[136:139]
s_waitcnt vmcnt(6)
v_mfma_f32_16x16x32_bf16 v[180:183], v[36:39], a[112:115], v[180:183]
ds_read_b64_tr_b16 v[28:29], v7 offset:16384
v_accvgpr_write_b32 a128, v48
v_mfma_f32_16x16x32_bf16 v[188:191], v[36:39], a[116:119], v[188:191]
ds_read_b64_tr_b16 v[30:31], v7 offset:18432
v_accvgpr_write_b32 a129, v49
v_accvgpr_write_b32 a132, v50
v_mfma_f32_16x16x32_bf16 v[140:143], a[116:119], a[116:119], v[140:143]
v_accvgpr_write_b32 a133, v51
s_waitcnt lgkmcnt(4)
v_mfma_f32_16x16x32_bf16 v[160:163], v[40:43], a[120:123], v[160:163]
ds_read_b64_tr_b16 v[32:33], v8 offset:16384
v_mfma_f32_16x16x32_bf16 v[168:171], v[40:43], a[124:127], v[168:171]
ds_read_b64_tr_b16 v[34:35], v8 offset:18432
v_mfma_f32_16x16x32_bf16 v[128:131], v[144:147], a[120:123], v[128:131]
s_waitcnt vmcnt(5)
v_mfma_f32_16x16x32_bf16 v[164:167], v[44:47], a[120:123], v[164:167]
ds_read_b64_tr_b16 v[36:37], v9 offset:16384
v_accvgpr_write_b32 a130, v52
v_mfma_f32_16x16x32_bf16 v[172:175], v[44:47], a[124:127], v[172:175]
ds_read_b64_tr_b16 v[38:39], v9 offset:18432
v_accvgpr_write_b32 a131, v53
v_accvgpr_write_b32 a134, v54
v_mfma_f32_16x16x32_bf16 v[132:135], v[144:147], a[124:127], v[132:135]
v_mfma_f32_16x16x32_bf16 v[176:179], v[248:251], a[120:123], v[176:179]
ds_read_b64_tr_b16 v[40:41], v6 offset:20480
v_mfma_f32_16x16x32_bf16 v[184:187], v[248:251], a[124:127], v[184:187]
ds_read_b64_tr_b16 v[42:43], v6 offset:22528
v_accvgpr_write_b32 a135, v55
v_mfma_f32_16x16x32_bf16 v[136:139], a[120:123], a[120:123], v[136:139]
s_waitcnt vmcnt(4)
v_mfma_f32_16x16x32_bf16 v[180:183], v[252:255], a[120:123], v[180:183]
ds_read_b64_tr_b16 v[44:45], v7 offset:20480
v_accvgpr_write_b32 a136, v56
v_mfma_f32_16x16x32_bf16 v[188:191], v[252:255], a[124:127], v[188:191]
ds_read_b64_tr_b16 v[46:47], v7 offset:22528
v_accvgpr_write_b32 a137, v57
v_accvgpr_write_b32 a140, v58
v_mfma_f32_16x16x32_bf16 v[140:143], a[124:127], a[124:127], v[140:143]
v_accvgpr_write_b32 a141, v59
s_waitcnt lgkmcnt(4)
v_mfma_f32_16x16x32_bf16 v[160:163], v[24:27], a[128:131], v[160:163]
ds_read_b64_tr_b16 v[248:249], v8 offset:20480
v_mfma_f32_16x16x32_bf16 v[168:171], v[24:27], a[132:135], v[168:171]
ds_read_b64_tr_b16 v[250:251], v8 offset:22528
v_mfma_f32_16x16x32_bf16 v[128:131], v[144:147], a[128:131], v[128:131]
s_waitcnt vmcnt(3)
v_mfma_f32_16x16x32_bf16 v[164:167], v[28:31], a[128:131], v[164:167]
ds_read_b64_tr_b16 v[252:253], v9 offset:20480
v_accvgpr_write_b32 a138, v60
v_mfma_f32_16x16x32_bf16 v[172:175], v[28:31], a[132:135], v[172:175]
ds_read_b64_tr_b16 v[254:255], v9 offset:22528
v_accvgpr_write_b32 a139, v61
v_accvgpr_write_b32 a142, v62
v_mfma_f32_16x16x32_bf16 v[132:135], v[144:147], a[132:135], v[132:135]
v_mfma_f32_16x16x32_bf16 v[176:179], v[32:35], a[128:131], v[176:179]
v_mfma_f32_16x16x32_bf16 v[184:187], v[32:35], a[132:135], v[184:187]
s_waitcnt vmcnt(0)
s_barrier
ds_read_b64_tr_b16 v[24:25], v6 offset:24576
ds_read_b64_tr_b16 v[26:27], v6 offset:26624
v_accvgpr_write_b32 a143, v63
v_mfma_f32_16x16x32_bf16 v[136:139], a[128:131], a[128:131], v[136:139]
s_add_u32 m0, s30, 98304
s_add_u32 s6, s29, 1769600
buffer_load_dwordx4 v2, s[12:15], s6 offen offset:0 lds
v_mfma_f32_16x16x32_bf16 v[180:183], v[36:39], a[128:131], v[180:183]
buffer_load_dwordx4 v3, s[12:15], s6 offen offset:1024 lds
ds_read_b64_tr_b16 v[28:29], v7 offset:24576
v_mfma_f32_16x16x32_bf16 v[188:191], v[36:39], a[132:135], v[188:191]
ds_read_b64_tr_b16 v[30:31], v7 offset:26624
v_mfma_f32_16x16x32_bf16 v[140:143], a[132:135], a[132:135], v[140:143]
s_add_u32 m0, s30, 106496
s_add_u32 s6, s29, 2359424
buffer_load_dwordx4 v2, s[12:15], s6 offen offset:0 lds
s_waitcnt lgkmcnt(4)
v_mfma_f32_16x16x32_bf16 v[160:163], v[40:43], a[136:139], v[160:163]
buffer_load_dwordx4 v3, s[12:15], s6 offen offset:1024 lds
ds_read_b64_tr_b16 v[32:33], v8 offset:24576
v_mfma_f32_16x16x32_bf16 v[168:171], v[40:43], a[140:143], v[168:171]
ds_read_b64_tr_b16 v[34:35], v8 offset:26624
v_mfma_f32_16x16x32_bf16 v[128:131], v[144:147], a[136:139], v[128:131]
s_add_u32 m0, s30, 114688
s_add_u32 s6, s29, 2949248
buffer_load_dwordx4 v2, s[12:15], s6 offen offset:0 lds
v_mfma_f32_16x16x32_bf16 v[164:167], v[44:47], a[136:139], v[164:167]
s_branch PGB_1
.p2align 12
PSB_1:
s_setpc_b64 s[62:63]
PGB_1:
ds_read_b64_tr_b16 v[36:37], v9 offset:24576
v_mfma_f32_16x16x32_bf16 v[172:175], v[44:47], a[140:143], v[172:175]
ds_read_b64_tr_b16 v[38:39], v9 offset:26624
v_mfma_f32_16x16x32_bf16 v[132:135], v[144:147], a[140:143], v[132:135]
buffer_load_dwordx4 v3, s[12:15], s6 offen offset:1024 lds
v_mfma_f32_16x16x32_bf16 v[176:179], v[248:251], a[136:139], v[176:179]
ds_read_b64_tr_b16 v[40:41], v6 offset:28672
v_mfma_f32_16x16x32_bf16 v[184:187], v[248:251], a[140:143], v[184:187]
ds_read_b64_tr_b16 v[42:43], v6 offset:30720
v_mfma_f32_16x16x32_bf16 v[136:139], a[136:139], a[136:139], v[136:139]
s_add_u32 m0, s30, 122880
s_add_u32 s6, s29, 3539072
v_mfma_f32_16x16x32_bf16 v[180:183], v[252:255], a[136:139], v[180:183]
buffer_load_dwordx4 v2, s[12:15], s6 offen offset:0 lds
ds_read_b64_tr_b16 v[44:45], v7 offset:28672
v_mfma_f32_16x16x32_bf16 v[188:191], v[252:255], a[140:143], v[188:191]
ds_read_b64_tr_b16 v[46:47], v7 offset:30720
v_mfma_f32_16x16x32_bf16 v[140:143], a[140:143], a[140:143], v[140:143]
s_waitcnt lgkmcnt(4)
v_mfma_f32_16x16x32_bf16 v[192:195], v[24:27], a[0:3], 0
buffer_load_dwordx4 v3, s[12:15], s6 offen offset:1024 lds
ds_read_b64_tr_b16 v[248:249], v8 offset:28672
v_mfma_f32_16x16x32_bf16 v[200:203], v[24:27], a[4:7], 0
ds_read_b64_tr_b16 v[250:251], v8 offset:30720
v_mfma_f32_16x16x32_bf16 v[196:199], v[28:31], a[0:3], 0
ds_read_b64_tr_b16 v[252:253], v9 offset:28672
s_add_u32 m0, s30, 131072
s_add_u32 s6, s29, 4128896
v_mfma_f32_16x16x32_bf16 v[204:207], v[28:31], a[4:7], 0
ds_read_b64_tr_b16 v[254:255], v9 offset:30720
s_mov_b32 s40, 0xaaaaaaaa
s_mov_b32 s41, 0xaaaaaaaa
v_mfma_f32_16x16x32_bf16 v[208:211], v[32:35], a[0:3], 0
buffer_load_dwordx4 v2, s[12:15], s6 offen offset:0 lds
ds_read_b64_tr_b16 v[24:25], v6 offset:32768
v_mfma_f32_16x16x32_bf16 v[216:219], v[32:35], a[4:7], 0
ds_read_b64_tr_b16 v[26:27], v6 offset:34816
s_mov_b32 s56, 0xcccccccc
s_mov_b32 s57, 0xcccccccc
v_mfma_f32_16x16x32_bf16 v[212:215], v[36:39], a[0:3], 0
ds_read_b64_tr_b16 v[28:29], v7 offset:32768
s_mov_b32 s58, 0x00f0000f
s_mov_b32 s59, 0xf0000f00
v_mfma_f32_16x16x32_bf16 v[220:223], v[36:39], a[4:7], 0
ds_read_b64_tr_b16 v[30:31], v7 offset:34816
v_cmp_gt_u32 vcc, 32, v0
s_waitcnt lgkmcnt(4)
v_mfma_f32_16x16x32_bf16 v[192:195], v[40:43], a[8:11], v[192:195]
buffer_load_dwordx4 v3, s[12:15], s6 offen offset:1024 lds
ds_read_b64_tr_b16 v[32:33], v8 offset:32768
v_mfma_f32_16x16x32_bf16 v[200:203], v[40:43], a[12:15], v[200:203]
ds_read_b64_tr_b16 v[34:35], v8 offset:34816
v_cndmask_b32 v136, v136, v137, s[40:41]
v_cndmask_b32 v138, v138, v139, s[40:41]
v_mfma_f32_16x16x32_bf16 v[196:199], v[44:47], a[8:11], v[196:199]
ds_read_b64_tr_b16 v[36:37], v9 offset:32768
s_add_u32 m0, s30, 139264
s_add_u32 s6, s29, 4718720
v_mfma_f32_16x16x32_bf16 v[204:207], v[44:47], a[12:15], v[204:207]
ds_read_b64_tr_b16 v[38:39], v9 offset:34816
v_cndmask_b32 v140, v140, v141, s[40:41]
v_cndmask_b32 v142, v142, v143, s[40:41]
v_mfma_f32_16x16x32_bf16 v[208:211], v[248:251], a[8:11], v[208:211]
buffer_load_dwordx4 v2, s[12:15], s6 offen offset:0 lds
ds_read_b64_tr_b16 v[40:41], v6 offset:36864
v_mfma_f32_16x16x32_bf16 v[216:219], v[248:251], a[12:15], v[216:219]
ds_read_b64_tr_b16 v[42:43], v6 offset:38912
v_cndmask_b32 v136, v136, v138, s[56:57]
v_cndmask_b32 v140, v140, v142, s[56:57]
v_mfma_f32_16x16x32_bf16 v[212:215], v[252:255], a[8:11], v[212:215]
ds_read_b64_tr_b16 v[44:45], v7 offset:36864
v_cndmask_b32 v136, 0, v136, s[58:59]
v_cndmask_b32 v140, 0, v140, s[58:59]
v_mfma_f32_16x16x32_bf16 v[220:223], v[252:255], a[12:15], v[220:223]
ds_read_b64_tr_b16 v[46:47], v7 offset:38912
v_cndmask_b32 v128, v132, v128, vcc
s_waitcnt lgkmcnt(4)
v_mfma_f32_16x16x32_bf16 v[192:195], v[24:27], a[16:19], v[192:195]
buffer_load_dwordx4 v3, s[12:15], s6 offen offset:1024 lds
ds_read_b64_tr_b16 v[248:249], v8 offset:36864
v_mfma_f32_16x16x32_bf16 v[200:203], v[24:27], a[20:23], v[200:203]
ds_read_b64_tr_b16 v[250:251], v8 offset:38912
v_mul_f32 v128, 0xbae38e39, v128
v_permlane32_swap_b32 v136, v140
v_mfma_f32_16x16x32_bf16 v[196:199], v[28:31], a[16:19], v[196:199]
ds_read_b64_tr_b16 v[252:253], v9 offset:36864
s_add_u32 m0, s30, 0
s_add_u32 s6, s29, 256
v_mfma_f32_16x16x32_bf16 v[204:207], v[28:31], a[20:23], v[204:207]
ds_read_b64_tr_b16 v[254:255], v9 offset:38912
v_add_f32 v130, v136, v140
v_mov_b32 v131, v130
v_mfma_f32_16x16x32_bf16 v[208:211], v[32:35], a[16:19], v[208:211]
buffer_load_dwordx4 v2, s[12:15], s6 offen offset:0 lds
ds_read_b64_tr_b16 v[24:25], v6 offset:40960
v_mfma_f32_16x16x32_bf16 v[216:219], v[32:35], a[20:23], v[216:219]
ds_read_b64_tr_b16 v[26:27], v6 offset:43008
v_cvt_pk_bf16_f32 v132, v128, v128
s_mov_b32 s40, 0
v_mfma_f32_16x16x32_bf16 v[212:215], v[36:39], a[16:19], v[212:215]
ds_read_b64_tr_b16 v[28:29], v7 offset:40960
v_permlane16_swap_b32 v130, v131
v_add_f32 v130, v130, v131
v_mfma_f32_16x16x32_bf16 v[220:223], v[36:39], a[20:23], v[220:223]
ds_read_b64_tr_b16 v[30:31], v7 offset:43008
v_mul_f32 v130, 0x3ae38e39, v130
s_waitcnt lgkmcnt(4)
v_mfma_f32_16x16x32_bf16 v[192:195], v[40:43], a[24:27], v[192:195]
buffer_load_dwordx4 v3, s[12:15], s6 offen offset:1024 lds
ds_read_b64_tr_b16 v[32:33], v8 offset:40960
v_mfma_f32_16x16x32_bf16 v[200:203], v[40:43], a[28:31], v[200:203]
ds_read_b64_tr_b16 v[34:35], v8 offset:43008
v_fma_f32 v130, -v128, v128, v130
v_max_f32 v130, 0, v130
v_mfma_f32_16x16x32_bf16 v[196:199], v[44:47], a[24:27], v[196:199]
ds_read_b64_tr_b16 v[36:37], v9 offset:40960
s_add_u32 m0, s30, 8192
s_add_u32 s6, s29, 590080
v_mfma_f32_16x16x32_bf16 v[204:207], v[44:47], a[28:31], v[204:207]
ds_read_b64_tr_b16 v[38:39], v9 offset:43008
v_cvt_pk_bf16_f32 v130, v130, v130
v_and_b32 v130, s39, v130
v_mfma_f32_16x16x32_bf16 v[208:211], v[248:251], a[24:27], v[208:211]
buffer_load_dwordx4 v2, s[12:15], s6 offen offset:0 lds
ds_read_b64_tr_b16 v[40:41], v6 offset:45056
v_mfma_f32_16x16x32_bf16 v[216:219], v[248:251], a[28:31], v[216:219]
ds_read_b64_tr_b16 v[42:43], v6 offset:47104
v_add_f32 v130, 0x3727c5ac, v130
v_cvt_pk_bf16_f32 v130, v130, v130
v_mfma_f32_16x16x32_bf16 v[212:215], v[252:255], a[24:27], v[212:215]
ds_read_b64_tr_b16 v[44:45], v7 offset:45056
v_and_b32 v130, s39, v130
v_sqrt_f32 v130, v130
v_mfma_f32_16x16x32_bf16 v[220:223], v[252:255], a[28:31], v[220:223]
ds_read_b64_tr_b16 v[46:47], v7 offset:47104
v_mov_b32 v133, v132
s_waitcnt lgkmcnt(4)
v_mfma_f32_16x16x32_bf16 v[192:195], v[24:27], a[32:35], v[192:195]
buffer_load_dwordx4 v3, s[12:15], s6 offen offset:1024 lds
ds_read_b64_tr_b16 v[248:249], v8 offset:45056
v_mfma_f32_16x16x32_bf16 v[200:203], v[24:27], a[36:39], v[200:203]
ds_read_b64_tr_b16 v[250:251], v8 offset:47104
s_mov_b32 s41, 0xffff0000
v_cvt_pk_bf16_f32 v134, v130, 0
v_mfma_f32_16x16x32_bf16 v[196:199], v[28:31], a[32:35], v[196:199]
ds_read_b64_tr_b16 v[252:253], v9 offset:45056
s_add_u32 m0, s30, 16384
s_add_u32 s6, s29, 1179904
v_mfma_f32_16x16x32_bf16 v[204:207], v[28:31], a[36:39], v[204:207]
ds_read_b64_tr_b16 v[254:255], v9 offset:47104
v_permlane32_swap_b32 v132, v133
v_lshlrev_b32 v130, 16, v134
v_mfma_f32_16x16x32_bf16 v[208:211], v[32:35], a[32:35], v[208:211]
v_mfma_f32_16x16x32_bf16 v[216:219], v[32:35], a[36:39], v[216:219]
s_waitcnt vmcnt(10)
s_barrier
buffer_load_dwordx4 v2, s[12:15], s6 offen offset:0 lds
v_add_u32 v6, 49152, v6
ds_read_b64_tr_b16 v[24:25], v6 offset:0
ds_read_b64_tr_b16 v[26:27], v6 offset:2048
v_mfma_f32_16x16x32_bf16 v[212:215], v[36:39], a[32:35], v[212:215]
v_add_u32 v7, 49152, v7
ds_read_b64_tr_b16 v[28:29], v7 offset:0
v_mov_b32 v135, v134
v_mfma_f32_16x16x32_bf16 v[220:223], v[36:39], a[36:39], v[220:223]
ds_read_b64_tr_b16 v[30:31], v7 offset:2048
v_rcp_f32 v130, v130
s_waitcnt lgkmcnt(4)
v_mfma_f32_16x16x32_bf16 v[192:195], v[40:43], a[40:43], v[192:195]
buffer_load_dwordx4 v3, s[12:15], s6 offen offset:1024 lds
v_add_u32 v8, 49152, v8
ds_read_b64_tr_b16 v[32:33], v8 offset:0
v_mfma_f32_16x16x32_bf16 v[200:203], v[40:43], a[44:47], v[200:203]
ds_read_b64_tr_b16 v[34:35], v8 offset:2048
s_nop 0
v_mfma_f32_16x16x32_bf16 v[196:199], v[44:47], a[40:43], v[196:199]
v_add_u32 v9, 49152, v9
ds_read_b64_tr_b16 v[36:37], v9 offset:0
s_add_u32 m0, s30, 24576
v_mfma_f32_16x16x32_bf16 v[204:207], v[44:47], a[44:47], v[204:207]
ds_read_b64_tr_b16 v[38:39], v9 offset:2048
s_add_u32 s6, s29, 1769728
v_permlane32_swap_b32 v134, v135
v_mfma_f32_16x16x32_bf16 v[208:211], v[248:251], a[40:43], v[208:211]
buffer_load_dwordx4 v2, s[12:15], s6 offen offset:0 lds
ds_read_b64_tr_b16 v[40:41], v6 offset:4096
v_mfma_f32_16x16x32_bf16 v[216:219], v[248:251], a[44:47], v[216:219]
ds_read_b64_tr_b16 v[42:43], v6 offset:6144
v_mul_f32 v18, v130, v130
v_mul_f32 v16, v130, v130
v_mfma_f32_16x16x32_bf16 v[212:215], v[252:255], a[40:43], v[212:215]
ds_read_b64_tr_b16 v[44:45], v7 offset:4096
v_cndmask_b32 v226, v132, v134, s[40:41]
v_cndmask_b32 v231, v132, v134, s[40:41]
v_mfma_f32_16x16x32_bf16 v[220:223], v[252:255], a[44:47], v[220:223]
ds_read_b64_tr_b16 v[46:47], v7 offset:6144
v_cndmask_b32 v234, v133, v135, s[40:41]
s_waitcnt lgkmcnt(4)
v_mfma_f32_16x16x32_bf16 v[192:195], v[24:27], a[48:51], v[192:195]
buffer_load_dwordx4 v3, s[12:15], s6 offen offset:1024 lds
ds_read_b64_tr_b16 v[248:249], v8 offset:4096
v_mfma_f32_16x16x32_bf16 v[200:203], v[24:27], a[52:55], v[200:203]
ds_read_b64_tr_b16 v[250:251], v8 offset:6144
v_cndmask_b32 v239, v133, v135, s[40:41]
v_permlane32_swap_b32 v18, v16
v_mfma_f32_16x16x32_bf16 v[196:199], v[28:31], a[48:51], v[196:199]
ds_read_b64_tr_b16 v[252:253], v9 offset:4096
s_add_u32 m0, s30, 32768
v_mfma_f32_16x16x32_bf16 v[204:207], v[28:31], a[52:55], v[204:207]
ds_read_b64_tr_b16 v[254:255], v9 offset:6144
s_add_u32 s6, s29, 2359552
v_mfma_f32_16x16x32_bf16 v[160:163], v[244:247], v[226:229], v[160:163]
v_mfma_f32_16x16x32_bf16 v[164:167], v[244:247], v[230:233], v[164:167]
v_mfma_f32_16x16x32_bf16 v[176:179], v[244:247], v[224:227], v[176:179]
v_mfma_f32_16x16x32_bf16 v[180:183], v[244:247], v[228:231], v[180:183]
v_mfma_f32_16x16x32_bf16 v[168:171], v[244:247], v[234:237], v[168:171]
v_mfma_f32_16x16x32_bf16 v[172:175], v[244:247], v[238:241], v[172:175]
v_mfma_f32_16x16x32_bf16 v[184:187], v[244:247], v[232:235], v[184:187]
v_mfma_f32_16x16x32_bf16 v[188:191], v[244:247], v[236:239], v[188:191]
v_mfma_f32_16x16x32_bf16 v[208:211], v[32:35], a[48:51], v[208:211]
buffer_load_dwordx4 v2, s[12:15], s6 offen offset:0 lds
ds_read_b64_tr_b16 v[24:25], v6 offset:8192
v_mfma_f32_16x16x32_bf16 v[216:219], v[32:35], a[52:55], v[216:219]
ds_read_b64_tr_b16 v[26:27], v6 offset:10240
v_mfma_f32_16x16x32_bf16 v[212:215], v[36:39], a[48:51], v[212:215]
buffer_load_dwordx4 v[244:247], v1, s[8:11], s33 offen offset:1024 sc1
ds_read_b64_tr_b16 v[28:29], v7 offset:8192
v_mfma_f32_16x16x32_bf16 v[220:223], v[36:39], a[52:55], v[220:223]
ds_read_b64_tr_b16 v[30:31], v7 offset:10240
s_waitcnt lgkmcnt(4)
v_mfma_f32_16x16x32_bf16 v[192:195], v[40:43], a[56:59], v[192:195]
ds_read_b64_tr_b16 v[32:33], v8 offset:8192
v_mul_f32 v160, v160, |v160|
v_mul_f32 v161, v161, |v161|
v_mfma_f32_16x16x32_bf16 v[200:203], v[40:43], a[60:63], v[200:203]
ds_read_b64_tr_b16 v[34:35], v8 offset:10240
v_mul_f32 v162, v162, |v162|
v_mul_f32 v163, v163, |v163|
v_mfma_f32_16x16x32_bf16 v[196:199], v[44:47], a[56:59], v[196:199]
buffer_load_dwordx4 v3, s[12:15], s6 offen offset:1024 lds
ds_read_b64_tr_b16 v[36:37], v9 offset:8192
v_mfma_f32_16x16x32_bf16 v[204:207], v[44:47], a[60:63], v[204:207]
ds_read_b64_tr_b16 v[38:39], v9 offset:10240
v_mul_f32 v164, v164, |v164|
v_mul_f32 v165, v165, |v165|
v_mfma_f32_16x16x32_bf16 v[208:211], v[248:251], a[56:59], v[208:211]
ds_read_b64_tr_b16 v[40:41], v6 offset:12288
s_add_u32 m0, s30, 40960
s_add_u32 s6, s29, 2949376
v_mfma_f32_16x16x32_bf16 v[216:219], v[248:251], a[60:63], v[216:219]
ds_read_b64_tr_b16 v[42:43], v6 offset:14336
v_mul_f32 v166, v166, |v166|
v_mul_f32 v167, v167, |v167|
v_mfma_f32_16x16x32_bf16 v[212:215], v[252:255], a[56:59], v[212:215]
buffer_load_dwordx4 v2, s[12:15], s6 offen offset:0 lds
ds_read_b64_tr_b16 v[44:45], v7 offset:12288
v_mfma_f32_16x16x32_bf16 v[220:223], v[252:255], a[60:63], v[220:223]
ds_read_b64_tr_b16 v[46:47], v7 offset:14336
v_cvt_pk_bf16_f32 v160, v160, v161
s_waitcnt lgkmcnt(4)
v_mfma_f32_16x16x32_bf16 v[192:195], v[24:27], a[64:67], v[192:195]
ds_read_b64_tr_b16 v[248:249], v8 offset:12288
v_cvt_pk_bf16_f32 v161, v162, v163
v_cvt_pk_bf16_f32 v162, v164, v165
v_mfma_f32_16x16x32_bf16 v[200:203], v[24:27], a[68:71], v[200:203]
ds_read_b64_tr_b16 v[250:251], v8 offset:14336
v_cvt_pk_bf16_f32 v163, v166, v167
v_pk_max_i16 v48, v160, 0
v_mfma_f32_16x16x32_bf16 v[196:199], v[28:31], a[64:67], v[196:199]
buffer_load_dwordx4 v3, s[12:15], s6 offen offset:1024 lds
ds_read_b64_tr_b16 v[252:253], v9 offset:12288
v_mfma_f32_16x16x32_bf16 v[204:207], v[28:31], a[68:71], v[204:207]
ds_read_b64_tr_b16 v[254:255], v9 offset:14336
v_pk_max_i16 v49, v161, 0
v_pk_max_i16 v50, v162, 0
v_mfma_f32_16x16x32_bf16 v[208:211], v[32:35], a[64:67], v[208:211]
ds_read_b64_tr_b16 v[24:25], v6 offset:16384
v_pk_max_i16 v51, v163, 0
v_mul_f32 v168, v168, |v168|
v_mfma_f32_16x16x32_bf16 v[216:219], v[32:35], a[68:71], v[216:219]
ds_read_b64_tr_b16 v[26:27], v6 offset:18432
v_mul_f32 v169, v169, |v169|
v_mul_f32 v170, v170, |v170|
v_mfma_f32_16x16x32_bf16 v[212:215], v[36:39], a[64:67], v[212:215]
ds_read_b64_tr_b16 v[28:29], v7 offset:16384
s_add_u32 s51, s47, 0
v_mul_f32 v171, v171, |v171|
v_mfma_f32_16x16x32_bf16 v[220:223], v[36:39], a[68:71], v[220:223]
ds_read_b64_tr_b16 v[30:31], v7 offset:18432
v_mul_f32 v172, v172, |v172|
s_waitcnt lgkmcnt(4)
v_mfma_f32_16x16x32_bf16 v[192:195], v[40:43], a[72:75], v[192:195]
buffer_store_dwordx4 v[48:51], v1, s[8:11], s51 offen offset:0 sc1
ds_read_b64_tr_b16 v[32:33], v8 offset:16384
v_mfma_f32_16x16x32_bf16 v[200:203], v[40:43], a[76:79], v[200:203]
ds_read_b64_tr_b16 v[34:35], v8 offset:18432
v_mul_f32 v173, v173, |v173|
v_mul_f32 v174, v174, |v174|
v_mfma_f32_16x16x32_bf16 v[196:199], v[44:47], a[72:75], v[196:199]
ds_read_b64_tr_b16 v[36:37], v9 offset:16384
v_mul_f32 v175, v175, |v175|
v_cvt_pk_bf16_f32 v168, v168, v169
v_mfma_f32_16x16x32_bf16 v[204:207], v[44:47], a[76:79], v[204:207]
ds_read_b64_tr_b16 v[38:39], v9 offset:18432
v_cvt_pk_bf16_f32 v169, v170, v171
v_cvt_pk_bf16_f32 v170, v172, v173
v_mfma_f32_16x16x32_bf16 v[208:211], v[248:251], a[72:75], v[208:211]
ds_read_b64_tr_b16 v[40:41], v6 offset:20480
s_add_u32 m0, s30, 49152
s_add_u32 s6, s29, 3539200
v_mfma_f32_16x16x32_bf16 v[216:219], v[248:251], a[76:79], v[216:219]
ds_read_b64_tr_b16 v[42:43], v6 offset:22528
v_cvt_pk_bf16_f32 v171, v174, v175
v_pk_max_i16 v52, v168, 0
v_mfma_f32_16x16x32_bf16 v[212:215], v[252:255], a[72:75], v[212:215]
buffer_load_dwordx4 v2, s[12:15], s6 offen offset:0 lds
ds_read_b64_tr_b16 v[44:45], v7 offset:20480
v_mfma_f32_16x16x32_bf16 v[220:223], v[252:255], a[76:79], v[220:223]
ds_read_b64_tr_b16 v[46:47], v7 offset:22528
v_pk_max_i16 v53, v169, 0
s_waitcnt lgkmcnt(4)
v_mfma_f32_16x16x32_bf16 v[192:195], v[24:27], a[80:83], v[192:195]
ds_read_b64_tr_b16 v[248:249], v8 offset:20480
v_pk_max_i16 v54, v170, 0
v_pk_max_i16 v55, v171, 0
v_mfma_f32_16x16x32_bf16 v[200:203], v[24:27], a[84:87], v[200:203]
ds_read_b64_tr_b16 v[250:251], v8 offset:22528
v_mul_f32 v176, v176, |v176|
v_mul_f32 v177, v177, |v177|
v_mfma_f32_16x16x32_bf16 v[196:199], v[28:31], a[80:83], v[196:199]
ds_read_b64_tr_b16 v[252:253], v9 offset:20480
v_mul_f32 v178, v178, |v178|
v_mul_f32 v179, v179, |v179|
v_mfma_f32_16x16x32_bf16 v[204:207], v[28:31], a[84:87], v[204:207]
ds_read_b64_tr_b16 v[254:255], v9 offset:22528
v_mul_f32 v180, v180, |v180|
v_mul_f32 v181, v181, |v181|
v_mfma_f32_16x16x32_bf16 v[208:211], v[32:35], a[80:83], v[208:211]
v_mfma_f32_16x16x32_bf16 v[216:219], v[32:35], a[84:87], v[216:219]
s_waitcnt vmcnt(15)
s_barrier
buffer_load_dwordx4 v3, s[12:15], s6 offen offset:1024 lds
ds_read_b64_tr_b16 v[24:25], v6 offset:24576
ds_read_b64_tr_b16 v[26:27], v6 offset:26624
v_mfma_f32_16x16x32_bf16 v[212:215], v[36:39], a[80:83], v[212:215]
ds_read_b64_tr_b16 v[28:29], v7 offset:24576
v_mul_f32 v182, v182, |v182|
v_mul_f32 v183, v183, |v183|
v_mfma_f32_16x16x32_bf16 v[220:223], v[36:39], a[84:87], v[220:223]
ds_read_b64_tr_b16 v[30:31], v7 offset:26624
v_cvt_pk_bf16_f32 v176, v176, v177
s_waitcnt lgkmcnt(4)
v_mfma_f32_16x16x32_bf16 v[192:195], v[40:43], a[88:91], v[192:195]
buffer_store_dwordx4 v[52:55], v1, s[8:11], s51 offen offset:1024 sc1
ds_read_b64_tr_b16 v[32:33], v8 offset:24576
v_mfma_f32_16x16x32_bf16 v[200:203], v[40:43], a[92:95], v[200:203]
ds_read_b64_tr_b16 v[34:35], v8 offset:26624
v_cvt_pk_bf16_f32 v177, v178, v179
v_cvt_pk_bf16_f32 v178, v180, v181
v_mfma_f32_16x16x32_bf16 v[196:199], v[44:47], a[88:91], v[196:199]
ds_read_b64_tr_b16 v[36:37], v9 offset:24576
s_add_u32 m0, s30, 57344
s_add_u32 s6, s29, 4129024
v_mfma_f32_16x16x32_bf16 v[204:207], v[44:47], a[92:95], v[204:207]
ds_read_b64_tr_b16 v[38:39], v9 offset:26624
v_cvt_pk_bf16_f32 v179, v182, v183
v_pk_max_i16 v56, v176, 0
v_mfma_f32_16x16x32_bf16 v[208:211], v[248:251], a[88:91], v[208:211]
buffer_load_dwordx4 v2, s[12:15], s6 offen offset:0 lds
ds_read_b64_tr_b16 v[40:41], v6 offset:28672
v_mfma_f32_16x16x32_bf16 v[216:219], v[248:251], a[92:95], v[216:219]
ds_read_b64_tr_b16 v[42:43], v6 offset:30720
v_pk_max_i16 v57, v177, 0
v_pk_max_i16 v58, v178, 0
v_mfma_f32_16x16x32_bf16 v[212:215], v[252:255], a[88:91], v[212:215]
ds_read_b64_tr_b16 v[44:45], v7 offset:28672
v_pk_max_i16 v59, v179, 0
v_mul_f32 v184, v184, |v184|
v_mfma_f32_16x16x32_bf16 v[220:223], v[252:255], a[92:95], v[220:223]
ds_read_b64_tr_b16 v[46:47], v7 offset:30720
v_mul_f32 v185, v185, |v185|
s_waitcnt lgkmcnt(4)
v_mfma_f32_16x16x32_bf16 v[192:195], v[24:27], a[96:99], v[192:195]
buffer_load_dwordx4 v3, s[12:15], s6 offen offset:1024 lds
ds_read_b64_tr_b16 v[248:249], v8 offset:28672
v_mfma_f32_16x16x32_bf16 v[200:203], v[24:27], a[100:103], v[200:203]
ds_read_b64_tr_b16 v[250:251], v8 offset:30720
v_mul_f32 v186, v186, |v186|
v_mul_f32 v187, v187, |v187|
v_mfma_f32_16x16x32_bf16 v[196:199], v[28:31], a[96:99], v[196:199]
ds_read_b64_tr_b16 v[252:253], v9 offset:28672
s_add_u32 m0, s30, 65536
s_add_u32 s6, s29, 4718848
v_mfma_f32_16x16x32_bf16 v[204:207], v[28:31], a[100:103], v[204:207]
ds_read_b64_tr_b16 v[254:255], v9 offset:30720
v_mul_f32 v188, v188, |v188|
v_mul_f32 v189, v189, |v189|
v_mfma_f32_16x16x32_bf16 v[208:211], v[32:35], a[96:99], v[208:211]
buffer_load_dwordx4 v2, s[12:15], s6 offen offset:0 lds
ds_read_b64_tr_b16 v[24:25], v6 offset:32768
v_mfma_f32_16x16x32_bf16 v[216:219], v[32:35], a[100:103], v[216:219]
ds_read_b64_tr_b16 v[26:27], v6 offset:34816
v_mul_f32 v190, v190, |v190|
v_mul_f32 v191, v191, |v191|
v_mfma_f32_16x16x32_bf16 v[212:215], v[36:39], a[96:99], v[212:215]
ds_read_b64_tr_b16 v[28:29], v7 offset:32768
v_cvt_pk_bf16_f32 v184, v184, v185
v_cvt_pk_bf16_f32 v185, v186, v187
v_mfma_f32_16x16x32_bf16 v[220:223], v[36:39], a[100:103], v[220:223]
ds_read_b64_tr_b16 v[30:31], v7 offset:34816
v_cvt_pk_bf16_f32 v186, v188, v189
buffer_store_dwordx4 v[56:59], v1, s[8:11], s51 offen offset:2048 sc1
s_waitcnt lgkmcnt(4)
v_mfma_f32_16x16x32_bf16 v[192:195], v[40:43], a[104:107], v[192:195]
ds_read_b64_tr_b16 v[32:33], v8 offset:32768
v_cvt_pk_bf16_f32 v187, v190, v191
v_pk_max_i16 v60, v184, 0
v_mfma_f32_16x16x32_bf16 v[200:203], v[40:43], a[108:111], v[200:203]
ds_read_b64_tr_b16 v[34:35], v8 offset:34816
v_pk_max_i16 v61, v185, 0
v_pk_max_i16 v62, v186, 0
v_mfma_f32_16x16x32_bf16 v[196:199], v[44:47], a[104:107], v[196:199]
ds_read_b64_tr_b16 v[36:37], v9 offset:32768
v_mfma_f32_16x16x32_bf16 v[204:207], v[44:47], a[108:111], v[204:207]
ds_read_b64_tr_b16 v[38:39], v9 offset:34816
v_pk_max_i16 v63, v187, 0
v_mfma_f32_16x16x32_bf16 v[208:211], v[248:251], a[104:107], v[208:211]
buffer_load_dwordx4 v3, s[12:15], s6 offen offset:1024 lds
ds_read_b64_tr_b16 v[40:41], v6 offset:36864
v_mfma_f32_16x16x32_bf16 v[216:219], v[248:251], a[108:111], v[216:219]
ds_read_b64_tr_b16 v[42:43], v6 offset:38912
v_mfma_f32_16x16x32_bf16 v[212:215], v[252:255], a[104:107], v[212:215]
ds_read_b64_tr_b16 v[44:45], v7 offset:36864
v_mfma_f32_16x16x32_bf16 v[220:223], v[252:255], a[108:111], v[220:223]
ds_read_b64_tr_b16 v[46:47], v7 offset:38912
s_waitcnt lgkmcnt(4)
v_mfma_f32_16x16x32_bf16 v[192:195], v[24:27], a[112:115], v[192:195]
ds_read_b64_tr_b16 v[248:249], v8 offset:36864
s_add_u32 m0, s30, 73728
v_mfma_f32_16x16x32_bf16 v[200:203], v[24:27], a[116:119], v[200:203]
ds_read_b64_tr_b16 v[250:251], v8 offset:38912
s_add_u32 s6, s29, 384
v_mfma_f32_16x16x32_bf16 v[196:199], v[28:31], a[112:115], v[196:199]
buffer_load_dwordx4 v2, s[12:15], s6 offen offset:0 lds
ds_read_b64_tr_b16 v[252:253], v9 offset:36864
v_mfma_f32_16x16x32_bf16 v[204:207], v[28:31], a[116:119], v[204:207]
ds_read_b64_tr_b16 v[254:255], v9 offset:38912
v_mfma_f32_16x16x32_bf16 v[208:211], v[32:35], a[112:115], v[208:211]
ds_read_b64_tr_b16 v[24:25], v6 offset:40960
v_mfma_f32_16x16x32_bf16 v[216:219], v[32:35], a[116:119], v[216:219]
ds_read_b64_tr_b16 v[26:27], v6 offset:43008
v_mfma_f32_16x16x32_bf16 v[212:215], v[36:39], a[112:115], v[212:215]
ds_read_b64_tr_b16 v[28:29], v7 offset:40960
buffer_store_dwordx4 v[60:63], v1, s[8:11], s51 offen offset:3072 sc1
v_mfma_f32_16x16x32_bf16 v[220:223], v[36:39], a[116:119], v[220:223]
ds_read_b64_tr_b16 v[30:31], v7 offset:43008
s_waitcnt lgkmcnt(4)
v_mfma_f32_16x16x32_bf16 v[192:195], v[40:43], a[120:123], v[192:195]
ds_read_b64_tr_b16 v[32:33], v8 offset:40960
v_mfma_f32_16x16x32_bf16 v[200:203], v[40:43], a[124:127], v[200:203]
ds_read_b64_tr_b16 v[34:35], v8 offset:43008
v_mfma_f32_16x16x32_bf16 v[196:199], v[44:47], a[120:123], v[196:199]
ds_read_b64_tr_b16 v[36:37], v9 offset:40960
v_mfma_f32_16x16x32_bf16 v[204:207], v[44:47], a[124:127], v[204:207]
ds_read_b64_tr_b16 v[38:39], v9 offset:43008
v_mfma_f32_16x16x32_bf16 v[208:211], v[248:251], a[120:123], v[208:211]
ds_read_b64_tr_b16 v[40:41], v6 offset:45056
v_mfma_f32_16x16x32_bf16 v[216:219], v[248:251], a[124:127], v[216:219]
ds_read_b64_tr_b16 v[42:43], v6 offset:47104
v_mfma_f32_16x16x32_bf16 v[212:215], v[252:255], a[120:123], v[212:215]
buffer_load_dwordx4 v3, s[12:15], s6 offen offset:1024 lds
ds_read_b64_tr_b16 v[44:45], v7 offset:45056
v_mfma_f32_16x16x32_bf16 v[220:223], v[252:255], a[124:127], v[220:223]
ds_read_b64_tr_b16 v[46:47], v7 offset:47104
s_waitcnt lgkmcnt(4)
v_mfma_f32_16x16x32_bf16 v[192:195], v[24:27], a[128:131], v[192:195]
ds_read_b64_tr_b16 v[248:249], v8 offset:45056
v_mfma_f32_16x16x32_bf16 v[200:203], v[24:27], a[132:135], v[200:203]
ds_read_b64_tr_b16 v[250:251], v8 offset:47104
v_mfma_f32_16x16x32_bf16 v[196:199], v[28:31], a[128:131], v[196:199]
ds_read_b64_tr_b16 v[252:253], v9 offset:45056
s_add_u32 m0, s30, 81920
v_mfma_f32_16x16x32_bf16 v[204:207], v[28:31], a[132:135], v[204:207]
ds_read_b64_tr_b16 v[254:255], v9 offset:47104
s_add_u32 s6, s29, 590208
v_mfma_f32_16x16x32_bf16 v[208:211], v[32:35], a[128:131], v[208:211]
v_mfma_f32_16x16x32_bf16 v[216:219], v[32:35], a[132:135], v[216:219]
s_waitcnt vmcnt(19)
s_barrier
buffer_load_dwordx4 v2, s[12:15], s6 offen offset:0 lds
v_add_u32 v6, 4294868992, v6
ds_read_b64_tr_b16 v[24:25], v6 offset:0
ds_read_b64_tr_b16 v[26:27], v6 offset:2048
v_mfma_f32_16x16x32_bf16 v[212:215], v[36:39], a[128:131], v[212:215]
v_add_u32 v7, 4294868992, v7
ds_read_b64_tr_b16 v[28:29], v7 offset:0
v_mfma_f32_16x16x32_bf16 v[220:223], v[36:39], a[132:135], v[220:223]
ds_read_b64_tr_b16 v[30:31], v7 offset:2048
s_waitcnt lgkmcnt(4)
v_mfma_f32_16x16x32_bf16 v[192:195], v[40:43], a[136:139], v[192:195]
buffer_load_dwordx4 v3, s[12:15], s6 offen offset:1024 lds
v_add_u32 v8, 4294868992, v8
ds_read_b64_tr_b16 v[32:33], v8 offset:0
v_mfma_f32_16x16x32_bf16 v[200:203], v[40:43], a[140:143], v[200:203]
ds_read_b64_tr_b16 v[34:35], v8 offset:2048
v_mfma_f32_16x16x32_bf16 v[196:199], v[44:47], a[136:139], v[196:199]
v_add_u32 v9, 4294868992, v9
ds_read_b64_tr_b16 v[36:37], v9 offset:0
v_mfma_f32_16x16x32_bf16 v[204:207], v[44:47], a[140:143], v[204:207]
ds_read_b64_tr_b16 v[38:39], v9 offset:2048
s_add_u32 m0, s30, 90112
s_add_u32 s6, s29, 1180032
v_mfma_f32_16x16x32_bf16 v[208:211], v[248:251], a[136:139], v[208:211]
buffer_load_dwordx4 v2, s[12:15], s6 offen offset:0 lds
ds_read_b64_tr_b16 v[40:41], v6 offset:4096
v_mfma_f32_16x16x32_bf16 v[216:219], v[248:251], a[140:143], v[216:219]
s_branch PGB_2
.p2align 12
PSB_2:
s_setpc_b64 s[62:63]
PGB_2:
ds_read_b64_tr_b16 v[42:43], v6 offset:6144
v_mfma_f32_16x16x32_bf16 v[212:215], v[252:255], a[136:139], v[212:215]
ds_read_b64_tr_b16 v[44:45], v7 offset:4096
v_mfma_f32_16x16x32_bf16 v[220:223], v[252:255], a[140:143], v[220:223]
ds_read_b64_tr_b16 v[46:47], v7 offset:6144
s_waitcnt vmcnt(18)
v_mfma_f32_16x16x32_bf16 v[192:195], v[244:247], v[226:229], v[192:195]
v_mfma_f32_16x16x32_bf16 v[196:199], v[244:247], v[230:233], v[196:199]
v_mfma_f32_16x16x32_bf16 v[208:211], v[244:247], v[224:227], v[208:211]
v_mfma_f32_16x16x32_bf16 v[212:215], v[244:247], v[228:231], v[212:215]
v_mfma_f32_16x16x32_bf16 v[200:203], v[244:247], v[234:237], v[200:203]
v_mfma_f32_16x16x32_bf16 v[204:207], v[244:247], v[238:241], v[204:207]
v_mfma_f32_16x16x32_bf16 v[216:219], v[244:247], v[232:235], v[216:219]
v_mfma_f32_16x16x32_bf16 v[220:223], v[244:247], v[236:239], v[220:223]
s_waitcnt lgkmcnt(4)
v_mfma_f32_16x16x32_bf16 v[128:131], v[24:27], a[0:3], 0
buffer_load_dwordx4 v3, s[12:15], s6 offen offset:1024 lds
ds_read_b64_tr_b16 v[248:249], v8 offset:4096
v_mfma_f32_16x16x32_bf16 v[136:139], v[24:27], a[4:7], 0
ds_read_b64_tr_b16 v[250:251], v8 offset:6144
v_mfma_f32_16x16x32_bf16 v[132:135], v[28:31], a[0:3], 0
ds_read_b64_tr_b16 v[252:253], v9 offset:4096
v_mfma_f32_16x16x32_bf16 v[140:143], v[28:31], a[4:7], 0
ds_read_b64_tr_b16 v[254:255], v9 offset:6144
v_mfma_f32_16x16x32_bf16 v[144:147], v[32:35], a[0:3], 0
buffer_load_dwordx4 v[244:247], v1, s[8:11], s33 offen offset:2048 sc1
ds_read_b64_tr_b16 v[24:25], v6 offset:8192
v_mfma_f32_16x16x32_bf16 v[152:155], v[32:35], a[4:7], 0
ds_read_b64_tr_b16 v[26:27], v6 offset:10240
v_mul_f32 v192, v192, |v192|
v_mfma_f32_16x16x32_bf16 v[148:151], v[36:39], a[0:3], 0
ds_read_b64_tr_b16 v[28:29], v7 offset:8192
v_mul_f32 v193, v193, |v193|
v_mfma_f32_16x16x32_bf16 v[156:159], v[36:39], a[4:7], 0
ds_read_b64_tr_b16 v[30:31], v7 offset:10240
v_mul_f32 v194, v194, |v194|
s_waitcnt lgkmcnt(4)
v_mfma_f32_16x16x32_bf16 v[128:131], v[40:43], a[8:11], v[128:131]
ds_read_b64_tr_b16 v[32:33], v8 offset:8192
s_add_u32 m0, s30, 98304
v_mfma_f32_16x16x32_bf16 v[136:139], v[40:43], a[12:15], v[136:139]
ds_read_b64_tr_b16 v[34:35], v8 offset:10240
s_add_u32 s6, s29, 1769856
v_mul_f32 v195, v195, |v195|
v_mfma_f32_16x16x32_bf16 v[132:135], v[44:47], a[8:11], v[132:135]
buffer_load_dwordx4 v2, s[12:15], s6 offen offset:0 lds
ds_read_b64_tr_b16 v[36:37], v9 offset:8192
v_mfma_f32_16x16x32_bf16 v[140:143], v[44:47], a[12:15], v[140:143]
ds_read_b64_tr_b16 v[38:39], v9 offset:10240
v_mul_f32 v196, v196, |v196|
v_mfma_f32_16x16x32_bf16 v[144:147], v[248:251], a[8:11], v[144:147]
ds_read_b64_tr_b16 v[40:41], v6 offset:12288
v_mul_f32 v197, v197, |v197|
v_mfma_f32_16x16x32_bf16 v[152:155], v[248:251], a[12:15], v[152:155]
ds_read_b64_tr_b16 v[42:43], v6 offset:14336
v_mul_f32 v198, v198, |v198|
v_mul_f32 v199, v199, |v199|
v_mfma_f32_16x16x32_bf16 v[148:151], v[252:255], a[8:11], v[148:151]
ds_read_b64_tr_b16 v[44:45], v7 offset:12288
v_cvt_pk_bf16_f32 v192, v192, v193
v_mfma_f32_16x16x32_bf16 v[156:159], v[252:255], a[12:15], v[156:159]
ds_read_b64_tr_b16 v[46:47], v7 offset:14336
v_cvt_pk_bf16_f32 v193, v194, v195
s_waitcnt lgkmcnt(4)
v_mfma_f32_16x16x32_bf16 v[128:131], v[24:27], a[16:19], v[128:131]
buffer_load_dwordx4 v3, s[12:15], s6 offen offset:1024 lds
ds_read_b64_tr_b16 v[248:249], v8 offset:12288
v_mfma_f32_16x16x32_bf16 v[136:139], v[24:27], a[20:23], v[136:139]
ds_read_b64_tr_b16 v[250:251], v8 offset:14336
v_cvt_pk_bf16_f32 v194, v196, v197
v_mfma_f32_16x16x32_bf16 v[132:135], v[28:31], a[16:19], v[132:135]
ds_read_b64_tr_b16 v[252:253], v9 offset:12288
v_cvt_pk_bf16_f32 v195, v198, v199
v_mfma_f32_16x16x32_bf16 v[140:143], v[28:31], a[20:23], v[140:143]
ds_read_b64_tr_b16 v[254:255], v9 offset:14336
v_pk_max_i16 v64, v192, 0
v_pk_max_i16 v65, v193, 0
v_mfma_f32_16x16x32_bf16 v[144:147], v[32:35], a[16:19], v[144:147]
ds_read_b64_tr_b16 v[24:25], v6 offset:16384
s_add_u32 m0, s30, 106496
v_mfma_f32_16x16x32_bf16 v[152:155], v[32:35], a[20:23], v[152:155]
ds_read_b64_tr_b16 v[26:27], v6 offset:18432
s_add_u32 s6, s29, 2359680
v_pk_max_i16 v66, v194, 0
v_mfma_f32_16x16x32_bf16 v[148:151], v[36:39], a[16:19], v[148:151]
buffer_load_dwordx4 v2, s[12:15], s6 offen offset:0 lds
ds_read_b64_tr_b16 v[28:29], v7 offset:16384
v_mfma_f32_16x16x32_bf16 v[156:159], v[36:39], a[20:23], v[156:159]
ds_read_b64_tr_b16 v[30:31], v7 offset:18432
s_waitcnt lgkmcnt(4)
v_mfma_f32_16x16x32_bf16 v[128:131], v[40:43], a[24:27], v[128:131]
ds_read_b64_tr_b16 v[32:33], v8 offset:16384
v_pk_max_i16 v67, v195, 0
v_mfma_f32_16x16x32_bf16 v[136:139], v[40:43], a[28:31], v[136:139]
ds_read_b64_tr_b16 v[34:35], v8 offset:18432
v_mul_f32 v200, v200, |v200|
v_mul_f32 v201, v201, |v201|
v_mfma_f32_16x16x32_bf16 v[132:135], v[44:47], a[24:27], v[132:135]
ds_read_b64_tr_b16 v[36:37], v9 offset:16384
s_add_u32 s51, s47, 16384
v_mfma_f32_16x16x32_bf16 v[140:143], v[44:47], a[28:31], v[140:143]
ds_read_b64_tr_b16 v[38:39], v9 offset:18432
v_mul_f32 v202, v202, |v202|
v_mul_f32 v203, v203, |v203|
v_mfma_f32_16x16x32_bf16 v[144:147], v[248:251], a[24:27], v[144:147]
buffer_store_dwordx4 v[64:67], v1, s[8:11], s51 offen offset:0 sc1
ds_read_b64_tr_b16 v[40:41], v6 offset:20480
v_mfma_f32_16x16x32_bf16 v[152:155], v[248:251], a[28:31], v[152:155]
ds_read_b64_tr_b16 v[42:43], v6 offset:22528
v_mul_f32 v204, v204, |v204|
v_mfma_f32_16x16x32_bf16 v[148:151], v[252:255], a[24:27], v[148:151]
ds_read_b64_tr_b16 v[44:45], v7 offset:20480
v_mul_f32 v205, v205, |v205|
v_mfma_f32_16x16x32_bf16 v[156:159], v[252:255], a[28:31], v[156:159]
ds_read_b64_tr_b16 v[46:47], v7 offset:22528
v_mul_f32 v206, v206, |v206|
s_waitcnt lgkmcnt(4)
v_mfma_f32_16x16x32_bf16 v[128:131], v[24:27], a[32:35], v[128:131]
ds_read_b64_tr_b16 v[248:249], v8 offset:20480
v_mul_f32 v207, v207, |v207|
v_mfma_f32_16x16x32_bf16 v[136:139], v[24:27], a[36:39], v[136:139]
ds_read_b64_tr_b16 v[250:251], v8 offset:22528
v_cvt_pk_bf16_f32 v200, v200, v201
v_cvt_pk_bf16_f32 v201, v202, v203
v_mfma_f32_16x16x32_bf16 v[132:135], v[28:31], a[32:35], v[132:135]
buffer_load_dwordx4 v3, s[12:15], s6 offen offset:1024 lds
ds_read_b64_tr_b16 v[252:253], v9 offset:20480
v_mfma_f32_16x16x32_bf16 v[140:143], v[28:31], a[36:39], v[140:143]
ds_read_b64_tr_b16 v[254:255], v9 offset:22528
v_cvt_pk_bf16_f32 v202, v204, v205
v_mfma_f32_16x16x32_bf16 v[144:147], v[32:35], a[32:35], v[144:147]
v_mfma_f32_16x16x32_bf16 v[152:155], v[32:35], a[36:39], v[152:155]
s_waitcnt vmcnt(22)
s_barrier
ds_read_b64_tr_b16 v[24:25], v6 offset:24576
ds_read_b64_tr_b16 v[26:27], v6 offset:26624
s_add_u32 m0, s30, 114688
s_add_u32 s6, s29, 2949504
v_mfma_f32_16x16x32_bf16 v[148:151], v[36:39], a[32:35], v[148:151]
buffer_load_dwordx4 v2, s[12:15], s6 offen offset:0 lds
ds_read_b64_tr_b16 v[28:29], v7 offset:24576
v_mfma_f32_16x16x32_bf16 v[156:159], v[36:39], a[36:39], v[156:159]
ds_read_b64_tr_b16 v[30:31], v7 offset:26624
s_waitcnt lgkmcnt(4)
v_mfma_f32_16x16x32_bf16 v[128:131], v[40:43], a[40:43], v[128:131]
ds_read_b64_tr_b16 v[32:33], v8 offset:24576
v_cvt_pk_bf16_f32 v203, v206, v207
v_mfma_f32_16x16x32_bf16 v[136:139], v[40:43], a[44:47], v[136:139]
ds_read_b64_tr_b16 v[34:35], v8 offset:26624
v_pk_max_i16 v68, v200, 0
v_pk_max_i16 v69, v201, 0
v_mfma_f32_16x16x32_bf16 v[132:135], v[44:47], a[40:43], v[132:135]
buffer_load_dwordx4 v3, s[12:15], s6 offen offset:1024 lds
ds_read_b64_tr_b16 v[36:37], v9 offset:24576
v_mfma_f32_16x16x32_bf16 v[140:143], v[44:47], a[44:47], v[140:143]
ds_read_b64_tr_b16 v[38:39], v9 offset:26624
v_pk_max_i16 v70, v202, 0
v_mfma_f32_16x16x32_bf16 v[144:147], v[248:251], a[40:43], v[144:147]
ds_read_b64_tr_b16 v[40:41], v6 offset:28672
v_pk_max_i16 v71, v203, 0
v_mfma_f32_16x16x32_bf16 v[152:155], v[248:251], a[44:47], v[152:155]
ds_read_b64_tr_b16 v[42:43], v6 offset:30720
v_mul_f32 v208, v208, |v208|
v_mul_f32 v209, v209, |v209|
v_mfma_f32_16x16x32_bf16 v[148:151], v[252:255], a[40:43], v[148:151]
ds_read_b64_tr_b16 v[44:45], v7 offset:28672
v_mul_f32 v210, v210, |v210|
v_mfma_f32_16x16x32_bf16 v[156:159], v[252:255], a[44:47], v[156:159]
ds_read_b64_tr_b16 v[46:47], v7 offset:30720
v_mul_f32 v211, v211, |v211|
s_waitcnt lgkmcnt(4)
v_mfma_f32_16x16x32_bf16 v[128:131], v[24:27], a[48:51], v[128:131]
buffer_store_dwordx4 v[68:71], v1, s[8:11], s51 offen offset:1024 sc1
ds_read_b64_tr_b16 v[248:249], v8 offset:28672
v_mfma_f32_16x16x32_bf16 v[136:139], v[24:27], a[52:55], v[136:139]
ds_read_b64_tr_b16 v[250:251], v8 offset:30720
v_mul_f32 v212, v212, |v212|
v_mfma_f32_16x16x32_bf16 v[132:135], v[28:31], a[48:51], v[132:135]
ds_read_b64_tr_b16 v[252:253], v9 offset:28672
v_mul_f32 v213, v213, |v213|
v_mfma_f32_16x16x32_bf16 v[140:143], v[28:31], a[52:55], v[140:143]
ds_read_b64_tr_b16 v[254:255], v9 offset:30720
v_mul_f32 v214, v214, |v214|
v_mul_f32 v215, v215, |v215|
v_mfma_f32_16x16x32_bf16 v[144:147], v[32:35], a[48:51], v[144:147]
ds_read_b64_tr_b16 v[24:25], v6 offset:32768
s_add_u32 m0, s30, 122880
v_mfma_f32_16x16x32_bf16 v[152:155], v[32:35], a[52:55], v[152:155]
ds_read_b64_tr_b16 v[26:27], v6 offset:34816
s_add_u32 s6, s29, 3539328
v_cvt_pk_bf16_f32 v208, v208, v209
v_mfma_f32_16x16x32_bf16 v[148:151], v[36:39], a[48:51], v[148:151]
buffer_load_dwordx4 v2, s[12:15], s6 offen offset:0 lds
ds_read_b64_tr_b16 v[28:29], v7 offset:32768
v_mfma_f32_16x16x32_bf16 v[156:159], v[36:39], a[52:55], v[156:159]
ds_read_b64_tr_b16 v[30:31], v7 offset:34816
s_waitcnt lgkmcnt(4)
v_mfma_f32_16x16x32_bf16 v[128:131], v[40:43], a[56:59], v[128:131]
ds_read_b64_tr_b16 v[32:33], v8 offset:32768
v_cvt_pk_bf16_f32 v209, v210, v211
v_mfma_f32_16x16x32_bf16 v[136:139], v[40:43], a[60:63], v[136:139]
ds_read_b64_tr_b16 v[34:35], v8 offset:34816
v_cvt_pk_bf16_f32 v210, v212, v213
v_cvt_pk_bf16_f32 v211, v214, v215
v_mfma_f32_16x16x32_bf16 v[132:135], v[44:47], a[56:59], v[132:135]
ds_read_b64_tr_b16 v[36:37], v9 offset:32768
v_pk_max_i16 v72, v208, 0
v_mfma_f32_16x16x32_bf16 v[140:143], v[44:47], a[60:63], v[140:143]
ds_read_b64_tr_b16 v[38:39], v9 offset:34816
v_pk_max_i16 v73, v209, 0
v_pk_max_i16 v74, v210, 0
v_mfma_f32_16x16x32_bf16 v[144:147], v[248:251], a[56:59], v[144:147]
buffer_load_dwordx4 v3, s[12:15], s6 offen offset:1024 lds
ds_read_b64_tr_b16 v[40:41], v6 offset:36864
v_mfma_f32_16x16x32_bf16 v[152:155], v[248:251], a[60:63], v[152:155]
ds_read_b64_tr_b16 v[42:43], v6 offset:38912
v_pk_max_i16 v75, v211, 0
v_mfma_f32_16x16x32_bf16 v[148:151], v[252:255], a[56:59], v[148:151]
ds_read_b64_tr_b16 v[44:45], v7 offset:36864
v_mul_f32 v216, v216, |v216|
v_mfma_f32_16x16x32_bf16 v[156:159], v[252:255], a[60:63], v[156:159]
ds_read_b64_tr_b16 v[46:47], v7 offset:38912
v_mul_f32 v217, v217, |v217|
s_waitcnt lgkmcnt(4)
v_mfma_f32_16x16x32_bf16 v[128:131], v[24:27], a[64:67], v[128:131]
buffer_store_dwordx4 v[72:75], v1, s[8:11], s51 offen offset:2048 sc1
ds_read_b64_tr_b16 v[248:249], v8 offset:36864
v_mfma_f32_16x16x32_bf16 v[136:139], v[24:27], a[68:71], v[136:139]
ds_read_b64_tr_b16 v[250:251], v8 offset:38912
v_mul_f32 v218, v218, |v218|
v_mfma_f32_16x16x32_bf16 v[132:135], v[28:31], a[64:67], v[132:135]
ds_read_b64_tr_b16 v[252:253], v9 offset:36864
v_mul_f32 v219, v219, |v219|
v_mfma_f32_16x16x32_bf16 v[140:143], v[28:31], a[68:71], v[140:143]
ds_read_b64_tr_b16 v[254:255], v9 offset:38912
v_mul_f32 v220, v220, |v220|
v_mul_f32 v221, v221, |v221|
v_mfma_f32_16x16x32_bf16 v[144:147], v[32:35], a[64:67], v[144:147]
ds_read_b64_tr_b16 v[24:25], v6 offset:40960
s_add_u32 m0, s30, 131072
v_mfma_f32_16x16x32_bf16 v[152:155], v[32:35], a[68:71], v[152:155]
ds_read_b64_tr_b16 v[26:27], v6 offset:43008
s_add_u32 s6, s29, 4129152
v_mul_f32 v222, v222, |v222|
v_mfma_f32_16x16x32_bf16 v[148:151], v[36:39], a[64:67], v[148:151]
buffer_load_dwordx4 v2, s[12:15], s6 offen offset:0 lds
ds_read_b64_tr_b16 v[28:29], v7 offset:40960
v_mfma_f32_16x16x32_bf16 v[156:159], v[36:39], a[68:71], v[156:159]
ds_read_b64_tr_b16 v[30:31], v7 offset:43008
s_waitcnt lgkmcnt(4)
v_mfma_f32_16x16x32_bf16 v[128:131], v[40:43], a[72:75], v[128:131]
ds_read_b64_tr_b16 v[32:33], v8 offset:40960
v_mul_f32 v223, v223, |v223|
v_mfma_f32_16x16x32_bf16 v[136:139], v[40:43], a[76:79], v[136:139]
ds_read_b64_tr_b16 v[34:35], v8 offset:43008
v_cvt_pk_bf16_f32 v216, v216, v217
v_cvt_pk_bf16_f32 v217, v218, v219
v_mfma_f32_16x16x32_bf16 v[132:135], v[44:47], a[72:75], v[132:135]
ds_read_b64_tr_b16 v[36:37], v9 offset:40960
v_cvt_pk_bf16_f32 v218, v220, v221
v_mfma_f32_16x16x32_bf16 v[140:143], v[44:47], a[76:79], v[140:143]
ds_read_b64_tr_b16 v[38:39], v9 offset:43008
v_cvt_pk_bf16_f32 v219, v222, v223
v_pk_max_i16 v76, v216, 0
v_mfma_f32_16x16x32_bf16 v[144:147], v[248:251], a[72:75], v[144:147]
v_mfma_f32_16x16x32_bf16 v[152:155], v[248:251], a[76:79], v[152:155]
s_waitcnt vmcnt(18)
buffer_store_dword v15, off, s[8:11], s37 offset:128 sc1
ds_read_b64_tr_b16 v[40:41], v6 offset:45056
ds_read_b64_tr_b16 v[42:43], v6 offset:47104
v_mfma_f32_16x16x32_bf16 v[148:151], v[252:255], a[72:75], v[148:151]
ds_read_b64_tr_b16 v[44:45], v7 offset:45056
v_pk_max_i16 v77, v217, 0
v_mfma_f32_16x16x32_bf16 v[156:159], v[252:255], a[76:79], v[156:159]
ds_read_b64_tr_b16 v[46:47], v7 offset:47104
v_pk_max_i16 v78, v218, 0
s_waitcnt lgkmcnt(4)
v_mfma_f32_16x16x32_bf16 v[128:131], v[24:27], a[80:83], v[128:131]
ds_read_b64_tr_b16 v[248:249], v8 offset:45056
v_mfma_f32_16x16x32_bf16 v[136:139], v[24:27], a[84:87], v[136:139]
ds_read_b64_tr_b16 v[250:251], v8 offset:47104
v_pk_max_i16 v79, v219, 0
v_mfma_f32_16x16x32_bf16 v[132:135], v[28:31], a[80:83], v[132:135]
buffer_load_dwordx4 v3, s[12:15], s6 offen offset:1024 lds
ds_read_b64_tr_b16 v[252:253], v9 offset:45056
v_mfma_f32_16x16x32_bf16 v[140:143], v[28:31], a[84:87], v[140:143]
ds_read_b64_tr_b16 v[254:255], v9 offset:47104
v_mfma_f32_16x16x32_bf16 v[144:147], v[32:35], a[80:83], v[144:147]
v_mfma_f32_16x16x32_bf16 v[152:155], v[32:35], a[84:87], v[152:155]
s_barrier
buffer_store_dwordx4 v[76:79], v1, s[8:11], s51 offen offset:3072 sc1
v_add_u32 v6, 49152, v6
ds_read_b64_tr_b16 v[24:25], v6 offset:0
ds_read_b64_tr_b16 v[26:27], v6 offset:2048
v_mfma_f32_16x16x32_bf16 v[148:151], v[36:39], a[80:83], v[148:151]
v_add_u32 v7, 49152, v7
ds_read_b64_tr_b16 v[28:29], v7 offset:0
s_add_u32 m0, s30, 139264
v_mfma_f32_16x16x32_bf16 v[156:159], v[36:39], a[84:87], v[156:159]
ds_read_b64_tr_b16 v[30:31], v7 offset:2048
s_add_u32 s6, s29, 4718976
s_waitcnt lgkmcnt(4)
v_mfma_f32_16x16x32_bf16 v[128:131], v[40:43], a[88:91], v[128:131]
buffer_load_dwordx4 v2, s[12:15], s6 offen offset:0 lds
v_add_u32 v8, 49152, v8
ds_read_b64_tr_b16 v[32:33], v8 offset:0
v_mfma_f32_16x16x32_bf16 v[136:139], v[40:43], a[92:95], v[136:139]
ds_read_b64_tr_b16 v[34:35], v8 offset:2048
v_mfma_f32_16x16x32_bf16 v[132:135], v[44:47], a[88:91], v[132:135]
v_add_u32 v9, 49152, v9
ds_read_b64_tr_b16 v[36:37], v9 offset:0
v_mfma_f32_16x16x32_bf16 v[140:143], v[44:47], a[92:95], v[140:143]
ds_read_b64_tr_b16 v[38:39], v9 offset:2048
v_mfma_f32_16x16x32_bf16 v[144:147], v[248:251], a[88:91], v[144:147]
buffer_load_dwordx4 v3, s[12:15], s6 offen offset:1024 lds
ds_read_b64_tr_b16 v[40:41], v6 offset:4096
v_mfma_f32_16x16x32_bf16 v[152:155], v[248:251], a[92:95], v[152:155]
ds_read_b64_tr_b16 v[42:43], v6 offset:6144
v_mfma_f32_16x16x32_bf16 v[148:151], v[252:255], a[88:91], v[148:151]
ds_read_b64_tr_b16 v[44:45], v7 offset:4096
v_mfma_f32_16x16x32_bf16 v[156:159], v[252:255], a[92:95], v[156:159]
ds_read_b64_tr_b16 v[46:47], v7 offset:6144
s_waitcnt lgkmcnt(4)
v_mfma_f32_16x16x32_bf16 v[128:131], v[24:27], a[96:99], v[128:131]
ds_read_b64_tr_b16 v[248:249], v8 offset:4096
s_add_u32 m0, s30, 0
v_mfma_f32_16x16x32_bf16 v[136:139], v[24:27], a[100:103], v[136:139]
ds_read_b64_tr_b16 v[250:251], v8 offset:6144
s_add_u32 s6, s29, 512
v_mfma_f32_16x16x32_bf16 v[132:135], v[28:31], a[96:99], v[132:135]
buffer_load_dwordx4 v2, s[12:15], s6 offen offset:0 lds
ds_read_b64_tr_b16 v[252:253], v9 offset:4096
v_mfma_f32_16x16x32_bf16 v[140:143], v[28:31], a[100:103], v[140:143]
ds_read_b64_tr_b16 v[254:255], v9 offset:6144
v_mfma_f32_16x16x32_bf16 v[144:147], v[32:35], a[96:99], v[144:147]
ds_read_b64_tr_b16 v[24:25], v6 offset:8192
v_mfma_f32_16x16x32_bf16 v[152:155], v[32:35], a[100:103], v[152:155]
ds_read_b64_tr_b16 v[26:27], v6 offset:10240
v_mfma_f32_16x16x32_bf16 v[148:151], v[36:39], a[96:99], v[148:151]
ds_read_b64_tr_b16 v[28:29], v7 offset:8192
v_mfma_f32_16x16x32_bf16 v[156:159], v[36:39], a[100:103], v[156:159]
ds_read_b64_tr_b16 v[30:31], v7 offset:10240
s_waitcnt lgkmcnt(4)
v_mfma_f32_16x16x32_bf16 v[128:131], v[40:43], a[104:107], v[128:131]
buffer_load_dwordx4 v3, s[12:15], s6 offen offset:1024 lds
ds_read_b64_tr_b16 v[32:33], v8 offset:8192
v_mfma_f32_16x16x32_bf16 v[136:139], v[40:43], a[108:111], v[136:139]
ds_read_b64_tr_b16 v[34:35], v8 offset:10240
v_mfma_f32_16x16x32_bf16 v[132:135], v[44:47], a[104:107], v[132:135]
ds_read_b64_tr_b16 v[36:37], v9 offset:8192
v_mfma_f32_16x16x32_bf16 v[140:143], v[44:47], a[108:111], v[140:143]
ds_read_b64_tr_b16 v[38:39], v9 offset:10240
v_mfma_f32_16x16x32_bf16 v[144:147], v[248:251], a[104:107], v[144:147]
ds_read_b64_tr_b16 v[40:41], v6 offset:12288
s_add_u32 m0, s30, 8192
v_mfma_f32_16x16x32_bf16 v[152:155], v[248:251], a[108:111], v[152:155]
ds_read_b64_tr_b16 v[42:43], v6 offset:14336
s_add_u32 s6, s29, 590336
v_mfma_f32_16x16x32_bf16 v[148:151], v[252:255], a[104:107], v[148:151]
buffer_load_dwordx4 v2, s[12:15], s6 offen offset:0 lds
ds_read_b64_tr_b16 v[44:45], v7 offset:12288
v_mfma_f32_16x16x32_bf16 v[156:159], v[252:255], a[108:111], v[156:159]
ds_read_b64_tr_b16 v[46:47], v7 offset:14336
s_waitcnt lgkmcnt(4)
v_mfma_f32_16x16x32_bf16 v[128:131], v[24:27], a[112:115], v[128:131]
ds_read_b64_tr_b16 v[248:249], v8 offset:12288
v_mfma_f32_16x16x32_bf16 v[136:139], v[24:27], a[116:119], v[136:139]
ds_read_b64_tr_b16 v[250:251], v8 offset:14336
v_mfma_f32_16x16x32_bf16 v[132:135], v[28:31], a[112:115], v[132:135]
ds_read_b64_tr_b16 v[252:253], v9 offset:12288
v_mfma_f32_16x16x32_bf16 v[140:143], v[28:31], a[116:119], v[140:143]
ds_read_b64_tr_b16 v[254:255], v9 offset:14336
v_mfma_f32_16x16x32_bf16 v[144:147], v[32:35], a[112:115], v[144:147]
buffer_load_dwordx4 v3, s[12:15], s6 offen offset:1024 lds
ds_read_b64_tr_b16 v[24:25], v6 offset:16384
v_mfma_f32_16x16x32_bf16 v[152:155], v[32:35], a[116:119], v[152:155]
ds_read_b64_tr_b16 v[26:27], v6 offset:18432
v_mfma_f32_16x16x32_bf16 v[148:151], v[36:39], a[112:115], v[148:151]
ds_read_b64_tr_b16 v[28:29], v7 offset:16384
v_mfma_f32_16x16x32_bf16 v[156:159], v[36:39], a[116:119], v[156:159]
ds_read_b64_tr_b16 v[30:31], v7 offset:18432
s_waitcnt lgkmcnt(4)
v_mfma_f32_16x16x32_bf16 v[128:131], v[40:43], a[120:123], v[128:131]
ds_read_b64_tr_b16 v[32:33], v8 offset:16384
s_add_u32 m0, s30, 16384
v_mfma_f32_16x16x32_bf16 v[136:139], v[40:43], a[124:127], v[136:139]
ds_read_b64_tr_b16 v[34:35], v8 offset:18432
s_add_u32 s6, s29, 1180160
v_mfma_f32_16x16x32_bf16 v[132:135], v[44:47], a[120:123], v[132:135]
buffer_load_dwordx4 v2, s[12:15], s6 offen offset:0 lds
ds_read_b64_tr_b16 v[36:37], v9 offset:16384
v_mfma_f32_16x16x32_bf16 v[140:143], v[44:47], a[124:127], v[140:143]
ds_read_b64_tr_b16 v[38:39], v9 offset:18432
v_mfma_f32_16x16x32_bf16 v[144:147], v[248:251], a[120:123], v[144:147]
ds_read_b64_tr_b16 v[40:41], v6 offset:20480
v_mfma_f32_16x16x32_bf16 v[152:155], v[248:251], a[124:127], v[152:155]
ds_read_b64_tr_b16 v[42:43], v6 offset:22528
v_mfma_f32_16x16x32_bf16 v[148:151], v[252:255], a[120:123], v[148:151]
ds_read_b64_tr_b16 v[44:45], v7 offset:20480
v_mfma_f32_16x16x32_bf16 v[156:159], v[252:255], a[124:127], v[156:159]
ds_read_b64_tr_b16 v[46:47], v7 offset:22528
s_waitcnt lgkmcnt(4)
v_mfma_f32_16x16x32_bf16 v[128:131], v[24:27], a[128:131], v[128:131]
buffer_load_dwordx4 v3, s[12:15], s6 offen offset:1024 lds
ds_read_b64_tr_b16 v[248:249], v8 offset:20480
v_mfma_f32_16x16x32_bf16 v[136:139], v[24:27], a[132:135], v[136:139]
ds_read_b64_tr_b16 v[250:251], v8 offset:22528
v_mfma_f32_16x16x32_bf16 v[132:135], v[28:31], a[128:131], v[132:135]
ds_read_b64_tr_b16 v[252:253], v9 offset:20480
v_mfma_f32_16x16x32_bf16 v[140:143], v[28:31], a[132:135], v[140:143]
ds_read_b64_tr_b16 v[254:255], v9 offset:22528
v_mfma_f32_16x16x32_bf16 v[144:147], v[32:35], a[128:131], v[144:147]
v_mfma_f32_16x16x32_bf16 v[152:155], v[32:35], a[132:135], v[152:155]
s_waitcnt vmcnt(24)
s_barrier
ds_read_b64_tr_b16 v[24:25], v6 offset:24576
ds_read_b64_tr_b16 v[26:27], v6 offset:26624
s_add_u32 m0, s30, 24576
s_add_u32 s6, s29, 1769984
v_mfma_f32_16x16x32_bf16 v[148:151], v[36:39], a[128:131], v[148:151]
buffer_load_dwordx4 v2, s[12:15], s6 offen offset:0 lds
ds_read_b64_tr_b16 v[28:29], v7 offset:24576
v_mfma_f32_16x16x32_bf16 v[156:159], v[36:39], a[132:135], v[156:159]
ds_read_b64_tr_b16 v[30:31], v7 offset:26624
s_waitcnt lgkmcnt(4)
v_mfma_f32_16x16x32_bf16 v[128:131], v[40:43], a[136:139], v[128:131]
ds_read_b64_tr_b16 v[32:33], v8 offset:24576
v_mfma_f32_16x16x32_bf16 v[136:139], v[40:43], a[140:143], v[136:139]
ds_read_b64_tr_b16 v[34:35], v8 offset:26624
v_mfma_f32_16x16x32_bf16 v[132:135], v[44:47], a[136:139], v[132:135]
ds_read_b64_tr_b16 v[36:37], v9 offset:24576
v_mfma_f32_16x16x32_bf16 v[140:143], v[44:47], a[140:143], v[140:143]
ds_read_b64_tr_b16 v[38:39], v9 offset:26624
v_mfma_f32_16x16x32_bf16 v[144:147], v[248:251], a[136:139], v[144:147]
buffer_load_dwordx4 v3, s[12:15], s6 offen offset:1024 lds
ds_read_b64_tr_b16 v[40:41], v6 offset:28672
v_mfma_f32_16x16x32_bf16 v[152:155], v[248:251], a[140:143], v[152:155]
ds_read_b64_tr_b16 v[42:43], v6 offset:30720
v_mfma_f32_16x16x32_bf16 v[148:151], v[252:255], a[136:139], v[148:151]
ds_read_b64_tr_b16 v[44:45], v7 offset:28672
v_mfma_f32_16x16x32_bf16 v[156:159], v[252:255], a[140:143], v[156:159]
ds_read_b64_tr_b16 v[46:47], v7 offset:30720
s_waitcnt vmcnt(25)
v_mfma_f32_16x16x32_bf16 v[128:131], v[244:247], v[226:229], v[128:131]
v_mfma_f32_16x16x32_bf16 v[132:135], v[244:247], v[230:233], v[132:135]
v_mfma_f32_16x16x32_bf16 v[144:147], v[244:247], v[224:227], v[144:147]
v_mfma_f32_16x16x32_bf16 v[148:151], v[244:247], v[228:231], v[148:151]
v_mfma_f32_16x16x32_bf16 v[136:139], v[244:247], v[234:237], v[136:139]
v_mfma_f32_16x16x32_bf16 v[140:143], v[244:247], v[238:241], v[140:143]
v_mfma_f32_16x16x32_bf16 v[152:155], v[244:247], v[232:235], v[152:155]
v_mfma_f32_16x16x32_bf16 v[156:159], v[244:247], v[236:239], v[156:159]
s_waitcnt lgkmcnt(4)
v_mfma_f32_16x16x32_bf16 v[160:163], v[24:27], a[0:3], 0
ds_read_b64_tr_b16 v[248:249], v8 offset:28672
v_mfma_f32_16x16x32_bf16 v[168:171], v[24:27], a[4:7], 0
ds_read_b64_tr_b16 v[250:251], v8 offset:30720
v_mfma_f32_16x16x32_bf16 v[164:167], v[28:31], a[0:3], 0
buffer_load_dwordx4 v[244:247], v1, s[8:11], s33 offen offset:3072 sc1
ds_read_b64_tr_b16 v[252:253], v9 offset:28672
v_mfma_f32_16x16x32_bf16 v[172:175], v[28:31], a[4:7], 0
ds_read_b64_tr_b16 v[254:255], v9 offset:30720
v_mfma_f32_16x16x32_bf16 v[176:179], v[32:35], a[0:3], 0
ds_read_b64_tr_b16 v[24:25], v6 offset:32768
v_mul_f32 v128, v128, |v128|
v_mfma_f32_16x16x32_bf16 v[184:187], v[32:35], a[4:7], 0
ds_read_b64_tr_b16 v[26:27], v6 offset:34816
v_mul_f32 v129, v129, |v129|
v_mul_f32 v130, v130, |v130|
v_mfma_f32_16x16x32_bf16 v[180:183], v[36:39], a[0:3], 0
ds_read_b64_tr_b16 v[28:29], v7 offset:32768
s_add_u32 m0, s30, 32768
v_mfma_f32_16x16x32_bf16 v[188:191], v[36:39], a[4:7], 0
ds_read_b64_tr_b16 v[30:31], v7 offset:34816
s_add_u32 s6, s29, 2359808
s_waitcnt lgkmcnt(4)
v_mfma_f32_16x16x32_bf16 v[160:163], v[40:43], a[8:11], v[160:163]
buffer_load_dwordx4 v2, s[12:15], s6 offen offset:0 lds
ds_read_b64_tr_b16 v[32:33], v8 offset:32768
v_mfma_f32_16x16x32_bf16 v[168:171], v[40:43], a[12:15], v[168:171]
ds_read_b64_tr_b16 v[34:35], v8 offset:34816
v_mul_f32 v131, v131, |v131|
v_mfma_f32_16x16x32_bf16 v[164:167], v[44:47], a[8:11], v[164:167]
ds_read_b64_tr_b16 v[36:37], v9 offset:32768
v_mul_f32 v132, v132, |v132|
v_mfma_f32_16x16x32_bf16 v[172:175], v[44:47], a[12:15], v[172:175]
ds_read_b64_tr_b16 v[38:39], v9 offset:34816
v_mul_f32 v133, v133, |v133|
v_mul_f32 v134, v134, |v134|
v_mfma_f32_16x16x32_bf16 v[176:179], v[248:251], a[8:11], v[176:179]
ds_read_b64_tr_b16 v[40:41], v6 offset:36864
v_mul_f32 v135, v135, |v135|
v_mfma_f32_16x16x32_bf16 v[184:187], v[248:251], a[12:15], v[184:187]
ds_read_b64_tr_b16 v[42:43], v6 offset:38912
v_cvt_pk_bf16_f32 v128, v128, v129
v_cvt_pk_bf16_f32 v129, v130, v131
v_mfma_f32_16x16x32_bf16 v[180:183], v[252:255], a[8:11], v[180:183]
buffer_load_dwordx4 v3, s[12:15], s6 offen offset:1024 lds
ds_read_b64_tr_b16 v[44:45], v7 offset:36864
v_mfma_f32_16x16x32_bf16 v[188:191], v[252:255], a[12:15], v[188:191]
ds_read_b64_tr_b16 v[46:47], v7 offset:38912
s_waitcnt lgkmcnt(4)
v_mfma_f32_16x16x32_bf16 v[160:163], v[24:27], a[16:19], v[160:163]
ds_read_b64_tr_b16 v[248:249], v8 offset:36864
v_cvt_pk_bf16_f32 v130, v132, v133
v_mfma_f32_16x16x32_bf16 v[168:171], v[24:27], a[20:23], v[168:171]
ds_read_b64_tr_b16 v[250:251], v8 offset:38912
v_cvt_pk_bf16_f32 v131, v134, v135
v_pk_max_i16 v80, v128, 0
v_mfma_f32_16x16x32_bf16 v[164:167], v[28:31], a[16:19], v[164:167]
s_branch PGB_3
.p2align 12
PSB_3:
s_setpc_b64 s[62:63]
PGB_3:
ds_read_b64_tr_b16 v[252:253], v9 offset:36864
s_add_u32 m0, s30, 40960
v_mfma_f32_16x16x32_bf16 v[172:175], v[28:31], a[20:23], v[172:175]
ds_read_b64_tr_b16 v[254:255], v9 offset:38912
s_add_u32 s6, s29, 2949632
v_pk_max_i16 v81, v129, 0
v_mfma_f32_16x16x32_bf16 v[176:179], v[32:35], a[16:19], v[176:179]
buffer_load_dwordx4 v2, s[12:15], s6 offen offset:0 lds
ds_read_b64_tr_b16 v[24:25], v6 offset:40960
v_mfma_f32_16x16x32_bf16 v[184:187], v[32:35], a[20:23], v[184:187]
ds_read_b64_tr_b16 v[26:27], v6 offset:43008
v_pk_max_i16 v82, v130, 0
v_mfma_f32_16x16x32_bf16 v[180:183], v[36:39], a[16:19], v[180:183]
ds_read_b64_tr_b16 v[28:29], v7 offset:40960
v_pk_max_i16 v83, v131, 0
v_mfma_f32_16x16x32_bf16 v[188:191], v[36:39], a[20:23], v[188:191]
ds_read_b64_tr_b16 v[30:31], v7 offset:43008
v_mul_f32 v136, v136, |v136|
s_waitcnt lgkmcnt(4)
v_mfma_f32_16x16x32_bf16 v[160:163], v[40:43], a[24:27], v[160:163]
ds_read_b64_tr_b16 v[32:33], v8 offset:40960
s_add_u32 s51, s47, 32768
v_mfma_f32_16x16x32_bf16 v[168:171], v[40:43], a[28:31], v[168:171]
ds_read_b64_tr_b16 v[34:35], v8 offset:43008
v_mul_f32 v137, v137, |v137|
v_mul_f32 v138, v138, |v138|
v_mfma_f32_16x16x32_bf16 v[164:167], v[44:47], a[24:27], v[164:167]
buffer_store_dwordx4 v[80:83], v1, s[8:11], s51 offen offset:0 sc1
ds_read_b64_tr_b16 v[36:37], v9 offset:40960
v_mfma_f32_16x16x32_bf16 v[172:175], v[44:47], a[28:31], v[172:175]
ds_read_b64_tr_b16 v[38:39], v9 offset:43008
v_mul_f32 v139, v139, |v139|
v_mfma_f32_16x16x32_bf16 v[176:179], v[248:251], a[24:27], v[176:179]
ds_read_b64_tr_b16 v[40:41], v6 offset:45056
v_mul_f32 v140, v140, |v140|
v_mfma_f32_16x16x32_bf16 v[184:187], v[248:251], a[28:31], v[184:187]
ds_read_b64_tr_b16 v[42:43], v6 offset:47104
v_mul_f32 v141, v141, |v141|
v_mul_f32 v142, v142, |v142|
v_mfma_f32_16x16x32_bf16 v[180:183], v[252:255], a[24:27], v[180:183]
ds_read_b64_tr_b16 v[44:45], v7 offset:45056
v_mul_f32 v143, v143, |v143|
v_mfma_f32_16x16x32_bf16 v[188:191], v[252:255], a[28:31], v[188:191]
ds_read_b64_tr_b16 v[46:47], v7 offset:47104
v_cvt_pk_bf16_f32 v136, v136, v137
s_waitcnt lgkmcnt(4)
v_mfma_f32_16x16x32_bf16 v[160:163], v[24:27], a[32:35], v[160:163]
buffer_load_dwordx4 v3, s[12:15], s6 offen offset:1024 lds
ds_read_b64_tr_b16 v[248:249], v8 offset:45056
v_mfma_f32_16x16x32_bf16 v[168:171], v[24:27], a[36:39], v[168:171]
ds_read_b64_tr_b16 v[250:251], v8 offset:47104
v_cvt_pk_bf16_f32 v137, v138, v139
v_mfma_f32_16x16x32_bf16 v[164:167], v[28:31], a[32:35], v[164:167]
ds_read_b64_tr_b16 v[252:253], v9 offset:45056
v_cvt_pk_bf16_f32 v138, v140, v141
v_mfma_f32_16x16x32_bf16 v[172:175], v[28:31], a[36:39], v[172:175]
ds_read_b64_tr_b16 v[254:255], v9 offset:47104
v_cvt_pk_bf16_f32 v139, v142, v143
v_pk_max_i16 v84, v136, 0
v_mfma_f32_16x16x32_bf16 v[176:179], v[32:35], a[32:35], v[176:179]
v_mfma_f32_16x16x32_bf16 v[184:187], v[32:35], a[36:39], v[184:187]
s_waitcnt vmcnt(24)
s_barrier
v_add_u32 v6, 49152, v6
ds_read_b64_tr_b16 v[24:25], v6 offset:0
ds_read_b64_tr_b16 v[26:27], v6 offset:2048
s_add_u32 m0, s30, 49152
s_add_u32 s6, s29, 3539456
v_mfma_f32_16x16x32_bf16 v[180:183], v[36:39], a[32:35], v[180:183]
buffer_load_dwordx4 v2, s[12:15], s6 offen offset:0 lds
v_add_u32 v7, 49152, v7
ds_read_b64_tr_b16 v[28:29], v7 offset:0
v_mfma_f32_16x16x32_bf16 v[188:191], v[36:39], a[36:39], v[188:191]
ds_read_b64_tr_b16 v[30:31], v7 offset:2048
s_waitcnt lgkmcnt(4)
v_mfma_f32_16x16x32_bf16 v[160:163], v[40:43], a[40:43], v[160:163]
v_mfma_f32_16x16x32_bf16 v[168:171], v[40:43], a[44:47], v[168:171]
s_waitcnt vmcnt(17)
buffer_store_dword v15, off, s[8:11], s37 offset:256 sc1
v_add_u32 v8, 49152, v8
ds_read_b64_tr_b16 v[32:33], v8 offset:0
ds_read_b64_tr_b16 v[34:35], v8 offset:2048
v_mfma_f32_16x16x32_bf16 v[164:167], v[44:47], a[40:43], v[164:167]
v_add_u32 v9, 49152, v9
ds_read_b64_tr_b16 v[36:37], v9 offset:0
v_mfma_f32_16x16x32_bf16 v[172:175], v[44:47], a[44:47], v[172:175]
ds_read_b64_tr_b16 v[38:39], v9 offset:2048
v_pk_max_i16 v85, v137, 0
v_pk_max_i16 v86, v138, 0
v_mfma_f32_16x16x32_bf16 v[176:179], v[248:251], a[40:43], v[176:179]
ds_read_b64_tr_b16 v[40:41], v6 offset:4096
s_load_dwordx4 s[56:59], s[8:9], s36 offset:128 glc
v_mfma_f32_16x16x32_bf16 v[184:187], v[248:251], a[44:47], v[184:187]
ds_read_b64_tr_b16 v[42:43], v6 offset:6144
v_pk_max_i16 v87, v139, 0
v_mul_f32 v144, v144, |v144|
v_mfma_f32_16x16x32_bf16 v[180:183], v[252:255], a[40:43], v[180:183]
buffer_load_dwordx4 v3, s[12:15], s6 offen offset:1024 lds
ds_read_b64_tr_b16 v[44:45], v7 offset:4096
v_mfma_f32_16x16x32_bf16 v[188:191], v[252:255], a[44:47], v[188:191]
ds_read_b64_tr_b16 v[46:47], v7 offset:6144
s_waitcnt lgkmcnt(4)
v_mfma_f32_16x16x32_bf16 v[160:163], v[24:27], a[48:51], v[160:163]
buffer_store_dwordx4 v[84:87], v1, s[8:11], s51 offen offset:1024 sc1
ds_read_b64_tr_b16 v[248:249], v8 offset:4096
v_mfma_f32_16x16x32_bf16 v[168:171], v[24:27], a[52:55], v[168:171]
ds_read_b64_tr_b16 v[250:251], v8 offset:6144
v_mul_f32 v145, v145, |v145|
v_mfma_f32_16x16x32_bf16 v[164:167], v[28:31], a[48:51], v[164:167]
ds_read_b64_tr_b16 v[252:253], v9 offset:4096
v_mul_f32 v146, v146, |v146|
v_mfma_f32_16x16x32_bf16 v[172:175], v[28:31], a[52:55], v[172:175]
ds_read_b64_tr_b16 v[254:255], v9 offset:6144
v_mul_f32 v147, v147, |v147|
v_mul_f32 v148, v148, |v148|
v_mfma_f32_16x16x32_bf16 v[176:179], v[32:35], a[48:51], v[176:179]
ds_read_b64_tr_b16 v[24:25], v6 offset:8192
s_add_u32 m0, s30, 57344
v_mfma_f32_16x16x32_bf16 v[184:187], v[32:35], a[52:55], v[184:187]
ds_read_b64_tr_b16 v[26:27], v6 offset:10240
s_add_u32 s6, s29, 4129280
v_mul_f32 v149, v149, |v149|
v_mfma_f32_16x16x32_bf16 v[180:183], v[36:39], a[48:51], v[180:183]
buffer_load_dwordx4 v2, s[12:15], s6 offen offset:0 lds
ds_read_b64_tr_b16 v[28:29], v7 offset:8192
v_mfma_f32_16x16x32_bf16 v[188:191], v[36:39], a[52:55], v[188:191]
ds_read_b64_tr_b16 v[30:31], v7 offset:10240
s_waitcnt lgkmcnt(4)
v_mfma_f32_16x16x32_bf16 v[160:163], v[40:43], a[56:59], v[160:163]
ds_read_b64_tr_b16 v[32:33], v8 offset:8192
v_mul_f32 v150, v150, |v150|
v_mfma_f32_16x16x32_bf16 v[168:171], v[40:43], a[60:63], v[168:171]
ds_read_b64_tr_b16 v[34:35], v8 offset:10240
v_mul_f32 v151, v151, |v151|
v_cvt_pk_bf16_f32 v144, v144, v145
v_mfma_f32_16x16x32_bf16 v[164:167], v[44:47], a[56:59], v[164:167]
ds_read_b64_tr_b16 v[36:37], v9 offset:8192
v_cvt_pk_bf16_f32 v145, v146, v147
v_mfma_f32_16x16x32_bf16 v[172:175], v[44:47], a[60:63], v[172:175]
ds_read_b64_tr_b16 v[38:39], v9 offset:10240
v_cvt_pk_bf16_f32 v146, v148, v149
v_cvt_pk_bf16_f32 v147, v150, v151
v_mfma_f32_16x16x32_bf16 v[176:179], v[248:251], a[56:59], v[176:179]
buffer_load_dwordx4 v3, s[12:15], s6 offen offset:1024 lds
ds_read_b64_tr_b16 v[40:41], v6 offset:12288
v_mfma_f32_16x16x32_bf16 v[184:187], v[248:251], a[60:63], v[184:187]
ds_read_b64_tr_b16 v[42:43], v6 offset:14336
v_pk_max_i16 v88, v144, 0
v_mfma_f32_16x16x32_bf16 v[180:183], v[252:255], a[56:59], v[180:183]
ds_read_b64_tr_b16 v[44:45], v7 offset:12288
v_pk_max_i16 v89, v145, 0
v_mfma_f32_16x16x32_bf16 v[188:191], v[252:255], a[60:63], v[188:191]
ds_read_b64_tr_b16 v[46:47], v7 offset:14336
v_pk_max_i16 v90, v146, 0
s_waitcnt lgkmcnt(4)
v_mfma_f32_16x16x32_bf16 v[160:163], v[24:27], a[64:67], v[160:163]
ds_read_b64_tr_b16 v[248:249], v8 offset:12288
s_add_u32 m0, s30, 65536
v_mfma_f32_16x16x32_bf16 v[168:171], v[24:27], a[68:71], v[168:171]
ds_read_b64_tr_b16 v[250:251], v8 offset:14336
s_add_u32 s6, s29, 4719104
v_pk_max_i16 v91, v147, 0
v_mfma_f32_16x16x32_bf16 v[164:167], v[28:31], a[64:67], v[164:167]
buffer_load_dwordx4 v2, s[12:15], s6 offen offset:0 lds
ds_read_b64_tr_b16 v[252:253], v9 offset:12288
v_mfma_f32_16x16x32_bf16 v[172:175], v[28:31], a[68:71], v[172:175]
ds_read_b64_tr_b16 v[254:255], v9 offset:14336
v_mul_f32 v152, v152, |v152|
v_mfma_f32_16x16x32_bf16 v[176:179], v[32:35], a[64:67], v[176:179]
buffer_store_dwordx4 v[88:91], v1, s[8:11], s51 offen offset:2048 sc1
ds_read_b64_tr_b16 v[24:25], v6 offset:16384
v_mfma_f32_16x16x32_bf16 v[184:187], v[32:35], a[68:71], v[184:187]
ds_read_b64_tr_b16 v[26:27], v6 offset:18432
v_mul_f32 v153, v153, |v153|
v_mfma_f32_16x16x32_bf16 v[180:183], v[36:39], a[64:67], v[180:183]
ds_read_b64_tr_b16 v[28:29], v7 offset:16384
v_mul_f32 v154, v154, |v154|
v_mfma_f32_16x16x32_bf16 v[188:191], v[36:39], a[68:71], v[188:191]
ds_read_b64_tr_b16 v[30:31], v7 offset:18432
v_mul_f32 v155, v155, |v155|
s_waitcnt lgkmcnt(4)
v_mfma_f32_16x16x32_bf16 v[160:163], v[40:43], a[72:75], v[160:163]
ds_read_b64_tr_b16 v[32:33], v8 offset:16384
v_mul_f32 v156, v156, |v156|
v_mfma_f32_16x16x32_bf16 v[168:171], v[40:43], a[76:79], v[168:171]
ds_read_b64_tr_b16 v[34:35], v8 offset:18432
v_mul_f32 v157, v157, |v157|
v_mul_f32 v158, v158, |v158|
v_mfma_f32_16x16x32_bf16 v[164:167], v[44:47], a[72:75], v[164:167]
buffer_load_dwordx4 v3, s[12:15], s6 offen offset:1024 lds
ds_read_b64_tr_b16 v[36:37], v9 offset:16384
v_mfma_f32_16x16x32_bf16 v[172:175], v[44:47], a[76:79], v[172:175]
ds_read_b64_tr_b16 v[38:39], v9 offset:18432
v_mul_f32 v159, v159, |v159|
v_mfma_f32_16x16x32_bf16 v[176:179], v[248:251], a[72:75], v[176:179]
ds_read_b64_tr_b16 v[40:41], v6 offset:20480
v_cvt_pk_bf16_f32 v152, v152, v153
v_mfma_f32_16x16x32_bf16 v[184:187], v[248:251], a[76:79], v[184:187]
ds_read_b64_tr_b16 v[42:43], v6 offset:22528
v_cvt_pk_bf16_f32 v153, v154, v155
v_cvt_pk_bf16_f32 v154, v156, v157
v_mfma_f32_16x16x32_bf16 v[180:183], v[252:255], a[72:75], v[180:183]
ds_read_b64_tr_b16 v[44:45], v7 offset:20480
v_cvt_pk_bf16_f32 v155, v158, v159
v_mfma_f32_16x16x32_bf16 v[188:191], v[252:255], a[76:79], v[188:191]
ds_read_b64_tr_b16 v[46:47], v7 offset:22528
v_pk_max_i16 v92, v152, 0
s_waitcnt lgkmcnt(0)
v_mfma_f32_16x16x32_bf16 v[160:163], v[24:27], a[80:83], v[160:163]
ds_read_b64_tr_b16 v[248:249], v8 offset:20480
s_xor_b64 s[56:57], s[56:57], s[0:1]
s_xor_b64 s[58:59], s[58:59], s[0:1]
s_or_b64 s[56:57], s[56:57], s[58:59]
v_mfma_f32_16x16x32_bf16 v[168:171], v[24:27], a[84:87], v[168:171]
ds_read_b64_tr_b16 v[250:251], v8 offset:22528
s_cbranch_scc1 K3B_slow1
K3B_back1:
s_add_u32 s7, s48, 0
v_mfma_f32_16x16x32_bf16 v[164:167], v[28:31], a[80:83], v[164:167]
buffer_load_dwordx4 a[144:147], v1, s[8:11], s7 offen offset:0 sc1
ds_read_b64_tr_b16 v[252:253], v9 offset:20480
v_mfma_f32_16x16x32_bf16 v[172:175], v[28:31], a[84:87], v[172:175]
ds_read_b64_tr_b16 v[254:255], v9 offset:22528
v_pk_max_i16 v93, v153, 0
v_mfma_f32_16x16x32_bf16 v[176:179], v[32:35], a[80:83], v[176:179]
v_mfma_f32_16x16x32_bf16 v[184:187], v[32:35], a[84:87], v[184:187]
s_waitcnt vmcnt(24)
s_barrier
ds_read_b64_tr_b16 v[24:25], v6 offset:24576
ds_read_b64_tr_b16 v[26:27], v6 offset:26624
v_mfma_f32_16x16x32_bf16 v[180:183], v[36:39], a[80:83], v[180:183]
ds_read_b64_tr_b16 v[28:29], v7 offset:24576
v_pk_max_i16 v94, v154, 0
v_mfma_f32_16x16x32_bf16 v[188:191], v[36:39], a[84:87], v[188:191]
ds_read_b64_tr_b16 v[30:31], v7 offset:26624
v_pk_max_i16 v95, v155, 0
s_waitcnt lgkmcnt(4)
v_mfma_f32_16x16x32_bf16 v[160:163], v[40:43], a[88:91], v[160:163]
buffer_load_dwordx4 a[148:151], v1, s[8:11], s7 offen offset:1024 sc1
ds_read_b64_tr_b16 v[32:33], v8 offset:24576
v_mfma_f32_16x16x32_bf16 v[168:171], v[40:43], a[92:95], v[168:171]
ds_read_b64_tr_b16 v[34:35], v8 offset:26624
v_mfma_f32_16x16x32_bf16 v[164:167], v[44:47], a[88:91], v[164:167]
buffer_store_dwordx4 v[92:95], v1, s[8:11], s51 offen offset:3072 sc1
ds_read_b64_tr_b16 v[36:37], v9 offset:24576
v_mfma_f32_16x16x32_bf16 v[172:175], v[44:47], a[92:95], v[172:175]
ds_read_b64_tr_b16 v[38:39], v9 offset:26624
v_mfma_f32_16x16x32_bf16 v[176:179], v[248:251], a[88:91], v[176:179]
ds_read_b64_tr_b16 v[40:41], v6 offset:28672
v_mfma_f32_16x16x32_bf16 v[184:187], v[248:251], a[92:95], v[184:187]
ds_read_b64_tr_b16 v[42:43], v6 offset:30720
v_mfma_f32_16x16x32_bf16 v[180:183], v[252:255], a[88:91], v[180:183]
ds_read_b64_tr_b16 v[44:45], v7 offset:28672
v_mfma_f32_16x16x32_bf16 v[188:191], v[252:255], a[92:95], v[188:191]
ds_read_b64_tr_b16 v[46:47], v7 offset:30720
s_waitcnt lgkmcnt(4)
v_mfma_f32_16x16x32_bf16 v[160:163], v[24:27], a[96:99], v[160:163]
buffer_load_dwordx4 a[152:155], v1, s[8:11], s7 offen offset:2048 sc1
ds_read_b64_tr_b16 v[248:249], v8 offset:28672
v_mfma_f32_16x16x32_bf16 v[168:171], v[24:27], a[100:103], v[168:171]
ds_read_b64_tr_b16 v[250:251], v8 offset:30720
v_mfma_f32_16x16x32_bf16 v[164:167], v[28:31], a[96:99], v[164:167]
ds_read_b64_tr_b16 v[252:253], v9 offset:28672
v_mfma_f32_16x16x32_bf16 v[172:175], v[28:31], a[100:103], v[172:175]
ds_read_b64_tr_b16 v[254:255], v9 offset:30720
v_mfma_f32_16x16x32_bf16 v[176:179], v[32:35], a[96:99], v[176:179]
ds_read_b64_tr_b16 v[24:25], v6 offset:32768
v_mfma_f32_16x16x32_bf16 v[184:187], v[32:35], a[100:103], v[184:187]
ds_read_b64_tr_b16 v[26:27], v6 offset:34816
v_mfma_f32_16x16x32_bf16 v[180:183], v[36:39], a[96:99], v[180:183]
buffer_load_dwordx4 a[156:159], v1, s[8:11], s7 offen offset:3072 sc1
ds_read_b64_tr_b16 v[28:29], v7 offset:32768
v_mfma_f32_16x16x32_bf16 v[188:191], v[36:39], a[100:103], v[188:191]
ds_read_b64_tr_b16 v[30:31], v7 offset:34816
s_waitcnt lgkmcnt(4)
v_mfma_f32_16x16x32_bf16 v[160:163], v[40:43], a[104:107], v[160:163]
ds_read_b64_tr_b16 v[32:33], v8 offset:32768
v_mfma_f32_16x16x32_bf16 v[168:171], v[40:43], a[108:111], v[168:171]
ds_read_b64_tr_b16 v[34:35], v8 offset:34816
v_mfma_f32_16x16x32_bf16 v[164:167], v[44:47], a[104:107], v[164:167]
ds_read_b64_tr_b16 v[36:37], v9 offset:32768
v_mfma_f32_16x16x32_bf16 v[172:175], v[44:47], a[108:111], v[172:175]
ds_read_b64_tr_b16 v[38:39], v9 offset:34816
s_add_u32 s7, s49, 0
v_mfma_f32_16x16x32_bf16 v[176:179], v[248:251], a[104:107], v[176:179]
buffer_load_dwordx4 a[160:163], v1, s[8:11], s7 offen offset:0 sc1
ds_read_b64_tr_b16 v[40:41], v6 offset:36864
v_mfma_f32_16x16x32_bf16 v[184:187], v[248:251], a[108:111], v[184:187]
ds_read_b64_tr_b16 v[42:43], v6 offset:38912
v_mfma_f32_16x16x32_bf16 v[180:183], v[252:255], a[104:107], v[180:183]
ds_read_b64_tr_b16 v[44:45], v7 offset:36864
v_mfma_f32_16x16x32_bf16 v[188:191], v[252:255], a[108:111], v[188:191]
ds_read_b64_tr_b16 v[46:47], v7 offset:38912
s_waitcnt lgkmcnt(4)
v_mfma_f32_16x16x32_bf16 v[160:163], v[24:27], a[112:115], v[160:163]
ds_read_b64_tr_b16 v[248:249], v8 offset:36864
v_mfma_f32_16x16x32_bf16 v[168:171], v[24:27], a[116:119], v[168:171]
ds_read_b64_tr_b16 v[250:251], v8 offset:38912
v_mfma_f32_16x16x32_bf16 v[164:167], v[28:31], a[112:115], v[164:167]
buffer_load_dwordx4 a[164:167], v1, s[8:11], s7 offen offset:1024 sc1
ds_read_b64_tr_b16 v[252:253], v9 offset:36864
v_mfma_f32_16x16x32_bf16 v[172:175], v[28:31], a[116:119], v[172:175]
ds_read_b64_tr_b16 v[254:255], v9 offset:38912
v_mfma_f32_16x16x32_bf16 v[176:179], v[32:35], a[112:115], v[176:179]
ds_read_b64_tr_b16 v[24:25], v6 offset:40960
v_mfma_f32_16x16x32_bf16 v[184:187], v[32:35], a[116:119], v[184:187]
ds_read_b64_tr_b16 v[26:27], v6 offset:43008
v_mfma_f32_16x16x32_bf16 v[180:183], v[36:39], a[112:115], v[180:183]
ds_read_b64_tr_b16 v[28:29], v7 offset:40960
v_mfma_f32_16x16x32_bf16 v[188:191], v[36:39], a[116:119], v[188:191]
ds_read_b64_tr_b16 v[30:31], v7 offset:43008
s_waitcnt lgkmcnt(4)
v_mfma_f32_16x16x32_bf16 v[160:163], v[40:43], a[120:123], v[160:163]
buffer_load_dwordx4 a[168:171], v1, s[8:11], s7 offen offset:2048 sc1
ds_read_b64_tr_b16 v[32:33], v8 offset:40960
v_mfma_f32_16x16x32_bf16 v[168:171], v[40:43], a[124:127], v[168:171]
ds_read_b64_tr_b16 v[34:35], v8 offset:43008
v_mfma_f32_16x16x32_bf16 v[164:167], v[44:47], a[120:123], v[164:167]
ds_read_b64_tr_b16 v[36:37], v9 offset:40960
v_mfma_f32_16x16x32_bf16 v[172:175], v[44:47], a[124:127], v[172:175]
ds_read_b64_tr_b16 v[38:39], v9 offset:43008
v_mfma_f32_16x16x32_bf16 v[176:179], v[248:251], a[120:123], v[176:179]
ds_read_b64_tr_b16 v[40:41], v6 offset:45056
v_mfma_f32_16x16x32_bf16 v[184:187], v[248:251], a[124:127], v[184:187]
ds_read_b64_tr_b16 v[42:43], v6 offset:47104
v_mfma_f32_16x16x32_bf16 v[180:183], v[252:255], a[120:123], v[180:183]
buffer_load_dwordx4 a[172:175], v1, s[8:11], s7 offen offset:3072 sc1
ds_read_b64_tr_b16 v[44:45], v7 offset:45056
v_mfma_f32_16x16x32_bf16 v[188:191], v[252:255], a[124:127], v[188:191]
ds_read_b64_tr_b16 v[46:47], v7 offset:47104
s_waitcnt lgkmcnt(4)
v_mfma_f32_16x16x32_bf16 v[160:163], v[24:27], a[128:131], v[160:163]
ds_read_b64_tr_b16 v[248:249], v8 offset:45056
v_mfma_f32_16x16x32_bf16 v[168:171], v[24:27], a[132:135], v[168:171]
ds_read_b64_tr_b16 v[250:251], v8 offset:47104
v_mfma_f32_16x16x32_bf16 v[164:167], v[28:31], a[128:131], v[164:167]
ds_read_b64_tr_b16 v[252:253], v9 offset:45056
v_mfma_f32_16x16x32_bf16 v[172:175], v[28:31], a[132:135], v[172:175]
ds_read_b64_tr_b16 v[254:255], v9 offset:47104
s_add_u32 s7, s34, 294912
v_mfma_f32_16x16x32_bf16 v[176:179], v[32:35], a[128:131], v[176:179]
v_mfma_f32_16x16x32_bf16 v[184:187], v[32:35], a[132:135], v[184:187]
s_waitcnt vmcnt(26)
s_barrier
buffer_load_dwordx4 a[176:179], v1, s[8:11], s7 offen offset:0 sc1
v_add_u32 v6, 4294868992, v6
ds_read_b64_tr_b16 v[24:25], v6 offset:0
ds_read_b64_tr_b16 v[26:27], v6 offset:2048
v_mfma_f32_16x16x32_bf16 v[180:183], v[36:39], a[128:131], v[180:183]
v_add_u32 v7, 4294868992, v7
ds_read_b64_tr_b16 v[28:29], v7 offset:0
v_mfma_f32_16x16x32_bf16 v[188:191], v[36:39], a[132:135], v[188:191]
ds_read_b64_tr_b16 v[30:31], v7 offset:2048
s_waitcnt lgkmcnt(4)
v_mfma_f32_16x16x32_bf16 v[160:163], v[40:43], a[136:139], v[160:163]
buffer_load_dwordx4 a[180:183], v1, s[8:11], s7 offen offset:1024 sc1
v_add_u32 v8, 4294868992, v8
ds_read_b64_tr_b16 v[32:33], v8 offset:0
v_mfma_f32_16x16x32_bf16 v[168:171], v[40:43], a[140:143], v[168:171]
ds_read_b64_tr_b16 v[34:35], v8 offset:2048
v_mfma_f32_16x16x32_bf16 v[164:167], v[44:47], a[136:139], v[164:167]
v_add_u32 v9, 4294868992, v9
ds_read_b64_tr_b16 v[36:37], v9 offset:0
v_mfma_f32_16x16x32_bf16 v[172:175], v[44:47], a[140:143], v[172:175]
ds_read_b64_tr_b16 v[38:39], v9 offset:2048
s_add_u32 m0, s30, 73728
s_add_u32 s6, s96, 0
v_mfma_f32_16x16x32_bf16 v[176:179], v[248:251], a[136:139], v[176:179]
buffer_load_dwordx4 v4, s[16:19], s6 offen offset:0 lds
ds_read_b64_tr_b16 v[40:41], v6 offset:4096
v_mfma_f32_16x16x32_bf16 v[184:187], v[248:251], a[140:143], v[184:187]
ds_read_b64_tr_b16 v[42:43], v6 offset:6144
v_mfma_f32_16x16x32_bf16 v[180:183], v[252:255], a[136:139], v[180:183]
ds_read_b64_tr_b16 v[44:45], v7 offset:4096
v_mfma_f32_16x16x32_bf16 v[188:191], v[252:255], a[140:143], v[188:191]
ds_read_b64_tr_b16 v[46:47], v7 offset:6144
s_waitcnt vmcnt(26)
v_mfma_f32_16x16x32_bf16 v[160:163], v[244:247], v[226:229], v[160:163]
v_mfma_f32_16x16x32_bf16 v[164:167], v[244:247], v[230:233], v[164:167]
v_mfma_f32_16x16x32_bf16 v[176:179], v[244:247], v[224:227], v[176:179]
v_mfma_f32_16x16x32_bf16 v[180:183], v[244:247], v[228:231], v[180:183]
v_mfma_f32_16x16x32_bf16 v[168:171], v[244:247], v[234:237], v[168:171]
v_mfma_f32_16x16x32_bf16 v[172:175], v[244:247], v[238:241], v[172:175]
v_mfma_f32_16x16x32_bf16 v[184:187], v[244:247], v[232:235], v[184:187]
v_mfma_f32_16x16x32_bf16 v[188:191], v[244:247], v[236:239], v[188:191]
s_waitcnt lgkmcnt(4)
v_mfma_f32_16x16x32_bf16 v[128:131], v[24:27], a[0:3], 0
buffer_load_dwordx4 v5, s[16:19], s6 offen offset:1024 lds
ds_read_b64_tr_b16 v[248:249], v8 offset:4096
v_mfma_f32_16x16x32_bf16 v[136:139], v[24:27], a[4:7], 0
ds_read_b64_tr_b16 v[250:251], v8 offset:6144
v_mfma_f32_16x16x32_bf16 v[132:135], v[28:31], a[0:3], 0
ds_read_b64_tr_b16 v[252:253], v9 offset:4096
v_mfma_f32_16x16x32_bf16 v[140:143], v[28:31], a[4:7], 0
ds_read_b64_tr_b16 v[254:255], v9 offset:6144
v_mfma_f32_16x16x32_bf16 v[144:147], v[32:35], a[0:3], 0
buffer_load_dwordx4 v[244:247], v1, s[8:11], s50 offen offset:0 sc1
ds_read_b64_tr_b16 v[24:25], v6 offset:8192
v_mfma_f32_16x16x32_bf16 v[152:155], v[32:35], a[4:7], 0
ds_read_b64_tr_b16 v[26:27], v6 offset:10240
v_mul_f32 v160, v160, |v160|
v_mfma_f32_16x16x32_bf16 v[148:151], v[36:39], a[0:3], 0
ds_read_b64_tr_b16 v[28:29], v7 offset:8192
s_add_u32 m0, s30, 81920
v_mfma_f32_16x16x32_bf16 v[156:159], v[36:39], a[4:7], 0
ds_read_b64_tr_b16 v[30:31], v7 offset:10240
s_add_u32 s6, s96, 73728
s_waitcnt lgkmcnt(4)
v_mfma_f32_16x16x32_bf16 v[128:131], v[40:43], a[8:11], v[128:131]
buffer_load_dwordx4 v4, s[16:19], s6 offen offset:0 lds
ds_read_b64_tr_b16 v[32:33], v8 offset:8192
v_mfma_f32_16x16x32_bf16 v[136:139], v[40:43], a[12:15], v[136:139]
ds_read_b64_tr_b16 v[34:35], v8 offset:10240
s_load_dwordx4 s[56:59], s[8:9], s36 offset:256 glc
v_mfma_f32_16x16x32_bf16 v[132:135], v[44:47], a[8:11], v[132:135]
ds_read_b64_tr_b16 v[36:37], v9 offset:8192
v_mul_f32 v161, v161, |v161|
v_mfma_f32_16x16x32_bf16 v[140:143], v[44:47], a[12:15], v[140:143]
ds_read_b64_tr_b16 v[38:39], v9 offset:10240
v_mul_f32 v162, v162, |v162|
v_mul_f32 v163, v163, |v163|
v_mfma_f32_16x16x32_bf16 v[144:147], v[248:251], a[8:11], v[144:147]
buffer_load_dwordx4 v5, s[16:19], s6 offen offset:1024 lds
ds_read_b64_tr_b16 v[40:41], v6 offset:12288
v_mfma_f32_16x16x32_bf16 v[152:155], v[248:251], a[12:15], v[152:155]
ds_read_b64_tr_b16 v[42:43], v6 offset:14336
v_mul_f32 v164, v164, |v164|
v_mfma_f32_16x16x32_bf16 v[148:151], v[252:255], a[8:11], v[148:151]
ds_read_b64_tr_b16 v[44:45], v7 offset:12288
s_add_u32 m0, s30, 90112
v_mfma_f32_16x16x32_bf16 v[156:159], v[252:255], a[12:15], v[156:159]
ds_read_b64_tr_b16 v[46:47], v7 offset:14336
s_add_u32 s6, s96, 147456
s_waitcnt lgkmcnt(4)
v_mfma_f32_16x16x32_bf16 v[128:131], v[24:27], a[16:19], v[128:131]
buffer_load_dwordx4 v4, s[16:19], s6 offen offset:0 lds
ds_read_b64_tr_b16 v[248:249], v8 offset:12288
v_mfma_f32_16x16x32_bf16 v[136:139], v[24:27], a[20:23], v[136:139]
ds_read_b64_tr_b16 v[250:251], v8 offset:14336
v_mul_f32 v165, v165, |v165|
v_mfma_f32_16x16x32_bf16 v[132:135], v[28:31], a[16:19], v[132:135]
ds_read_b64_tr_b16 v[252:253], v9 offset:12288
v_mul_f32 v166, v166, |v166|
v_mfma_f32_16x16x32_bf16 v[140:143], v[28:31], a[20:23], v[140:143]
ds_read_b64_tr_b16 v[254:255], v9 offset:14336
v_mul_f32 v167, v167, |v167|
v_cvt_pk_bf16_f32 v160, v160, v161
v_mfma_f32_16x16x32_bf16 v[144:147], v[32:35], a[16:19], v[144:147]
buffer_load_dwordx4 v5, s[16:19], s6 offen offset:1024 lds
ds_read_b64_tr_b16 v[24:25], v6 offset:16384
v_mfma_f32_16x16x32_bf16 v[152:155], v[32:35], a[20:23], v[152:155]
ds_read_b64_tr_b16 v[26:27], v6 offset:18432
v_cvt_pk_bf16_f32 v161, v162, v163
v_mfma_f32_16x16x32_bf16 v[148:151], v[36:39], a[16:19], v[148:151]
ds_read_b64_tr_b16 v[28:29], v7 offset:16384
v_cvt_pk_bf16_f32 v162, v164, v165
v_mfma_f32_16x16x32_bf16 v[156:159], v[36:39], a[20:23], v[156:159]
ds_read_b64_tr_b16 v[30:31], v7 offset:18432
v_cvt_pk_bf16_f32 v163, v166, v167
s_waitcnt lgkmcnt(4)
v_mfma_f32_16x16x32_bf16 v[128:131], v[40:43], a[24:27], v[128:131]
ds_read_b64_tr_b16 v[32:33], v8 offset:16384
v_pk_max_i16 v96, v160, 0
v_mfma_f32_16x16x32_bf16 v[136:139], v[40:43], a[28:31], v[136:139]
ds_read_b64_tr_b16 v[34:35], v8 offset:18432
v_pk_max_i16 v97, v161, 0
v_pk_max_i16 v98, v162, 0
v_mfma_f32_16x16x32_bf16 v[132:135], v[44:47], a[24:27], v[132:135]
buffer_load_dwordx4 a[184:187], v1, s[8:11], s7 offen offset:2048 sc1
ds_read_b64_tr_b16 v[36:37], v9 offset:16384
v_mfma_f32_16x16x32_bf16 v[140:143], v[44:47], a[28:31], v[140:143]
ds_read_b64_tr_b16 v[38:39], v9 offset:18432
v_pk_max_i16 v99, v163, 0
v_mfma_f32_16x16x32_bf16 v[144:147], v[248:251], a[24:27], v[144:147]
ds_read_b64_tr_b16 v[40:41], v6 offset:20480
s_add_u32 s51, s47, 49152
v_mfma_f32_16x16x32_bf16 v[152:155], v[248:251], a[28:31], v[152:155]
ds_read_b64_tr_b16 v[42:43], v6 offset:22528
v_mul_f32 v168, v168, |v168|
v_mul_f32 v169, v169, |v169|
v_mfma_f32_16x16x32_bf16 v[148:151], v[252:255], a[24:27], v[148:151]
buffer_store_dwordx4 v[96:99], v1, s[8:11], s51 offen offset:0 sc1
ds_read_b64_tr_b16 v[44:45], v7 offset:20480
v_mfma_f32_16x16x32_bf16 v[156:159], v[252:255], a[28:31], v[156:159]
ds_read_b64_tr_b16 v[46:47], v7 offset:22528
s_waitcnt lgkmcnt(4)
v_mfma_f32_16x16x32_bf16 v[128:131], v[24:27], a[32:35], v[128:131]
ds_read_b64_tr_b16 v[248:249], v8 offset:20480
v_mul_f32 v170, v170, |v170|
v_mfma_f32_16x16x32_bf16 v[136:139], v[24:27], a[36:39], v[136:139]
ds_read_b64_tr_b16 v[250:251], v8 offset:22528
v_mul_f32 v171, v171, |v171|
v_mul_f32 v172, v172, |v172|
v_mfma_f32_16x16x32_bf16 v[132:135], v[28:31], a[32:35], v[132:135]
ds_read_b64_tr_b16 v[252:253], v9 offset:20480
v_mul_f32 v173, v173, |v173|
v_mfma_f32_16x16x32_bf16 v[140:143], v[28:31], a[36:39], v[140:143]
ds_read_b64_tr_b16 v[254:255], v9 offset:22528
v_mul_f32 v174, v174, |v174|
v_mul_f32 v175, v175, |v175|
v_mfma_f32_16x16x32_bf16 v[144:147], v[32:35], a[32:35], v[144:147]
v_mfma_f32_16x16x32_bf16 v[152:155], v[32:35], a[36:39], v[152:155]
s_waitcnt vmcnt(29)
s_barrier
buffer_load_dwordx4 a[188:191], v1, s[8:11], s7 offen offset:3072 sc1
ds_read_b64_tr_b16 v[24:25], v6 offset:24576
ds_read_b64_tr_b16 v[26:27], v6 offset:26624
v_mfma_f32_16x16x32_bf16 v[148:151], v[36:39], a[32:35], v[148:151]
ds_read_b64_tr_b16 v[28:29], v7 offset:24576
s_add_u32 m0, s30, 98304
v_mfma_f32_16x16x32_bf16 v[156:159], v[36:39], a[36:39], v[156:159]
ds_read_b64_tr_b16 v[30:31], v7 offset:26624
s_add_u32 s6, s43, 0
s_waitcnt lgkmcnt(0)
v_mfma_f32_16x16x32_bf16 v[128:131], v[40:43], a[40:43], v[128:131]
buffer_load_dwordx4 v4, s[16:19], s6 offen offset:0 lds
s_branch PGB_4
.p2align 12
PSB_4:
s_setpc_b64 s[62:63]
PGB_4:
ds_read_b64_tr_b16 v[32:33], v8 offset:24576
s_xor_b64 s[56:57], s[56:57], s[0:1]
s_xor_b64 s[58:59], s[58:59], s[0:1]
v_mfma_f32_16x16x32_bf16 v[136:139], v[40:43], a[44:47], v[136:139]
ds_read_b64_tr_b16 v[34:35], v8 offset:26624
s_or_b64 s[56:57], s[56:57], s[58:59]
s_cbranch_scc1 K3B_slow2
K3B_back2:
v_mfma_f32_16x16x32_bf16 v[132:135], v[44:47], a[40:43], v[132:135]
ds_read_b64_tr_b16 v[36:37], v9 offset:24576
v_cvt_pk_bf16_f32 v168, v168, v169
v_mfma_f32_16x16x32_bf16 v[140:143], v[44:47], a[44:47], v[140:143]
ds_read_b64_tr_b16 v[38:39], v9 offset:26624
v_cvt_pk_bf16_f32 v169, v170, v171
v_cvt_pk_bf16_f32 v170, v172, v173
v_mfma_f32_16x16x32_bf16 v[144:147], v[248:251], a[40:43], v[144:147]
buffer_load_dwordx4 v5, s[16:19], s6 offen offset:1024 lds
ds_read_b64_tr_b16 v[40:41], v6 offset:28672
v_mfma_f32_16x16x32_bf16 v[152:155], v[248:251], a[44:47], v[152:155]
ds_read_b64_tr_b16 v[42:43], v6 offset:30720
v_cvt_pk_bf16_f32 v171, v174, v175
v_mfma_f32_16x16x32_bf16 v[148:151], v[252:255], a[40:43], v[148:151]
v_mfma_f32_16x16x32_bf16 v[156:159], v[252:255], a[44:47], v[156:159]
s_waitcnt vmcnt(20)
buffer_store_dword v15, off, s[8:11], s37 offset:384 sc1
ds_read_b64_tr_b16 v[44:45], v7 offset:28672
ds_read_b64_tr_b16 v[46:47], v7 offset:30720
s_waitcnt lgkmcnt(4)
v_mfma_f32_16x16x32_bf16 v[128:131], v[24:27], a[48:51], v[128:131]
ds_read_b64_tr_b16 v[248:249], v8 offset:28672
v_pk_max_i16 v100, v168, 0
v_mfma_f32_16x16x32_bf16 v[136:139], v[24:27], a[52:55], v[136:139]
ds_read_b64_tr_b16 v[250:251], v8 offset:30720
v_pk_max_i16 v101, v169, 0
v_pk_max_i16 v102, v170, 0
v_mfma_f32_16x16x32_bf16 v[132:135], v[28:31], a[48:51], v[132:135]
ds_read_b64_tr_b16 v[252:253], v9 offset:28672
s_add_u32 m0, s30, 106496
v_mfma_f32_16x16x32_bf16 v[140:143], v[28:31], a[52:55], v[140:143]
ds_read_b64_tr_b16 v[254:255], v9 offset:30720
s_add_u32 s6, s43, 73728
v_pk_max_i16 v103, v171, 0
v_mfma_f32_16x16x32_bf16 v[144:147], v[32:35], a[48:51], v[144:147]
buffer_load_dwordx4 v4, s[16:19], s6 offen offset:0 lds
ds_read_b64_tr_b16 v[24:25], v6 offset:32768
v_mfma_f32_16x16x32_bf16 v[152:155], v[32:35], a[52:55], v[152:155]
ds_read_b64_tr_b16 v[26:27], v6 offset:34816
v_mul_f32 v176, v176, |v176|
v_mfma_f32_16x16x32_bf16 v[148:151], v[36:39], a[48:51], v[148:151]
buffer_store_dwordx4 v[100:103], v1, s[8:11], s51 offen offset:1024 sc1
ds_read_b64_tr_b16 v[28:29], v7 offset:32768
v_mfma_f32_16x16x32_bf16 v[156:159], v[36:39], a[52:55], v[156:159]
ds_read_b64_tr_b16 v[30:31], v7 offset:34816
s_waitcnt lgkmcnt(4)
v_mfma_f32_16x16x32_bf16 v[128:131], v[40:43], a[56:59], v[128:131]
ds_read_b64_tr_b16 v[32:33], v8 offset:32768
v_mul_f32 v177, v177, |v177|
v_mfma_f32_16x16x32_bf16 v[136:139], v[40:43], a[60:63], v[136:139]
ds_read_b64_tr_b16 v[34:35], v8 offset:34816
v_mul_f32 v178, v178, |v178|
v_mul_f32 v179, v179, |v179|
v_mfma_f32_16x16x32_bf16 v[132:135], v[44:47], a[56:59], v[132:135]
buffer_load_dwordx4 v5, s[16:19], s6 offen offset:1024 lds
ds_read_b64_tr_b16 v[36:37], v9 offset:32768
v_mfma_f32_16x16x32_bf16 v[140:143], v[44:47], a[60:63], v[140:143]
ds_read_b64_tr_b16 v[38:39], v9 offset:34816
v_mul_f32 v180, v180, |v180|
v_mfma_f32_16x16x32_bf16 v[144:147], v[248:251], a[56:59], v[144:147]
ds_read_b64_tr_b16 v[40:41], v6 offset:36864
s_add_u32 m0, s30, 114688
v_mfma_f32_16x16x32_bf16 v[152:155], v[248:251], a[60:63], v[152:155]
ds_read_b64_tr_b16 v[42:43], v6 offset:38912
s_add_u32 s6, s43, 147456
v_mul_f32 v181, v181, |v181|
v_mfma_f32_16x16x32_bf16 v[148:151], v[252:255], a[56:59], v[148:151]
buffer_load_dwordx4 v4, s[16:19], s6 offen offset:0 lds
ds_read_b64_tr_b16 v[44:45], v7 offset:36864
v_mfma_f32_16x16x32_bf16 v[156:159], v[252:255], a[60:63], v[156:159]
ds_read_b64_tr_b16 v[46:47], v7 offset:38912
s_waitcnt lgkmcnt(4)
v_mfma_f32_16x16x32_bf16 v[128:131], v[24:27], a[64:67], v[128:131]
ds_read_b64_tr_b16 v[248:249], v8 offset:36864
v_mul_f32 v182, v182, |v182|
v_mfma_f32_16x16x32_bf16 v[136:139], v[24:27], a[68:71], v[136:139]
ds_read_b64_tr_b16 v[250:251], v8 offset:38912
v_mul_f32 v183, v183, |v183|
v_cvt_pk_bf16_f32 v176, v176, v177
v_mfma_f32_16x16x32_bf16 v[132:135], v[28:31], a[64:67], v[132:135]
buffer_load_dwordx4 v5, s[16:19], s6 offen offset:1024 lds
ds_read_b64_tr_b16 v[252:253], v9 offset:36864
v_mfma_f32_16x16x32_bf16 v[140:143], v[28:31], a[68:71], v[140:143]
ds_read_b64_tr_b16 v[254:255], v9 offset:38912
v_cvt_pk_bf16_f32 v177, v178, v179
v_mfma_f32_16x16x32_bf16 v[144:147], v[32:35], a[64:67], v[144:147]
ds_read_b64_tr_b16 v[24:25], v6 offset:40960
v_cvt_pk_bf16_f32 v178, v180, v181
v_mfma_f32_16x16x32_bf16 v[152:155], v[32:35], a[68:71], v[152:155]
ds_read_b64_tr_b16 v[26:27], v6 offset:43008
v_cvt_pk_bf16_f32 v179, v182, v183
v_pk_max_i16 v104, v176, 0
v_mfma_f32_16x16x32_bf16 v[148:151], v[36:39], a[64:67], v[148:151]
ds_read_b64_tr_b16 v[28:29], v7 offset:40960
v_pk_max_i16 v105, v177, 0
v_mfma_f32_16x16x32_bf16 v[156:159], v[36:39], a[68:71], v[156:159]
ds_read_b64_tr_b16 v[30:31], v7 offset:43008
v_pk_max_i16 v106, v178, 0
s_waitcnt lgkmcnt(4)
v_mfma_f32_16x16x32_bf16 v[128:131], v[40:43], a[72:75], v[128:131]
ds_read_b64_tr_b16 v[32:33], v8 offset:40960
s_add_u32 s7, s48, 16384
v_mfma_f32_16x16x32_bf16 v[136:139], v[40:43], a[76:79], v[136:139]
ds_read_b64_tr_b16 v[34:35], v8 offset:43008
v_pk_max_i16 v107, v179, 0
v_mul_f32 v184, v184, |v184|
v_mfma_f32_16x16x32_bf16 v[132:135], v[44:47], a[72:75], v[132:135]
buffer_load_dwordx4 a[192:195], v1, s[8:11], s7 offen offset:0 sc1
ds_read_b64_tr_b16 v[36:37], v9 offset:40960
v_mfma_f32_16x16x32_bf16 v[140:143], v[44:47], a[76:79], v[140:143]
ds_read_b64_tr_b16 v[38:39], v9 offset:43008
v_mul_f32 v185, v185, |v185|
v_mfma_f32_16x16x32_bf16 v[144:147], v[248:251], a[72:75], v[144:147]
buffer_store_dwordx4 v[104:107], v1, s[8:11], s51 offen offset:2048 sc1
ds_read_b64_tr_b16 v[40:41], v6 offset:45056
v_mfma_f32_16x16x32_bf16 v[152:155], v[248:251], a[76:79], v[152:155]
ds_read_b64_tr_b16 v[42:43], v6 offset:47104
v_mul_f32 v186, v186, |v186|
v_mfma_f32_16x16x32_bf16 v[148:151], v[252:255], a[72:75], v[148:151]
ds_read_b64_tr_b16 v[44:45], v7 offset:45056
v_mul_f32 v187, v187, |v187|
v_mfma_f32_16x16x32_bf16 v[156:159], v[252:255], a[76:79], v[156:159]
ds_read_b64_tr_b16 v[46:47], v7 offset:47104
v_mul_f32 v188, v188, |v188|
s_waitcnt lgkmcnt(4)
v_mfma_f32_16x16x32_bf16 v[128:131], v[24:27], a[80:83], v[128:131]
ds_read_b64_tr_b16 v[248:249], v8 offset:45056
v_mul_f32 v189, v189, |v189|
v_mfma_f32_16x16x32_bf16 v[136:139], v[24:27], a[84:87], v[136:139]
ds_read_b64_tr_b16 v[250:251], v8 offset:47104
v_mul_f32 v190, v190, |v190|
v_mul_f32 v191, v191, |v191|
v_mfma_f32_16x16x32_bf16 v[132:135], v[28:31], a[80:83], v[132:135]
ds_read_b64_tr_b16 v[252:253], v9 offset:45056
v_cvt_pk_bf16_f32 v184, v184, v185
v_mfma_f32_16x16x32_bf16 v[140:143], v[28:31], a[84:87], v[140:143]
ds_read_b64_tr_b16 v[254:255], v9 offset:47104
v_cvt_pk_bf16_f32 v185, v186, v187
v_cvt_pk_bf16_f32 v186, v188, v189
v_mfma_f32_16x16x32_bf16 v[144:147], v[32:35], a[80:83], v[144:147]
v_mfma_f32_16x16x32_bf16 v[152:155], v[32:35], a[84:87], v[152:155]
s_barrier
v_add_u32 v6, 49152, v6
ds_read_b64_tr_b16 v[24:25], v6 offset:0
ds_read_b64_tr_b16 v[26:27], v6 offset:2048
v_mfma_f32_16x16x32_bf16 v[148:151], v[36:39], a[80:83], v[148:151]
buffer_load_dwordx4 a[196:199], v1, s[8:11], s7 offen offset:1024 sc1
v_add_u32 v7, 49152, v7
ds_read_b64_tr_b16 v[28:29], v7 offset:0
v_mfma_f32_16x16x32_bf16 v[156:159], v[36:39], a[84:87], v[156:159]
ds_read_b64_tr_b16 v[30:31], v7 offset:2048
s_waitcnt lgkmcnt(4)
v_mfma_f32_16x16x32_bf16 v[128:131], v[40:43], a[88:91], v[128:131]
v_add_u32 v8, 49152, v8
ds_read_b64_tr_b16 v[32:33], v8 offset:0
v_mfma_f32_16x16x32_bf16 v[136:139], v[40:43], a[92:95], v[136:139]
ds_read_b64_tr_b16 v[34:35], v8 offset:2048
s_add_u32 m0, s30, 122880
s_add_u32 s6, s96, 221184
v_mfma_f32_16x16x32_bf16 v[132:135], v[44:47], a[88:91], v[132:135]
buffer_load_dwordx4 v4, s[16:19], s6 offen offset:0 lds
v_add_u32 v9, 49152, v9
ds_read_b64_tr_b16 v[36:37], v9 offset:0
v_mfma_f32_16x16x32_bf16 v[140:143], v[44:47], a[92:95], v[140:143]
ds_read_b64_tr_b16 v[38:39], v9 offset:2048
v_mfma_f32_16x16x32_bf16 v[144:147], v[248:251], a[88:91], v[144:147]
ds_read_b64_tr_b16 v[40:41], v6 offset:4096
v_cvt_pk_bf16_f32 v187, v190, v191
v_mfma_f32_16x16x32_bf16 v[152:155], v[248:251], a[92:95], v[152:155]
ds_read_b64_tr_b16 v[42:43], v6 offset:6144
v_pk_max_i16 v108, v184, 0
v_pk_max_i16 v109, v185, 0
v_mfma_f32_16x16x32_bf16 v[148:151], v[252:255], a[88:91], v[148:151]
buffer_load_dwordx4 v5, s[16:19], s6 offen offset:1024 lds
ds_read_b64_tr_b16 v[44:45], v7 offset:4096
v_mfma_f32_16x16x32_bf16 v[156:159], v[252:255], a[92:95], v[156:159]
ds_read_b64_tr_b16 v[46:47], v7 offset:6144
s_waitcnt lgkmcnt(4)
v_mfma_f32_16x16x32_bf16 v[128:131], v[24:27], a[96:99], v[128:131]
ds_read_b64_tr_b16 v[248:249], v8 offset:4096
s_add_u32 m0, s30, 131072
v_mfma_f32_16x16x32_bf16 v[136:139], v[24:27], a[100:103], v[136:139]
ds_read_b64_tr_b16 v[250:251], v8 offset:6144
s_add_u32 s6, s96, 294912
v_pk_max_i16 v110, v186, 0
v_mfma_f32_16x16x32_bf16 v[132:135], v[28:31], a[96:99], v[132:135]
buffer_load_dwordx4 v4, s[16:19], s6 offen offset:0 lds
ds_read_b64_tr_b16 v[252:253], v9 offset:4096
v_mfma_f32_16x16x32_bf16 v[140:143], v[28:31], a[100:103], v[140:143]
ds_read_b64_tr_b16 v[254:255], v9 offset:6144
v_pk_max_i16 v111, v187, 0
v_mfma_f32_16x16x32_bf16 v[144:147], v[32:35], a[96:99], v[144:147]
ds_read_b64_tr_b16 v[24:25], v6 offset:8192
v_mfma_f32_16x16x32_bf16 v[152:155], v[32:35], a[100:103], v[152:155]
ds_read_b64_tr_b16 v[26:27], v6 offset:10240
v_mfma_f32_16x16x32_bf16 v[148:151], v[36:39], a[96:99], v[148:151]
buffer_store_dwordx4 v[108:111], v1, s[8:11], s51 offen offset:3072 sc1
ds_read_b64_tr_b16 v[28:29], v7 offset:8192
v_mfma_f32_16x16x32_bf16 v[156:159], v[36:39], a[100:103], v[156:159]
ds_read_b64_tr_b16 v[30:31], v7 offset:10240
s_waitcnt lgkmcnt(4)
v_mfma_f32_16x16x32_bf16 v[128:131], v[40:43], a[104:107], v[128:131]
ds_read_b64_tr_b16 v[32:33], v8 offset:8192
v_mfma_f32_16x16x32_bf16 v[136:139], v[40:43], a[108:111], v[136:139]
ds_read_b64_tr_b16 v[34:35], v8 offset:10240
v_mfma_f32_16x16x32_bf16 v[132:135], v[44:47], a[104:107], v[132:135]
buffer_load_dwordx4 v5, s[16:19], s6 offen offset:1024 lds
ds_read_b64_tr_b16 v[36:37], v9 offset:8192
v_mfma_f32_16x16x32_bf16 v[140:143], v[44:47], a[108:111], v[140:143]
ds_read_b64_tr_b16 v[38:39], v9 offset:10240
v_mfma_f32_16x16x32_bf16 v[144:147], v[248:251], a[104:107], v[144:147]
ds_read_b64_tr_b16 v[40:41], v6 offset:12288
s_add_u32 m0, s30, 139264
v_mfma_f32_16x16x32_bf16 v[152:155], v[248:251], a[108:111], v[152:155]
ds_read_b64_tr_b16 v[42:43], v6 offset:14336
s_add_u32 s6, s97, 0
v_mfma_f32_16x16x32_bf16 v[148:151], v[252:255], a[104:107], v[148:151]
buffer_load_dwordx4 v4, s[16:19], s6 offen offset:0 lds
ds_read_b64_tr_b16 v[44:45], v7 offset:12288
v_mfma_f32_16x16x32_bf16 v[156:159], v[252:255], a[108:111], v[156:159]
ds_read_b64_tr_b16 v[46:47], v7 offset:14336
s_waitcnt lgkmcnt(4)
v_mfma_f32_16x16x32_bf16 v[128:131], v[24:27], a[112:115], v[128:131]
ds_read_b64_tr_b16 v[248:249], v8 offset:12288
v_mfma_f32_16x16x32_bf16 v[136:139], v[24:27], a[116:119], v[136:139]
ds_read_b64_tr_b16 v[250:251], v8 offset:14336
v_mfma_f32_16x16x32_bf16 v[132:135], v[28:31], a[112:115], v[132:135]
buffer_load_dwordx4 v5, s[16:19], s6 offen offset:1024 lds
ds_read_b64_tr_b16 v[252:253], v9 offset:12288
v_mfma_f32_16x16x32_bf16 v[140:143], v[28:31], a[116:119], v[140:143]
ds_read_b64_tr_b16 v[254:255], v9 offset:14336
v_mfma_f32_16x16x32_bf16 v[144:147], v[32:35], a[112:115], v[144:147]
ds_read_b64_tr_b16 v[24:25], v6 offset:16384
v_mfma_f32_16x16x32_bf16 v[152:155], v[32:35], a[116:119], v[152:155]
ds_read_b64_tr_b16 v[26:27], v6 offset:18432
v_mfma_f32_16x16x32_bf16 v[148:151], v[36:39], a[112:115], v[148:151]
ds_read_b64_tr_b16 v[28:29], v7 offset:16384
v_mfma_f32_16x16x32_bf16 v[156:159], v[36:39], a[116:119], v[156:159]
ds_read_b64_tr_b16 v[30:31], v7 offset:18432
s_waitcnt lgkmcnt(4)
v_mfma_f32_16x16x32_bf16 v[128:131], v[40:43], a[120:123], v[128:131]
buffer_load_dwordx4 a[200:203], v1, s[8:11], s7 offen offset:2048 sc1
ds_read_b64_tr_b16 v[32:33], v8 offset:16384
v_mfma_f32_16x16x32_bf16 v[136:139], v[40:43], a[124:127], v[136:139]
ds_read_b64_tr_b16 v[34:35], v8 offset:18432
v_mfma_f32_16x16x32_bf16 v[132:135], v[44:47], a[120:123], v[132:135]
ds_read_b64_tr_b16 v[36:37], v9 offset:16384
v_mfma_f32_16x16x32_bf16 v[140:143], v[44:47], a[124:127], v[140:143]
ds_read_b64_tr_b16 v[38:39], v9 offset:18432
v_mfma_f32_16x16x32_bf16 v[144:147], v[248:251], a[120:123], v[144:147]
ds_read_b64_tr_b16 v[40:41], v6 offset:20480
v_mfma_f32_16x16x32_bf16 v[152:155], v[248:251], a[124:127], v[152:155]
ds_read_b64_tr_b16 v[42:43], v6 offset:22528
v_mfma_f32_16x16x32_bf16 v[148:151], v[252:255], a[120:123], v[148:151]
buffer_load_dwordx4 a[204:207], v1, s[8:11], s7 offen offset:3072 sc1
ds_read_b64_tr_b16 v[44:45], v7 offset:20480
v_mfma_f32_16x16x32_bf16 v[156:159], v[252:255], a[124:127], v[156:159]
ds_read_b64_tr_b16 v[46:47], v7 offset:22528
s_waitcnt lgkmcnt(4)
v_mfma_f32_16x16x32_bf16 v[128:131], v[24:27], a[128:131], v[128:131]
ds_read_b64_tr_b16 v[248:249], v8 offset:20480
v_mfma_f32_16x16x32_bf16 v[136:139], v[24:27], a[132:135], v[136:139]
ds_read_b64_tr_b16 v[250:251], v8 offset:22528
v_mfma_f32_16x16x32_bf16 v[132:135], v[28:31], a[128:131], v[132:135]
ds_read_b64_tr_b16 v[252:253], v9 offset:20480
v_mfma_f32_16x16x32_bf16 v[140:143], v[28:31], a[132:135], v[140:143]
ds_read_b64_tr_b16 v[254:255], v9 offset:22528
s_add_u32 s7, s49, 16384
v_mfma_f32_16x16x32_bf16 v[144:147], v[32:35], a[128:131], v[144:147]
v_mfma_f32_16x16x32_bf16 v[152:155], v[32:35], a[132:135], v[152:155]
s_waitcnt vmcnt(23)
s_barrier
buffer_load_dwordx4 a[208:211], v1, s[8:11], s7 offen offset:0 sc1
ds_read_b64_tr_b16 v[24:25], v10 offset:24576
ds_read_b64_tr_b16 v[26:27], v10 offset:26624
v_mfma_f32_16x16x32_bf16 v[148:151], v[36:39], a[128:131], v[148:151]
ds_read_b64_tr_b16 v[28:29], v11 offset:24576
v_mfma_f32_16x16x32_bf16 v[156:159], v[36:39], a[132:135], v[156:159]
ds_read_b64_tr_b16 v[30:31], v11 offset:26624
s_waitcnt lgkmcnt(4)
v_mfma_f32_16x16x32_bf16 v[128:131], v[40:43], a[136:139], v[128:131]
ds_read_b64_tr_b16 v[32:33], v12 offset:24576
s_add_u32 m0, s30, 0
v_mfma_f32_16x16x32_bf16 v[136:139], v[40:43], a[140:143], v[136:139]
ds_read_b64_tr_b16 v[34:35], v12 offset:26624
s_add_u32 s6, s98, 0
v_mfma_f32_16x16x32_bf16 v[132:135], v[44:47], a[136:139], v[132:135]
buffer_load_dwordx4 v4, s[16:19], s6 offen offset:0 lds
ds_read_b64_tr_b16 v[36:37], v13 offset:24576
v_mfma_f32_16x16x32_bf16 v[140:143], v[44:47], a[140:143], v[140:143]
ds_read_b64_tr_b16 v[38:39], v13 offset:26624
v_mfma_f32_16x16x32_bf16 v[144:147], v[248:251], a[136:139], v[144:147]
ds_read_b64_tr_b16 v[40:41], v10 offset:28672
v_mfma_f32_16x16x32_bf16 v[152:155], v[248:251], a[140:143], v[152:155]
ds_read_b64_tr_b16 v[42:43], v10 offset:30720
v_mfma_f32_16x16x32_bf16 v[148:151], v[252:255], a[136:139], v[148:151]
buffer_load_dwordx4 v5, s[16:19], s6 offen offset:1024 lds
ds_read_b64_tr_b16 v[44:45], v11 offset:28672
v_mfma_f32_16x16x32_bf16 v[156:159], v[252:255], a[140:143], v[156:159]
ds_read_b64_tr_b16 v[46:47], v11 offset:30720
v_mfma_f32_16x16x32_bf16 v[128:131], v[244:247], v[226:229], v[128:131]
v_mfma_f32_16x16x32_bf16 v[132:135], v[244:247], v[230:233], v[132:135]
v_mfma_f32_16x16x32_bf16 v[144:147], v[244:247], v[224:227], v[144:147]
v_mfma_f32_16x16x32_bf16 v[148:151], v[244:247], v[228:231], v[148:151]
v_mfma_f32_16x16x32_bf16 v[136:139], v[244:247], v[234:237], v[136:139]
v_mfma_f32_16x16x32_bf16 v[140:143], v[244:247], v[238:241], v[140:143]
v_mfma_f32_16x16x32_bf16 v[152:155], v[244:247], v[232:235], v[152:155]
v_mfma_f32_16x16x32_bf16 v[156:159], v[244:247], v[236:239], v[156:159]
s_waitcnt lgkmcnt(4)
v_mfma_f32_16x16x32_bf16 v[192:195], v[24:27], v[48:51], 0
ds_read_b64_tr_b16 v[248:249], v12 offset:28672
s_add_u32 m0, s30, 8192
v_mfma_f32_16x16x32_bf16 v[200:203], v[24:27], v[52:55], 0
ds_read_b64_tr_b16 v[250:251], v12 offset:30720
s_add_u32 s6, s55, 1105920
v_mfma_f32_16x16x32_bf16 v[196:199], v[28:31], v[48:51], 0
buffer_load_dwordx4 v4, s[16:19], s6 offen offset:0 lds
ds_read_b64_tr_b16 v[252:253], v13 offset:28672
v_mfma_f32_16x16x32_bf16 v[204:207], v[28:31], v[52:55], 0
ds_read_b64_tr_b16 v[254:255], v13 offset:30720
v_mfma_f32_16x16x32_bf16 v[208:211], v[32:35], v[48:51], 0
ds_read_b64_tr_b16 v[24:25], v10 offset:32768
v_mul_f32 v128, v128, |v128|
v_mul_f32 v129, v129, |v129|
v_mfma_f32_16x16x32_bf16 v[216:219], v[32:35], v[52:55], 0
ds_read_b64_tr_b16 v[26:27], v10 offset:34816
v_mul_f32 v130, v130, |v130|
v_mul_f32 v131, v131, |v131|
v_mfma_f32_16x16x32_bf16 v[212:215], v[36:39], v[48:51], 0
buffer_load_dwordx4 v5, s[16:19], s6 offen offset:1024 lds
ds_read_b64_tr_b16 v[28:29], v11 offset:32768
v_mfma_f32_16x16x32_bf16 v[220:223], v[36:39], v[52:55], 0
ds_read_b64_tr_b16 v[30:31], v11 offset:34816
v_mul_f32 v132, v132, |v132|
s_waitcnt lgkmcnt(4)
v_mfma_f32_16x16x32_bf16 v[192:195], v[40:43], v[56:59], v[192:195]
ds_read_b64_tr_b16 v[32:33], v12 offset:32768
s_add_u32 m0, s30, 16384
s_add_u32 s6, s97, 73728
v_mfma_f32_16x16x32_bf16 v[200:203], v[40:43], v[60:63], v[200:203]
ds_read_b64_tr_b16 v[34:35], v12 offset:34816
v_mul_f32 v133, v133, |v133|
v_mul_f32 v134, v134, |v134|
v_mfma_f32_16x16x32_bf16 v[196:199], v[44:47], v[56:59], v[196:199]
buffer_load_dwordx4 v4, s[16:19], s6 offen offset:0 lds
ds_read_b64_tr_b16 v[36:37], v13 offset:32768
v_mfma_f32_16x16x32_bf16 v[204:207], v[44:47], v[60:63], v[204:207]
ds_read_b64_tr_b16 v[38:39], v13 offset:34816
v_mul_f32 v135, v135, |v135|
v_cvt_pk_bf16_f32 v128, v128, v129
v_mfma_f32_16x16x32_bf16 v[208:211], v[248:251], v[56:59], v[208:211]
ds_read_b64_tr_b16 v[40:41], v10 offset:36864
v_cvt_pk_bf16_f32 v129, v130, v131
v_cvt_pk_bf16_f32 v130, v132, v133
v_mfma_f32_16x16x32_bf16 v[216:219], v[248:251], v[60:63], v[216:219]
ds_read_b64_tr_b16 v[42:43], v10 offset:38912
v_cvt_pk_bf16_f32 v131, v134, v135
v_pk_max_i16 v112, v128, 0
v_mfma_f32_16x16x32_bf16 v[212:215], v[252:255], v[56:59], v[212:215]
buffer_load_dwordx4 v5, s[16:19], s6 offen offset:1024 lds
ds_read_b64_tr_b16 v[44:45], v11 offset:36864
v_mfma_f32_16x16x32_bf16 v[220:223], v[252:255], v[60:63], v[220:223]
ds_read_b64_tr_b16 v[46:47], v11 offset:38912
s_load_dwordx4 s[56:59], s[8:9], s36 offset:384 glc
s_waitcnt lgkmcnt(4)
v_mfma_f32_16x16x32_bf16 v[192:195], v[24:27], v[64:67], v[192:195]
ds_read_b64_tr_b16 v[248:249], v12 offset:36864
v_pk_max_i16 v113, v129, 0
v_pk_max_i16 v114, v130, 0
v_mfma_f32_16x16x32_bf16 v[200:203], v[24:27], v[68:71], v[200:203]
ds_read_b64_tr_b16 v[250:251], v12 offset:38912
v_pk_max_i16 v115, v131, 0
v_bitop3_b32 v132, v15, v112, v113 bitop3:0x96
v_mfma_f32_16x16x32_bf16 v[196:199], v[28:31], v[64:67], v[196:199]
ds_read_b64_tr_b16 v[252:253], v13 offset:36864
v_bitop3_b32 v132, v132, v114, v115 bitop3:0x96
v_mul_f32 v136, v136, |v136|
v_mfma_f32_16x16x32_bf16 v[204:207], v[28:31], v[68:71], v[204:207]
ds_read_b64_tr_b16 v[254:255], v13 offset:38912
v_mul_f32 v137, v137, |v137|
v_mul_f32 v138, v138, |v138|
v_mfma_f32_16x16x32_bf16 v[208:211], v[32:35], v[64:67], v[208:211]
buffer_load_dwordx4 a[212:215], v1, s[8:11], s7 offen offset:1024 sc1
ds_read_b64_tr_b16 v[24:25], v10 offset:40960
v_mfma_f32_16x16x32_bf16 v[216:219], v[32:35], v[68:71], v[216:219]
ds_read_b64_tr_b16 v[26:27], v10 offset:43008
s_add_u32 s51, s47, 65536
v_mul_f32 v139, v139, |v139|
v_mfma_f32_16x16x32_bf16 v[212:215], v[36:39], v[64:67], v[212:215]
buffer_store_dwordx4 v[112:115], v1, s[8:11], s51 offen offset:0 sc1
ds_read_b64_tr_b16 v[28:29], v11 offset:40960
v_mfma_f32_16x16x32_bf16 v[220:223], v[36:39], v[68:71], v[220:223]
ds_read_b64_tr_b16 v[30:31], v11 offset:43008
v_mul_f32 v140, v140, |v140|
s_waitcnt lgkmcnt(4)
v_mfma_f32_16x16x32_bf16 v[192:195], v[40:43], v[72:75], v[192:195]
ds_read_b64_tr_b16 v[32:33], v12 offset:40960
v_mul_f32 v141, v141, |v141|
v_mul_f32 v142, v142, |v142|
v_mfma_f32_16x16x32_bf16 v[200:203], v[40:43], v[76:79], v[200:203]
ds_read_b64_tr_b16 v[34:35], v12 offset:43008
v_mul_f32 v143, v143, |v143|
v_cvt_pk_bf16_f32 v136, v136, v137
v_mfma_f32_16x16x32_bf16 v[196:199], v[44:47], v[72:75], v[196:199]
ds_read_b64_tr_b16 v[36:37], v13 offset:40960
v_cvt_pk_bf16_f32 v137, v138, v139
v_cvt_pk_bf16_f32 v138, v140, v141
v_mfma_f32_16x16x32_bf16 v[204:207], v[44:47], v[76:79], v[204:207]
ds_read_b64_tr_b16 v[38:39], v13 offset:43008
v_cvt_pk_bf16_f32 v139, v142, v143
v_pk_max_i16 v116, v136, 0
v_mfma_f32_16x16x32_bf16 v[208:211], v[248:251], v[72:75], v[208:211]
buffer_load_dwordx4 a[216:219], v1, s[8:11], s7 offen offset:2048 sc1
ds_read_b64_tr_b16 v[40:41], v10 offset:45056
v_mfma_f32_16x16x32_bf16 v[216:219], v[248:251], v[76:79], v[216:219]
ds_read_b64_tr_b16 v[42:43], v10 offset:47104
v_pk_max_i16 v117, v137, 0
v_pk_max_i16 v118, v138, 0
v_mfma_f32_16x16x32_bf16 v[212:215], v[252:255], v[72:75], v[212:215]
v_mfma_f32_16x16x32_bf16 v[220:223], v[252:255], v[76:79], v[220:223]
s_waitcnt vmcnt(15)
buffer_store_dword v15, off, s[8:11], s37 offset:512 sc1
ds_read_b64_tr_b16 v[44:45], v11 offset:45056
ds_read_b64_tr_b16 v[46:47], v11 offset:47104
s_waitcnt lgkmcnt(4)
v_mfma_f32_16x16x32_bf16 v[192:195], v[24:27], v[80:83], v[192:195]
ds_read_b64_tr_b16 v[248:249], v12 offset:45056
v_pk_max_i16 v119, v139, 0
v_bitop3_b32 v132, v132, v116, v117 bitop3:0x96
v_mfma_f32_16x16x32_bf16 v[200:203], v[24:27], v[84:87], v[200:203]
ds_read_b64_tr_b16 v[250:251], v12 offset:47104
v_bitop3_b32 v132, v132, v118, v119 bitop3:0x96
v_mul_f32 v144, v144, |v144|
v_mfma_f32_16x16x32_bf16 v[196:199], v[28:31], v[80:83], v[196:199]
ds_read_b64_tr_b16 v[252:253], v13 offset:45056
v_mul_f32 v145, v145, |v145|
v_mul_f32 v146, v146, |v146|
v_mfma_f32_16x16x32_bf16 v[204:207], v[28:31], v[84:87], v[204:207]
ds_read_b64_tr_b16 v[254:255], v13 offset:47104
v_mul_f32 v147, v147, |v147|
v_mul_f32 v148, v148, |v148|
v_mfma_f32_16x16x32_bf16 v[208:211], v[32:35], v[80:83], v[208:211]
v_mfma_f32_16x16x32_bf16 v[216:219], v[32:35], v[84:87], v[216:219]
s_barrier
buffer_load_dwordx4 a[220:223], v1, s[8:11], s7 offen offset:3072 sc1
v_add_u32 v10, 49152, v10
ds_read_b64_tr_b16 v[24:25], v10 offset:0
ds_read_b64_tr_b16 v[26:27], v10 offset:2048
v_mfma_f32_16x16x32_bf16 v[212:215], v[36:39], v[80:83], v[212:215]
buffer_store_dwordx4 v[116:119], v1, s[8:11], s51 offen offset:1024 sc1
v_add_u32 v11, 49152, v11
ds_read_b64_tr_b16 v[28:29], v11 offset:0
v_mfma_f32_16x16x32_bf16 v[220:223], v[36:39], v[84:87], v[220:223]
ds_read_b64_tr_b16 v[30:31], v11 offset:2048
s_waitcnt lgkmcnt(4)
v_mfma_f32_16x16x32_bf16 v[192:195], v[40:43], v[88:91], v[192:195]
v_add_u32 v12, 49152, v12
ds_read_b64_tr_b16 v[32:33], v12 offset:0
s_add_u32 m0, s30, 24576
v_mfma_f32_16x16x32_bf16 v[200:203], v[40:43], v[92:95], v[200:203]
ds_read_b64_tr_b16 v[34:35], v12 offset:2048
s_add_u32 s6, s98, 73728
v_mul_f32 v149, v149, |v149|
v_mfma_f32_16x16x32_bf16 v[196:199], v[44:47], v[88:91], v[196:199]
buffer_load_dwordx4 v4, s[16:19], s6 offen offset:0 lds
v_add_u32 v13, 49152, v13
ds_read_b64_tr_b16 v[36:37], v13 offset:0
v_mfma_f32_16x16x32_bf16 v[204:207], v[44:47], v[92:95], v[204:207]
ds_read_b64_tr_b16 v[38:39], v13 offset:2048
v_mul_f32 v150, v150, |v150|
v_mfma_f32_16x16x32_bf16 v[208:211], v[248:251], v[88:91], v[208:211]
ds_read_b64_tr_b16 v[40:41], v10 offset:4096
v_mul_f32 v151, v151, |v151|
v_cvt_pk_bf16_f32 v144, v144, v145
v_mfma_f32_16x16x32_bf16 v[216:219], v[248:251], v[92:95], v[216:219]
ds_read_b64_tr_b16 v[42:43], v10 offset:6144
v_cvt_pk_bf16_f32 v145, v146, v147
v_cvt_pk_bf16_f32 v146, v148, v149
v_mfma_f32_16x16x32_bf16 v[212:215], v[252:255], v[88:91], v[212:215]
buffer_load_dwordx4 v5, s[16:19], s6 offen offset:1024 lds
ds_read_b64_tr_b16 v[44:45], v11 offset:4096
v_mfma_f32_16x16x32_bf16 v[220:223], v[252:255], v[92:95], v[220:223]
ds_read_b64_tr_b16 v[46:47], v11 offset:6144
v_cvt_pk_bf16_f32 v147, v150, v151
s_waitcnt lgkmcnt(0)
v_mfma_f32_16x16x32_bf16 v[160:163], v[24:27], v[48:51], 0
ds_read_b64_tr_b16 v[248:249], v12 offset:4096
s_xor_b64 s[56:57], s[56:57], s[0:1]
s_xor_b64 s[58:59], s[58:59], s[0:1]
s_or_b64 s[56:57], s[56:57], s[58:59]
v_mfma_f32_16x16x32_bf16 v[168:171], v[24:27], v[52:55], 0
ds_read_b64_tr_b16 v[250:251], v12 offset:6144
s_cbranch_scc1 K3B_slow3
K3B_back3:
s_add_u32 m0, s30, 32768
s_add_u32 s6, s55, 1179648
v_mfma_f32_16x16x32_bf16 v[164:167], v[28:31], v[48:51], 0
buffer_load_dwordx4 v4, s[16:19], s6 offen offset:0 lds
ds_read_b64_tr_b16 v[252:253], v13 offset:4096
v_mfma_f32_16x16x32_bf16 v[172:175], v[28:31], v[52:55], 0
ds_read_b64_tr_b16 v[254:255], v13 offset:6144
v_pk_max_i16 v120, v144, 0
v_pk_max_i16 v121, v145, 0
v_mfma_f32_16x16x32_bf16 v[176:179], v[32:35], v[48:51], 0
s_branch PGB_5
.p2align 12
PSB_5:
s_setpc_b64 s[62:63]
PGB_5:
ds_read_b64_tr_b16 v[24:25], v10 offset:8192
v_pk_max_i16 v122, v146, 0
v_pk_max_i16 v123, v147, 0
v_mfma_f32_16x16x32_bf16 v[184:187], v[32:35], v[52:55], 0
ds_read_b64_tr_b16 v[26:27], v10 offset:10240
v_bitop3_b32 v132, v132, v120, v121 bitop3:0x96
v_bitop3_b32 v132, v132, v122, v123 bitop3:0x96
v_mfma_f32_16x16x32_bf16 v[180:183], v[36:39], v[48:51], 0
buffer_load_dwordx4 v5, s[16:19], s6 offen offset:1024 lds
ds_read_b64_tr_b16 v[28:29], v11 offset:8192
v_mfma_f32_16x16x32_bf16 v[188:191], v[36:39], v[52:55], 0
ds_read_b64_tr_b16 v[30:31], v11 offset:10240
v_mul_f32 v152, v152, |v152|
s_waitcnt lgkmcnt(4)
v_mfma_f32_16x16x32_bf16 v[160:163], v[40:43], v[56:59], v[160:163]
buffer_store_dwordx4 v[120:123], v1, s[8:11], s51 offen offset:2048 sc1
ds_read_b64_tr_b16 v[32:33], v12 offset:8192
v_mfma_f32_16x16x32_bf16 v[168:171], v[40:43], v[60:63], v[168:171]
ds_read_b64_tr_b16 v[34:35], v12 offset:10240
v_mul_f32 v153, v153, |v153|
v_mul_f32 v154, v154, |v154|
v_mfma_f32_16x16x32_bf16 v[164:167], v[44:47], v[56:59], v[164:167]
ds_read_b64_tr_b16 v[36:37], v13 offset:8192
s_add_u32 m0, s30, 40960
s_add_u32 s6, s97, 147456
v_mfma_f32_16x16x32_bf16 v[172:175], v[44:47], v[60:63], v[172:175]
ds_read_b64_tr_b16 v[38:39], v13 offset:10240
v_mul_f32 v155, v155, |v155|
v_mul_f32 v156, v156, |v156|
v_mfma_f32_16x16x32_bf16 v[176:179], v[248:251], v[56:59], v[176:179]
buffer_load_dwordx4 v4, s[16:19], s6 offen offset:0 lds
ds_read_b64_tr_b16 v[40:41], v10 offset:12288
v_mfma_f32_16x16x32_bf16 v[184:187], v[248:251], v[60:63], v[184:187]
ds_read_b64_tr_b16 v[42:43], v10 offset:14336
v_mul_f32 v157, v157, |v157|
v_mul_f32 v158, v158, |v158|
v_mfma_f32_16x16x32_bf16 v[180:183], v[252:255], v[56:59], v[180:183]
ds_read_b64_tr_b16 v[44:45], v11 offset:12288
v_mul_f32 v159, v159, |v159|
v_cvt_pk_bf16_f32 v152, v152, v153
v_mfma_f32_16x16x32_bf16 v[188:191], v[252:255], v[60:63], v[188:191]
ds_read_b64_tr_b16 v[46:47], v11 offset:14336
v_cvt_pk_bf16_f32 v153, v154, v155
s_waitcnt lgkmcnt(4)
v_mfma_f32_16x16x32_bf16 v[160:163], v[24:27], v[64:67], v[160:163]
buffer_load_dwordx4 v5, s[16:19], s6 offen offset:1024 lds
ds_read_b64_tr_b16 v[248:249], v12 offset:12288
v_mfma_f32_16x16x32_bf16 v[168:171], v[24:27], v[68:71], v[168:171]
ds_read_b64_tr_b16 v[250:251], v12 offset:14336
v_cvt_pk_bf16_f32 v154, v156, v157
v_cvt_pk_bf16_f32 v155, v158, v159
v_mfma_f32_16x16x32_bf16 v[164:167], v[28:31], v[64:67], v[164:167]
ds_read_b64_tr_b16 v[252:253], v13 offset:12288
s_add_u32 s7, s34, 311296
v_pk_max_i16 v124, v152, 0
v_mfma_f32_16x16x32_bf16 v[172:175], v[28:31], v[68:71], v[172:175]
ds_read_b64_tr_b16 v[254:255], v13 offset:14336
v_pk_max_i16 v125, v153, 0
v_pk_max_i16 v126, v154, 0
v_mfma_f32_16x16x32_bf16 v[176:179], v[32:35], v[64:67], v[176:179]
buffer_load_dwordx4 a[224:227], v1, s[8:11], s7 offen offset:0 sc1
ds_read_b64_tr_b16 v[24:25], v10 offset:16384
v_mfma_f32_16x16x32_bf16 v[184:187], v[32:35], v[68:71], v[184:187]
ds_read_b64_tr_b16 v[26:27], v10 offset:18432
v_pk_max_i16 v127, v155, 0
v_bitop3_b32 v132, v132, v124, v125 bitop3:0x96
v_mfma_f32_16x16x32_bf16 v[180:183], v[36:39], v[64:67], v[180:183]
ds_read_b64_tr_b16 v[28:29], v11 offset:16384
v_bitop3_b32 v132, v132, v126, v127 bitop3:0x96
v_mfma_f32_16x16x32_bf16 v[188:191], v[36:39], v[68:71], v[188:191]
ds_read_b64_tr_b16 v[30:31], v11 offset:18432
s_waitcnt lgkmcnt(4)
v_mfma_f32_16x16x32_bf16 v[160:163], v[40:43], v[72:75], v[160:163]
buffer_load_dwordx4 a[228:231], v1, s[8:11], s7 offen offset:1024 sc1
ds_read_b64_tr_b16 v[32:33], v12 offset:16384
v_mfma_f32_16x16x32_bf16 v[168:171], v[40:43], v[76:79], v[168:171]
ds_read_b64_tr_b16 v[34:35], v12 offset:18432
v_mfma_f32_16x16x32_bf16 v[164:167], v[44:47], v[72:75], v[164:167]
buffer_store_dwordx4 v[124:127], v1, s[8:11], s51 offen offset:3072 sc1
ds_read_b64_tr_b16 v[36:37], v13 offset:16384
v_mfma_f32_16x16x32_bf16 v[172:175], v[44:47], v[76:79], v[172:175]
ds_read_b64_tr_b16 v[38:39], v13 offset:18432
v_mfma_f32_16x16x32_bf16 v[176:179], v[248:251], v[72:75], v[176:179]
ds_read_b64_tr_b16 v[40:41], v10 offset:20480
v_mfma_f32_16x16x32_bf16 v[184:187], v[248:251], v[76:79], v[184:187]
ds_read_b64_tr_b16 v[42:43], v10 offset:22528
v_mfma_f32_16x16x32_bf16 v[180:183], v[252:255], v[72:75], v[180:183]
buffer_load_dwordx4 a[232:235], v1, s[8:11], s7 offen offset:2048 sc1
ds_read_b64_tr_b16 v[44:45], v11 offset:20480
v_mfma_f32_16x16x32_bf16 v[188:191], v[252:255], v[76:79], v[188:191]
ds_read_b64_tr_b16 v[46:47], v11 offset:22528
s_waitcnt lgkmcnt(4)
v_mfma_f32_16x16x32_bf16 v[160:163], v[24:27], v[80:83], v[160:163]
ds_read_b64_tr_b16 v[248:249], v12 offset:20480
v_mfma_f32_16x16x32_bf16 v[168:171], v[24:27], v[84:87], v[168:171]
ds_read_b64_tr_b16 v[250:251], v12 offset:22528
v_mfma_f32_16x16x32_bf16 v[164:167], v[28:31], v[80:83], v[164:167]
buffer_load_dwordx4 a[236:239], v1, s[8:11], s7 offen offset:3072 sc1
ds_read_b64_tr_b16 v[252:253], v13 offset:20480
v_mfma_f32_16x16x32_bf16 v[172:175], v[28:31], v[84:87], v[172:175]
ds_read_b64_tr_b16 v[254:255], v13 offset:22528
v_mfma_f32_16x16x32_bf16 v[176:179], v[32:35], v[80:83], v[176:179]
v_mfma_f32_16x16x32_bf16 v[184:187], v[32:35], v[84:87], v[184:187]
s_waitcnt vmcnt(27)
s_barrier
ds_read_b64_tr_b16 v[24:25], v10 offset:24576
ds_read_b64_tr_b16 v[26:27], v10 offset:26624
s_add_u32 s7, s48, 32768
v_mfma_f32_16x16x32_bf16 v[180:183], v[36:39], v[80:83], v[180:183]
buffer_load_dwordx4 a[240:243], v1, s[8:11], s7 offen offset:0 sc1
ds_read_b64_tr_b16 v[28:29], v11 offset:24576
v_mfma_f32_16x16x32_bf16 v[188:191], v[36:39], v[84:87], v[188:191]
ds_read_b64_tr_b16 v[30:31], v11 offset:26624
s_waitcnt lgkmcnt(4)
v_mfma_f32_16x16x32_bf16 v[160:163], v[40:43], v[88:91], v[160:163]
ds_read_b64_tr_b16 v[32:33], v12 offset:24576
v_mfma_f32_16x16x32_bf16 v[168:171], v[40:43], v[92:95], v[168:171]
ds_read_b64_tr_b16 v[34:35], v12 offset:26624
buffer_store_dword v132, v19, s[8:11], s51 offen sc1
v_mfma_f32_16x16x32_bf16 v[164:167], v[44:47], v[88:91], v[164:167]
ds_read_b64_tr_b16 v[36:37], v13 offset:24576
v_mfma_f32_16x16x32_bf16 v[172:175], v[44:47], v[92:95], v[172:175]
ds_read_b64_tr_b16 v[38:39], v13 offset:26624
v_mfma_f32_16x16x32_bf16 v[176:179], v[248:251], v[88:91], v[176:179]
ds_read_b64_tr_b16 v[40:41], v10 offset:28672
v_mfma_f32_16x16x32_bf16 v[184:187], v[248:251], v[92:95], v[184:187]
ds_read_b64_tr_b16 v[42:43], v10 offset:30720
v_mfma_f32_16x16x32_bf16 v[180:183], v[252:255], v[88:91], v[180:183]
buffer_load_dwordx4 a[244:247], v1, s[8:11], s7 offen offset:1024 sc1
ds_read_b64_tr_b16 v[44:45], v11 offset:28672
v_mfma_f32_16x16x32_bf16 v[188:191], v[252:255], v[92:95], v[188:191]
ds_read_b64_tr_b16 v[46:47], v11 offset:30720
s_waitcnt lgkmcnt(4)
v_mfma_f32_16x16x32_bf16 v[192:195], v[24:27], v[96:99], v[192:195]
ds_read_b64_tr_b16 v[248:249], v12 offset:28672
s_add_u32 m0, s30, 49152
v_mfma_f32_16x16x32_bf16 v[200:203], v[24:27], v[100:103], v[200:203]
ds_read_b64_tr_b16 v[250:251], v12 offset:30720
s_add_u32 s6, s98, 147456
v_mfma_f32_16x16x32_bf16 v[196:199], v[28:31], v[96:99], v[196:199]
buffer_load_dwordx4 v4, s[16:19], s6 offen offset:0 lds
ds_read_b64_tr_b16 v[252:253], v13 offset:28672
v_mfma_f32_16x16x32_bf16 v[204:207], v[28:31], v[100:103], v[204:207]
ds_read_b64_tr_b16 v[254:255], v13 offset:30720
v_mfma_f32_16x16x32_bf16 v[208:211], v[32:35], v[96:99], v[208:211]
ds_read_b64_tr_b16 v[24:25], v10 offset:32768
v_mfma_f32_16x16x32_bf16 v[216:219], v[32:35], v[100:103], v[216:219]
ds_read_b64_tr_b16 v[26:27], v10 offset:34816
v_mfma_f32_16x16x32_bf16 v[212:215], v[36:39], v[96:99], v[212:215]
buffer_load_dwordx4 v5, s[16:19], s6 offen offset:1024 lds
ds_read_b64_tr_b16 v[28:29], v11 offset:32768
v_mfma_f32_16x16x32_bf16 v[220:223], v[36:39], v[100:103], v[220:223]
ds_read_b64_tr_b16 v[30:31], v11 offset:34816
s_waitcnt lgkmcnt(4)
v_mfma_f32_16x16x32_bf16 v[192:195], v[40:43], v[104:107], v[192:195]
ds_read_b64_tr_b16 v[32:33], v12 offset:32768
s_add_u32 m0, s30, 57344
v_mfma_f32_16x16x32_bf16 v[200:203], v[40:43], v[108:111], v[200:203]
ds_read_b64_tr_b16 v[34:35], v12 offset:34816
s_add_u32 s6, s55, 1253376
v_mfma_f32_16x16x32_bf16 v[196:199], v[44:47], v[104:107], v[196:199]
buffer_load_dwordx4 v4, s[16:19], s6 offen offset:0 lds
ds_read_b64_tr_b16 v[36:37], v13 offset:32768
v_mfma_f32_16x16x32_bf16 v[204:207], v[44:47], v[108:111], v[204:207]
ds_read_b64_tr_b16 v[38:39], v13 offset:34816
v_mfma_f32_16x16x32_bf16 v[208:211], v[248:251], v[104:107], v[208:211]
ds_read_b64_tr_b16 v[40:41], v10 offset:36864
v_mfma_f32_16x16x32_bf16 v[216:219], v[248:251], v[108:111], v[216:219]
ds_read_b64_tr_b16 v[42:43], v10 offset:38912
v_mfma_f32_16x16x32_bf16 v[212:215], v[252:255], v[104:107], v[212:215]
buffer_load_dwordx4 v5, s[16:19], s6 offen offset:1024 lds
ds_read_b64_tr_b16 v[44:45], v11 offset:36864
v_mfma_f32_16x16x32_bf16 v[220:223], v[252:255], v[108:111], v[220:223]
ds_read_b64_tr_b16 v[46:47], v11 offset:38912
s_waitcnt lgkmcnt(4)
v_mfma_f32_16x16x32_bf16 v[192:195], v[24:27], v[112:115], v[192:195]
ds_read_b64_tr_b16 v[248:249], v12 offset:36864
s_add_u32 m0, s30, 65536
v_mfma_f32_16x16x32_bf16 v[200:203], v[24:27], v[116:119], v[200:203]
ds_read_b64_tr_b16 v[250:251], v12 offset:38912
s_add_u32 s6, s97, 221184
v_mfma_f32_16x16x32_bf16 v[196:199], v[28:31], v[112:115], v[196:199]
buffer_load_dwordx4 v4, s[16:19], s6 offen offset:0 lds
ds_read_b64_tr_b16 v[252:253], v13 offset:36864
v_mfma_f32_16x16x32_bf16 v[204:207], v[28:31], v[116:119], v[204:207]
ds_read_b64_tr_b16 v[254:255], v13 offset:38912
v_mfma_f32_16x16x32_bf16 v[208:211], v[32:35], v[112:115], v[208:211]
ds_read_b64_tr_b16 v[24:25], v10 offset:40960
v_mfma_f32_16x16x32_bf16 v[216:219], v[32:35], v[116:119], v[216:219]
ds_read_b64_tr_b16 v[26:27], v10 offset:43008
v_mfma_f32_16x16x32_bf16 v[212:215], v[36:39], v[112:115], v[212:215]
buffer_load_dwordx4 v5, s[16:19], s6 offen offset:1024 lds
ds_read_b64_tr_b16 v[28:29], v11 offset:40960
v_mfma_f32_16x16x32_bf16 v[220:223], v[36:39], v[116:119], v[220:223]
ds_read_b64_tr_b16 v[30:31], v11 offset:43008
s_waitcnt lgkmcnt(4)
v_mfma_f32_16x16x32_bf16 v[192:195], v[40:43], v[120:123], v[192:195]
ds_read_b64_tr_b16 v[32:33], v12 offset:40960
v_mfma_f32_16x16x32_bf16 v[200:203], v[40:43], v[124:127], v[200:203]
ds_read_b64_tr_b16 v[34:35], v12 offset:43008
v_mfma_f32_16x16x32_bf16 v[196:199], v[44:47], v[120:123], v[196:199]
buffer_load_dwordx4 a[248:251], v1, s[8:11], s7 offen offset:2048 sc1
ds_read_b64_tr_b16 v[36:37], v13 offset:40960
v_mfma_f32_16x16x32_bf16 v[204:207], v[44:47], v[124:127], v[204:207]
ds_read_b64_tr_b16 v[38:39], v13 offset:43008
v_mfma_f32_16x16x32_bf16 v[208:211], v[248:251], v[120:123], v[208:211]
ds_read_b64_tr_b16 v[40:41], v10 offset:45056
v_mfma_f32_16x16x32_bf16 v[216:219], v[248:251], v[124:127], v[216:219]
ds_read_b64_tr_b16 v[42:43], v10 offset:47104
v_mfma_f32_16x16x32_bf16 v[212:215], v[252:255], v[120:123], v[212:215]
buffer_load_dwordx4 a[252:255], v1, s[8:11], s7 offen offset:3072 sc1
ds_read_b64_tr_b16 v[44:45], v11 offset:45056
v_mfma_f32_16x16x32_bf16 v[220:223], v[252:255], v[124:127], v[220:223]
ds_read_b64_tr_b16 v[46:47], v11 offset:47104
s_waitcnt lgkmcnt(4)
v_mfma_f32_16x16x32_bf16 v[192:195], v[24:27], a[144:147], v[192:195]
ds_read_b64_tr_b16 v[248:249], v12 offset:45056
v_mfma_f32_16x16x32_bf16 v[200:203], v[24:27], a[148:151], v[200:203]
ds_read_b64_tr_b16 v[250:251], v12 offset:47104
s_add_u32 s7, s49, 32768
v_mfma_f32_16x16x32_bf16 v[196:199], v[28:31], a[144:147], v[196:199]
buffer_load_dwordx4 a[0:3], v1, s[8:11], s7 offen offset:0 sc1
ds_read_b64_tr_b16 v[252:253], v13 offset:45056
v_mfma_f32_16x16x32_bf16 v[204:207], v[28:31], a[148:151], v[204:207]
ds_read_b64_tr_b16 v[254:255], v13 offset:47104
v_mfma_f32_16x16x32_bf16 v[208:211], v[32:35], a[144:147], v[208:211]
v_mfma_f32_16x16x32_bf16 v[216:219], v[32:35], a[148:151], v[216:219]
s_waitcnt vmcnt(30)
s_barrier
v_add_u32 v10, 4294868992, v10
ds_read_b64_tr_b16 v[24:25], v10 offset:0
ds_read_b64_tr_b16 v[26:27], v10 offset:2048
v_mfma_f32_16x16x32_bf16 v[212:215], v[36:39], a[144:147], v[212:215]
buffer_load_dwordx4 a[4:7], v1, s[8:11], s7 offen offset:1024 sc1
v_add_u32 v11, 4294868992, v11
ds_read_b64_tr_b16 v[28:29], v11 offset:0
v_mfma_f32_16x16x32_bf16 v[220:223], v[36:39], a[148:151], v[220:223]
ds_read_b64_tr_b16 v[30:31], v11 offset:2048
s_waitcnt lgkmcnt(4)
v_mfma_f32_16x16x32_bf16 v[192:195], v[40:43], a[152:155], v[192:195]
v_add_u32 v12, 4294868992, v12
ds_read_b64_tr_b16 v[32:33], v12 offset:0
v_mfma_f32_16x16x32_bf16 v[200:203], v[40:43], a[156:159], v[200:203]
ds_read_b64_tr_b16 v[34:35], v12 offset:2048
v_mfma_f32_16x16x32_bf16 v[196:199], v[44:47], a[152:155], v[196:199]
buffer_load_dwordx4 a[8:11], v1, s[8:11], s7 offen offset:2048 sc1
v_add_u32 v13, 4294868992, v13
ds_read_b64_tr_b16 v[36:37], v13 offset:0
v_mfma_f32_16x16x32_bf16 v[204:207], v[44:47], a[156:159], v[204:207]
ds_read_b64_tr_b16 v[38:39], v13 offset:2048
v_mfma_f32_16x16x32_bf16 v[208:211], v[248:251], a[152:155], v[208:211]
ds_read_b64_tr_b16 v[40:41], v10 offset:4096
v_mfma_f32_16x16x32_bf16 v[216:219], v[248:251], a[156:159], v[216:219]
ds_read_b64_tr_b16 v[42:43], v10 offset:6144
v_mfma_f32_16x16x32_bf16 v[212:215], v[252:255], a[152:155], v[212:215]
buffer_load_dwordx4 a[12:15], v1, s[8:11], s7 offen offset:3072 sc1
ds_read_b64_tr_b16 v[44:45], v11 offset:4096
v_mfma_f32_16x16x32_bf16 v[220:223], v[252:255], a[156:159], v[220:223]
ds_read_b64_tr_b16 v[46:47], v11 offset:6144
s_load_dwordx4 s[56:59], s[8:9], s36 offset:512 glc
s_waitcnt lgkmcnt(4)
v_mfma_f32_16x16x32_bf16 v[192:195], v[24:27], a[160:163], v[192:195]
ds_read_b64_tr_b16 v[248:249], v12 offset:4096
s_add_u32 s7, s34, 327680
v_mfma_f32_16x16x32_bf16 v[200:203], v[24:27], a[164:167], v[200:203]
ds_read_b64_tr_b16 v[250:251], v12 offset:6144
v_lshrrev_b32 v158, 4, v0
v_lshl_add_u32 v20, v158, 3, s28
v_mfma_f32_16x16x32_bf16 v[196:199], v[28:31], a[160:163], v[196:199]
buffer_load_dwordx4 a[16:19], v1, s[8:11], s7 offen offset:0 sc1
ds_read_b64_tr_b16 v[252:253], v13 offset:4096
v_mfma_f32_16x16x32_bf16 v[204:207], v[28:31], a[164:167], v[204:207]
ds_read_b64_tr_b16 v[254:255], v13 offset:6144
v_lshl_add_u32 v21, v158, 3, s31
v_mfma_f32_16x16x32_bf16 v[208:211], v[32:35], a[160:163], v[208:211]
ds_read_b64_tr_b16 v[24:25], v10 offset:8192
v_and_b32 v2, 31, v0
v_mfma_f32_16x16x32_bf16 v[216:219], v[32:35], a[164:167], v[216:219]
ds_read_b64_tr_b16 v[26:27], v10 offset:10240
v_mul_u32_u24 v2, 1152, v2
v_lshrrev_b32 v22, 5, v0
v_mfma_f32_16x16x32_bf16 v[212:215], v[36:39], a[160:163], v[212:215]
buffer_load_dwordx4 a[20:23], v1, s[8:11], s7 offen offset:1024 sc1
ds_read_b64_tr_b16 v[28:29], v11 offset:8192
v_mfma_f32_16x16x32_bf16 v[220:223], v[36:39], a[164:167], v[220:223]
ds_read_b64_tr_b16 v[30:31], v11 offset:10240
s_waitcnt lgkmcnt(4)
v_mfma_f32_16x16x32_bf16 v[192:195], v[40:43], a[168:171], v[192:195]
ds_read_b64_tr_b16 v[32:33], v12 offset:8192
v_lshl_add_u32 v2, v22, 4, v2
v_mfma_f32_16x16x32_bf16 v[200:203], v[40:43], a[172:175], v[200:203]
ds_read_b64_tr_b16 v[34:35], v12 offset:10240
v_bfe_u32 v152, v0, 2, 2
v_xor_b32 v158, v152, v158
v_mfma_f32_16x16x32_bf16 v[196:199], v[44:47], a[168:171], v[196:199]
buffer_load_dwordx4 v[128:131], v1, s[8:11], s25 offen offset:0 sc1
ds_read_b64_tr_b16 v[36:37], v13 offset:8192
v_mfma_f32_16x16x32_bf16 v[204:207], v[44:47], a[172:175], v[204:207]
ds_read_b64_tr_b16 v[38:39], v13 offset:10240
v_add_u32 v158, -1, v158
v_mfma_f32_16x16x32_bf16 v[208:211], v[248:251], a[168:171], v[208:211]
ds_read_b64_tr_b16 v[40:41], v10 offset:12288
v_ashrrev_i32 v158, 31, v158
v_mfma_f32_16x16x32_bf16 v[216:219], v[248:251], a[172:175], v[216:219]
ds_read_b64_tr_b16 v[42:43], v10 offset:14336
v_and_b32 v152, 1, v0
v_lshlrev_b32 v152, 4, v152
v_mfma_f32_16x16x32_bf16 v[212:215], v[252:255], a[168:171], v[212:215]
global_load_dwordx2 v[140:141], v20, s[4:5] offset:0
ds_read_b64_tr_b16 v[44:45], v11 offset:12288
v_mfma_f32_16x16x32_bf16 v[220:223], v[252:255], a[172:175], v[220:223]
ds_read_b64_tr_b16 v[46:47], v11 offset:14336
s_waitcnt lgkmcnt(4)
v_mfma_f32_16x16x32_bf16 v[192:195], v[24:27], a[176:179], v[192:195]
buffer_load_dwordx4 v[132:135], v1, s[8:11], s25 offen offset:1024 sc1
ds_read_b64_tr_b16 v[248:249], v12 offset:12288
v_mfma_f32_16x16x32_bf16 v[200:203], v[24:27], a[180:183], v[200:203]
ds_read_b64_tr_b16 v[250:251], v12 offset:14336
v_mov_b32 v153, 0x3f80
v_mfma_f32_16x16x32_bf16 v[196:199], v[28:31], a[176:179], v[196:199]
global_load_dwordx2 v[142:143], v20, s[4:5] offset:32
ds_read_b64_tr_b16 v[252:253], v13 offset:12288
v_mfma_f32_16x16x32_bf16 v[204:207], v[28:31], a[180:183], v[204:207]
ds_read_b64_tr_b16 v[254:255], v13 offset:14336
v_lshlrev_b32 v152, v152, v153
v_mfma_f32_16x16x32_bf16 v[208:211], v[32:35], a[176:179], v[208:211]
ds_read_b64_tr_b16 v[24:25], v10 offset:16384
v_and_b32 v158, v158, v152
v_mfma_f32_16x16x32_bf16 v[216:219], v[32:35], a[180:183], v[216:219]
ds_read_b64_tr_b16 v[26:27], v10 offset:18432
v_bfe_i32 v152, v0, 1, 1
v_and_b32 v155, v152, v158
v_mfma_f32_16x16x32_bf16 v[212:215], v[36:39], a[176:179], v[212:215]
buffer_load_dwordx4 a[24:27], v1, s[8:11], s7 offen offset:2048 sc1
ds_read_b64_tr_b16 v[28:29], v11 offset:16384
v_mfma_f32_16x16x32_bf16 v[220:223], v[36:39], a[180:183], v[220:223]
ds_read_b64_tr_b16 v[30:31], v11 offset:18432
s_waitcnt lgkmcnt(4)
v_mfma_f32_16x16x32_bf16 v[192:195], v[40:43], a[184:187], v[192:195]
ds_read_b64_tr_b16 v[32:33], v12 offset:16384
v_xor_b32 v154, v155, v158
v_mfma_f32_16x16x32_bf16 v[200:203], v[40:43], a[188:191], v[200:203]
ds_read_b64_tr_b16 v[34:35], v12 offset:18432
v_mov_b32 v152, 0
v_mov_b32 v153, 0
v_mfma_f32_16x16x32_bf16 v[196:199], v[44:47], a[184:187], v[196:199]
buffer_load_dwordx4 a[28:31], v1, s[8:11], s7 offen offset:3072 sc1
ds_read_b64_tr_b16 v[36:37], v13 offset:16384
v_mfma_f32_16x16x32_bf16 v[204:207], v[44:47], a[188:191], v[204:207]
ds_read_b64_tr_b16 v[38:39], v13 offset:18432
v_mov_b32 v156, 0
v_mfma_f32_16x16x32_bf16 v[208:211], v[248:251], a[184:187], v[208:211]
ds_read_b64_tr_b16 v[40:41], v10 offset:20480
s_add_u32 m0, s30, 73728
v_mfma_f32_16x16x32_bf16 v[216:219], v[248:251], a[188:191], v[216:219]
ds_read_b64_tr_b16 v[42:43], v10 offset:22528
s_add_u32 s6, s98, 221184
v_mov_b32 v157, 0
v_mfma_f32_16x16x32_bf16 v[212:215], v[252:255], a[184:187], v[212:215]
buffer_load_dwordx4 v4, s[16:19], s6 offen offset:0 lds
ds_read_b64_tr_b16 v[44:45], v11 offset:20480
v_mfma_f32_16x16x32_bf16 v[220:223], v[252:255], a[188:191], v[220:223]
ds_read_b64_tr_b16 v[46:47], v11 offset:22528
s_waitcnt lgkmcnt(0)
v_mfma_f32_16x16x32_bf16 v[192:195], v[24:27], a[192:195], v[192:195]
ds_read_b64_tr_b16 v[248:249], v12 offset:20480
s_xor_b64 s[56:57], s[56:57], s[0:1]
s_xor_b32 s58, s58, s0
s_or_b32 s57, s57, s58
v_mfma_f32_16x16x32_bf16 v[200:203], v[24:27], a[196:199], v[200:203]
ds_read_b64_tr_b16 v[250:251], v12 offset:22528
s_or_b32 s56, s56, s57
s_cbranch_scc1 K3B_slow4
K3B_back4:
s_add_u32 s7, s48, 49152
v_mfma_f32_16x16x32_bf16 v[196:199], v[28:31], a[192:195], v[196:199]
buffer_load_dwordx4 a[32:35], v1, s[8:11], s7 offen offset:0 sc1
ds_read_b64_tr_b16 v[252:253], v13 offset:20480
v_mfma_f32_16x16x32_bf16 v[204:207], v[28:31], a[196:199], v[204:207]
ds_read_b64_tr_b16 v[254:255], v13 offset:22528
v_mfma_f32_16x16x32_bf16 v[208:211], v[32:35], a[192:195], v[208:211]
v_mfma_f32_16x16x32_bf16 v[216:219], v[32:35], a[196:199], v[216:219]
s_waitcnt vmcnt(30)
s_barrier
ds_read_b64_tr_b16 v[24:25], v10 offset:24576
ds_read_b64_tr_b16 v[26:27], v10 offset:26624
v_mfma_f32_16x16x32_bf16 v[212:215], v[36:39], a[192:195], v[212:215]
buffer_load_dwordx4 a[36:39], v1, s[8:11], s7 offen offset:1024 sc1
ds_read_b64_tr_b16 v[28:29], v11 offset:24576
v_mfma_f32_16x16x32_bf16 v[220:223], v[36:39], a[196:199], v[220:223]
ds_read_b64_tr_b16 v[30:31], v11 offset:26624
s_waitcnt lgkmcnt(4)
v_mfma_f32_16x16x32_bf16 v[192:195], v[40:43], a[200:203], v[192:195]
ds_read_b64_tr_b16 v[32:33], v12 offset:24576
v_mfma_f32_16x16x32_bf16 v[200:203], v[40:43], a[204:207], v[200:203]
ds_read_b64_tr_b16 v[34:35], v12 offset:26624
v_mfma_f32_16x16x32_bf16 v[196:199], v[44:47], a[200:203], v[196:199]
buffer_load_dwordx4 v5, s[16:19], s6 offen offset:1024 lds
ds_read_b64_tr_b16 v[36:37], v13 offset:24576
v_mfma_f32_16x16x32_bf16 v[204:207], v[44:47], a[204:207], v[204:207]
ds_read_b64_tr_b16 v[38:39], v13 offset:26624
v_mfma_f32_16x16x32_bf16 v[208:211], v[248:251], a[200:203], v[208:211]
ds_read_b64_tr_b16 v[40:41], v10 offset:28672
s_add_u32 m0, s30, 81920
v_mfma_f32_16x16x32_bf16 v[216:219], v[248:251], a[204:207], v[216:219]
ds_read_b64_tr_b16 v[42:43], v10 offset:30720
s_add_u32 s6, s97, 294912
v_mfma_f32_16x16x32_bf16 v[212:215], v[252:255], a[200:203], v[212:215]
buffer_load_dwordx4 v4, s[16:19], s6 offen offset:0 lds
ds_read_b64_tr_b16 v[44:45], v11 offset:28672
v_mfma_f32_16x16x32_bf16 v[220:223], v[252:255], a[204:207], v[220:223]
ds_read_b64_tr_b16 v[46:47], v11 offset:30720
s_waitcnt lgkmcnt(4)
v_mfma_f32_16x16x32_bf16 v[192:195], v[24:27], a[208:211], v[192:195]
ds_read_b64_tr_b16 v[248:249], v12 offset:28672
v_mfma_f32_16x16x32_bf16 v[200:203], v[24:27], a[212:215], v[200:203]
ds_read_b64_tr_b16 v[250:251], v12 offset:30720
v_mfma_f32_16x16x32_bf16 v[196:199], v[28:31], a[208:211], v[196:199]
ds_read_b64_tr_b16 v[252:253], v13 offset:28672
v_mfma_f32_16x16x32_bf16 v[204:207], v[28:31], a[212:215], v[204:207]
ds_read_b64_tr_b16 v[254:255], v13 offset:30720
v_mfma_f32_16x16x32_bf16 v[208:211], v[32:35], a[208:211], v[208:211]
ds_read_b64_tr_b16 v[24:25], v10 offset:32768
v_mfma_f32_16x16x32_bf16 v[216:219], v[32:35], a[212:215], v[216:219]
ds_read_b64_tr_b16 v[26:27], v10 offset:34816
v_mfma_f32_16x16x32_bf16 v[212:215], v[36:39], a[208:211], v[212:215]
ds_read_b64_tr_b16 v[28:29], v11 offset:32768
v_mfma_f32_16x16x32_bf16 v[220:223], v[36:39], a[212:215], v[220:223]
ds_read_b64_tr_b16 v[30:31], v11 offset:34816
s_waitcnt lgkmcnt(4)
v_mfma_f32_16x16x32_bf16 v[192:195], v[40:43], a[216:219], v[192:195]
ds_read_b64_tr_b16 v[32:33], v12 offset:32768
v_mfma_f32_16x16x32_bf16 v[200:203], v[40:43], a[220:223], v[200:203]
ds_read_b64_tr_b16 v[34:35], v12 offset:34816
v_mfma_f32_16x16x32_bf16 v[196:199], v[44:47], a[216:219], v[196:199]
ds_read_b64_tr_b16 v[36:37], v13 offset:32768
v_mfma_f32_16x16x32_bf16 v[204:207], v[44:47], a[220:223], v[204:207]
ds_read_b64_tr_b16 v[38:39], v13 offset:34816
v_mfma_f32_16x16x32_bf16 v[208:211], v[248:251], a[216:219], v[208:211]
buffer_load_dwordx4 v5, s[16:19], s6 offen offset:1024 lds
ds_read_b64_tr_b16 v[40:41], v10 offset:36864
v_mfma_f32_16x16x32_bf16 v[216:219], v[248:251], a[220:223], v[216:219]
ds_read_b64_tr_b16 v[42:43], v10 offset:38912
v_mfma_f32_16x16x32_bf16 v[212:215], v[252:255], a[216:219], v[212:215]
ds_read_b64_tr_b16 v[44:45], v11 offset:36864
s_add_u32 m0, s30, 90112
s_add_u32 s6, s98, 294912
v_mfma_f32_16x16x32_bf16 v[220:223], v[252:255], a[220:223], v[220:223]
ds_read_b64_tr_b16 v[46:47], v11 offset:38912
s_waitcnt vmcnt(32)
s_waitcnt lgkmcnt(4)
v_mfma_f32_16x16x32_bf16 v[192:195], v[24:27], a[224:227], v[192:195]
buffer_load_dwordx4 v4, s[16:19], s6 offen offset:0 lds
ds_read_b64_tr_b16 v[248:249], v12 offset:36864
v_mfma_f32_16x16x32_bf16 v[200:203], v[24:27], a[228:231], v[200:203]
ds_read_b64_tr_b16 v[250:251], v12 offset:38912
v_mfma_f32_16x16x32_bf16 v[196:199], v[28:31], a[224:227], v[196:199]
ds_read_b64_tr_b16 v[252:253], v13 offset:36864
v_mfma_f32_16x16x32_bf16 v[204:207], v[28:31], a[228:231], v[204:207]
ds_read_b64_tr_b16 v[254:255], v13 offset:38912
v_mfma_f32_16x16x32_bf16 v[208:211], v[32:35], a[224:227], v[208:211]
buffer_load_dwordx4 v5, s[16:19], s6 offen offset:1024 lds
ds_read_b64_tr_b16 v[24:25], v10 offset:40960
v_mfma_f32_16x16x32_bf16 v[216:219], v[32:35], a[228:231], v[216:219]
ds_read_b64_tr_b16 v[26:27], v10 offset:43008
v_mfma_f32_16x16x32_bf16 v[212:215], v[36:39], a[224:227], v[212:215]
ds_read_b64_tr_b16 v[28:29], v11 offset:40960
v_mfma_f32_16x16x32_bf16 v[220:223], v[36:39], a[228:231], v[220:223]
ds_read_b64_tr_b16 v[30:31], v11 offset:43008
s_waitcnt vmcnt(31)
s_waitcnt lgkmcnt(4)
v_mfma_f32_16x16x32_bf16 v[192:195], v[40:43], a[232:235], v[192:195]
buffer_load_dwordx4 a[40:43], v1, s[8:11], s7 offen offset:2048 sc1
ds_read_b64_tr_b16 v[32:33], v12 offset:40960
v_mfma_f32_16x16x32_bf16 v[200:203], v[40:43], a[236:239], v[200:203]
ds_read_b64_tr_b16 v[34:35], v12 offset:43008
v_mfma_f32_16x16x32_bf16 v[196:199], v[44:47], a[232:235], v[196:199]
ds_read_b64_tr_b16 v[36:37], v13 offset:40960
v_mfma_f32_16x16x32_bf16 v[204:207], v[44:47], a[236:239], v[204:207]
ds_read_b64_tr_b16 v[38:39], v13 offset:43008
v_mfma_f32_16x16x32_bf16 v[208:211], v[248:251], a[232:235], v[208:211]
buffer_load_dwordx4 a[44:47], v1, s[8:11], s7 offen offset:3072 sc1
ds_read_b64_tr_b16 v[40:41], v10 offset:45056
v_mfma_f32_16x16x32_bf16 v[216:219], v[248:251], a[236:239], v[216:219]
ds_read_b64_tr_b16 v[42:43], v10 offset:47104
v_mfma_f32_16x16x32_bf16 v[212:215], v[252:255], a[232:235], v[212:215]
ds_read_b64_tr_b16 v[44:45], v11 offset:45056
s_add_u32 s7, s49, 49152
v_mfma_f32_16x16x32_bf16 v[220:223], v[252:255], a[236:239], v[220:223]
ds_read_b64_tr_b16 v[46:47], v11 offset:47104
s_waitcnt vmcnt(30)
s_waitcnt lgkmcnt(4)
v_mfma_f32_16x16x32_bf16 v[192:195], v[24:27], a[240:243], v[192:195]
buffer_load_dwordx4 a[48:51], v1, s[8:11], s7 offen offset:0 sc1
ds_read_b64_tr_b16 v[248:249], v12 offset:45056
v_mfma_f32_16x16x32_bf16 v[200:203], v[24:27], a[244:247], v[200:203]
ds_read_b64_tr_b16 v[250:251], v12 offset:47104
v_mfma_f32_16x16x32_bf16 v[196:199], v[28:31], a[240:243], v[196:199]
ds_read_b64_tr_b16 v[252:253], v13 offset:45056
v_mfma_f32_16x16x32_bf16 v[204:207], v[28:31], a[244:247], v[204:207]
ds_read_b64_tr_b16 v[254:255], v13 offset:47104
v_mfma_f32_16x16x32_bf16 v[208:211], v[32:35], a[240:243], v[208:211]
v_mfma_f32_16x16x32_bf16 v[216:219], v[32:35], a[244:247], v[216:219]
s_waitcnt vmcnt(25)
s_barrier
buffer_load_dwordx4 a[52:55], v1, s[8:11], s7 offen offset:1024 sc1
v_add_u32 v10, 49152, v10
ds_read_b64_tr_b16 v[24:25], v10 offset:0
ds_read_b64_tr_b16 v[26:27], v10 offset:2048
v_mfma_f32_16x16x32_bf16 v[212:215], v[36:39], a[240:243], v[212:215]
v_add_u32 v11, 49152, v11
ds_read_b64_tr_b16 v[28:29], v11 offset:0
v_mfma_f32_16x16x32_bf16 v[220:223], v[36:39], a[244:247], v[220:223]
ds_read_b64_tr_b16 v[30:31], v11 offset:2048
s_waitcnt vmcnt(24)
s_waitcnt lgkmcnt(4)
v_mfma_f32_16x16x32_bf16 v[192:195], v[40:43], a[248:251], v[192:195]
buffer_load_dwordx4 a[56:59], v1, s[8:11], s7 offen offset:2048 sc1
v_add_u32 v12, 49152, v12
ds_read_b64_tr_b16 v[32:33], v12 offset:0
v_mfma_f32_16x16x32_bf16 v[200:203], v[40:43], a[252:255], v[200:203]
s_branch PGB_6
.p2align 12
PSB_6:
s_setpc_b64 s[62:63]
PGB_6:
ds_read_b64_tr_b16 v[34:35], v12 offset:2048
v_mfma_f32_16x16x32_bf16 v[196:199], v[44:47], a[248:251], v[196:199]
v_add_u32 v13, 49152, v13
ds_read_b64_tr_b16 v[36:37], v13 offset:0
v_mfma_f32_16x16x32_bf16 v[204:207], v[44:47], a[252:255], v[204:207]
ds_read_b64_tr_b16 v[38:39], v13 offset:2048
s_waitcnt vmcnt(15)
v_mfma_f32_16x16x32_bf16 v[208:211], v[248:251], a[248:251], v[208:211]
buffer_load_dwordx4 a[60:63], v1, s[8:11], s7 offen offset:3072 sc1
ds_read_b64_tr_b16 v[40:41], v10 offset:4096
v_mfma_f32_16x16x32_bf16 v[216:219], v[248:251], a[252:255], v[216:219]
ds_read_b64_tr_b16 v[42:43], v10 offset:6144
v_lshlrev_b32 v224, 16, v128
v_mfma_f32_16x16x32_bf16 v[212:215], v[252:255], a[248:251], v[212:215]
ds_read_b64_tr_b16 v[44:45], v11 offset:4096
s_add_u32 s7, s48, 65536
v_mfma_f32_16x16x32_bf16 v[220:223], v[252:255], a[252:255], v[220:223]
ds_read_b64_tr_b16 v[46:47], v11 offset:6144
v_and_b32 v225, s39, v128
s_waitcnt lgkmcnt(4)
v_mfma_f32_16x16x32_bf16 v[192:195], v[24:27], a[0:3], v[192:195]
buffer_load_dwordx4 v[48:51], v1, s[8:11], s7 offen offset:0 sc1
ds_read_b64_tr_b16 v[248:249], v12 offset:4096
v_mfma_f32_16x16x32_bf16 v[200:203], v[24:27], a[4:7], v[200:203]
ds_read_b64_tr_b16 v[250:251], v12 offset:6144
v_lshlrev_b32 v226, 16, v129
v_mfma_f32_16x16x32_bf16 v[196:199], v[28:31], a[0:3], v[196:199]
ds_read_b64_tr_b16 v[252:253], v13 offset:4096
v_and_b32 v227, s39, v129
v_mfma_f32_16x16x32_bf16 v[204:207], v[28:31], a[4:7], v[204:207]
ds_read_b64_tr_b16 v[254:255], v13 offset:6144
v_lshlrev_b32 v228, 16, v130
v_and_b32 v229, s39, v130
v_mfma_f32_16x16x32_bf16 v[208:211], v[32:35], a[0:3], v[208:211]
buffer_load_dwordx4 v[52:55], v1, s[8:11], s7 offen offset:1024 sc1
ds_read_b64_tr_b16 v[24:25], v10 offset:8192
v_mfma_f32_16x16x32_bf16 v[216:219], v[32:35], a[4:7], v[216:219]
ds_read_b64_tr_b16 v[26:27], v10 offset:10240
v_lshlrev_b32 v230, 16, v131
v_mfma_f32_16x16x32_bf16 v[212:215], v[36:39], a[0:3], v[212:215]
ds_read_b64_tr_b16 v[28:29], v11 offset:8192
v_and_b32 v231, s39, v131
v_mfma_f32_16x16x32_bf16 v[220:223], v[36:39], a[4:7], v[220:223]
ds_read_b64_tr_b16 v[30:31], v11 offset:10240
v_lshlrev_b32 v232, 16, v132
s_waitcnt lgkmcnt(4)
v_mfma_f32_16x16x32_bf16 v[192:195], v[40:43], a[8:11], v[192:195]
buffer_load_dwordx4 v[56:59], v1, s[8:11], s7 offen offset:2048 sc1
ds_read_b64_tr_b16 v[32:33], v12 offset:8192
v_mfma_f32_16x16x32_bf16 v[200:203], v[40:43], a[12:15], v[200:203]
ds_read_b64_tr_b16 v[34:35], v12 offset:10240
v_and_b32 v233, s39, v132
v_mfma_f32_16x16x32_bf16 v[196:199], v[44:47], a[8:11], v[196:199]
ds_read_b64_tr_b16 v[36:37], v13 offset:8192
v_lshlrev_b32 v234, 16, v133
v_mfma_f32_16x16x32_bf16 v[204:207], v[44:47], a[12:15], v[204:207]
ds_read_b64_tr_b16 v[38:39], v13 offset:10240
v_and_b32 v235, s39, v133
v_lshlrev_b32 v236, 16, v134
v_mfma_f32_16x16x32_bf16 v[208:211], v[248:251], a[8:11], v[208:211]
buffer_load_dwordx4 v[60:63], v1, s[8:11], s7 offen offset:3072 sc1
ds_read_b64_tr_b16 v[40:41], v10 offset:12288
v_mfma_f32_16x16x32_bf16 v[216:219], v[248:251], a[12:15], v[216:219]
ds_read_b64_tr_b16 v[42:43], v10 offset:14336
v_and_b32 v237, s39, v134
v_mfma_f32_16x16x32_bf16 v[212:215], v[252:255], a[8:11], v[212:215]
buffer_load_dword v80, v19, s[8:11], s7 offen sc1
ds_read_b64_tr_b16 v[44:45], v11 offset:12288
v_mfma_f32_16x16x32_bf16 v[220:223], v[252:255], a[12:15], v[220:223]
ds_read_b64_tr_b16 v[46:47], v11 offset:14336
s_waitcnt lgkmcnt(4)
v_mfma_f32_16x16x32_bf16 v[192:195], v[24:27], a[16:19], v[192:195]
ds_read_b64_tr_b16 v[248:249], v12 offset:12288
s_add_u32 s7, s49, 65536
v_mfma_f32_16x16x32_bf16 v[200:203], v[24:27], a[20:23], v[200:203]
ds_read_b64_tr_b16 v[250:251], v12 offset:14336
v_lshlrev_b32 v238, 16, v135
v_and_b32 v239, s39, v135
v_mfma_f32_16x16x32_bf16 v[196:199], v[28:31], a[16:19], v[196:199]
buffer_load_dwordx4 v[64:67], v1, s[8:11], s7 offen offset:0 sc1
ds_read_b64_tr_b16 v[252:253], v13 offset:12288
v_mfma_f32_16x16x32_bf16 v[204:207], v[28:31], a[20:23], v[204:207]
ds_read_b64_tr_b16 v[254:255], v13 offset:14336
v_lshlrev_b32 v128, 16, v140
v_mfma_f32_16x16x32_bf16 v[208:211], v[32:35], a[16:19], v[208:211]
ds_read_b64_tr_b16 v[24:25], v10 offset:16384
v_and_b32 v129, s39, v140
v_mfma_f32_16x16x32_bf16 v[216:219], v[32:35], a[20:23], v[216:219]
ds_read_b64_tr_b16 v[26:27], v10 offset:18432
v_lshlrev_b32 v130, 16, v141
v_and_b32 v131, s39, v141
v_mfma_f32_16x16x32_bf16 v[212:215], v[36:39], a[16:19], v[212:215]
buffer_load_dwordx4 v[68:71], v1, s[8:11], s7 offen offset:1024 sc1
ds_read_b64_tr_b16 v[28:29], v11 offset:16384
v_mfma_f32_16x16x32_bf16 v[220:223], v[36:39], a[20:23], v[220:223]
ds_read_b64_tr_b16 v[30:31], v11 offset:18432
s_waitcnt vmcnt(21)
s_waitcnt lgkmcnt(4)
v_mfma_f32_16x16x32_bf16 v[192:195], v[40:43], a[24:27], v[192:195]
ds_read_b64_tr_b16 v[32:33], v12 offset:16384
v_add_f32 v224, v224, v128
v_mfma_f32_16x16x32_bf16 v[200:203], v[40:43], a[28:31], v[200:203]
ds_read_b64_tr_b16 v[34:35], v12 offset:18432
v_add_f32 v225, v225, v129
v_add_f32 v226, v226, v130
v_mfma_f32_16x16x32_bf16 v[196:199], v[44:47], a[24:27], v[196:199]
buffer_load_dwordx4 v[72:75], v1, s[8:11], s7 offen offset:2048 sc1
ds_read_b64_tr_b16 v[36:37], v13 offset:16384
v_mfma_f32_16x16x32_bf16 v[204:207], v[44:47], a[28:31], v[204:207]
ds_read_b64_tr_b16 v[38:39], v13 offset:18432
v_add_f32 v227, v227, v131
v_mfma_f32_16x16x32_bf16 v[208:211], v[248:251], a[24:27], v[208:211]
ds_read_b64_tr_b16 v[40:41], v10 offset:20480
v_add_f32 v228, v228, v128
v_mfma_f32_16x16x32_bf16 v[216:219], v[248:251], a[28:31], v[216:219]
ds_read_b64_tr_b16 v[42:43], v10 offset:22528
v_add_f32 v229, v229, v129
v_add_f32 v230, v230, v130
v_mfma_f32_16x16x32_bf16 v[212:215], v[252:255], a[24:27], v[212:215]
buffer_load_dwordx4 v[76:79], v1, s[8:11], s7 offen offset:3072 sc1
ds_read_b64_tr_b16 v[44:45], v11 offset:20480
v_mfma_f32_16x16x32_bf16 v[220:223], v[252:255], a[28:31], v[220:223]
ds_read_b64_tr_b16 v[46:47], v11 offset:22528
s_waitcnt vmcnt(20)
s_waitcnt lgkmcnt(4)
v_mfma_f32_16x16x32_bf16 v[192:195], v[24:27], a[32:35], v[192:195]
buffer_load_dword v81, v19, s[8:11], s7 offen sc1
ds_read_b64_tr_b16 v[248:249], v12 offset:20480
v_mfma_f32_16x16x32_bf16 v[200:203], v[24:27], a[36:39], v[200:203]
ds_read_b64_tr_b16 v[250:251], v12 offset:22528
v_add_f32 v231, v231, v131
v_mfma_f32_16x16x32_bf16 v[196:199], v[28:31], a[32:35], v[196:199]
ds_read_b64_tr_b16 v[252:253], v13 offset:20480
s_add_u32 m0, s30, 98304
v_mfma_f32_16x16x32_bf16 v[204:207], v[28:31], a[36:39], v[204:207]
ds_read_b64_tr_b16 v[254:255], v13 offset:22528
s_add_u32 s6, s43, 221184
v_lshlrev_b32 v132, 16, v142
v_mfma_f32_16x16x32_bf16 v[208:211], v[32:35], a[32:35], v[208:211]
v_mfma_f32_16x16x32_bf16 v[216:219], v[32:35], a[36:39], v[216:219]
s_waitcnt vmcnt(16)
s_barrier
buffer_load_dwordx4 v4, s[16:19], s6 offen offset:0 lds
ds_read_b64_tr_b16 v[24:25], v10 offset:24576
ds_read_b64_tr_b16 v[26:27], v10 offset:26624
v_mfma_f32_16x16x32_bf16 v[212:215], v[36:39], a[32:35], v[212:215]
ds_read_b64_tr_b16 v[28:29], v11 offset:24576
v_and_b32 v133, s39, v142
v_lshlrev_b32 v134, 16, v143
v_mfma_f32_16x16x32_bf16 v[220:223], v[36:39], a[36:39], v[220:223]
ds_read_b64_tr_b16 v[30:31], v11 offset:26624
s_waitcnt vmcnt(15)
s_waitcnt lgkmcnt(4)
v_mfma_f32_16x16x32_bf16 v[192:195], v[40:43], a[40:43], v[192:195]
buffer_load_dwordx4 v5, s[16:19], s6 offen offset:1024 lds
ds_read_b64_tr_b16 v[32:33], v12 offset:24576
v_mfma_f32_16x16x32_bf16 v[200:203], v[40:43], a[44:47], v[200:203]
ds_read_b64_tr_b16 v[34:35], v12 offset:26624
v_and_b32 v135, s39, v143
v_mfma_f32_16x16x32_bf16 v[196:199], v[44:47], a[40:43], v[196:199]
ds_read_b64_tr_b16 v[36:37], v13 offset:24576
s_add_u32 m0, s30, 106496
s_add_u32 s6, s43, 294912
v_mfma_f32_16x16x32_bf16 v[204:207], v[44:47], a[44:47], v[204:207]
ds_read_b64_tr_b16 v[38:39], v13 offset:26624
v_add_f32 v232, v232, v132
v_add_f32 v233, v233, v133
v_mfma_f32_16x16x32_bf16 v[208:211], v[248:251], a[40:43], v[208:211]
buffer_load_dwordx4 v4, s[16:19], s6 offen offset:0 lds
ds_read_b64_tr_b16 v[40:41], v10 offset:28672
v_mfma_f32_16x16x32_bf16 v[216:219], v[248:251], a[44:47], v[216:219]
ds_read_b64_tr_b16 v[42:43], v10 offset:30720
v_add_f32 v234, v234, v134
v_add_f32 v235, v235, v135
v_mfma_f32_16x16x32_bf16 v[212:215], v[252:255], a[40:43], v[212:215]
ds_read_b64_tr_b16 v[44:45], v11 offset:28672
v_add_f32 v236, v236, v132
v_add_f32 v237, v237, v133
v_mfma_f32_16x16x32_bf16 v[220:223], v[252:255], a[44:47], v[220:223]
ds_read_b64_tr_b16 v[46:47], v11 offset:30720
v_add_f32 v238, v238, v134
s_waitcnt vmcnt(15)
s_waitcnt lgkmcnt(4)
v_mfma_f32_16x16x32_bf16 v[192:195], v[24:27], a[48:51], v[192:195]
buffer_load_dwordx4 v5, s[16:19], s6 offen offset:1024 lds
ds_read_b64_tr_b16 v[248:249], v12 offset:28672
v_mfma_f32_16x16x32_bf16 v[200:203], v[24:27], a[52:55], v[200:203]
ds_read_b64_tr_b16 v[250:251], v12 offset:30720
v_add_f32 v239, v239, v135
v_mfma_f32_16x16x32_bf16 v[196:199], v[28:31], a[48:51], v[196:199]
ds_read_b64_tr_b16 v[252:253], v13 offset:28672
s_add_u32 m0, s30, 114688
s_add_u32 s6, s44, 0
v_mfma_f32_16x16x32_bf16 v[204:207], v[28:31], a[52:55], v[204:207]
ds_read_b64_tr_b16 v[254:255], v13 offset:30720
s_barrier
s_waitcnt vmcnt(9)
v_mfma_f32_16x16x32_bf16 v[208:211], v[32:35], a[48:51], v[208:211]
buffer_load_dwordx4 v4, s[16:19], s6 offen offset:0 lds
ds_read_b64_tr_b16 v[24:25], v10 offset:32768
v_bitop3_b32 v80, v80, v48, v49 bitop3:0x96
v_mfma_f32_16x16x32_bf16 v[216:219], v[32:35], a[52:55], v[216:219]
ds_read_b64_tr_b16 v[26:27], v10 offset:34816
v_bitop3_b32 v80, v80, v50, v51 bitop3:0x96
v_bitop3_b32 v80, v80, v52, v53 bitop3:0x96
v_mfma_f32_16x16x32_bf16 v[212:215], v[36:39], a[48:51], v[212:215]
ds_read_b64_tr_b16 v[28:29], v11 offset:32768
v_bitop3_b32 v80, v80, v54, v55 bitop3:0x96
v_bitop3_b32 v80, v80, v56, v57 bitop3:0x96
v_mfma_f32_16x16x32_bf16 v[220:223], v[36:39], a[52:55], v[220:223]
ds_read_b64_tr_b16 v[30:31], v11 offset:34816
v_bitop3_b32 v80, v80, v58, v59 bitop3:0x96
s_waitcnt lgkmcnt(4)
v_mfma_f32_16x16x32_bf16 v[192:195], v[40:43], a[56:59], v[192:195]
buffer_load_dwordx4 v5, s[16:19], s6 offen offset:1024 lds
ds_read_b64_tr_b16 v[32:33], v12 offset:32768
v_bitop3_b32 v80, v80, v60, v61 bitop3:0x96
v_mfma_f32_16x16x32_bf16 v[200:203], v[40:43], a[60:63], v[200:203]
ds_read_b64_tr_b16 v[34:35], v12 offset:34816
v_bitop3_b32 v80, v80, v62, v63 bitop3:0x96
v_cmp_ne_u32 s[56:57], s52, v80
v_mfma_f32_16x16x32_bf16 v[196:199], v[44:47], a[56:59], v[196:199]
ds_read_b64_tr_b16 v[36:37], v13 offset:32768
s_cmp_lg_u64 s[56:57], 0
v_mfma_f32_16x16x32_bf16 v[204:207], v[44:47], a[60:63], v[204:207]
ds_read_b64_tr_b16 v[38:39], v13 offset:34816
s_cbranch_scc1 K3B_dr0
K3B_dk0:
s_add_u32 m0, s30, 122880
s_add_u32 s6, s45, 0
v_mfma_f32_16x16x32_bf16 v[208:211], v[248:251], a[56:59], v[208:211]
buffer_load_dwordx4 v4, s[16:19], s6 offen offset:0 lds
ds_read_b64_tr_b16 v[40:41], v10 offset:36864
v_mfma_f32_16x16x32_bf16 v[216:219], v[248:251], a[60:63], v[216:219]
ds_read_b64_tr_b16 v[42:43], v10 offset:38912
v_mfma_f32_16x16x32_bf16 v[212:215], v[252:255], a[56:59], v[212:215]
ds_read_b64_tr_b16 v[44:45], v11 offset:36864
v_mfma_f32_16x16x32_bf16 v[220:223], v[252:255], a[60:63], v[220:223]
ds_read_b64_tr_b16 v[46:47], v11 offset:38912
s_waitcnt lgkmcnt(4)
v_mfma_f32_16x16x32_bf16 v[192:195], v[24:27], v[48:51], v[192:195]
buffer_load_dwordx4 v5, s[16:19], s6 offen offset:1024 lds
ds_read_b64_tr_b16 v[248:249], v12 offset:36864
v_mfma_f32_16x16x32_bf16 v[200:203], v[24:27], v[52:55], v[200:203]
ds_read_b64_tr_b16 v[250:251], v12 offset:38912
v_mfma_f32_16x16x32_bf16 v[196:199], v[28:31], v[48:51], v[196:199]
ds_read_b64_tr_b16 v[252:253], v13 offset:36864
s_add_u32 m0, s30, 131072
v_mfma_f32_16x16x32_bf16 v[204:207], v[28:31], v[52:55], v[204:207]
ds_read_b64_tr_b16 v[254:255], v13 offset:38912
s_add_u32 s6, s54, 1105920
s_waitcnt vmcnt(8)
v_mfma_f32_16x16x32_bf16 v[208:211], v[32:35], v[48:51], v[208:211]
buffer_load_dwordx4 v4, s[16:19], s6 offen offset:0 lds
ds_read_b64_tr_b16 v[24:25], v10 offset:40960
v_bitop3_b32 v81, v81, v64, v65 bitop3:0x96
v_mfma_f32_16x16x32_bf16 v[216:219], v[32:35], v[52:55], v[216:219]
ds_read_b64_tr_b16 v[26:27], v10 offset:43008
v_bitop3_b32 v81, v81, v66, v67 bitop3:0x96
v_bitop3_b32 v81, v81, v68, v69 bitop3:0x96
v_mfma_f32_16x16x32_bf16 v[212:215], v[36:39], v[48:51], v[212:215]
ds_read_b64_tr_b16 v[28:29], v11 offset:40960
v_bitop3_b32 v81, v81, v70, v71 bitop3:0x96
v_bitop3_b32 v81, v81, v72, v73 bitop3:0x96
v_bitop3_b32 v81, v81, v74, v75 bitop3:0x96
v_bitop3_b32 v81, v81, v76, v77 bitop3:0x96
v_bitop3_b32 v81, v81, v78, v79 bitop3:0x96
v_mfma_f32_16x16x32_bf16 v[220:223], v[36:39], v[52:55], v[220:223]
ds_read_b64_tr_b16 v[30:31], v11 offset:43008
v_cmp_ne_u32 s[56:57], s52, v81
s_cmp_lg_u64 s[56:57], 0
s_cbranch_scc1 K3B_dr1
K3B_dk1:
s_waitcnt lgkmcnt(4)
v_mfma_f32_16x16x32_bf16 v[192:195], v[40:43], v[56:59], v[192:195]
buffer_load_dwordx4 v5, s[16:19], s6 offen offset:1024 lds
ds_read_b64_tr_b16 v[32:33], v12 offset:40960
v_mfma_f32_16x16x32_bf16 v[200:203], v[40:43], v[60:63], v[200:203]
ds_read_b64_tr_b16 v[34:35], v12 offset:43008
v_mfma_f32_16x16x32_bf16 v[196:199], v[44:47], v[56:59], v[196:199]
ds_read_b64_tr_b16 v[36:37], v13 offset:40960
s_add_u32 m0, s30, 139264
v_mfma_f32_16x16x32_bf16 v[204:207], v[44:47], v[60:63], v[204:207]
ds_read_b64_tr_b16 v[38:39], v13 offset:43008
s_add_u32 s6, s44, 73728
v_mfma_f32_16x16x32_bf16 v[208:211], v[248:251], v[56:59], v[208:211]
buffer_load_dwordx4 v4, s[16:19], s6 offen offset:0 lds
ds_read_b64_tr_b16 v[40:41], v10 offset:45056
v_mfma_f32_16x16x32_bf16 v[216:219], v[248:251], v[60:63], v[216:219]
ds_read_b64_tr_b16 v[42:43], v10 offset:47104
v_mfma_f32_16x16x32_bf16 v[212:215], v[252:255], v[56:59], v[212:215]
ds_read_b64_tr_b16 v[44:45], v11 offset:45056
v_mfma_f32_16x16x32_bf16 v[220:223], v[252:255], v[60:63], v[220:223]
ds_read_b64_tr_b16 v[46:47], v11 offset:47104
s_waitcnt lgkmcnt(4)
v_mfma_f32_16x16x32_bf16 v[192:195], v[24:27], v[64:67], v[192:195]
buffer_load_dwordx4 v5, s[16:19], s6 offen offset:1024 lds
ds_read_b64_tr_b16 v[248:249], v12 offset:45056
v_mfma_f32_16x16x32_bf16 v[200:203], v[24:27], v[68:71], v[200:203]
ds_read_b64_tr_b16 v[250:251], v12 offset:47104
v_mfma_f32_16x16x32_bf16 v[196:199], v[28:31], v[64:67], v[196:199]
ds_read_b64_tr_b16 v[252:253], v13 offset:45056
s_add_u32 m0, s30, 0
v_mfma_f32_16x16x32_bf16 v[204:207], v[28:31], v[68:71], v[204:207]
ds_read_b64_tr_b16 v[254:255], v13 offset:47104
s_add_u32 s6, s45, 73728
v_mfma_f32_16x16x32_bf16 v[208:211], v[32:35], v[64:67], v[208:211]
v_mfma_f32_16x16x32_bf16 v[216:219], v[32:35], v[68:71], v[216:219]
s_waitcnt vmcnt(6)
s_barrier
buffer_load_dwordx4 v4, s[16:19], s6 offen offset:0 lds
v_add_u32 v12, 49152, v12
ds_read_b64_tr_b16 v[24:25], v12 offset:0
ds_read_b64_tr_b16 v[26:27], v12 offset:2048
v_mfma_f32_16x16x32_bf16 v[212:215], v[36:39], v[64:67], v[212:215]
v_add_u32 v13, 49152, v13
ds_read_b64_tr_b16 v[28:29], v13 offset:0
v_mfma_f32_16x16x32_bf16 v[220:223], v[36:39], v[68:71], v[220:223]
ds_read_b64_tr_b16 v[30:31], v13 offset:2048
s_waitcnt lgkmcnt(4)
v_mfma_f32_16x16x32_bf16 v[192:195], v[40:43], v[72:75], v[192:195]
buffer_load_dwordx4 v5, s[16:19], s6 offen offset:1024 lds
ds_read_b64_tr_b16 v[32:33], v12 offset:4096
v_mfma_f32_16x16x32_bf16 v[200:203], v[40:43], v[76:79], v[200:203]
ds_read_b64_tr_b16 v[34:35], v12 offset:6144
v_mfma_f32_16x16x32_bf16 v[196:199], v[44:47], v[72:75], v[196:199]
ds_read_b64_tr_b16 v[36:37], v13 offset:4096
s_add_u32 m0, s30, 8192
v_mfma_f32_16x16x32_bf16 v[204:207], v[44:47], v[76:79], v[204:207]
ds_read_b64_tr_b16 v[38:39], v13 offset:6144
s_add_u32 s6, s54, 1179648
v_mfma_f32_16x16x32_bf16 v[208:211], v[248:251], v[72:75], v[208:211]
buffer_load_dwordx4 v4, s[16:19], s6 offen offset:0 lds
ds_read_b64_tr_b16 v[40:41], v12 offset:8192
v_mfma_f32_16x16x32_bf16 v[216:219], v[248:251], v[76:79], v[216:219]
ds_read_b64_tr_b16 v[42:43], v12 offset:10240
v_mfma_f32_16x16x32_bf16 v[212:215], v[252:255], v[72:75], v[212:215]
ds_read_b64_tr_b16 v[44:45], v13 offset:8192
v_mfma_f32_16x16x32_bf16 v[220:223], v[252:255], v[76:79], v[220:223]
ds_read_b64_tr_b16 v[46:47], v13 offset:10240
s_waitcnt lgkmcnt(4)
v_mfma_f32_16x16x32_bf16 v[176:179], v[24:27], v[96:99], v[176:179]
buffer_load_dwordx4 v5, s[16:19], s6 offen offset:1024 lds
ds_read_b64_tr_b16 v[248:249], v12 offset:12288
v_mfma_f32_16x16x32_bf16 v[184:187], v[24:27], v[100:103], v[184:187]
ds_read_b64_tr_b16 v[250:251], v12 offset:14336
v_cvt_pk_bf16_f32 v192, v192, v193
v_cvt_pk_bf16_f32 v193, v194, v195
v_mfma_f32_16x16x32_bf16 v[180:183], v[28:31], v[96:99], v[180:183]
ds_read_b64_tr_b16 v[252:253], v13 offset:12288
s_add_u32 m0, s30, 16384
s_add_u32 s6, s44, 147456
v_mfma_f32_16x16x32_bf16 v[188:191], v[28:31], v[100:103], v[188:191]
ds_read_b64_tr_b16 v[254:255], v13 offset:14336
v_cvt_pk_bf16_f32 v194, v196, v197
v_cvt_pk_bf16_f32 v195, v198, v199
v_mfma_f32_16x16x32_bf16 v[176:179], v[32:35], v[104:107], v[176:179]
buffer_load_dwordx4 v4, s[16:19], s6 offen offset:0 lds
ds_read_b64_tr_b16 v[24:25], v12 offset:16384
v_mfma_f32_16x16x32_bf16 v[184:187], v[32:35], v[108:111], v[184:187]
ds_read_b64_tr_b16 v[26:27], v12 offset:18432
v_mfma_f32_16x16x32_bf16 v[180:183], v[36:39], v[104:107], v[180:183]
ds_read_b64_tr_b16 v[28:29], v13 offset:16384
v_mfma_f32_16x16x32_bf16 v[188:191], v[36:39], v[108:111], v[188:191]
ds_read_b64_tr_b16 v[30:31], v13 offset:18432
s_waitcnt lgkmcnt(4)
v_mfma_f32_16x16x32_bf16 v[176:179], v[40:43], v[112:115], v[176:179]
buffer_load_dwordx4 v5, s[16:19], s6 offen offset:1024 lds
ds_read_b64_tr_b16 v[32:33], v12 offset:20480
v_mfma_f32_16x16x32_bf16 v[184:187], v[40:43], v[116:119], v[184:187]
ds_read_b64_tr_b16 v[34:35], v12 offset:22528
v_mfma_f32_16x16x32_bf16 v[180:183], v[44:47], v[112:115], v[180:183]
ds_read_b64_tr_b16 v[36:37], v13 offset:20480
s_add_u32 m0, s30, 24576
v_mfma_f32_16x16x32_bf16 v[188:191], v[44:47], v[116:119], v[188:191]
ds_read_b64_tr_b16 v[38:39], v13 offset:22528
s_add_u32 s6, s45, 147456
v_mfma_f32_16x16x32_bf16 v[176:179], v[248:251], v[120:123], v[176:179]
v_mfma_f32_16x16x32_bf16 v[184:187], v[248:251], v[124:127], v[184:187]
s_waitcnt vmcnt(6)
s_barrier
buffer_load_dwordx4 v4, s[16:19], s6 offen offset:0 lds
ds_read_b64_tr_b16 v[40:41], v12 offset:24576
ds_read_b64_tr_b16 v[42:43], v12 offset:26624
v_mfma_f32_16x16x32_bf16 v[180:183], v[252:255], v[120:123], v[180:183]
ds_read_b64_tr_b16 v[44:45], v13 offset:24576
v_mfma_f32_16x16x32_bf16 v[188:191], v[252:255], v[124:127], v[188:191]
ds_read_b64_tr_b16 v[46:47], v13 offset:26624
s_waitcnt lgkmcnt(4)
v_mfma_f32_16x16x32_bf16 v[176:179], v[24:27], a[144:147], v[176:179]
buffer_load_dwordx4 v5, s[16:19], s6 offen offset:1024 lds
ds_read_b64_tr_b16 v[248:249], v12 offset:28672
v_mfma_f32_16x16x32_bf16 v[184:187], v[24:27], a[148:151], v[184:187]
ds_read_b64_tr_b16 v[250:251], v12 offset:30720
v_mfma_f32_16x16x32_bf16 v[180:183], v[28:31], a[144:147], v[180:183]
ds_read_b64_tr_b16 v[252:253], v13 offset:28672
s_add_u32 m0, s30, 32768
v_mfma_f32_16x16x32_bf16 v[188:191], v[28:31], a[148:151], v[188:191]
ds_read_b64_tr_b16 v[254:255], v13 offset:30720
s_add_u32 s6, s54, 1253376
v_mfma_f32_16x16x32_bf16 v[176:179], v[32:35], a[152:155], v[176:179]
buffer_load_dwordx4 v4, s[16:19], s6 offen offset:0 lds
ds_read_b64_tr_b16 v[24:25], v12 offset:32768
v_mfma_f32_16x16x32_bf16 v[184:187], v[32:35], a[156:159], v[184:187]
ds_read_b64_tr_b16 v[26:27], v12 offset:34816
v_mfma_f32_16x16x32_bf16 v[180:183], v[36:39], a[152:155], v[180:183]
ds_read_b64_tr_b16 v[28:29], v13 offset:32768
v_mfma_f32_16x16x32_bf16 v[188:191], v[36:39], a[156:159], v[188:191]
ds_read_b64_tr_b16 v[30:31], v13 offset:34816
s_waitcnt lgkmcnt(4)
v_mfma_f32_16x16x32_bf16 v[176:179], v[40:43], a[160:163], v[176:179]
buffer_load_dwordx4 v5, s[16:19], s6 offen offset:1024 lds
ds_read_b64_tr_b16 v[32:33], v12 offset:36864
v_mfma_f32_16x16x32_bf16 v[184:187], v[40:43], a[164:167], v[184:187]
ds_read_b64_tr_b16 v[34:35], v12 offset:38912
v_mfma_f32_16x16x32_bf16 v[180:183], v[44:47], a[160:163], v[180:183]
ds_read_b64_tr_b16 v[36:37], v13 offset:36864
s_add_u32 m0, s30, 40960
v_mfma_f32_16x16x32_bf16 v[188:191], v[44:47], a[164:167], v[188:191]
ds_read_b64_tr_b16 v[38:39], v13 offset:38912
s_add_u32 s6, s44, 221184
v_mfma_f32_16x16x32_bf16 v[176:179], v[248:251], a[168:171], v[176:179]
buffer_load_dwordx4 v4, s[16:19], s6 offen offset:0 lds
ds_read_b64_tr_b16 v[40:41], v12 offset:40960
v_mfma_f32_16x16x32_bf16 v[184:187], v[248:251], a[172:175], v[184:187]
ds_read_b64_tr_b16 v[42:43], v12 offset:43008
v_mfma_f32_16x16x32_bf16 v[180:183], v[252:255], a[168:171], v[180:183]
ds_read_b64_tr_b16 v[44:45], v13 offset:40960
v_mfma_f32_16x16x32_bf16 v[188:191], v[252:255], a[172:175], v[188:191]
ds_read_b64_tr_b16 v[46:47], v13 offset:43008
s_waitcnt lgkmcnt(4)
v_mfma_f32_16x16x32_bf16 v[176:179], v[24:27], a[176:179], v[176:179]
buffer_load_dwordx4 v5, s[16:19], s6 offen offset:1024 lds
ds_read_b64_tr_b16 v[248:249], v12 offset:45056
v_mfma_f32_16x16x32_bf16 v[184:187], v[24:27], a[180:183], v[184:187]
ds_read_b64_tr_b16 v[250:251], v12 offset:47104
v_mfma_f32_16x16x32_bf16 v[180:183], v[28:31], a[176:179], v[180:183]
ds_read_b64_tr_b16 v[252:253], v13 offset:45056
s_add_u32 m0, s30, 49152
v_mfma_f32_16x16x32_bf16 v[188:191], v[28:31], a[180:183], v[188:191]
ds_read_b64_tr_b16 v[254:255], v13 offset:47104
s_add_u32 s6, s45, 221184
v_mfma_f32_16x16x32_bf16 v[176:179], v[32:35], a[184:187], v[176:179]
v_mfma_f32_16x16x32_bf16 v[184:187], v[32:35], a[188:191], v[184:187]
s_waitcnt vmcnt(6)
s_barrier
buffer_load_dwordx4 v4, s[16:19], s6 offen offset:0 lds
v_add_u32 v12, 4294868992, v12
ds_read_b64_tr_b16 v[24:25], v12 offset:0
ds_read_b64_tr_b16 v[26:27], v12 offset:2048
v_mfma_f32_16x16x32_bf16 v[180:183], v[36:39], a[184:187], v[180:183]
v_add_u32 v13, 4294868992, v13
ds_read_b64_tr_b16 v[28:29], v13 offset:0
v_mfma_f32_16x16x32_bf16 v[188:191], v[36:39], a[188:191], v[188:191]
ds_read_b64_tr_b16 v[30:31], v13 offset:2048
s_waitcnt lgkmcnt(4)
v_mfma_f32_16x16x32_bf16 v[176:179], v[40:43], a[192:195], v[176:179]
buffer_load_dwordx4 v5, s[16:19], s6 offen offset:1024 lds
ds_read_b64_tr_b16 v[32:33], v12 offset:4096
v_mfma_f32_16x16x32_bf16 v[184:187], v[40:43], a[196:199], v[184:187]
ds_read_b64_tr_b16 v[34:35], v12 offset:6144
v_mfma_f32_16x16x32_bf16 v[180:183], v[44:47], a[192:195], v[180:183]
ds_read_b64_tr_b16 v[36:37], v13 offset:4096
s_add_u32 m0, s30, 57344
v_mfma_f32_16x16x32_bf16 v[188:191], v[44:47], a[196:199], v[188:191]
ds_read_b64_tr_b16 v[38:39], v13 offset:6144
s_add_u32 s6, s44, 294912
v_mfma_f32_16x16x32_bf16 v[176:179], v[248:251], a[200:203], v[176:179]
buffer_load_dwordx4 v4, s[16:19], s6 offen offset:0 lds
ds_read_b64_tr_b16 v[40:41], v12 offset:8192
v_mfma_f32_16x16x32_bf16 v[184:187], v[248:251], a[204:207], v[184:187]
ds_read_b64_tr_b16 v[42:43], v12 offset:10240
v_mfma_f32_16x16x32_bf16 v[180:183], v[252:255], a[200:203], v[180:183]
ds_read_b64_tr_b16 v[44:45], v13 offset:8192
v_mfma_f32_16x16x32_bf16 v[188:191], v[252:255], a[204:207], v[188:191]
ds_read_b64_tr_b16 v[46:47], v13 offset:10240
s_waitcnt lgkmcnt(4)
v_mfma_f32_16x16x32_bf16 v[176:179], v[24:27], a[208:211], v[176:179]
buffer_load_dwordx4 v5, s[16:19], s6 offen offset:1024 lds
ds_read_b64_tr_b16 v[248:249], v12 offset:12288
v_mfma_f32_16x16x32_bf16 v[184:187], v[24:27], a[212:215], v[184:187]
ds_read_b64_tr_b16 v[250:251], v12 offset:14336
v_mfma_f32_16x16x32_bf16 v[180:183], v[28:31], a[208:211], v[180:183]
ds_read_b64_tr_b16 v[252:253], v13 offset:12288
s_add_u32 m0, s30, 65536
v_mfma_f32_16x16x32_bf16 v[188:191], v[28:31], a[212:215], v[188:191]
ds_read_b64_tr_b16 v[254:255], v13 offset:14336
s_add_u32 s6, s45, 294912
v_mfma_f32_16x16x32_bf16 v[176:179], v[32:35], a[216:219], v[176:179]
buffer_load_dwordx4 v4, s[16:19], s6 offen offset:0 lds
ds_read_b64_tr_b16 v[24:25], v12 offset:16384
v_mfma_f32_16x16x32_bf16 v[184:187], v[32:35], a[220:223], v[184:187]
ds_read_b64_tr_b16 v[26:27], v12 offset:18432
v_mfma_f32_16x16x32_bf16 v[180:183], v[36:39], a[216:219], v[180:183]
ds_read_b64_tr_b16 v[28:29], v13 offset:16384
v_mfma_f32_16x16x32_bf16 v[188:191], v[36:39], a[220:223], v[188:191]
ds_read_b64_tr_b16 v[30:31], v13 offset:18432
s_waitcnt lgkmcnt(4)
v_mfma_f32_16x16x32_bf16 v[176:179], v[40:43], a[224:227], v[176:179]
buffer_load_dwordx4 v5, s[16:19], s6 offen offset:1024 lds
ds_read_b64_tr_b16 v[32:33], v12 offset:20480
v_mfma_f32_16x16x32_bf16 v[184:187], v[40:43], a[228:231], v[184:187]
ds_read_b64_tr_b16 v[34:35], v12 offset:22528
v_mfma_f32_16x16x32_bf16 v[180:183], v[44:47], a[224:227], v[180:183]
buffer_store_dwordx4 v[192:195], v1, s[8:11], s65 offen offset:0 sc1
ds_read_b64_tr_b16 v[36:37], v13 offset:20480
v_mfma_f32_16x16x32_bf16 v[188:191], v[44:47], a[228:231], v[188:191]
ds_read_b64_tr_b16 v[38:39], v13 offset:22528
v_bitop3_b32 v21, v15, v192, v193 bitop3:0x96
v_bitop3_b32 v21, v21, v194, v195 bitop3:0x96
v_mfma_f32_16x16x32_bf16 v[176:179], v[248:251], a[232:235], v[176:179]
v_mfma_f32_16x16x32_bf16 v[184:187], v[248:251], a[236:239], v[184:187]
s_waitcnt vmcnt(7)
s_barrier
ds_read_b64_tr_b16 v[40:41], v12 offset:24576
ds_read_b64_tr_b16 v[42:43], v12 offset:26624
v_cvt_pk_bf16_f32 v200, v200, v201
v_mfma_f32_16x16x32_bf16 v[180:183], v[252:255], a[232:235], v[180:183]
ds_read_b64_tr_b16 v[44:45], v13 offset:24576
v_cvt_pk_bf16_f32 v201, v202, v203
v_cvt_pk_bf16_f32 v202, v204, v205
v_mfma_f32_16x16x32_bf16 v[188:191], v[252:255], a[236:239], v[188:191]
ds_read_b64_tr_b16 v[46:47], v13 offset:26624
v_cvt_pk_bf16_f32 v203, v206, v207
s_waitcnt lgkmcnt(4)
v_mfma_f32_16x16x32_bf16 v[176:179], v[24:27], a[240:243], v[176:179]
buffer_store_dwordx4 v[200:203], v1, s[8:11], s65 offen offset:1024 sc1
ds_read_b64_tr_b16 v[248:249], v12 offset:28672
v_mfma_f32_16x16x32_bf16 v[184:187], v[24:27], a[244:247], v[184:187]
ds_read_b64_tr_b16 v[250:251], v12 offset:30720
v_bitop3_b32 v21, v21, v200, v201 bitop3:0x96
v_bitop3_b32 v21, v21, v202, v203 bitop3:0x96
v_mfma_f32_16x16x32_bf16 v[180:183], v[28:31], a[240:243], v[180:183]
buffer_store_dword v21, v17, s[8:11], s65 offen offset:3072 sc1
ds_read_b64_tr_b16 v[252:253], v13 offset:28672
v_mfma_f32_16x16x32_bf16 v[188:191], v[28:31], a[244:247], v[188:191]
ds_read_b64_tr_b16 v[254:255], v13 offset:30720
v_cvt_pk_bf16_f32 v208, v208, v209
v_cvt_pk_bf16_f32 v209, v210, v211
v_mfma_f32_16x16x32_bf16 v[176:179], v[32:35], a[248:251], v[176:179]
s_branch PGB_7
.p2align 12
PSB_7:
s_setpc_b64 s[62:63]
PGB_7:
ds_read_b64_tr_b16 v[24:25], v12 offset:32768
v_cvt_pk_bf16_f32 v210, v212, v213
v_mfma_f32_16x16x32_bf16 v[184:187], v[32:35], a[252:255], v[184:187]
ds_read_b64_tr_b16 v[26:27], v12 offset:34816
v_cvt_pk_bf16_f32 v211, v214, v215
v_mfma_f32_16x16x32_bf16 v[180:183], v[36:39], a[248:251], v[180:183]
buffer_store_dwordx4 v[208:211], v1, s[8:11], s66 offen offset:0 sc1
ds_read_b64_tr_b16 v[28:29], v13 offset:32768
v_mfma_f32_16x16x32_bf16 v[188:191], v[36:39], a[252:255], v[188:191]
ds_read_b64_tr_b16 v[30:31], v13 offset:34816
v_bitop3_b32 v22, v15, v208, v209 bitop3:0x96
s_waitcnt lgkmcnt(4)
v_mfma_f32_16x16x32_bf16 v[176:179], v[40:43], a[0:3], v[176:179]
ds_read_b64_tr_b16 v[32:33], v12 offset:36864
v_bitop3_b32 v22, v22, v210, v211 bitop3:0x96
v_cvt_pk_bf16_f32 v216, v216, v217
v_mfma_f32_16x16x32_bf16 v[184:187], v[40:43], a[4:7], v[184:187]
ds_read_b64_tr_b16 v[34:35], v12 offset:38912
v_cvt_pk_bf16_f32 v217, v218, v219
v_cvt_pk_bf16_f32 v218, v220, v221
v_mfma_f32_16x16x32_bf16 v[180:183], v[44:47], a[0:3], v[180:183]
ds_read_b64_tr_b16 v[36:37], v13 offset:36864
v_mfma_f32_16x16x32_bf16 v[188:191], v[44:47], a[4:7], v[188:191]
ds_read_b64_tr_b16 v[38:39], v13 offset:38912
v_cvt_pk_bf16_f32 v219, v222, v223
v_mfma_f32_16x16x32_bf16 v[176:179], v[248:251], a[8:11], v[176:179]
buffer_store_dwordx4 v[216:219], v1, s[8:11], s66 offen offset:1024 sc1
ds_read_b64_tr_b16 v[40:41], v12 offset:40960
v_mfma_f32_16x16x32_bf16 v[184:187], v[248:251], a[12:15], v[184:187]
ds_read_b64_tr_b16 v[42:43], v12 offset:43008
v_bitop3_b32 v22, v22, v216, v217 bitop3:0x96
v_bitop3_b32 v22, v22, v218, v219 bitop3:0x96
v_mfma_f32_16x16x32_bf16 v[180:183], v[252:255], a[8:11], v[180:183]
buffer_store_dword v22, v17, s[8:11], s66 offen offset:3072 sc1
ds_read_b64_tr_b16 v[44:45], v13 offset:40960
v_mfma_f32_16x16x32_bf16 v[188:191], v[252:255], a[12:15], v[188:191]
ds_read_b64_tr_b16 v[46:47], v13 offset:43008
s_waitcnt lgkmcnt(4)
v_mfma_f32_16x16x32_bf16 v[176:179], v[24:27], a[16:19], v[176:179]
ds_read_b64_tr_b16 v[248:249], v12 offset:45056
v_mfma_f32_16x16x32_bf16 v[184:187], v[24:27], a[20:23], v[184:187]
ds_read_b64_tr_b16 v[250:251], v12 offset:47104
v_mfma_f32_16x16x32_bf16 v[180:183], v[28:31], a[16:19], v[180:183]
ds_read_b64_tr_b16 v[252:253], v13 offset:45056
v_mfma_f32_16x16x32_bf16 v[188:191], v[28:31], a[20:23], v[188:191]
ds_read_b64_tr_b16 v[254:255], v13 offset:47104
v_mfma_f32_16x16x32_bf16 v[176:179], v[32:35], a[24:27], v[176:179]
v_mfma_f32_16x16x32_bf16 v[184:187], v[32:35], a[28:31], v[184:187]
s_waitcnt vmcnt(6)
s_barrier
v_add_u32 v12, 49152, v12
ds_read_b64_tr_b16 v[24:25], v12 offset:0
ds_read_b64_tr_b16 v[26:27], v12 offset:2048
v_mfma_f32_16x16x32_bf16 v[180:183], v[36:39], a[24:27], v[180:183]
v_add_u32 v13, 49152, v13
ds_read_b64_tr_b16 v[28:29], v13 offset:0
v_mfma_f32_16x16x32_bf16 v[188:191], v[36:39], a[28:31], v[188:191]
ds_read_b64_tr_b16 v[30:31], v13 offset:2048
s_waitcnt lgkmcnt(4)
v_mfma_f32_16x16x32_bf16 v[176:179], v[40:43], a[32:35], v[176:179]
ds_read_b64_tr_b16 v[32:33], v12 offset:4096
v_mfma_f32_16x16x32_bf16 v[184:187], v[40:43], a[36:39], v[184:187]
ds_read_b64_tr_b16 v[34:35], v12 offset:6144
v_mfma_f32_16x16x32_bf16 v[180:183], v[44:47], a[32:35], v[180:183]
ds_read_b64_tr_b16 v[36:37], v13 offset:4096
v_mfma_f32_16x16x32_bf16 v[188:191], v[44:47], a[36:39], v[188:191]
ds_read_b64_tr_b16 v[38:39], v13 offset:6144
v_mfma_f32_16x16x32_bf16 v[176:179], v[248:251], a[40:43], v[176:179]
ds_read_b64_tr_b16 v[40:41], v12 offset:8192
v_mfma_f32_16x16x32_bf16 v[184:187], v[248:251], a[44:47], v[184:187]
ds_read_b64_tr_b16 v[42:43], v12 offset:10240
v_mfma_f32_16x16x32_bf16 v[180:183], v[252:255], a[40:43], v[180:183]
ds_read_b64_tr_b16 v[44:45], v13 offset:8192
v_mfma_f32_16x16x32_bf16 v[188:191], v[252:255], a[44:47], v[188:191]
ds_read_b64_tr_b16 v[46:47], v13 offset:10240
s_waitcnt lgkmcnt(4)
v_mfma_f32_16x16x32_bf16 v[176:179], v[24:27], a[48:51], v[176:179]
ds_read_b64_tr_b16 v[248:249], v12 offset:12288
v_mfma_f32_16x16x32_bf16 v[184:187], v[24:27], a[52:55], v[184:187]
ds_read_b64_tr_b16 v[250:251], v12 offset:14336
v_mfma_f32_16x16x32_bf16 v[180:183], v[28:31], a[48:51], v[180:183]
buffer_load_dwordx4 v[192:195], v1, s[8:11], s68 offen offset:0 sc1
ds_read_b64_tr_b16 v[252:253], v13 offset:12288
v_mfma_f32_16x16x32_bf16 v[188:191], v[28:31], a[52:55], v[188:191]
ds_read_b64_tr_b16 v[254:255], v13 offset:14336
v_mfma_f32_16x16x32_bf16 v[176:179], v[32:35], a[56:59], v[176:179]
ds_read_b64_tr_b16 v[24:25], v12 offset:16384
v_mfma_f32_16x16x32_bf16 v[184:187], v[32:35], a[60:63], v[184:187]
ds_read_b64_tr_b16 v[26:27], v12 offset:18432
v_mfma_f32_16x16x32_bf16 v[180:183], v[36:39], a[56:59], v[180:183]
ds_read_b64_tr_b16 v[28:29], v13 offset:16384
v_mfma_f32_16x16x32_bf16 v[188:191], v[36:39], a[60:63], v[188:191]
ds_read_b64_tr_b16 v[30:31], v13 offset:18432
s_waitcnt lgkmcnt(4)
v_mfma_f32_16x16x32_bf16 v[176:179], v[40:43], v[48:51], v[176:179]
buffer_load_dwordx4 v[196:199], v1, s[8:11], s68 offen offset:1024 sc1
ds_read_b64_tr_b16 v[32:33], v12 offset:20480
v_mfma_f32_16x16x32_bf16 v[184:187], v[40:43], v[52:55], v[184:187]
ds_read_b64_tr_b16 v[34:35], v12 offset:22528
v_mfma_f32_16x16x32_bf16 v[180:183], v[44:47], v[48:51], v[180:183]
ds_read_b64_tr_b16 v[36:37], v13 offset:20480
v_mfma_f32_16x16x32_bf16 v[188:191], v[44:47], v[52:55], v[188:191]
ds_read_b64_tr_b16 v[38:39], v13 offset:22528
v_mfma_f32_16x16x32_bf16 v[176:179], v[248:251], v[56:59], v[176:179]
v_add_u32 v10, 49152, v10
ds_read_b64_tr_b16 v[40:41], v10 offset:0
v_mfma_f32_16x16x32_bf16 v[184:187], v[248:251], v[60:63], v[184:187]
ds_read_b64_tr_b16 v[42:43], v10 offset:2048
v_mfma_f32_16x16x32_bf16 v[180:183], v[252:255], v[56:59], v[180:183]
buffer_load_dword v204, v17, s[8:11], s68 offen offset:3072 sc1
v_add_u32 v11, 49152, v11
ds_read_b64_tr_b16 v[44:45], v11 offset:0
v_mfma_f32_16x16x32_bf16 v[188:191], v[252:255], v[60:63], v[188:191]
ds_read_b64_tr_b16 v[46:47], v11 offset:2048
s_waitcnt lgkmcnt(4)
v_mfma_f32_16x16x32_bf16 v[176:179], v[24:27], v[64:67], v[176:179]
ds_read_b64_tr_b16 v[248:249], v10 offset:4096
v_mfma_f32_16x16x32_bf16 v[184:187], v[24:27], v[68:71], v[184:187]
ds_read_b64_tr_b16 v[250:251], v10 offset:6144
v_mfma_f32_16x16x32_bf16 v[180:183], v[28:31], v[64:67], v[180:183]
ds_read_b64_tr_b16 v[252:253], v11 offset:4096
v_mfma_f32_16x16x32_bf16 v[188:191], v[28:31], v[68:71], v[188:191]
ds_read_b64_tr_b16 v[254:255], v11 offset:6144
v_mfma_f32_16x16x32_bf16 v[176:179], v[32:35], v[72:75], v[176:179]
buffer_load_dwordx4 v[208:211], v1, s[8:11], s69 offen offset:0 sc1
ds_read_b64_tr_b16 v[24:25], v10 offset:8192
v_mfma_f32_16x16x32_bf16 v[184:187], v[32:35], v[76:79], v[184:187]
ds_read_b64_tr_b16 v[26:27], v10 offset:10240
v_mfma_f32_16x16x32_bf16 v[180:183], v[36:39], v[72:75], v[180:183]
ds_read_b64_tr_b16 v[28:29], v11 offset:8192
v_mfma_f32_16x16x32_bf16 v[188:191], v[36:39], v[76:79], v[188:191]
ds_read_b64_tr_b16 v[30:31], v11 offset:10240
s_waitcnt lgkmcnt(4)
v_mfma_f32_16x16x32_bf16 v[160:163], v[40:43], v[96:99], v[160:163]
ds_read_b64_tr_b16 v[32:33], v10 offset:12288
v_mfma_f32_16x16x32_bf16 v[168:171], v[40:43], v[100:103], v[168:171]
ds_read_b64_tr_b16 v[34:35], v10 offset:14336
v_mfma_f32_16x16x32_bf16 v[164:167], v[44:47], v[96:99], v[164:167]
ds_read_b64_tr_b16 v[36:37], v11 offset:12288
v_mfma_f32_16x16x32_bf16 v[172:175], v[44:47], v[100:103], v[172:175]
ds_read_b64_tr_b16 v[38:39], v11 offset:14336
v_mfma_f32_16x16x32_bf16 v[160:163], v[248:251], v[104:107], v[160:163]
ds_read_b64_tr_b16 v[40:41], v10 offset:16384
v_cvt_pk_bf16_f32 v176, v176, v177
v_cvt_pk_bf16_f32 v177, v178, v179
v_mfma_f32_16x16x32_bf16 v[168:171], v[248:251], v[108:111], v[168:171]
ds_read_b64_tr_b16 v[42:43], v10 offset:18432
v_cvt_pk_bf16_f32 v178, v180, v181
v_cvt_pk_bf16_f32 v179, v182, v183
v_mfma_f32_16x16x32_bf16 v[164:167], v[252:255], v[104:107], v[164:167]
buffer_store_dwordx4 v[176:179], v1, s[8:11], s64 offen offset:0 sc1
ds_read_b64_tr_b16 v[44:45], v11 offset:16384
v_mfma_f32_16x16x32_bf16 v[172:175], v[252:255], v[108:111], v[172:175]
ds_read_b64_tr_b16 v[46:47], v11 offset:18432
v_bitop3_b32 v20, v15, v176, v177 bitop3:0x96
s_waitcnt lgkmcnt(4)
v_mfma_f32_16x16x32_bf16 v[160:163], v[24:27], v[112:115], v[160:163]
ds_read_b64_tr_b16 v[248:249], v10 offset:20480
v_bitop3_b32 v20, v20, v178, v179 bitop3:0x96
v_cvt_pk_bf16_f32 v184, v184, v185
v_mfma_f32_16x16x32_bf16 v[168:171], v[24:27], v[116:119], v[168:171]
ds_read_b64_tr_b16 v[250:251], v10 offset:22528
v_cvt_pk_bf16_f32 v185, v186, v187
v_cvt_pk_bf16_f32 v186, v188, v189
v_mfma_f32_16x16x32_bf16 v[164:167], v[28:31], v[112:115], v[164:167]
ds_read_b64_tr_b16 v[252:253], v11 offset:20480
v_mfma_f32_16x16x32_bf16 v[172:175], v[28:31], v[116:119], v[172:175]
ds_read_b64_tr_b16 v[254:255], v11 offset:22528
v_cvt_pk_bf16_f32 v187, v190, v191
v_mfma_f32_16x16x32_bf16 v[160:163], v[32:35], v[120:123], v[160:163]
buffer_store_dwordx4 v[184:187], v1, s[8:11], s64 offen offset:1024 sc1
ds_read_b64_tr_b16 v[24:25], v10 offset:24576
v_mfma_f32_16x16x32_bf16 v[168:171], v[32:35], v[124:127], v[168:171]
ds_read_b64_tr_b16 v[26:27], v10 offset:26624
v_bitop3_b32 v20, v20, v184, v185 bitop3:0x96
v_bitop3_b32 v20, v20, v186, v187 bitop3:0x96
v_mfma_f32_16x16x32_bf16 v[164:167], v[36:39], v[120:123], v[164:167]
buffer_store_dword v20, v17, s[8:11], s64 offen offset:3072 sc1
ds_read_b64_tr_b16 v[28:29], v11 offset:24576
v_mfma_f32_16x16x32_bf16 v[172:175], v[36:39], v[124:127], v[172:175]
ds_read_b64_tr_b16 v[30:31], v11 offset:26624
s_waitcnt lgkmcnt(4)
v_mfma_f32_16x16x32_bf16 v[160:163], v[40:43], a[144:147], v[160:163]
ds_read_b64_tr_b16 v[32:33], v10 offset:28672
v_mfma_f32_16x16x32_bf16 v[168:171], v[40:43], a[148:151], v[168:171]
ds_read_b64_tr_b16 v[34:35], v10 offset:30720
v_mfma_f32_16x16x32_bf16 v[164:167], v[44:47], a[144:147], v[164:167]
ds_read_b64_tr_b16 v[36:37], v11 offset:28672
v_mfma_f32_16x16x32_bf16 v[172:175], v[44:47], a[148:151], v[172:175]
ds_read_b64_tr_b16 v[38:39], v11 offset:30720
v_mfma_f32_16x16x32_bf16 v[160:163], v[248:251], a[152:155], v[160:163]
buffer_load_dwordx4 v[212:215], v1, s[8:11], s69 offen offset:1024 sc1
ds_read_b64_tr_b16 v[40:41], v10 offset:32768
v_mfma_f32_16x16x32_bf16 v[168:171], v[248:251], a[156:159], v[168:171]
ds_read_b64_tr_b16 v[42:43], v10 offset:34816
v_mfma_f32_16x16x32_bf16 v[164:167], v[252:255], a[152:155], v[164:167]
ds_read_b64_tr_b16 v[44:45], v11 offset:32768
v_mfma_f32_16x16x32_bf16 v[172:175], v[252:255], a[156:159], v[172:175]
ds_read_b64_tr_b16 v[46:47], v11 offset:34816
s_waitcnt lgkmcnt(4)
v_mfma_f32_16x16x32_bf16 v[160:163], v[24:27], a[160:163], v[160:163]
ds_read_b64_tr_b16 v[248:249], v10 offset:36864
v_mfma_f32_16x16x32_bf16 v[168:171], v[24:27], a[164:167], v[168:171]
ds_read_b64_tr_b16 v[250:251], v10 offset:38912
v_mfma_f32_16x16x32_bf16 v[164:167], v[28:31], a[160:163], v[164:167]
buffer_load_dword v220, v17, s[8:11], s69 offen offset:3072 sc1
ds_read_b64_tr_b16 v[252:253], v11 offset:36864
v_mfma_f32_16x16x32_bf16 v[172:175], v[28:31], a[164:167], v[172:175]
ds_read_b64_tr_b16 v[254:255], v11 offset:38912
v_mfma_f32_16x16x32_bf16 v[160:163], v[32:35], a[168:171], v[160:163]
ds_read_b64_tr_b16 v[24:25], v10 offset:40960
v_mfma_f32_16x16x32_bf16 v[168:171], v[32:35], a[172:175], v[168:171]
ds_read_b64_tr_b16 v[26:27], v10 offset:43008
v_mfma_f32_16x16x32_bf16 v[164:167], v[36:39], a[168:171], v[164:167]
ds_read_b64_tr_b16 v[28:29], v11 offset:40960
v_mfma_f32_16x16x32_bf16 v[172:175], v[36:39], a[172:175], v[172:175]
ds_read_b64_tr_b16 v[30:31], v11 offset:43008
s_waitcnt lgkmcnt(4)
v_mfma_f32_16x16x32_bf16 v[160:163], v[40:43], a[176:179], v[160:163]
ds_read_b64_tr_b16 v[32:33], v10 offset:45056
v_mfma_f32_16x16x32_bf16 v[168:171], v[40:43], a[180:183], v[168:171]
ds_read_b64_tr_b16 v[34:35], v10 offset:47104
v_mfma_f32_16x16x32_bf16 v[164:167], v[44:47], a[176:179], v[164:167]
ds_read_b64_tr_b16 v[36:37], v11 offset:45056
v_mfma_f32_16x16x32_bf16 v[172:175], v[44:47], a[180:183], v[172:175]
ds_read_b64_tr_b16 v[38:39], v11 offset:47104
v_mfma_f32_16x16x32_bf16 v[160:163], v[248:251], a[184:187], v[160:163]
v_add_u32 v10, 4294868992, v10
ds_read_b64_tr_b16 v[40:41], v10 offset:0
v_mfma_f32_16x16x32_bf16 v[168:171], v[248:251], a[188:191], v[168:171]
ds_read_b64_tr_b16 v[42:43], v10 offset:2048
v_mfma_f32_16x16x32_bf16 v[164:167], v[252:255], a[184:187], v[164:167]
v_add_u32 v11, 4294868992, v11
ds_read_b64_tr_b16 v[44:45], v11 offset:0
v_mfma_f32_16x16x32_bf16 v[172:175], v[252:255], a[188:191], v[172:175]
ds_read_b64_tr_b16 v[46:47], v11 offset:2048
s_waitcnt lgkmcnt(4)
v_mfma_f32_16x16x32_bf16 v[160:163], v[24:27], a[192:195], v[160:163]
ds_read_b64_tr_b16 v[248:249], v10 offset:4096
v_mfma_f32_16x16x32_bf16 v[168:171], v[24:27], a[196:199], v[168:171]
ds_read_b64_tr_b16 v[250:251], v10 offset:6144
v_mfma_f32_16x16x32_bf16 v[164:167], v[28:31], a[192:195], v[164:167]
ds_read_b64_tr_b16 v[252:253], v11 offset:4096
v_mfma_f32_16x16x32_bf16 v[172:175], v[28:31], a[196:199], v[172:175]
ds_read_b64_tr_b16 v[254:255], v11 offset:6144
v_mfma_f32_16x16x32_bf16 v[160:163], v[32:35], a[200:203], v[160:163]
ds_read_b64_tr_b16 v[24:25], v10 offset:8192
v_mfma_f32_16x16x32_bf16 v[168:171], v[32:35], a[204:207], v[168:171]
ds_read_b64_tr_b16 v[26:27], v10 offset:10240
v_mfma_f32_16x16x32_bf16 v[164:167], v[36:39], a[200:203], v[164:167]
ds_read_b64_tr_b16 v[28:29], v11 offset:8192
v_mfma_f32_16x16x32_bf16 v[172:175], v[36:39], a[204:207], v[172:175]
ds_read_b64_tr_b16 v[30:31], v11 offset:10240
s_waitcnt lgkmcnt(4)
v_mfma_f32_16x16x32_bf16 v[160:163], v[40:43], a[208:211], v[160:163]
ds_read_b64_tr_b16 v[32:33], v10 offset:12288
v_mfma_f32_16x16x32_bf16 v[168:171], v[40:43], a[212:215], v[168:171]
ds_read_b64_tr_b16 v[34:35], v10 offset:14336
v_mfma_f32_16x16x32_bf16 v[164:167], v[44:47], a[208:211], v[164:167]
ds_read_b64_tr_b16 v[36:37], v11 offset:12288
v_mfma_f32_16x16x32_bf16 v[172:175], v[44:47], a[212:215], v[172:175]
ds_read_b64_tr_b16 v[38:39], v11 offset:14336
v_mfma_f32_16x16x32_bf16 v[160:163], v[248:251], a[216:219], v[160:163]
ds_read_b64_tr_b16 v[40:41], v10 offset:16384
v_mfma_f32_16x16x32_bf16 v[168:171], v[248:251], a[220:223], v[168:171]
ds_read_b64_tr_b16 v[42:43], v10 offset:18432
v_mfma_f32_16x16x32_bf16 v[164:167], v[252:255], a[216:219], v[164:167]
ds_read_b64_tr_b16 v[44:45], v11 offset:16384
v_mfma_f32_16x16x32_bf16 v[172:175], v[252:255], a[220:223], v[172:175]
ds_read_b64_tr_b16 v[46:47], v11 offset:18432
s_waitcnt lgkmcnt(4)
v_mfma_f32_16x16x32_bf16 v[160:163], v[24:27], a[224:227], v[160:163]
ds_read_b64_tr_b16 v[248:249], v10 offset:20480
v_mfma_f32_16x16x32_bf16 v[168:171], v[24:27], a[228:231], v[168:171]
ds_read_b64_tr_b16 v[250:251], v10 offset:22528
v_mfma_f32_16x16x32_bf16 v[164:167], v[28:31], a[224:227], v[164:167]
ds_read_b64_tr_b16 v[252:253], v11 offset:20480
v_mfma_f32_16x16x32_bf16 v[172:175], v[28:31], a[228:231], v[172:175]
ds_read_b64_tr_b16 v[254:255], v11 offset:22528
v_mfma_f32_16x16x32_bf16 v[160:163], v[32:35], a[232:235], v[160:163]
ds_read_b64_tr_b16 v[24:25], v10 offset:24576
v_mfma_f32_16x16x32_bf16 v[168:171], v[32:35], a[236:239], v[168:171]
ds_read_b64_tr_b16 v[26:27], v10 offset:26624
v_mfma_f32_16x16x32_bf16 v[164:167], v[36:39], a[232:235], v[164:167]
ds_read_b64_tr_b16 v[28:29], v11 offset:24576
v_mfma_f32_16x16x32_bf16 v[172:175], v[36:39], a[236:239], v[172:175]
ds_read_b64_tr_b16 v[30:31], v11 offset:26624
s_waitcnt lgkmcnt(4)
v_mfma_f32_16x16x32_bf16 v[160:163], v[40:43], a[240:243], v[160:163]
ds_read_b64_tr_b16 v[32:33], v10 offset:28672
v_mfma_f32_16x16x32_bf16 v[168:171], v[40:43], a[244:247], v[168:171]
ds_read_b64_tr_b16 v[34:35], v10 offset:30720
v_mfma_f32_16x16x32_bf16 v[164:167], v[44:47], a[240:243], v[164:167]
ds_read_b64_tr_b16 v[36:37], v11 offset:28672
v_mfma_f32_16x16x32_bf16 v[172:175], v[44:47], a[244:247], v[172:175]
ds_read_b64_tr_b16 v[38:39], v11 offset:30720
v_mfma_f32_16x16x32_bf16 v[160:163], v[248:251], a[248:251], v[160:163]
ds_read_b64_tr_b16 v[40:41], v10 offset:32768
v_mfma_f32_16x16x32_bf16 v[168:171], v[248:251], a[252:255], v[168:171]
ds_read_b64_tr_b16 v[42:43], v10 offset:34816
v_mfma_f32_16x16x32_bf16 v[164:167], v[252:255], a[248:251], v[164:167]
buffer_load_dwordx4 v[176:179], v1, s[8:11], s67 offen offset:0 sc1
ds_read_b64_tr_b16 v[44:45], v11 offset:32768
v_mfma_f32_16x16x32_bf16 v[172:175], v[252:255], a[252:255], v[172:175]
ds_read_b64_tr_b16 v[46:47], v11 offset:34816
s_waitcnt lgkmcnt(4)
v_mfma_f32_16x16x32_bf16 v[160:163], v[24:27], a[0:3], v[160:163]
ds_read_b64_tr_b16 v[248:249], v10 offset:36864
v_mfma_f32_16x16x32_bf16 v[168:171], v[24:27], a[4:7], v[168:171]
ds_read_b64_tr_b16 v[250:251], v10 offset:38912
v_mfma_f32_16x16x32_bf16 v[164:167], v[28:31], a[0:3], v[164:167]
ds_read_b64_tr_b16 v[252:253], v11 offset:36864
v_mfma_f32_16x16x32_bf16 v[172:175], v[28:31], a[4:7], v[172:175]
ds_read_b64_tr_b16 v[254:255], v11 offset:38912
v_mfma_f32_16x16x32_bf16 v[160:163], v[32:35], a[8:11], v[160:163]
buffer_load_dwordx4 v[180:183], v1, s[8:11], s67 offen offset:1024 sc1
ds_read_b64_tr_b16 v[24:25], v10 offset:40960
v_mfma_f32_16x16x32_bf16 v[168:171], v[32:35], a[12:15], v[168:171]
ds_read_b64_tr_b16 v[26:27], v10 offset:43008
v_mfma_f32_16x16x32_bf16 v[164:167], v[36:39], a[8:11], v[164:167]
ds_read_b64_tr_b16 v[28:29], v11 offset:40960
v_mfma_f32_16x16x32_bf16 v[172:175], v[36:39], a[12:15], v[172:175]
ds_read_b64_tr_b16 v[30:31], v11 offset:43008
s_waitcnt lgkmcnt(4)
v_mfma_f32_16x16x32_bf16 v[160:163], v[40:43], a[16:19], v[160:163]
ds_read_b64_tr_b16 v[32:33], v10 offset:45056
v_mfma_f32_16x16x32_bf16 v[168:171], v[40:43], a[20:23], v[168:171]
ds_read_b64_tr_b16 v[34:35], v10 offset:47104
v_mfma_f32_16x16x32_bf16 v[164:167], v[44:47], a[16:19], v[164:167]
buffer_load_dword v188, v17, s[8:11], s67 offen offset:3072 sc1
ds_read_b64_tr_b16 v[36:37], v11 offset:45056
v_mfma_f32_16x16x32_bf16 v[172:175], v[44:47], a[20:23], v[172:175]
ds_read_b64_tr_b16 v[38:39], v11 offset:47104
v_mfma_f32_16x16x32_bf16 v[160:163], v[248:251], a[24:27], v[160:163]
v_add_u32 v10, 49152, v10
ds_read_b64_tr_b16 v[40:41], v10 offset:0
v_mfma_f32_16x16x32_bf16 v[168:171], v[248:251], a[28:31], v[168:171]
ds_read_b64_tr_b16 v[42:43], v10 offset:2048
v_mfma_f32_16x16x32_bf16 v[164:167], v[252:255], a[24:27], v[164:167]
v_add_u32 v11, 49152, v11
ds_read_b64_tr_b16 v[44:45], v11 offset:0
v_mfma_f32_16x16x32_bf16 v[172:175], v[252:255], a[28:31], v[172:175]
ds_read_b64_tr_b16 v[46:47], v11 offset:2048
s_waitcnt lgkmcnt(4)
v_mfma_f32_16x16x32_bf16 v[160:163], v[24:27], a[32:35], v[160:163]
ds_read_b64_tr_b16 v[248:249], v10 offset:4096
v_mfma_f32_16x16x32_bf16 v[168:171], v[24:27], a[36:39], v[168:171]
ds_read_b64_tr_b16 v[250:251], v10 offset:6144
v_mfma_f32_16x16x32_bf16 v[164:167], v[28:31], a[32:35], v[164:167]
ds_read_b64_tr_b16 v[252:253], v11 offset:4096
v_mfma_f32_16x16x32_bf16 v[172:175], v[28:31], a[36:39], v[172:175]
ds_read_b64_tr_b16 v[254:255], v11 offset:6144
v_mfma_f32_16x16x32_bf16 v[160:163], v[32:35], a[40:43], v[160:163]
ds_read_b64_tr_b16 v[24:25], v10 offset:8192
v_mfma_f32_16x16x32_bf16 v[168:171], v[32:35], a[44:47], v[168:171]
ds_read_b64_tr_b16 v[26:27], v10 offset:10240
v_mfma_f32_16x16x32_bf16 v[164:167], v[36:39], a[40:43], v[164:167]
ds_read_b64_tr_b16 v[28:29], v11 offset:8192
v_mfma_f32_16x16x32_bf16 v[172:175], v[36:39], a[44:47], v[172:175]
ds_read_b64_tr_b16 v[30:31], v11 offset:10240
s_waitcnt lgkmcnt(4)
v_mfma_f32_16x16x32_bf16 v[160:163], v[40:43], a[48:51], v[160:163]
ds_read_b64_tr_b16 v[32:33], v10 offset:12288
v_mfma_f32_16x16x32_bf16 v[168:171], v[40:43], a[52:55], v[168:171]
ds_read_b64_tr_b16 v[34:35], v10 offset:14336
v_mfma_f32_16x16x32_bf16 v[164:167], v[44:47], a[48:51], v[164:167]
ds_read_b64_tr_b16 v[36:37], v11 offset:12288
v_mfma_f32_16x16x32_bf16 v[172:175], v[44:47], a[52:55], v[172:175]
ds_read_b64_tr_b16 v[38:39], v11 offset:14336
v_mfma_f32_16x16x32_bf16 v[160:163], v[248:251], a[56:59], v[160:163]
ds_read_b64_tr_b16 v[40:41], v10 offset:16384
v_mfma_f32_16x16x32_bf16 v[168:171], v[248:251], a[60:63], v[168:171]
ds_read_b64_tr_b16 v[42:43], v10 offset:18432
v_mfma_f32_16x16x32_bf16 v[164:167], v[252:255], a[56:59], v[164:167]
ds_read_b64_tr_b16 v[44:45], v11 offset:16384
v_mfma_f32_16x16x32_bf16 v[172:175], v[252:255], a[60:63], v[172:175]
ds_read_b64_tr_b16 v[46:47], v11 offset:18432
s_waitcnt lgkmcnt(4)
v_mfma_f32_16x16x32_bf16 v[160:163], v[24:27], v[48:51], v[160:163]
ds_read_b64_tr_b16 v[248:249], v10 offset:20480
v_mfma_f32_16x16x32_bf16 v[168:171], v[24:27], v[52:55], v[168:171]
ds_read_b64_tr_b16 v[250:251], v10 offset:22528
v_mfma_f32_16x16x32_bf16 v[164:167], v[28:31], v[48:51], v[164:167]
ds_read_b64_tr_b16 v[252:253], v11 offset:20480
v_mfma_f32_16x16x32_bf16 v[172:175], v[28:31], v[52:55], v[172:175]
ds_read_b64_tr_b16 v[254:255], v11 offset:22528
v_mfma_f32_16x16x32_bf16 v[160:163], v[32:35], v[56:59], v[160:163]
v_mfma_f32_16x16x32_bf16 v[168:171], v[32:35], v[60:63], v[168:171]
v_mfma_f32_16x16x32_bf16 v[164:167], v[36:39], v[56:59], v[164:167]
v_mfma_f32_16x16x32_bf16 v[172:175], v[36:39], v[60:63], v[172:175]
s_waitcnt lgkmcnt(0)
v_mfma_f32_16x16x32_bf16 v[160:163], v[40:43], v[64:67], v[160:163]
v_mfma_f32_16x16x32_bf16 v[168:171], v[40:43], v[68:71], v[168:171]
v_mfma_f32_16x16x32_bf16 v[164:167], v[44:47], v[64:67], v[164:167]
v_mfma_f32_16x16x32_bf16 v[172:175], v[44:47], v[68:71], v[172:175]
v_mfma_f32_16x16x32_bf16 v[160:163], v[248:251], v[72:75], v[160:163]
v_mfma_f32_16x16x32_bf16 v[168:171], v[248:251], v[76:79], v[168:171]
v_mfma_f32_16x16x32_bf16 v[164:167], v[252:255], v[72:75], v[164:167]
v_mfma_f32_16x16x32_bf16 v[172:175], v[252:255], v[76:79], v[172:175]
s_mov_b32 s51, 0
s_waitcnt vmcnt(9)
K3B_chk2:
v_bitop3_b32 v205, v192, v193, v194 bitop3:0x96
v_bitop3_b32 v204, v204, v195, v196 bitop3:0x96
v_bitop3_b32 v205, v205, v197, v198 bitop3:0x96
v_bitop3_b32 v204, v204, v205, v199 bitop3:0x96
v_cmp_ne_u32 vcc, s52, v204
s_cbranch_vccnz K3B_rt2
K3B_go2:
v_mfma_f32_16x16x32_bf16 v[160:163], v[154:157], v[192:195], v[160:163]
v_mfma_f32_16x16x32_bf16 v[164:167], v[152:155], v[192:195], v[164:167]
v_mfma_f32_16x16x32_bf16 v[168:171], v[154:157], v[196:199], v[168:171]
v_mfma_f32_16x16x32_bf16 v[172:175], v[152:155], v[196:199], v[172:175]
s_waitcnt vmcnt(3)
K3B_chk3:
v_bitop3_b32 v221, v208, v209, v210 bitop3:0x96
v_bitop3_b32 v220, v220, v211, v212 bitop3:0x96
v_bitop3_b32 v221, v221, v213, v214 bitop3:0x96
v_bitop3_b32 v220, v220, v221, v215 bitop3:0x96
v_cmp_ne_u32 vcc, s52, v220
s_cbranch_vccnz K3B_rt3
K3B_go3:
v_mfma_f32_16x16x32_bf16 v[160:163], v[154:157], v[208:211], v[160:163]
v_mfma_f32_16x16x32_bf16 v[164:167], v[152:155], v[208:211], v[164:167]
v_mfma_f32_16x16x32_bf16 v[168:171], v[154:157], v[212:215], v[168:171]
v_mfma_f32_16x16x32_bf16 v[172:175], v[152:155], v[212:215], v[172:175]
s_waitcnt vmcnt(0)
K3B_chk1:
v_bitop3_b32 v189, v176, v177, v178 bitop3:0x96
v_bitop3_b32 v188, v188, v179, v180 bitop3:0x96
v_bitop3_b32 v189, v189, v181, v182 bitop3:0x96
v_bitop3_b32 v188, v188, v189, v183 bitop3:0x96
v_cmp_ne_u32 vcc, s52, v188
s_cbranch_vccnz K3B_rt1
K3B_go1:
v_mfma_f32_16x16x32_bf16 v[160:163], v[154:157], v[176:179], v[160:163]
v_mfma_f32_16x16x32_bf16 v[164:167], v[152:155], v[176:179], v[164:167]
v_mfma_f32_16x16x32_bf16 v[168:171], v[154:157], v[180:183], v[168:171]
v_mfma_f32_16x16x32_bf16 v[172:175], v[152:155], v[180:183], v[172:175]
s_nop 4
v_fma_f32 v160, v160, v18, v224
v_fma_f32 v161, v161, v18, v225
v_fma_f32 v162, v162, v18, v226
v_fma_f32 v163, v163, v18, v227
v_fma_f32 v168, v168, v16, v228
v_fma_f32 v169, v169, v16, v229
v_fma_f32 v170, v170, v16, v230
v_fma_f32 v171, v171, v16, v231
v_cvt_pk_bf16_f32 v128, v160, v161
v_cvt_pk_bf16_f32 v129, v162, v163
v_cvt_pk_bf16_f32 v130, v168, v169
v_cvt_pk_bf16_f32 v131, v170, v171
s_nop 0
v_permlane16_swap_b32 v128, v130
v_permlane16_swap_b32 v129, v131
buffer_store_dwordx4 v[128:131], v2, s[20:23], s38 offen offset:0
v_fma_f32 v164, v164, v18, v232
v_fma_f32 v165, v165, v18, v233
v_fma_f32 v166, v166, v18, v234
v_fma_f32 v167, v167, v18, v235
v_fma_f32 v172, v172, v16, v236
v_fma_f32 v173, v173, v16, v237
v_fma_f32 v174, v174, v16, v238
v_fma_f32 v175, v175, v16, v239
v_cvt_pk_bf16_f32 v132, v164, v165
v_cvt_pk_bf16_f32 v133, v166, v167
v_cvt_pk_bf16_f32 v134, v172, v173
v_cvt_pk_bf16_f32 v135, v174, v175
s_nop 0
v_permlane16_swap_b32 v132, v134
v_permlane16_swap_b32 v133, v135
buffer_store_dwordx4 v[132:135], v2, s[20:23], s38 offen offset:32
s_endpgm
K3B_rt1:
s_add_u32 s51, s51, 1
s_cmp_gt_u32 s51, 20000
s_cbranch_scc1 K3B_go1
buffer_load_dwordx4 v[176:179], v1, s[8:11], s67 offen offset:0 sc1
buffer_load_dwordx4 v[180:183], v1, s[8:11], s67 offen offset:1024 sc1
buffer_load_dword v188, v17, s[8:11], s67 offen offset:3072 sc1
s_waitcnt vmcnt(0)
s_branch K3B_chk1
K3B_rt2:
s_add_u32 s51, s51, 1
s_cmp_gt_u32 s51, 20000
s_cbranch_scc1 K3B_go2
buffer_load_dwordx4 v[192:195], v1, s[8:11], s68 offen offset:0 sc1
buffer_load_dwordx4 v[196:199], v1, s[8:11], s68 offen offset:1024 sc1
buffer_load_dword v204, v17, s[8:11], s68 offen offset:3072 sc1
s_waitcnt vmcnt(0)
s_branch K3B_chk2
K3B_rt3:
s_add_u32 s51, s51, 1
s_cmp_gt_u32 s51, 20000
s_cbranch_scc1 K3B_go3
buffer_load_dwordx4 v[208:211], v1, s[8:11], s69 offen offset:0 sc1
buffer_load_dwordx4 v[212:215], v1, s[8:11], s69 offen offset:1024 sc1
buffer_load_dword v220, v17, s[8:11], s69 offen offset:3072 sc1
s_waitcnt vmcnt(0)
s_branch K3B_chk3
K3B_dr0:
s_mov_b32 s59, 0
s_add_u32 s53, s53, 10000
s_add_u32 s58, s48, 65536
K3B_dl0:
buffer_load_dwordx4 v[48:51], v1, s[8:11], s58 offen offset:0 sc1
buffer_load_dwordx4 v[52:55], v1, s[8:11], s58 offen offset:1024 sc1
buffer_load_dwordx4 v[56:59], v1, s[8:11], s58 offen offset:2048 sc1
buffer_load_dwordx4 v[60:63], v1, s[8:11], s58 offen offset:3072 sc1
buffer_load_dword v80, v19, s[8:11], s58 offen sc1
s_add_u32 s59, s59, 1
s_waitcnt vmcnt(0)
v_bitop3_b32 v80, v80, v48, v49 bitop3:0x96
v_bitop3_b32 v80, v80, v50, v51 bitop3:0x96
v_bitop3_b32 v80, v80, v52, v53 bitop3:0x96
v_bitop3_b32 v80, v80, v54, v55 bitop3:0x96
v_bitop3_b32 v80, v80, v56, v57 bitop3:0x96
v_bitop3_b32 v80, v80, v58, v59 bitop3:0x96
v_bitop3_b32 v80, v80, v60, v61 bitop3:0x96
v_bitop3_b32 v80, v80, v62, v63 bitop3:0x96
v_cmp_ne_u32 s[56:57], s52, v80
s_cmp_gt_u32 s59, 20000
s_cbranch_scc1 K3B_dk0
s_cmp_lg_u64 s[56:57], 0
s_cbranch_scc1 K3B_dl0
s_branch K3B_dk0
K3B_dr1:
s_mov_b32 s59, 0
s_add_u32 s53, s53, 10000
s_add_u32 s58, s49, 65536
K3B_dl1:
buffer_load_dwordx4 v[64:67], v1, s[8:11], s58 offen offset:0 sc1
buffer_load_dwordx4 v[68:71], v1, s[8:11], s58 offen offset:1024 sc1
buffer_load_dwordx4 v[72:75], v1, s[8:11], s58 offen offset:2048 sc1
buffer_load_dwordx4 v[76:79], v1, s[8:11], s58 offen offset:3072 sc1
buffer_load_dword v81, v19, s[8:11], s58 offen sc1
s_add_u32 s59, s59, 1
s_waitcnt vmcnt(0)
v_bitop3_b32 v81, v81, v64, v65 bitop3:0x96
v_bitop3_b32 v81, v81, v66, v67 bitop3:0x96
v_bitop3_b32 v81, v81, v68, v69 bitop3:0x96
v_bitop3_b32 v81, v81, v70, v71 bitop3:0x96
v_bitop3_b32 v81, v81, v72, v73 bitop3:0x96
v_bitop3_b32 v81, v81, v74, v75 bitop3:0x96
v_bitop3_b32 v81, v81, v76, v77 bitop3:0x96
v_bitop3_b32 v81, v81, v78, v79 bitop3:0x96
v_cmp_ne_u32 s[56:57], s52, v81
s_cmp_gt_u32 s59, 20000
s_cbranch_scc1 K3B_dk1
s_cmp_lg_u64 s[56:57], 0
s_cbranch_scc1 K3B_dl1
s_branch K3B_dk1
K3B_slow1:
s_mov_b32 s58, 0
s_add_u32 s53, s53, 1
K3B_sl1:
buffer_load_dword v14, v17, s[8:11], s36 offen offset:128 sc1
s_add_u32 s58, s58, 1
s_waitcnt vmcnt(0)
v_cmp_ne_u32 s[56:57], s52, v14
s_cmp_gt_u32 s58, 20000
s_cbranch_scc1 K3B_back1
s_and_b32 s56, s56, 15
s_cbranch_scc1 K3B_sl1
s_branch K3B_back1
K3B_slow2:
s_mov_b32 s58, 0
s_add_u32 s53, s53, 10
K3B_sl2:
buffer_load_dword v14, v17, s[8:11], s36 offen offset:256 sc1
s_add_u32 s58, s58, 1
s_waitcnt vmcnt(0)
v_cmp_ne_u32 s[56:57], s52, v14
s_cmp_gt_u32 s58, 20000
s_cbranch_scc1 K3B_back2
s_and_b32 s56, s56, 15
s_cbranch_scc1 K3B_sl2
s_branch K3B_back2
K3B_slow3:
s_mov_b32 s58, 0
s_add_u32 s53, s53, 100
K3B_sl3:
buffer_load_dword v14, v17, s[8:11], s36 offen offset:384 sc1
s_add_u32 s58, s58, 1
s_waitcnt vmcnt(0)
v_cmp_ne_u32 s[56:57], s52, v14
s_cmp_gt_u32 s58, 20000
s_cbranch_scc1 K3B_back3
s_and_b32 s56, s56, 15
s_cbranch_scc1 K3B_sl3
s_branch K3B_back3
K3B_slow4:
s_mov_b32 s58, 0
s_add_u32 s53, s53, 1000
K3B_sl4:
buffer_load_dword v14, v17, s[8:11], s36 offen offset:512 sc1
s_add_u32 s58, s58, 1
s_waitcnt vmcnt(0)
v_cmp_ne_u32 s[56:57], s52, v14
s_cmp_gt_u32 s58, 20000
s_cbranch_scc1 K3B_back4
s_and_b32 s56, s56, 7
s_cbranch_scc1 K3B_sl4
s_branch K3B_back4
K3_C:
s_add_u32 s47, s34, 294912
s_lshl_b32 s43, s24, 5
s_lshl_b32 s38, s25, 2
s_add_u32 s38, s38, s26
s_mul_i32 s38, s38, 196608
s_lshl_b32 s3, s27, 12
s_add_u32 s38, s38, s3
s_mul_i32 s46, s24, 49152
s_add_u32 s46, s46, s38
s_xor_b32 s3, s24, 1
s_mul_i32 s3, s3, 49152
s_add_u32 s3, s3, s38
s_add_u32 s64, s3, 30408704
s_add_u32 s67, s46, 30408704
s_xor_b32 s3, s24, 2
s_mul_i32 s3, s3, 49152
s_add_u32 s3, s3, s38
s_add_u32 s65, s3, 30425088
s_add_u32 s68, s46, 30425088
s_xor_b32 s3, s24, 3
s_mul_i32 s3, s3, 49152
s_add_u32 s3, s3, s38
s_add_u32 s66, s3, 30441472
s_add_u32 s69, s46, 30441472
s_mul_i32 s3, s31, 36864
s_lshl_b32 s28, s26, 8
s_lshl_b32 s31, s24, 6
s_add_u32 s28, s28, s31
s_lshl_b32 s31, s24, 5
s_add_u32 s31, s31, 1024
s_add_u32 s38, s28, s3
s_add_u32 s46, s31, s3
s_lshl_b32 s25, s28, 5
s_add_u32 s25, s25, s32
s_lshl_b32 s26, s31, 5
s_add_u32 s26, s26, s32
s_lshl_b32 s42, s27, 12
v_add_u32 v23, s42, v1
v_add_u32 v23, 98304, v23
v_add_u32 v242, 8, v23
s_and_b32 s3, s2, 7
s_lshl_b32 s3, s3, 12
s_add_u32 s3, s3, 4751360
s_mov_b32 s50, 0
s_cmp_lt_u32 s2, 144
s_cbranch_scc1 K3C_pl
s_cmp_lg_u32 s27, 0
s_cbranch_scc1 K3C_qk
s_sub_u32 s56, s2, 144
s_lshl_b32 s56, s56, 4
s_add_u32 s56, s56, s3
K3C_ql:
buffer_load_dword v57, off, s[8:11], s56 sc1
s_add_u32 s50, s50, 1
s_waitcnt vmcnt(0)
v_cmp_ne_u32 vcc, s52, v57
s_cbranch_vccz K3C_qk
s_sleep 4
s_cmp_lt_u32 s50, 20000
s_cbranch_scc1 K3C_ql
K3C_qk:
s_barrier
K3C_pl:
buffer_load_dword v60, v56, s[8:11], s3 offen sc1
s_add_u32 s50, s50, 1
s_waitcnt vmcnt(0)
v_cmp_ne_u32 vcc, s52, v60
s_cbranch_vccz K3C_pk
s_sleep 2
s_cmp_lt_u32 s50, 20000
s_cbranch_scc1 K3C_pl
K3C_pk:
s_barrier
s_add_u32 m0, s42, 98304
s_add_u32 s7, s32, 0
buffer_load_dwordx4 v1, s[8:11], s7 offen offset:0 sc1 lds
buffer_load_dwordx4 v1, s[8:11], s7 offen offset:1024 sc1 lds
buffer_load_dwordx4 v1, s[8:11], s7 offen offset:2048 sc1 lds
buffer_load_dwordx4 v1, s[8:11], s7 offen offset:3072 sc1 lds
s_add_u32 m0, s42, 114688
s_add_u32 s7, s32, 4096
buffer_load_dwordx4 v1, s[8:11], s7 offen offset:0 sc1 lds
buffer_load_dwordx4 v1, s[8:11], s7 offen offset:1024 sc1 lds
buffer_load_dwordx4 v1, s[8:11], s7 offen offset:2048 sc1 lds
buffer_load_dwordx4 v1, s[8:11], s7 offen offset:3072 sc1 lds
s_add_u32 m0, s42, 131072
s_add_u32 s7, s32, 8192
buffer_load_dwordx4 v1, s[8:11], s7 offen offset:0 sc1 lds
buffer_load_dwordx4 v1, s[8:11], s7 offen offset:1024 sc1 lds
buffer_load_dwordx4 v1, s[8:11], s7 offen offset:2048 sc1 lds
buffer_load_dwordx4 v1, s[8:11], s7 offen offset:3072 sc1 lds
s_add_u32 s50, s33, 4096
s_mov_b32 s0, s52
s_mov_b32 s1, s52
s_branch PGC_0
.p2align 12
PSC_0:
s_setpc_b64 s[62:63]
PGC_0:
ds_read_b64_tr_b16 v[24:25], v6 offset:0
ds_read_b64_tr_b16 v[26:27], v6 offset:2048
ds_read_b64_tr_b16 v[28:29], v7 offset:0
ds_read_b64_tr_b16 v[30:31], v7 offset:2048
ds_read_b64_tr_b16 v[32:33], v8 offset:0
ds_read_b64_tr_b16 v[34:35], v8 offset:2048
ds_read_b64_tr_b16 v[36:37], v9 offset:0
ds_read_b64_tr_b16 v[38:39], v9 offset:2048
ds_read_b64_tr_b16 v[40:41], v6 offset:4096
ds_read_b64_tr_b16 v[42:43], v6 offset:6144
ds_read_b64_tr_b16 v[44:45], v7 offset:4096
ds_read_b64_tr_b16 v[46:47], v7 offset:6144
s_waitcnt vmcnt(10)
ds_read2st64_b64 a[0:3], v23 offset0:0 offset1:2
ds_read2st64_b64 a[4:7], v242 offset0:0 offset1:2
s_waitcnt lgkmcnt(0)
v_mfma_f32_16x16x32_bf16 v[160:163], v[24:27], a[0:3], 0
ds_read_b64_tr_b16 v[120:121], v8 offset:4096
v_mfma_f32_16x16x32_bf16 v[168:171], v[24:27], a[4:7], 0
ds_read_b64_tr_b16 v[122:123], v8 offset:6144
v_mfma_f32_16x16x32_bf16 v[128:131], v[144:147], a[0:3], 0
s_add_u32 m0, s42, 147456
s_add_u32 s7, s32, 12288
buffer_load_dwordx4 v1, s[8:11], s7 offen offset:0 sc1 lds
s_waitcnt vmcnt(9)
v_mfma_f32_16x16x32_bf16 v[164:167], v[28:31], a[0:3], 0
buffer_load_dwordx4 v1, s[8:11], s7 offen offset:1024 sc1 lds
ds_read_b64_tr_b16 v[124:125], v9 offset:4096
v_mfma_f32_16x16x32_bf16 v[172:175], v[28:31], a[4:7], 0
ds_read_b64_tr_b16 v[126:127], v9 offset:6144
ds_read2st64_b64 a[8:11], v23 offset0:4 offset1:6
ds_read2st64_b64 a[12:15], v242 offset0:4 offset1:6
v_mfma_f32_16x16x32_bf16 v[132:135], v[144:147], a[4:7], 0
buffer_load_dwordx4 v1, s[8:11], s7 offen offset:2048 sc1 lds
v_mfma_f32_16x16x32_bf16 v[176:179], v[32:35], a[0:3], 0
buffer_load_dwordx4 v1, s[8:11], s7 offen offset:3072 sc1 lds
ds_read_b64_tr_b16 v[24:25], v6 offset:8192
v_mfma_f32_16x16x32_bf16 v[184:187], v[32:35], a[4:7], 0
ds_read_b64_tr_b16 v[26:27], v6 offset:10240
v_mfma_f32_16x16x32_bf16 v[136:139], a[0:3], a[0:3], 0
s_add_u32 m0, s42, 98304
s_add_u32 s7, s32, 16384
buffer_load_dwordx4 v1, s[8:11], s7 offen offset:0 sc1 lds
v_mfma_f32_16x16x32_bf16 v[180:183], v[36:39], a[0:3], 0
ds_read_b64_tr_b16 v[28:29], v7 offset:8192
v_mfma_f32_16x16x32_bf16 v[188:191], v[36:39], a[4:7], 0
ds_read_b64_tr_b16 v[30:31], v7 offset:10240
v_mfma_f32_16x16x32_bf16 v[140:143], a[4:7], a[4:7], 0
s_waitcnt lgkmcnt(4)
v_mfma_f32_16x16x32_bf16 v[160:163], v[40:43], a[8:11], v[160:163]
buffer_load_dwordx4 v1, s[8:11], s7 offen offset:1024 sc1 lds
ds_read_b64_tr_b16 v[32:33], v8 offset:8192
v_mfma_f32_16x16x32_bf16 v[168:171], v[40:43], a[12:15], v[168:171]
ds_read_b64_tr_b16 v[34:35], v8 offset:10240
v_mfma_f32_16x16x32_bf16 v[128:131], v[144:147], a[8:11], v[128:131]
s_waitcnt vmcnt(12)
v_mfma_f32_16x16x32_bf16 v[164:167], v[44:47], a[8:11], v[164:167]
buffer_load_dwordx4 v1, s[8:11], s7 offen offset:2048 sc1 lds
ds_read_b64_tr_b16 v[36:37], v9 offset:8192
v_mfma_f32_16x16x32_bf16 v[172:175], v[44:47], a[12:15], v[172:175]
ds_read_b64_tr_b16 v[38:39], v9 offset:10240
ds_read2st64_b64 a[16:19], v23 offset0:32 offset1:34
ds_read2st64_b64 a[20:23], v242 offset0:32 offset1:34
v_mfma_f32_16x16x32_bf16 v[132:135], v[144:147], a[12:15], v[132:135]
v_mfma_f32_16x16x32_bf16 v[176:179], v[120:123], a[8:11], v[176:179]
buffer_load_dwordx4 v1, s[8:11], s7 offen offset:3072 sc1 lds
ds_read_b64_tr_b16 v[40:41], v6 offset:12288
v_mfma_f32_16x16x32_bf16 v[184:187], v[120:123], a[12:15], v[184:187]
ds_read_b64_tr_b16 v[42:43], v6 offset:14336
v_mfma_f32_16x16x32_bf16 v[136:139], a[8:11], a[8:11], v[136:139]
v_mfma_f32_16x16x32_bf16 v[180:183], v[124:127], a[8:11], v[180:183]
buffer_load_dwordx4 v[244:247], v1, s[8:11], s33 offen offset:0 sc1
ds_read_b64_tr_b16 v[44:45], v7 offset:12288
v_mfma_f32_16x16x32_bf16 v[188:191], v[124:127], a[12:15], v[188:191]
ds_read_b64_tr_b16 v[46:47], v7 offset:14336
v_mfma_f32_16x16x32_bf16 v[140:143], a[12:15], a[12:15], v[140:143]
s_waitcnt lgkmcnt(4)
v_mfma_f32_16x16x32_bf16 v[160:163], v[24:27], a[16:19], v[160:163]
ds_read_b64_tr_b16 v[120:121], v8 offset:12288
v_mfma_f32_16x16x32_bf16 v[168:171], v[24:27], a[20:23], v[168:171]
ds_read_b64_tr_b16 v[122:123], v8 offset:14336
v_mfma_f32_16x16x32_bf16 v[128:131], v[144:147], a[16:19], v[128:131]
s_add_u32 m0, s42, 114688
s_add_u32 s7, s32, 20480
buffer_load_dwordx4 v1, s[8:11], s7 offen offset:0 sc1 lds
s_waitcnt vmcnt(14)
v_mfma_f32_16x16x32_bf16 v[164:167], v[28:31], a[16:19], v[164:167]
ds_read_b64_tr_b16 v[124:125], v9 offset:12288
v_mfma_f32_16x16x32_bf16 v[172:175], v[28:31], a[20:23], v[172:175]
ds_read_b64_tr_b16 v[126:127], v9 offset:14336
ds_read2st64_b64 a[24:27], v23 offset0:36 offset1:38
ds_read2st64_b64 a[28:31], v242 offset0:36 offset1:38
v_mfma_f32_16x16x32_bf16 v[132:135], v[144:147], a[20:23], v[132:135]
buffer_load_dwordx4 v1, s[8:11], s7 offen offset:1024 sc1 lds
v_mfma_f32_16x16x32_bf16 v[176:179], v[32:35], a[16:19], v[176:179]
ds_read_b64_tr_b16 v[24:25], v6 offset:16384
v_mfma_f32_16x16x32_bf16 v[184:187], v[32:35], a[20:23], v[184:187]
ds_read_b64_tr_b16 v[26:27], v6 offset:18432
v_mfma_f32_16x16x32_bf16 v[136:139], a[16:19], a[16:19], v[136:139]
v_mfma_f32_16x16x32_bf16 v[180:183], v[36:39], a[16:19], v[180:183]
ds_read_b64_tr_b16 v[28:29], v7 offset:16384
v_mfma_f32_16x16x32_bf16 v[188:191], v[36:39], a[20:23], v[188:191]
ds_read_b64_tr_b16 v[30:31], v7 offset:18432
v_mfma_f32_16x16x32_bf16 v[140:143], a[20:23], a[20:23], v[140:143]
s_waitcnt lgkmcnt(4)
v_mfma_f32_16x16x32_bf16 v[160:163], v[40:43], a[24:27], v[160:163]
ds_read_b64_tr_b16 v[32:33], v8 offset:16384
v_mfma_f32_16x16x32_bf16 v[168:171], v[40:43], a[28:31], v[168:171]
ds_read_b64_tr_b16 v[34:35], v8 offset:18432
v_mfma_f32_16x16x32_bf16 v[128:131], v[144:147], a[24:27], v[128:131]
s_waitcnt vmcnt(13)
v_mfma_f32_16x16x32_bf16 v[164:167], v[44:47], a[24:27], v[164:167]
ds_read_b64_tr_b16 v[36:37], v9 offset:16384
v_mfma_f32_16x16x32_bf16 v[172:175], v[44:47], a[28:31], v[172:175]
ds_read_b64_tr_b16 v[38:39], v9 offset:18432
ds_read2st64_b64 a[32:35], v23 offset0:64 offset1:66
ds_read2st64_b64 a[36:39], v242 offset0:64 offset1:66
v_mfma_f32_16x16x32_bf16 v[132:135], v[144:147], a[28:31], v[132:135]
v_mfma_f32_16x16x32_bf16 v[176:179], v[120:123], a[24:27], v[176:179]
ds_read_b64_tr_b16 v[40:41], v6 offset:20480
v_mfma_f32_16x16x32_bf16 v[184:187], v[120:123], a[28:31], v[184:187]
ds_read_b64_tr_b16 v[42:43], v6 offset:22528
v_mfma_f32_16x16x32_bf16 v[136:139], a[24:27], a[24:27], v[136:139]
buffer_load_dwordx4 v1, s[8:11], s7 offen offset:2048 sc1 lds
v_mfma_f32_16x16x32_bf16 v[180:183], v[124:127], a[24:27], v[180:183]
ds_read_b64_tr_b16 v[44:45], v7 offset:20480
v_mfma_f32_16x16x32_bf16 v[188:191], v[124:127], a[28:31], v[188:191]
ds_read_b64_tr_b16 v[46:47], v7 offset:22528
v_mfma_f32_16x16x32_bf16 v[140:143], a[28:31], a[28:31], v[140:143]
s_waitcnt lgkmcnt(4)
v_mfma_f32_16x16x32_bf16 v[160:163], v[24:27], a[32:35], v[160:163]
ds_read_b64_tr_b16 v[120:121], v8 offset:20480
v_mfma_f32_16x16x32_bf16 v[168:171], v[24:27], a[36:39], v[168:171]
ds_read_b64_tr_b16 v[122:123], v8 offset:22528
v_mfma_f32_16x16x32_bf16 v[128:131], v[144:147], a[32:35], v[128:131]
buffer_load_dwordx4 v1, s[8:11], s7 offen offset:3072 sc1 lds
s_waitcnt vmcnt(13)
v_mfma_f32_16x16x32_bf16 v[164:167], v[28:31], a[32:35], v[164:167]
ds_read_b64_tr_b16 v[124:125], v9 offset:20480
v_mfma_f32_16x16x32_bf16 v[172:175], v[28:31], a[36:39], v[172:175]
ds_read_b64_tr_b16 v[126:127], v9 offset:22528
ds_read2st64_b64 a[40:43], v23 offset0:68 offset1:70
ds_read2st64_b64 a[44:47], v242 offset0:68 offset1:70
v_mfma_f32_16x16x32_bf16 v[132:135], v[144:147], a[36:39], v[132:135]
v_mfma_f32_16x16x32_bf16 v[176:179], v[32:35], a[32:35], v[176:179]
v_mfma_f32_16x16x32_bf16 v[184:187], v[32:35], a[36:39], v[184:187]
s_barrier
ds_read_b64_tr_b16 v[24:25], v6 offset:24576
ds_read_b64_tr_b16 v[26:27], v6 offset:26624
v_mfma_f32_16x16x32_bf16 v[136:139], a[32:35], a[32:35], v[136:139]
s_add_u32 m0, s42, 131072
s_add_u32 s7, s32, 24576
buffer_load_dwordx4 v1, s[8:11], s7 offen offset:0 sc1 lds
v_mfma_f32_16x16x32_bf16 v[180:183], v[36:39], a[32:35], v[180:183]
ds_read_b64_tr_b16 v[28:29], v7 offset:24576
v_mfma_f32_16x16x32_bf16 v[188:191], v[36:39], a[36:39], v[188:191]
ds_read_b64_tr_b16 v[30:31], v7 offset:26624
v_mfma_f32_16x16x32_bf16 v[140:143], a[36:39], a[36:39], v[140:143]
s_waitcnt lgkmcnt(4)
v_mfma_f32_16x16x32_bf16 v[160:163], v[40:43], a[40:43], v[160:163]
buffer_load_dwordx4 v1, s[8:11], s7 offen offset:1024 sc1 lds
ds_read_b64_tr_b16 v[32:33], v8 offset:24576
v_mfma_f32_16x16x32_bf16 v[168:171], v[40:43], a[44:47], v[168:171]
ds_read_b64_tr_b16 v[34:35], v8 offset:26624
v_mfma_f32_16x16x32_bf16 v[128:131], v[144:147], a[40:43], v[128:131]
s_waitcnt vmcnt(13)
v_mfma_f32_16x16x32_bf16 v[164:167], v[44:47], a[40:43], v[164:167]
buffer_load_dwordx4 v1, s[8:11], s7 offen offset:2048 sc1 lds
ds_read_b64_tr_b16 v[36:37], v9 offset:24576
v_mfma_f32_16x16x32_bf16 v[172:175], v[44:47], a[44:47], v[172:175]
ds_read_b64_tr_b16 v[38:39], v9 offset:26624
ds_read2st64_b64 a[48:51], v23 offset0:96 offset1:98
ds_read2st64_b64 a[52:55], v242 offset0:96 offset1:98
v_mfma_f32_16x16x32_bf16 v[132:135], v[144:147], a[44:47], v[132:135]
v_mfma_f32_16x16x32_bf16 v[176:179], v[120:123], a[40:43], v[176:179]
buffer_load_dwordx4 v1, s[8:11], s7 offen offset:3072 sc1 lds
ds_read_b64_tr_b16 v[40:41], v6 offset:28672
v_mfma_f32_16x16x32_bf16 v[184:187], v[120:123], a[44:47], v[184:187]
ds_read_b64_tr_b16 v[42:43], v6 offset:30720
v_mfma_f32_16x16x32_bf16 v[136:139], a[40:43], a[40:43], v[136:139]
s_add_u32 m0, s30, 73728
s_add_u32 s6, s29, 128
v_mfma_f32_16x16x32_bf16 v[180:183], v[124:127], a[40:43], v[180:183]
buffer_load_dwordx4 v2, s[12:15], s6 offen offset:0 lds
ds_read_b64_tr_b16 v[44:45], v7 offset:28672
v_mfma_f32_16x16x32_bf16 v[188:191], v[124:127], a[44:47], v[188:191]
ds_read_b64_tr_b16 v[46:47], v7 offset:30720
v_mfma_f32_16x16x32_bf16 v[140:143], a[44:47], a[44:47], v[140:143]
s_waitcnt lgkmcnt(4)
v_mfma_f32_16x16x32_bf16 v[160:163], v[24:27], a[48:51], v[160:163]
ds_read_b64_tr_b16 v[120:121], v8 offset:28672
v_mfma_f32_16x16x32_bf16 v[168:171], v[24:27], a[52:55], v[168:171]
ds_read_b64_tr_b16 v[122:123], v8 offset:30720
v_mfma_f32_16x16x32_bf16 v[128:131], v[144:147], a[48:51], v[128:131]
s_add_u32 m0, s42, 147456
s_add_u32 s7, s32, 28672
buffer_load_dwordx4 v1, s[8:11], s7 offen offset:0 sc1 lds
s_waitcnt vmcnt(15)
v_mfma_f32_16x16x32_bf16 v[164:167], v[28:31], a[48:51], v[164:167]
ds_read_b64_tr_b16 v[124:125], v9 offset:28672
v_mfma_f32_16x16x32_bf16 v[172:175], v[28:31], a[52:55], v[172:175]
ds_read_b64_tr_b16 v[126:127], v9 offset:30720
ds_read2st64_b64 a[56:59], v23 offset0:100 offset1:102
ds_read2st64_b64 a[60:63], v242 offset0:100 offset1:102
v_mfma_f32_16x16x32_bf16 v[132:135], v[144:147], a[52:55], v[132:135]
buffer_load_dwordx4 v1, s[8:11], s7 offen offset:1024 sc1 lds
v_mfma_f32_16x16x32_bf16 v[176:179], v[32:35], a[48:51], v[176:179]
ds_read_b64_tr_b16 v[24:25], v6 offset:32768
v_mfma_f32_16x16x32_bf16 v[184:187], v[32:35], a[52:55], v[184:187]
ds_read_b64_tr_b16 v[26:27], v6 offset:34816
v_mfma_f32_16x16x32_bf16 v[136:139], a[48:51], a[48:51], v[136:139]
s_add_u32 m0, s30, 73728
s_nop 0
buffer_load_dwordx4 v3, s[12:15], s6 offen offset:1024 lds
v_mfma_f32_16x16x32_bf16 v[180:183], v[36:39], a[48:51], v[180:183]
ds_read_b64_tr_b16 v[28:29], v7 offset:32768
v_mfma_f32_16x16x32_bf16 v[188:191], v[36:39], a[52:55], v[188:191]
ds_read_b64_tr_b16 v[30:31], v7 offset:34816
v_mfma_f32_16x16x32_bf16 v[140:143], a[52:55], a[52:55], v[140:143]
s_add_u32 m0, s30, 81920
s_add_u32 s6, s29, 589952
s_waitcnt lgkmcnt(4)
v_mfma_f32_16x16x32_bf16 v[160:163], v[40:43], a[56:59], v[160:163]
buffer_load_dwordx4 v2, s[12:15], s6 offen offset:0 lds
ds_read_b64_tr_b16 v[32:33], v8 offset:32768
v_mfma_f32_16x16x32_bf16 v[168:171], v[40:43], a[60:63], v[168:171]
ds_read_b64_tr_b16 v[34:35], v8 offset:34816
v_mfma_f32_16x16x32_bf16 v[128:131], v[144:147], a[56:59], v[128:131]
s_waitcnt vmcnt(16)
v_mfma_f32_16x16x32_bf16 v[164:167], v[44:47], a[56:59], v[164:167]
ds_read_b64_tr_b16 v[36:37], v9 offset:32768
v_mfma_f32_16x16x32_bf16 v[172:175], v[44:47], a[60:63], v[172:175]
ds_read_b64_tr_b16 v[38:39], v9 offset:34816
ds_read2st64_b64 a[64:67], v23 offset0:0 offset1:2
ds_read2st64_b64 a[68:71], v242 offset0:0 offset1:2
v_mfma_f32_16x16x32_bf16 v[132:135], v[144:147], a[60:63], v[132:135]
v_mfma_f32_16x16x32_bf16 v[176:179], v[120:123], a[56:59], v[176:179]
ds_read_b64_tr_b16 v[40:41], v6 offset:36864
v_mfma_f32_16x16x32_bf16 v[184:187], v[120:123], a[60:63], v[184:187]
ds_read_b64_tr_b16 v[42:43], v6 offset:38912
v_mfma_f32_16x16x32_bf16 v[136:139], a[56:59], a[56:59], v[136:139]
s_add_u32 m0, s42, 147456
s_nop 0
buffer_load_dwordx4 v1, s[8:11], s7 offen offset:2048 sc1 lds
v_mfma_f32_16x16x32_bf16 v[180:183], v[124:127], a[56:59], v[180:183]
ds_read_b64_tr_b16 v[44:45], v7 offset:36864
v_mfma_f32_16x16x32_bf16 v[188:191], v[124:127], a[60:63], v[188:191]
ds_read_b64_tr_b16 v[46:47], v7 offset:38912
v_mfma_f32_16x16x32_bf16 v[140:143], a[60:63], a[60:63], v[140:143]
s_waitcnt lgkmcnt(4)
v_mfma_f32_16x16x32_bf16 v[160:163], v[24:27], a[64:67], v[160:163]
ds_read_b64_tr_b16 v[120:121], v8 offset:36864
v_mfma_f32_16x16x32_bf16 v[168:171], v[24:27], a[68:71], v[168:171]
ds_read_b64_tr_b16 v[122:123], v8 offset:38912
v_mfma_f32_16x16x32_bf16 v[128:131], v[144:147], a[64:67], v[128:131]
buffer_load_dwordx4 v1, s[8:11], s7 offen offset:3072 sc1 lds
s_waitcnt vmcnt(16)
v_mfma_f32_16x16x32_bf16 v[164:167], v[28:31], a[64:67], v[164:167]
ds_read_b64_tr_b16 v[124:125], v9 offset:36864
v_mfma_f32_16x16x32_bf16 v[172:175], v[28:31], a[68:71], v[172:175]
ds_read_b64_tr_b16 v[126:127], v9 offset:38912
ds_read2st64_b64 a[72:75], v23 offset0:4 offset1:6
ds_read2st64_b64 a[76:79], v242 offset0:4 offset1:6
v_mfma_f32_16x16x32_bf16 v[132:135], v[144:147], a[68:71], v[132:135]
v_mfma_f32_16x16x32_bf16 v[176:179], v[32:35], a[64:67], v[176:179]
ds_read_b64_tr_b16 v[24:25], v6 offset:40960
v_mfma_f32_16x16x32_bf16 v[184:187], v[32:35], a[68:71], v[184:187]
ds_read_b64_tr_b16 v[26:27], v6 offset:43008
v_mfma_f32_16x16x32_bf16 v[136:139], a[64:67], a[64:67], v[136:139]
s_add_u32 s7, s32, 32768
buffer_load_dwordx4 v[48:51], v1, s[8:11], s7 offen offset:0 sc1
v_mfma_f32_16x16x32_bf16 v[180:183], v[36:39], a[64:67], v[180:183]
ds_read_b64_tr_b16 v[28:29], v7 offset:40960
v_mfma_f32_16x16x32_bf16 v[188:191], v[36:39], a[68:71], v[188:191]
ds_read_b64_tr_b16 v[30:31], v7 offset:43008
v_mfma_f32_16x16x32_bf16 v[140:143], a[68:71], a[68:71], v[140:143]
s_waitcnt lgkmcnt(4)
v_mfma_f32_16x16x32_bf16 v[160:163], v[40:43], a[72:75], v[160:163]
ds_read_b64_tr_b16 v[32:33], v8 offset:40960
v_mfma_f32_16x16x32_bf16 v[168:171], v[40:43], a[76:79], v[168:171]
ds_read_b64_tr_b16 v[34:35], v8 offset:43008
v_mfma_f32_16x16x32_bf16 v[128:131], v[144:147], a[72:75], v[128:131]
buffer_load_dwordx4 v[52:55], v1, s[8:11], s7 offen offset:1024 sc1
s_waitcnt vmcnt(15)
v_mfma_f32_16x16x32_bf16 v[164:167], v[44:47], a[72:75], v[164:167]
ds_read_b64_tr_b16 v[36:37], v9 offset:40960
v_mfma_f32_16x16x32_bf16 v[172:175], v[44:47], a[76:79], v[172:175]
ds_read_b64_tr_b16 v[38:39], v9 offset:43008
ds_read2st64_b64 a[80:83], v23 offset0:32 offset1:34
ds_read2st64_b64 a[84:87], v242 offset0:32 offset1:34
v_mfma_f32_16x16x32_bf16 v[132:135], v[144:147], a[76:79], v[132:135]
v_mfma_f32_16x16x32_bf16 v[176:179], v[120:123], a[72:75], v[176:179]
ds_read_b64_tr_b16 v[40:41], v6 offset:45056
v_mfma_f32_16x16x32_bf16 v[184:187], v[120:123], a[76:79], v[184:187]
ds_read_b64_tr_b16 v[42:43], v6 offset:47104
v_mfma_f32_16x16x32_bf16 v[136:139], a[72:75], a[72:75], v[136:139]
buffer_load_dwordx4 v[56:59], v1, s[8:11], s7 offen offset:2048 sc1
v_mfma_f32_16x16x32_bf16 v[180:183], v[124:127], a[72:75], v[180:183]
ds_read_b64_tr_b16 v[44:45], v7 offset:45056
v_mfma_f32_16x16x32_bf16 v[188:191], v[124:127], a[76:79], v[188:191]
ds_read_b64_tr_b16 v[46:47], v7 offset:47104
v_mfma_f32_16x16x32_bf16 v[140:143], a[76:79], a[76:79], v[140:143]
s_waitcnt lgkmcnt(4)
v_mfma_f32_16x16x32_bf16 v[160:163], v[24:27], a[80:83], v[160:163]
buffer_load_dwordx4 v[60:63], v1, s[8:11], s7 offen offset:3072 sc1
ds_read_b64_tr_b16 v[120:121], v8 offset:45056
v_mfma_f32_16x16x32_bf16 v[168:171], v[24:27], a[84:87], v[168:171]
ds_read_b64_tr_b16 v[122:123], v8 offset:47104
v_mfma_f32_16x16x32_bf16 v[128:131], v[144:147], a[80:83], v[128:131]
s_add_u32 m0, s30, 81920
s_nop 0
buffer_load_dwordx4 v3, s[12:15], s6 offen offset:1024 lds
s_waitcnt vmcnt(16)
v_mfma_f32_16x16x32_bf16 v[164:167], v[28:31], a[80:83], v[164:167]
ds_read_b64_tr_b16 v[124:125], v9 offset:45056
v_mfma_f32_16x16x32_bf16 v[172:175], v[28:31], a[84:87], v[172:175]
ds_read_b64_tr_b16 v[126:127], v9 offset:47104
ds_read2st64_b64 a[88:91], v23 offset0:36 offset1:38
ds_read2st64_b64 a[92:95], v242 offset0:36 offset1:38
v_mfma_f32_16x16x32_bf16 v[132:135], v[144:147], a[84:87], v[132:135]
v_mfma_f32_16x16x32_bf16 v[176:179], v[32:35], a[80:83], v[176:179]
v_mfma_f32_16x16x32_bf16 v[184:187], v[32:35], a[84:87], v[184:187]
s_barrier
v_add_u32 v6, 49152, v6
ds_read_b64_tr_b16 v[24:25], v6 offset:0
ds_read_b64_tr_b16 v[26:27], v6 offset:2048
v_mfma_f32_16x16x32_bf16 v[136:139], a[80:83], a[80:83], v[136:139]
s_add_u32 m0, s30, 90112
s_add_u32 s6, s29, 1179776
buffer_load_dwordx4 v2, s[12:15], s6 offen offset:0 lds
v_mfma_f32_16x16x32_bf16 v[180:183], v[36:39], a[80:83], v[180:183]
buffer_load_dwordx4 v3, s[12:15], s6 offen offset:1024 lds
v_add_u32 v7, 49152, v7
ds_read_b64_tr_b16 v[28:29], v7 offset:0
v_mfma_f32_16x16x32_bf16 v[188:191], v[36:39], a[84:87], v[188:191]
ds_read_b64_tr_b16 v[30:31], v7 offset:2048
v_mfma_f32_16x16x32_bf16 v[140:143], a[84:87], a[84:87], v[140:143]
s_waitcnt lgkmcnt(4)
v_mfma_f32_16x16x32_bf16 v[160:163], v[40:43], a[88:91], v[160:163]
v_add_u32 v8, 49152, v8
ds_read_b64_tr_b16 v[32:33], v8 offset:0
v_mfma_f32_16x16x32_bf16 v[168:171], v[40:43], a[92:95], v[168:171]
ds_read_b64_tr_b16 v[34:35], v8 offset:2048
v_mfma_f32_16x16x32_bf16 v[128:131], v[144:147], a[88:91], v[128:131]
s_waitcnt vmcnt(16)
v_mfma_f32_16x16x32_bf16 v[164:167], v[44:47], a[88:91], v[164:167]
v_add_u32 v9, 49152, v9
ds_read_b64_tr_b16 v[36:37], v9 offset:0
v_mfma_f32_16x16x32_bf16 v[172:175], v[44:47], a[92:95], v[172:175]
ds_read_b64_tr_b16 v[38:39], v9 offset:2048
ds_read2st64_b64 a[96:99], v23 offset0:64 offset1:66
ds_read2st64_b64 a[100:103], v242 offset0:64 offset1:66
v_mfma_f32_16x16x32_bf16 v[132:135], v[144:147], a[92:95], v[132:135]
v_mfma_f32_16x16x32_bf16 v[176:179], v[120:123], a[88:91], v[176:179]
ds_read_b64_tr_b16 v[40:41], v6 offset:4096
v_mfma_f32_16x16x32_bf16 v[184:187], v[120:123], a[92:95], v[184:187]
ds_read_b64_tr_b16 v[42:43], v6 offset:6144
v_mfma_f32_16x16x32_bf16 v[136:139], a[88:91], a[88:91], v[136:139]
v_mfma_f32_16x16x32_bf16 v[180:183], v[124:127], a[88:91], v[180:183]
ds_read_b64_tr_b16 v[44:45], v7 offset:4096
v_mfma_f32_16x16x32_bf16 v[188:191], v[124:127], a[92:95], v[188:191]
ds_read_b64_tr_b16 v[46:47], v7 offset:6144
v_mfma_f32_16x16x32_bf16 v[140:143], a[92:95], a[92:95], v[140:143]
s_waitcnt lgkmcnt(4)
v_mfma_f32_16x16x32_bf16 v[160:163], v[24:27], a[96:99], v[160:163]
ds_read_b64_tr_b16 v[120:121], v8 offset:4096
v_mfma_f32_16x16x32_bf16 v[168:171], v[24:27], a[100:103], v[168:171]
ds_read_b64_tr_b16 v[122:123], v8 offset:6144
v_mfma_f32_16x16x32_bf16 v[128:131], v[144:147], a[96:99], v[128:131]
s_waitcnt vmcnt(14)
v_mfma_f32_16x16x32_bf16 v[164:167], v[28:31], a[96:99], v[164:167]
ds_read_b64_tr_b16 v[124:125], v9 offset:4096
v_mfma_f32_16x16x32_bf16 v[172:175], v[28:31], a[100:103], v[172:175]
ds_read_b64_tr_b16 v[126:127], v9 offset:6144
ds_read2st64_b64 a[104:107], v23 offset0:68 offset1:70
ds_read2st64_b64 a[108:111], v242 offset0:68 offset1:70
v_mfma_f32_16x16x32_bf16 v[132:135], v[144:147], a[100:103], v[132:135]
v_mfma_f32_16x16x32_bf16 v[176:179], v[32:35], a[96:99], v[176:179]
ds_read_b64_tr_b16 v[24:25], v6 offset:8192
v_mfma_f32_16x16x32_bf16 v[184:187], v[32:35], a[100:103], v[184:187]
ds_read_b64_tr_b16 v[26:27], v6 offset:10240
v_mfma_f32_16x16x32_bf16 v[136:139], a[96:99], a[96:99], v[136:139]
v_mfma_f32_16x16x32_bf16 v[180:183], v[36:39], a[96:99], v[180:183]
ds_read_b64_tr_b16 v[28:29], v7 offset:8192
v_mfma_f32_16x16x32_bf16 v[188:191], v[36:39], a[100:103], v[188:191]
ds_read_b64_tr_b16 v[30:31], v7 offset:10240
v_mfma_f32_16x16x32_bf16 v[140:143], a[100:103], a[100:103], v[140:143]
s_waitcnt lgkmcnt(4)
v_mfma_f32_16x16x32_bf16 v[160:163], v[40:43], a[104:107], v[160:163]
ds_read_b64_tr_b16 v[32:33], v8 offset:8192
v_mfma_f32_16x16x32_bf16 v[168:171], v[40:43], a[108:111], v[168:171]
ds_read_b64_tr_b16 v[34:35], v8 offset:10240
v_mfma_f32_16x16x32_bf16 v[128:131], v[144:147], a[104:107], v[128:131]
s_waitcnt vmcnt(11)
v_mfma_f32_16x16x32_bf16 v[164:167], v[44:47], a[104:107], v[164:167]
ds_read_b64_tr_b16 v[36:37], v9 offset:8192
v_mfma_f32_16x16x32_bf16 v[172:175], v[44:47], a[108:111], v[172:175]
ds_read_b64_tr_b16 v[38:39], v9 offset:10240
ds_read2st64_b64 a[112:115], v23 offset0:96 offset1:98
ds_read2st64_b64 a[116:119], v242 offset0:96 offset1:98
v_mfma_f32_16x16x32_bf16 v[132:135], v[144:147], a[108:111], v[132:135]
v_mfma_f32_16x16x32_bf16 v[176:179], v[120:123], a[104:107], v[176:179]
ds_read_b64_tr_b16 v[40:41], v6 offset:12288
v_mfma_f32_16x16x32_bf16 v[184:187], v[120:123], a[108:111], v[184:187]
ds_read_b64_tr_b16 v[42:43], v6 offset:14336
v_mfma_f32_16x16x32_bf16 v[136:139], a[104:107], a[104:107], v[136:139]
v_mfma_f32_16x16x32_bf16 v[180:183], v[124:127], a[104:107], v[180:183]
ds_read_b64_tr_b16 v[44:45], v7 offset:12288
v_mfma_f32_16x16x32_bf16 v[188:191], v[124:127], a[108:111], v[188:191]
ds_read_b64_tr_b16 v[46:47], v7 offset:14336
v_mfma_f32_16x16x32_bf16 v[140:143], a[108:111], a[108:111], v[140:143]
s_waitcnt lgkmcnt(4)
v_mfma_f32_16x16x32_bf16 v[160:163], v[24:27], a[112:115], v[160:163]
ds_read_b64_tr_b16 v[120:121], v8 offset:12288
v_mfma_f32_16x16x32_bf16 v[168:171], v[24:27], a[116:119], v[168:171]
ds_read_b64_tr_b16 v[122:123], v8 offset:14336
v_mfma_f32_16x16x32_bf16 v[128:131], v[144:147], a[112:115], v[128:131]
s_waitcnt vmcnt(7)
v_mfma_f32_16x16x32_bf16 v[164:167], v[28:31], a[112:115], v[164:167]
ds_read_b64_tr_b16 v[124:125], v9 offset:12288
v_mfma_f32_16x16x32_bf16 v[172:175], v[28:31], a[116:119], v[172:175]
ds_read_b64_tr_b16 v[126:127], v9 offset:14336
ds_read2st64_b64 a[120:123], v23 offset0:100 offset1:102
ds_read2st64_b64 a[124:127], v242 offset0:100 offset1:102
v_mfma_f32_16x16x32_bf16 v[132:135], v[144:147], a[116:119], v[132:135]
v_mfma_f32_16x16x32_bf16 v[176:179], v[32:35], a[112:115], v[176:179]
ds_read_b64_tr_b16 v[24:25], v6 offset:16384
v_mfma_f32_16x16x32_bf16 v[184:187], v[32:35], a[116:119], v[184:187]
ds_read_b64_tr_b16 v[26:27], v6 offset:18432
v_mfma_f32_16x16x32_bf16 v[136:139], a[112:115], a[112:115], v[136:139]
s_waitcnt vmcnt(6)
v_mfma_f32_16x16x32_bf16 v[180:183], v[36:39], a[112:115], v[180:183]
ds_read_b64_tr_b16 v[28:29], v7 offset:16384
v_accvgpr_write_b32 a128, v48
v_mfma_f32_16x16x32_bf16 v[188:191], v[36:39], a[116:119], v[188:191]
ds_read_b64_tr_b16 v[30:31], v7 offset:18432
v_accvgpr_write_b32 a129, v49
v_accvgpr_write_b32 a132, v50
v_mfma_f32_16x16x32_bf16 v[140:143], a[116:119], a[116:119], v[140:143]
v_accvgpr_write_b32 a133, v51
s_waitcnt lgkmcnt(4)
v_mfma_f32_16x16x32_bf16 v[160:163], v[40:43], a[120:123], v[160:163]
ds_read_b64_tr_b16 v[32:33], v8 offset:16384
v_mfma_f32_16x16x32_bf16 v[168:171], v[40:43], a[124:127], v[168:171]
ds_read_b64_tr_b16 v[34:35], v8 offset:18432
v_mfma_f32_16x16x32_bf16 v[128:131], v[144:147], a[120:123], v[128:131]
s_waitcnt vmcnt(5)
v_mfma_f32_16x16x32_bf16 v[164:167], v[44:47], a[120:123], v[164:167]
ds_read_b64_tr_b16 v[36:37], v9 offset:16384
v_accvgpr_write_b32 a130, v52
v_mfma_f32_16x16x32_bf16 v[172:175], v[44:47], a[124:127], v[172:175]
ds_read_b64_tr_b16 v[38:39], v9 offset:18432
v_accvgpr_write_b32 a131, v53
v_accvgpr_write_b32 a134, v54
v_mfma_f32_16x16x32_bf16 v[132:135], v[144:147], a[124:127], v[132:135]
v_mfma_f32_16x16x32_bf16 v[176:179], v[120:123], a[120:123], v[176:179]
ds_read_b64_tr_b16 v[40:41], v6 offset:20480
v_mfma_f32_16x16x32_bf16 v[184:187], v[120:123], a[124:127], v[184:187]
ds_read_b64_tr_b16 v[42:43], v6 offset:22528
v_accvgpr_write_b32 a135, v55
v_mfma_f32_16x16x32_bf16 v[136:139], a[120:123], a[120:123], v[136:139]
s_waitcnt vmcnt(4)
v_mfma_f32_16x16x32_bf16 v[180:183], v[124:127], a[120:123], v[180:183]
ds_read_b64_tr_b16 v[44:45], v7 offset:20480
v_accvgpr_write_b32 a136, v56
v_mfma_f32_16x16x32_bf16 v[188:191], v[124:127], a[124:127], v[188:191]
ds_read_b64_tr_b16 v[46:47], v7 offset:22528
v_accvgpr_write_b32 a137, v57
v_accvgpr_write_b32 a140, v58
v_mfma_f32_16x16x32_bf16 v[140:143], a[124:127], a[124:127], v[140:143]
v_accvgpr_write_b32 a141, v59
s_waitcnt lgkmcnt(4)
v_mfma_f32_16x16x32_bf16 v[160:163], v[24:27], a[128:131], v[160:163]
ds_read_b64_tr_b16 v[120:121], v8 offset:20480
v_mfma_f32_16x16x32_bf16 v[168:171], v[24:27], a[132:135], v[168:171]
ds_read_b64_tr_b16 v[122:123], v8 offset:22528
v_mfma_f32_16x16x32_bf16 v[128:131], v[144:147], a[128:131], v[128:131]
s_waitcnt vmcnt(3)
v_mfma_f32_16x16x32_bf16 v[164:167], v[28:31], a[128:131], v[164:167]
ds_read_b64_tr_b16 v[124:125], v9 offset:20480
v_accvgpr_write_b32 a138, v60
v_mfma_f32_16x16x32_bf16 v[172:175], v[28:31], a[132:135], v[172:175]
ds_read_b64_tr_b16 v[126:127], v9 offset:22528
v_accvgpr_write_b32 a139, v61
v_accvgpr_write_b32 a142, v62
v_mfma_f32_16x16x32_bf16 v[132:135], v[144:147], a[132:135], v[132:135]
v_mfma_f32_16x16x32_bf16 v[176:179], v[32:35], a[128:131], v[176:179]
v_mfma_f32_16x16x32_bf16 v[184:187], v[32:35], a[132:135], v[184:187]
s_waitcnt vmcnt(0)
s_barrier
ds_read_b64_tr_b16 v[24:25], v6 offset:24576
ds_read_b64_tr_b16 v[26:27], v6 offset:26624
v_accvgpr_write_b32 a143, v63
v_mfma_f32_16x16x32_bf16 v[136:139], a[128:131], a[128:131], v[136:139]
s_add_u32 m0, s30, 98304
s_add_u32 s6, s29, 1769600
buffer_load_dwordx4 v2, s[12:15], s6 offen offset:0 lds
v_mfma_f32_16x16x32_bf16 v[180:183], v[36:39], a[128:131], v[180:183]
buffer_load_dwordx4 v3, s[12:15], s6 offen offset:1024 lds
ds_read_b64_tr_b16 v[28:29], v7 offset:24576
v_mfma_f32_16x16x32_bf16 v[188:191], v[36:39], a[132:135], v[188:191]
ds_read_b64_tr_b16 v[30:31], v7 offset:26624
v_mfma_f32_16x16x32_bf16 v[140:143], a[132:135], a[132:135], v[140:143]
s_add_u32 m0, s30, 106496
s_add_u32 s6, s29, 2359424
buffer_load_dwordx4 v2, s[12:15], s6 offen offset:0 lds
s_waitcnt lgkmcnt(4)
v_mfma_f32_16x16x32_bf16 v[160:163], v[40:43], a[136:139], v[160:163]
buffer_load_dwordx4 v3, s[12:15], s6 offen offset:1024 lds
ds_read_b64_tr_b16 v[32:33], v8 offset:24576
v_mfma_f32_16x16x32_bf16 v[168:171], v[40:43], a[140:143], v[168:171]
ds_read_b64_tr_b16 v[34:35], v8 offset:26624
v_mfma_f32_16x16x32_bf16 v[128:131], v[144:147], a[136:139], v[128:131]
s_add_u32 m0, s30, 114688
s_add_u32 s6, s29, 2949248
buffer_load_dwordx4 v2, s[12:15], s6 offen offset:0 lds
v_mfma_f32_16x16x32_bf16 v[164:167], v[44:47], a[136:139], v[164:167]
s_branch PGC_1
.p2align 12
PSC_1:
s_setpc_b64 s[62:63]
PGC_1:
ds_read_b64_tr_b16 v[36:37], v9 offset:24576
v_mfma_f32_16x16x32_bf16 v[172:175], v[44:47], a[140:143], v[172:175]
ds_read_b64_tr_b16 v[38:39], v9 offset:26624
v_mfma_f32_16x16x32_bf16 v[132:135], v[144:147], a[140:143], v[132:135]
buffer_load_dwordx4 v3, s[12:15], s6 offen offset:1024 lds
v_mfma_f32_16x16x32_bf16 v[176:179], v[120:123], a[136:139], v[176:179]
ds_read_b64_tr_b16 v[40:41], v6 offset:28672
v_mfma_f32_16x16x32_bf16 v[184:187], v[120:123], a[140:143], v[184:187]
ds_read_b64_tr_b16 v[42:43], v6 offset:30720
v_mfma_f32_16x16x32_bf16 v[136:139], a[136:139], a[136:139], v[136:139]
s_add_u32 m0, s30, 122880
s_add_u32 s6, s29, 3539072
v_mfma_f32_16x16x32_bf16 v[180:183], v[124:127], a[136:139], v[180:183]
buffer_load_dwordx4 v2, s[12:15], s6 offen offset:0 lds
ds_read_b64_tr_b16 v[44:45], v7 offset:28672
v_mfma_f32_16x16x32_bf16 v[188:191], v[124:127], a[140:143], v[188:191]
ds_read_b64_tr_b16 v[46:47], v7 offset:30720
v_mfma_f32_16x16x32_bf16 v[140:143], a[140:143], a[140:143], v[140:143]
s_waitcnt lgkmcnt(4)
v_mfma_f32_16x16x32_bf16 v[192:195], v[24:27], a[0:3], 0
buffer_load_dwordx4 v3, s[12:15], s6 offen offset:1024 lds
ds_read_b64_tr_b16 v[120:121], v8 offset:28672
v_mfma_f32_16x16x32_bf16 v[200:203], v[24:27], a[4:7], 0
ds_read_b64_tr_b16 v[122:123], v8 offset:30720
v_mfma_f32_16x16x32_bf16 v[196:199], v[28:31], a[0:3], 0
ds_read_b64_tr_b16 v[124:125], v9 offset:28672
s_add_u32 m0, s30, 131072
s_add_u32 s6, s29, 4128896
v_mfma_f32_16x16x32_bf16 v[204:207], v[28:31], a[4:7], 0
ds_read_b64_tr_b16 v[126:127], v9 offset:30720
s_mov_b32 s40, 0xaaaaaaaa
s_mov_b32 s41, 0xaaaaaaaa
v_mfma_f32_16x16x32_bf16 v[208:211], v[32:35], a[0:3], 0
buffer_load_dwordx4 v2, s[12:15], s6 offen offset:0 lds
ds_read_b64_tr_b16 v[24:25], v6 offset:32768
v_mfma_f32_16x16x32_bf16 v[216:219], v[32:35], a[4:7], 0
ds_read_b64_tr_b16 v[26:27], v6 offset:34816
s_mov_b32 s56, 0xcccccccc
s_mov_b32 s57, 0xcccccccc
v_mfma_f32_16x16x32_bf16 v[212:215], v[36:39], a[0:3], 0
ds_read_b64_tr_b16 v[28:29], v7 offset:32768
s_mov_b32 s58, 0x00f0000f
s_mov_b32 s59, 0xf0000f00
v_mfma_f32_16x16x32_bf16 v[220:223], v[36:39], a[4:7], 0
ds_read_b64_tr_b16 v[30:31], v7 offset:34816
v_cmp_gt_u32 vcc, 32, v0
s_waitcnt lgkmcnt(4)
v_mfma_f32_16x16x32_bf16 v[192:195], v[40:43], a[8:11], v[192:195]
buffer_load_dwordx4 v3, s[12:15], s6 offen offset:1024 lds
ds_read_b64_tr_b16 v[32:33], v8 offset:32768
v_mfma_f32_16x16x32_bf16 v[200:203], v[40:43], a[12:15], v[200:203]
ds_read_b64_tr_b16 v[34:35], v8 offset:34816
v_cndmask_b32 v136, v136, v137, s[40:41]
v_cndmask_b32 v138, v138, v139, s[40:41]
v_mfma_f32_16x16x32_bf16 v[196:199], v[44:47], a[8:11], v[196:199]
ds_read_b64_tr_b16 v[36:37], v9 offset:32768
s_add_u32 m0, s30, 139264
s_add_u32 s6, s29, 4718720
v_mfma_f32_16x16x32_bf16 v[204:207], v[44:47], a[12:15], v[204:207]
ds_read_b64_tr_b16 v[38:39], v9 offset:34816
v_cndmask_b32 v140, v140, v141, s[40:41]
v_cndmask_b32 v142, v142, v143, s[40:41]
v_mfma_f32_16x16x32_bf16 v[208:211], v[120:123], a[8:11], v[208:211]
buffer_load_dwordx4 v2, s[12:15], s6 offen offset:0 lds
ds_read_b64_tr_b16 v[40:41], v6 offset:36864
v_mfma_f32_16x16x32_bf16 v[216:219], v[120:123], a[12:15], v[216:219]
ds_read_b64_tr_b16 v[42:43], v6 offset:38912
v_cndmask_b32 v136, v136, v138, s[56:57]
v_cndmask_b32 v140, v140, v142, s[56:57]
v_mfma_f32_16x16x32_bf16 v[212:215], v[124:127], a[8:11], v[212:215]
ds_read_b64_tr_b16 v[44:45], v7 offset:36864
v_cndmask_b32 v136, 0, v136, s[58:59]
v_cndmask_b32 v140, 0, v140, s[58:59]
v_mfma_f32_16x16x32_bf16 v[220:223], v[124:127], a[12:15], v[220:223]
ds_read_b64_tr_b16 v[46:47], v7 offset:38912
v_cndmask_b32 v128, v132, v128, vcc
s_waitcnt lgkmcnt(4)
v_mfma_f32_16x16x32_bf16 v[192:195], v[24:27], a[16:19], v[192:195]
buffer_load_dwordx4 v3, s[12:15], s6 offen offset:1024 lds
ds_read_b64_tr_b16 v[120:121], v8 offset:36864
v_mfma_f32_16x16x32_bf16 v[200:203], v[24:27], a[20:23], v[200:203]
ds_read_b64_tr_b16 v[122:123], v8 offset:38912
v_mul_f32 v128, 0xbae38e39, v128
v_permlane32_swap_b32 v136, v140
v_mfma_f32_16x16x32_bf16 v[196:199], v[28:31], a[16:19], v[196:199]
ds_read_b64_tr_b16 v[124:125], v9 offset:36864
s_add_u32 m0, s30, 0
s_add_u32 s6, s29, 256
v_mfma_f32_16x16x32_bf16 v[204:207], v[28:31], a[20:23], v[204:207]
ds_read_b64_tr_b16 v[126:127], v9 offset:38912
v_add_f32 v130, v136, v140
v_mov_b32 v131, v130
v_mfma_f32_16x16x32_bf16 v[208:211], v[32:35], a[16:19], v[208:211]
buffer_load_dwordx4 v2, s[12:15], s6 offen offset:0 lds
ds_read_b64_tr_b16 v[24:25], v6 offset:40960
v_mfma_f32_16x16x32_bf16 v[216:219], v[32:35], a[20:23], v[216:219]
ds_read_b64_tr_b16 v[26:27], v6 offset:43008
v_cvt_pk_bf16_f32 v132, v128, v128
s_mov_b32 s40, 0
v_mfma_f32_16x16x32_bf16 v[212:215], v[36:39], a[16:19], v[212:215]
ds_read_b64_tr_b16 v[28:29], v7 offset:40960
v_permlane16_swap_b32 v130, v131
v_add_f32 v130, v130, v131
v_mfma_f32_16x16x32_bf16 v[220:223], v[36:39], a[20:23], v[220:223]
ds_read_b64_tr_b16 v[30:31], v7 offset:43008
v_mul_f32 v130, 0x3ae38e39, v130
s_waitcnt lgkmcnt(4)
v_mfma_f32_16x16x32_bf16 v[192:195], v[40:43], a[24:27], v[192:195]
buffer_load_dwordx4 v3, s[12:15], s6 offen offset:1024 lds
ds_read_b64_tr_b16 v[32:33], v8 offset:40960
v_mfma_f32_16x16x32_bf16 v[200:203], v[40:43], a[28:31], v[200:203]
ds_read_b64_tr_b16 v[34:35], v8 offset:43008
v_fma_f32 v130, -v128, v128, v130
v_max_f32 v130, 0, v130
v_mfma_f32_16x16x32_bf16 v[196:199], v[44:47], a[24:27], v[196:199]
ds_read_b64_tr_b16 v[36:37], v9 offset:40960
s_add_u32 m0, s30, 8192
s_add_u32 s6, s29, 590080
v_mfma_f32_16x16x32_bf16 v[204:207], v[44:47], a[28:31], v[204:207]
ds_read_b64_tr_b16 v[38:39], v9 offset:43008
v_cvt_pk_bf16_f32 v130, v130, v130
v_and_b32 v130, s39, v130
v_mfma_f32_16x16x32_bf16 v[208:211], v[120:123], a[24:27], v[208:211]
buffer_load_dwordx4 v2, s[12:15], s6 offen offset:0 lds
ds_read_b64_tr_b16 v[40:41], v6 offset:45056
v_mfma_f32_16x16x32_bf16 v[216:219], v[120:123], a[28:31], v[216:219]
ds_read_b64_tr_b16 v[42:43], v6 offset:47104
v_add_f32 v130, 0x3727c5ac, v130
v_cvt_pk_bf16_f32 v130, v130, v130
v_mfma_f32_16x16x32_bf16 v[212:215], v[124:127], a[24:27], v[212:215]
ds_read_b64_tr_b16 v[44:45], v7 offset:45056
v_and_b32 v130, s39, v130
v_sqrt_f32 v130, v130
v_mfma_f32_16x16x32_bf16 v[220:223], v[124:127], a[28:31], v[220:223]
ds_read_b64_tr_b16 v[46:47], v7 offset:47104
v_mov_b32 v133, v132
s_waitcnt lgkmcnt(4)
v_mfma_f32_16x16x32_bf16 v[192:195], v[24:27], a[32:35], v[192:195]
buffer_load_dwordx4 v3, s[12:15], s6 offen offset:1024 lds
ds_read_b64_tr_b16 v[120:121], v8 offset:45056
v_mfma_f32_16x16x32_bf16 v[200:203], v[24:27], a[36:39], v[200:203]
ds_read_b64_tr_b16 v[122:123], v8 offset:47104
s_mov_b32 s41, 0xffff0000
v_cvt_pk_bf16_f32 v134, v130, 0
v_mfma_f32_16x16x32_bf16 v[196:199], v[28:31], a[32:35], v[196:199]
ds_read_b64_tr_b16 v[124:125], v9 offset:45056
s_add_u32 m0, s30, 16384
s_add_u32 s6, s29, 1179904
v_mfma_f32_16x16x32_bf16 v[204:207], v[28:31], a[36:39], v[204:207]
ds_read_b64_tr_b16 v[126:127], v9 offset:47104
v_permlane32_swap_b32 v132, v133
v_lshlrev_b32 v130, 16, v134
v_mfma_f32_16x16x32_bf16 v[208:211], v[32:35], a[32:35], v[208:211]
v_mfma_f32_16x16x32_bf16 v[216:219], v[32:35], a[36:39], v[216:219]
s_waitcnt vmcnt(10)
s_barrier
buffer_load_dwordx4 v2, s[12:15], s6 offen offset:0 lds
v_add_u32 v6, 49152, v6
ds_read_b64_tr_b16 v[24:25], v6 offset:0
ds_read_b64_tr_b16 v[26:27], v6 offset:2048
v_mfma_f32_16x16x32_bf16 v[212:215], v[36:39], a[32:35], v[212:215]
v_add_u32 v7, 49152, v7
ds_read_b64_tr_b16 v[28:29], v7 offset:0
v_mov_b32 v135, v134
v_mfma_f32_16x16x32_bf16 v[220:223], v[36:39], a[36:39], v[220:223]
ds_read_b64_tr_b16 v[30:31], v7 offset:2048
v_rcp_f32 v130, v130
s_waitcnt lgkmcnt(4)
v_mfma_f32_16x16x32_bf16 v[192:195], v[40:43], a[40:43], v[192:195]
buffer_load_dwordx4 v3, s[12:15], s6 offen offset:1024 lds
v_add_u32 v8, 49152, v8
ds_read_b64_tr_b16 v[32:33], v8 offset:0
v_mfma_f32_16x16x32_bf16 v[200:203], v[40:43], a[44:47], v[200:203]
ds_read_b64_tr_b16 v[34:35], v8 offset:2048
s_nop 0
v_mfma_f32_16x16x32_bf16 v[196:199], v[44:47], a[40:43], v[196:199]
v_add_u32 v9, 49152, v9
ds_read_b64_tr_b16 v[36:37], v9 offset:0
s_add_u32 m0, s30, 24576
v_mfma_f32_16x16x32_bf16 v[204:207], v[44:47], a[44:47], v[204:207]
ds_read_b64_tr_b16 v[38:39], v9 offset:2048
s_add_u32 s6, s29, 1769728
v_permlane32_swap_b32 v134, v135
v_mfma_f32_16x16x32_bf16 v[208:211], v[120:123], a[40:43], v[208:211]
buffer_load_dwordx4 v2, s[12:15], s6 offen offset:0 lds
ds_read_b64_tr_b16 v[40:41], v6 offset:4096
v_mfma_f32_16x16x32_bf16 v[216:219], v[120:123], a[44:47], v[216:219]
ds_read_b64_tr_b16 v[42:43], v6 offset:6144
v_mul_f32 v18, v130, v130
v_mul_f32 v16, v130, v130
v_mfma_f32_16x16x32_bf16 v[212:215], v[124:127], a[40:43], v[212:215]
ds_read_b64_tr_b16 v[44:45], v7 offset:4096
v_cndmask_b32 v226, v132, v134, s[40:41]
v_cndmask_b32 v231, v132, v134, s[40:41]
v_mfma_f32_16x16x32_bf16 v[220:223], v[124:127], a[44:47], v[220:223]
ds_read_b64_tr_b16 v[46:47], v7 offset:6144
v_cndmask_b32 v234, v133, v135, s[40:41]
s_waitcnt lgkmcnt(4)
v_mfma_f32_16x16x32_bf16 v[192:195], v[24:27], a[48:51], v[192:195]
buffer_load_dwordx4 v3, s[12:15], s6 offen offset:1024 lds
ds_read_b64_tr_b16 v[120:121], v8 offset:4096
v_mfma_f32_16x16x32_bf16 v[200:203], v[24:27], a[52:55], v[200:203]
ds_read_b64_tr_b16 v[122:123], v8 offset:6144
v_cndmask_b32 v239, v133, v135, s[40:41]
v_permlane32_swap_b32 v18, v16
v_mfma_f32_16x16x32_bf16 v[196:199], v[28:31], a[48:51], v[196:199]
ds_read_b64_tr_b16 v[124:125], v9 offset:4096
s_add_u32 m0, s30, 32768
v_mfma_f32_16x16x32_bf16 v[204:207], v[28:31], a[52:55], v[204:207]
ds_read_b64_tr_b16 v[126:127], v9 offset:6144
s_add_u32 s6, s29, 2359552
v_mfma_f32_16x16x32_bf16 v[160:163], v[244:247], v[226:229], v[160:163]
v_mfma_f32_16x16x32_bf16 v[164:167], v[244:247], v[230:233], v[164:167]
v_mfma_f32_16x16x32_bf16 v[176:179], v[244:247], v[224:227], v[176:179]
v_mfma_f32_16x16x32_bf16 v[180:183], v[244:247], v[228:231], v[180:183]
v_mfma_f32_16x16x32_bf16 v[168:171], v[244:247], v[234:237], v[168:171]
v_mfma_f32_16x16x32_bf16 v[172:175], v[244:247], v[238:241], v[172:175]
v_mfma_f32_16x16x32_bf16 v[184:187], v[244:247], v[232:235], v[184:187]
v_mfma_f32_16x16x32_bf16 v[188:191], v[244:247], v[236:239], v[188:191]
v_mfma_f32_16x16x32_bf16 v[208:211], v[32:35], a[48:51], v[208:211]
buffer_load_dwordx4 v2, s[12:15], s6 offen offset:0 lds
ds_read_b64_tr_b16 v[24:25], v6 offset:8192
v_mfma_f32_16x16x32_bf16 v[216:219], v[32:35], a[52:55], v[216:219]
ds_read_b64_tr_b16 v[26:27], v6 offset:10240
v_mfma_f32_16x16x32_bf16 v[212:215], v[36:39], a[48:51], v[212:215]
buffer_load_dwordx4 v[244:247], v1, s[8:11], s33 offen offset:1024 sc1
ds_read_b64_tr_b16 v[28:29], v7 offset:8192
v_mfma_f32_16x16x32_bf16 v[220:223], v[36:39], a[52:55], v[220:223]
ds_read_b64_tr_b16 v[30:31], v7 offset:10240
s_waitcnt lgkmcnt(4)
v_mfma_f32_16x16x32_bf16 v[192:195], v[40:43], a[56:59], v[192:195]
ds_read_b64_tr_b16 v[32:33], v8 offset:8192
v_mul_f32 v160, v160, |v160|
v_mul_f32 v161, v161, |v161|
v_mfma_f32_16x16x32_bf16 v[200:203], v[40:43], a[60:63], v[200:203]
ds_read_b64_tr_b16 v[34:35], v8 offset:10240
v_mul_f32 v162, v162, |v162|
v_mul_f32 v163, v163, |v163|
v_mfma_f32_16x16x32_bf16 v[196:199], v[44:47], a[56:59], v[196:199]
buffer_load_dwordx4 v3, s[12:15], s6 offen offset:1024 lds
ds_read_b64_tr_b16 v[36:37], v9 offset:8192
v_mfma_f32_16x16x32_bf16 v[204:207], v[44:47], a[60:63], v[204:207]
ds_read_b64_tr_b16 v[38:39], v9 offset:10240
v_mul_f32 v164, v164, |v164|
v_mul_f32 v165, v165, |v165|
v_mfma_f32_16x16x32_bf16 v[208:211], v[120:123], a[56:59], v[208:211]
ds_read_b64_tr_b16 v[40:41], v6 offset:12288
s_add_u32 m0, s30, 40960
s_add_u32 s6, s29, 2949376
v_mfma_f32_16x16x32_bf16 v[216:219], v[120:123], a[60:63], v[216:219]
ds_read_b64_tr_b16 v[42:43], v6 offset:14336
v_mul_f32 v166, v166, |v166|
v_mul_f32 v167, v167, |v167|
v_mfma_f32_16x16x32_bf16 v[212:215], v[124:127], a[56:59], v[212:215]
buffer_load_dwordx4 v2, s[12:15], s6 offen offset:0 lds
ds_read_b64_tr_b16 v[44:45], v7 offset:12288
v_mfma_f32_16x16x32_bf16 v[220:223], v[124:127], a[60:63], v[220:223]
ds_read_b64_tr_b16 v[46:47], v7 offset:14336
v_cvt_pk_bf16_f32 v160, v160, v161
s_waitcnt lgkmcnt(4)
v_mfma_f32_16x16x32_bf16 v[192:195], v[24:27], a[64:67], v[192:195]
ds_read_b64_tr_b16 v[120:121], v8 offset:12288
v_cvt_pk_bf16_f32 v161, v162, v163
v_cvt_pk_bf16_f32 v162, v164, v165
v_mfma_f32_16x16x32_bf16 v[200:203], v[24:27], a[68:71], v[200:203]
ds_read_b64_tr_b16 v[122:123], v8 offset:14336
v_cvt_pk_bf16_f32 v163, v166, v167
v_pk_max_i16 v48, v160, 0
v_mfma_f32_16x16x32_bf16 v[196:199], v[28:31], a[64:67], v[196:199]
buffer_load_dwordx4 v3, s[12:15], s6 offen offset:1024 lds
ds_read_b64_tr_b16 v[124:125], v9 offset:12288
v_mfma_f32_16x16x32_bf16 v[204:207], v[28:31], a[68:71], v[204:207]
ds_read_b64_tr_b16 v[126:127], v9 offset:14336
v_pk_max_i16 v49, v161, 0
v_pk_max_i16 v50, v162, 0
v_mfma_f32_16x16x32_bf16 v[208:211], v[32:35], a[64:67], v[208:211]
ds_read_b64_tr_b16 v[24:25], v6 offset:16384
v_pk_max_i16 v51, v163, 0
v_mul_f32 v168, v168, |v168|
v_mfma_f32_16x16x32_bf16 v[216:219], v[32:35], a[68:71], v[216:219]
ds_read_b64_tr_b16 v[26:27], v6 offset:18432
v_mul_f32 v169, v169, |v169|
v_mul_f32 v170, v170, |v170|
v_mfma_f32_16x16x32_bf16 v[212:215], v[36:39], a[64:67], v[212:215]
ds_read_b64_tr_b16 v[28:29], v7 offset:16384
s_add_u32 s51, s47, 0
v_mul_f32 v171, v171, |v171|
v_mfma_f32_16x16x32_bf16 v[220:223], v[36:39], a[68:71], v[220:223]
ds_read_b64_tr_b16 v[30:31], v7 offset:18432
v_mul_f32 v172, v172, |v172|
s_waitcnt lgkmcnt(4)
v_mfma_f32_16x16x32_bf16 v[192:195], v[40:43], a[72:75], v[192:195]
buffer_store_dwordx4 v[48:51], v1, s[8:11], s51 offen offset:0 sc1
ds_read_b64_tr_b16 v[32:33], v8 offset:16384
v_mfma_f32_16x16x32_bf16 v[200:203], v[40:43], a[76:79], v[200:203]
ds_read_b64_tr_b16 v[34:35], v8 offset:18432
v_mul_f32 v173, v173, |v173|
v_mul_f32 v174, v174, |v174|
v_mfma_f32_16x16x32_bf16 v[196:199], v[44:47], a[72:75], v[196:199]
ds_read_b64_tr_b16 v[36:37], v9 offset:16384
v_mul_f32 v175, v175, |v175|
v_cvt_pk_bf16_f32 v168, v168, v169
v_mfma_f32_16x16x32_bf16 v[204:207], v[44:47], a[76:79], v[204:207]
ds_read_b64_tr_b16 v[38:39], v9 offset:18432
v_cvt_pk_bf16_f32 v169, v170, v171
v_cvt_pk_bf16_f32 v170, v172, v173
v_mfma_f32_16x16x32_bf16 v[208:211], v[120:123], a[72:75], v[208:211]
ds_read_b64_tr_b16 v[40:41], v6 offset:20480
s_add_u32 m0, s30, 49152
s_add_u32 s6, s29, 3539200
v_mfma_f32_16x16x32_bf16 v[216:219], v[120:123], a[76:79], v[216:219]
ds_read_b64_tr_b16 v[42:43], v6 offset:22528
v_cvt_pk_bf16_f32 v171, v174, v175
v_pk_max_i16 v52, v168, 0
v_mfma_f32_16x16x32_bf16 v[212:215], v[124:127], a[72:75], v[212:215]
buffer_load_dwordx4 v2, s[12:15], s6 offen offset:0 lds
ds_read_b64_tr_b16 v[44:45], v7 offset:20480
v_mfma_f32_16x16x32_bf16 v[220:223], v[124:127], a[76:79], v[220:223]
ds_read_b64_tr_b16 v[46:47], v7 offset:22528
v_pk_max_i16 v53, v169, 0
s_waitcnt lgkmcnt(4)
v_mfma_f32_16x16x32_bf16 v[192:195], v[24:27], a[80:83], v[192:195]
ds_read_b64_tr_b16 v[120:121], v8 offset:20480
v_pk_max_i16 v54, v170, 0
v_pk_max_i16 v55, v171, 0
v_mfma_f32_16x16x32_bf16 v[200:203], v[24:27], a[84:87], v[200:203]
ds_read_b64_tr_b16 v[122:123], v8 offset:22528
v_mul_f32 v176, v176, |v176|
v_mul_f32 v177, v177, |v177|
v_mfma_f32_16x16x32_bf16 v[196:199], v[28:31], a[80:83], v[196:199]
ds_read_b64_tr_b16 v[124:125], v9 offset:20480
v_mul_f32 v178, v178, |v178|
v_mul_f32 v179, v179, |v179|
v_mfma_f32_16x16x32_bf16 v[204:207], v[28:31], a[84:87], v[204:207]
ds_read_b64_tr_b16 v[126:127], v9 offset:22528
v_mul_f32 v180, v180, |v180|
v_mul_f32 v181, v181, |v181|
v_mfma_f32_16x16x32_bf16 v[208:211], v[32:35], a[80:83], v[208:211]
v_mfma_f32_16x16x32_bf16 v[216:219], v[32:35], a[84:87], v[216:219]
s_waitcnt vmcnt(15)
s_barrier
buffer_load_dwordx4 v3, s[12:15], s6 offen offset:1024 lds
ds_read_b64_tr_b16 v[24:25], v6 offset:24576
ds_read_b64_tr_b16 v[26:27], v6 offset:26624
v_mfma_f32_16x16x32_bf16 v[212:215], v[36:39], a[80:83], v[212:215]
ds_read_b64_tr_b16 v[28:29], v7 offset:24576
v_mul_f32 v182, v182, |v182|
v_mul_f32 v183, v183, |v183|
v_mfma_f32_16x16x32_bf16 v[220:223], v[36:39], a[84:87], v[220:223]
ds_read_b64_tr_b16 v[30:31], v7 offset:26624
v_cvt_pk_bf16_f32 v176, v176, v177
s_waitcnt lgkmcnt(4)
v_mfma_f32_16x16x32_bf16 v[192:195], v[40:43], a[88:91], v[192:195]
buffer_store_dwordx4 v[52:55], v1, s[8:11], s51 offen offset:1024 sc1
ds_read_b64_tr_b16 v[32:33], v8 offset:24576
v_mfma_f32_16x16x32_bf16 v[200:203], v[40:43], a[92:95], v[200:203]
ds_read_b64_tr_b16 v[34:35], v8 offset:26624
v_cvt_pk_bf16_f32 v177, v178, v179
v_cvt_pk_bf16_f32 v178, v180, v181
v_mfma_f32_16x16x32_bf16 v[196:199], v[44:47], a[88:91], v[196:199]
ds_read_b64_tr_b16 v[36:37], v9 offset:24576
s_add_u32 m0, s30, 57344
s_add_u32 s6, s29, 4129024
v_mfma_f32_16x16x32_bf16 v[204:207], v[44:47], a[92:95], v[204:207]
ds_read_b64_tr_b16 v[38:39], v9 offset:26624
v_cvt_pk_bf16_f32 v179, v182, v183
v_pk_max_i16 v56, v176, 0
v_mfma_f32_16x16x32_bf16 v[208:211], v[120:123], a[88:91], v[208:211]
buffer_load_dwordx4 v2, s[12:15], s6 offen offset:0 lds
ds_read_b64_tr_b16 v[40:41], v6 offset:28672
v_mfma_f32_16x16x32_bf16 v[216:219], v[120:123], a[92:95], v[216:219]
ds_read_b64_tr_b16 v[42:43], v6 offset:30720
v_pk_max_i16 v57, v177, 0
v_pk_max_i16 v58, v178, 0
v_mfma_f32_16x16x32_bf16 v[212:215], v[124:127], a[88:91], v[212:215]
ds_read_b64_tr_b16 v[44:45], v7 offset:28672
v_pk_max_i16 v59, v179, 0
v_mul_f32 v184, v184, |v184|
v_mfma_f32_16x16x32_bf16 v[220:223], v[124:127], a[92:95], v[220:223]
ds_read_b64_tr_b16 v[46:47], v7 offset:30720
v_mul_f32 v185, v185, |v185|
s_waitcnt lgkmcnt(4)
v_mfma_f32_16x16x32_bf16 v[192:195], v[24:27], a[96:99], v[192:195]
buffer_load_dwordx4 v3, s[12:15], s6 offen offset:1024 lds
ds_read_b64_tr_b16 v[120:121], v8 offset:28672
v_mfma_f32_16x16x32_bf16 v[200:203], v[24:27], a[100:103], v[200:203]
ds_read_b64_tr_b16 v[122:123], v8 offset:30720
v_mul_f32 v186, v186, |v186|
v_mul_f32 v187, v187, |v187|
v_mfma_f32_16x16x32_bf16 v[196:199], v[28:31], a[96:99], v[196:199]
ds_read_b64_tr_b16 v[124:125], v9 offset:28672
s_add_u32 m0, s30, 65536
s_add_u32 s6, s29, 4718848
v_mfma_f32_16x16x32_bf16 v[204:207], v[28:31], a[100:103], v[204:207]
ds_read_b64_tr_b16 v[126:127], v9 offset:30720
v_mul_f32 v188, v188, |v188|
v_mul_f32 v189, v189, |v189|
v_mfma_f32_16x16x32_bf16 v[208:211], v[32:35], a[96:99], v[208:211]
buffer_load_dwordx4 v2, s[12:15], s6 offen offset:0 lds
ds_read_b64_tr_b16 v[24:25], v6 offset:32768
v_mfma_f32_16x16x32_bf16 v[216:219], v[32:35], a[100:103], v[216:219]
ds_read_b64_tr_b16 v[26:27], v6 offset:34816
v_mul_f32 v190, v190, |v190|
v_mul_f32 v191, v191, |v191|
v_mfma_f32_16x16x32_bf16 v[212:215], v[36:39], a[96:99], v[212:215]
ds_read_b64_tr_b16 v[28:29], v7 offset:32768
v_cvt_pk_bf16_f32 v184, v184, v185
v_cvt_pk_bf16_f32 v185, v186, v187
v_mfma_f32_16x16x32_bf16 v[220:223], v[36:39], a[100:103], v[220:223]
ds_read_b64_tr_b16 v[30:31], v7 offset:34816
v_cvt_pk_bf16_f32 v186, v188, v189
buffer_store_dwordx4 v[56:59], v1, s[8:11], s51 offen offset:2048 sc1
s_waitcnt lgkmcnt(4)
v_mfma_f32_16x16x32_bf16 v[192:195], v[40:43], a[104:107], v[192:195]
ds_read_b64_tr_b16 v[32:33], v8 offset:32768
v_cvt_pk_bf16_f32 v187, v190, v191
v_pk_max_i16 v60, v184, 0
v_mfma_f32_16x16x32_bf16 v[200:203], v[40:43], a[108:111], v[200:203]
ds_read_b64_tr_b16 v[34:35], v8 offset:34816
v_pk_max_i16 v61, v185, 0
v_pk_max_i16 v62, v186, 0
v_mfma_f32_16x16x32_bf16 v[196:199], v[44:47], a[104:107], v[196:199]
ds_read_b64_tr_b16 v[36:37], v9 offset:32768
v_mfma_f32_16x16x32_bf16 v[204:207], v[44:47], a[108:111], v[204:207]
ds_read_b64_tr_b16 v[38:39], v9 offset:34816
v_pk_max_i16 v63, v187, 0
v_mfma_f32_16x16x32_bf16 v[208:211], v[120:123], a[104:107], v[208:211]
buffer_load_dwordx4 v3, s[12:15], s6 offen offset:1024 lds
ds_read_b64_tr_b16 v[40:41], v6 offset:36864
v_mfma_f32_16x16x32_bf16 v[216:219], v[120:123], a[108:111], v[216:219]
ds_read_b64_tr_b16 v[42:43], v6 offset:38912
v_mfma_f32_16x16x32_bf16 v[212:215], v[124:127], a[104:107], v[212:215]
ds_read_b64_tr_b16 v[44:45], v7 offset:36864
v_mfma_f32_16x16x32_bf16 v[220:223], v[124:127], a[108:111], v[220:223]
ds_read_b64_tr_b16 v[46:47], v7 offset:38912
s_waitcnt lgkmcnt(4)
v_mfma_f32_16x16x32_bf16 v[192:195], v[24:27], a[112:115], v[192:195]
ds_read_b64_tr_b16 v[120:121], v8 offset:36864
s_add_u32 m0, s30, 73728
v_mfma_f32_16x16x32_bf16 v[200:203], v[24:27], a[116:119], v[200:203]
ds_read_b64_tr_b16 v[122:123], v8 offset:38912
s_add_u32 s6, s55, 1105920
v_mfma_f32_16x16x32_bf16 v[196:199], v[28:31], a[112:115], v[196:199]
buffer_load_dwordx4 v4, s[16:19], s6 offen offset:0 lds
ds_read_b64_tr_b16 v[124:125], v9 offset:36864
v_mfma_f32_16x16x32_bf16 v[204:207], v[28:31], a[116:119], v[204:207]
ds_read_b64_tr_b16 v[126:127], v9 offset:38912
v_mfma_f32_16x16x32_bf16 v[208:211], v[32:35], a[112:115], v[208:211]
ds_read_b64_tr_b16 v[24:25], v6 offset:40960
v_mfma_f32_16x16x32_bf16 v[216:219], v[32:35], a[116:119], v[216:219]
ds_read_b64_tr_b16 v[26:27], v6 offset:43008
v_mfma_f32_16x16x32_bf16 v[212:215], v[36:39], a[112:115], v[212:215]
ds_read_b64_tr_b16 v[28:29], v7 offset:40960
buffer_store_dwordx4 v[60:63], v1, s[8:11], s51 offen offset:3072 sc1
v_mfma_f32_16x16x32_bf16 v[220:223], v[36:39], a[116:119], v[220:223]
ds_read_b64_tr_b16 v[30:31], v7 offset:43008
s_waitcnt lgkmcnt(4)
v_mfma_f32_16x16x32_bf16 v[192:195], v[40:43], a[120:123], v[192:195]
ds_read_b64_tr_b16 v[32:33], v8 offset:40960
v_mfma_f32_16x16x32_bf16 v[200:203], v[40:43], a[124:127], v[200:203]
ds_read_b64_tr_b16 v[34:35], v8 offset:43008
v_mfma_f32_16x16x32_bf16 v[196:199], v[44:47], a[120:123], v[196:199]
ds_read_b64_tr_b16 v[36:37], v9 offset:40960
v_mfma_f32_16x16x32_bf16 v[204:207], v[44:47], a[124:127], v[204:207]
ds_read_b64_tr_b16 v[38:39], v9 offset:43008
v_mfma_f32_16x16x32_bf16 v[208:211], v[120:123], a[120:123], v[208:211]
ds_read_b64_tr_b16 v[40:41], v6 offset:45056
v_mfma_f32_16x16x32_bf16 v[216:219], v[120:123], a[124:127], v[216:219]
ds_read_b64_tr_b16 v[42:43], v6 offset:47104
v_mfma_f32_16x16x32_bf16 v[212:215], v[124:127], a[120:123], v[212:215]
buffer_load_dwordx4 v5, s[16:19], s6 offen offset:1024 lds
ds_read_b64_tr_b16 v[44:45], v7 offset:45056
v_mfma_f32_16x16x32_bf16 v[220:223], v[124:127], a[124:127], v[220:223]
ds_read_b64_tr_b16 v[46:47], v7 offset:47104
s_waitcnt lgkmcnt(4)
v_mfma_f32_16x16x32_bf16 v[192:195], v[24:27], a[128:131], v[192:195]
ds_read_b64_tr_b16 v[120:121], v8 offset:45056
v_mfma_f32_16x16x32_bf16 v[200:203], v[24:27], a[132:135], v[200:203]
ds_read_b64_tr_b16 v[122:123], v8 offset:47104
v_mfma_f32_16x16x32_bf16 v[196:199], v[28:31], a[128:131], v[196:199]
ds_read_b64_tr_b16 v[124:125], v9 offset:45056
s_add_u32 m0, s30, 81920
v_mfma_f32_16x16x32_bf16 v[204:207], v[28:31], a[132:135], v[204:207]
ds_read_b64_tr_b16 v[126:127], v9 offset:47104
s_add_u32 s6, s55, 1179648
v_mfma_f32_16x16x32_bf16 v[208:211], v[32:35], a[128:131], v[208:211]
v_mfma_f32_16x16x32_bf16 v[216:219], v[32:35], a[132:135], v[216:219]
s_waitcnt vmcnt(19)
s_barrier
buffer_load_dwordx4 v4, s[16:19], s6 offen offset:0 lds
v_add_u32 v6, 4294868992, v6
ds_read_b64_tr_b16 v[24:25], v6 offset:0
ds_read_b64_tr_b16 v[26:27], v6 offset:2048
v_mfma_f32_16x16x32_bf16 v[212:215], v[36:39], a[128:131], v[212:215]
v_add_u32 v7, 4294868992, v7
ds_read_b64_tr_b16 v[28:29], v7 offset:0
v_mfma_f32_16x16x32_bf16 v[220:223], v[36:39], a[132:135], v[220:223]
ds_read_b64_tr_b16 v[30:31], v7 offset:2048
s_waitcnt lgkmcnt(4)
v_mfma_f32_16x16x32_bf16 v[192:195], v[40:43], a[136:139], v[192:195]
buffer_load_dwordx4 v5, s[16:19], s6 offen offset:1024 lds
v_add_u32 v8, 4294868992, v8
ds_read_b64_tr_b16 v[32:33], v8 offset:0
v_mfma_f32_16x16x32_bf16 v[200:203], v[40:43], a[140:143], v[200:203]
ds_read_b64_tr_b16 v[34:35], v8 offset:2048
v_mfma_f32_16x16x32_bf16 v[196:199], v[44:47], a[136:139], v[196:199]
v_add_u32 v9, 4294868992, v9
ds_read_b64_tr_b16 v[36:37], v9 offset:0
v_mfma_f32_16x16x32_bf16 v[204:207], v[44:47], a[140:143], v[204:207]
ds_read_b64_tr_b16 v[38:39], v9 offset:2048
s_add_u32 m0, s30, 90112
s_add_u32 s6, s55, 1253376
v_mfma_f32_16x16x32_bf16 v[208:211], v[120:123], a[136:139], v[208:211]
buffer_load_dwordx4 v4, s[16:19], s6 offen offset:0 lds
ds_read_b64_tr_b16 v[40:41], v6 offset:4096
v_mfma_f32_16x16x32_bf16 v[216:219], v[120:123], a[140:143], v[216:219]
s_branch PGC_2
.p2align 12
PSC_2:
s_setpc_b64 s[62:63]
PGC_2:
ds_read_b64_tr_b16 v[42:43], v6 offset:6144
v_mfma_f32_16x16x32_bf16 v[212:215], v[124:127], a[136:139], v[212:215]
ds_read_b64_tr_b16 v[44:45], v7 offset:4096
v_mfma_f32_16x16x32_bf16 v[220:223], v[124:127], a[140:143], v[220:223]
ds_read_b64_tr_b16 v[46:47], v7 offset:6144
s_waitcnt vmcnt(18)
v_mfma_f32_16x16x32_bf16 v[192:195], v[244:247], v[226:229], v[192:195]
v_mfma_f32_16x16x32_bf16 v[196:199], v[244:247], v[230:233], v[196:199]
v_mfma_f32_16x16x32_bf16 v[208:211], v[244:247], v[224:227], v[208:211]
v_mfma_f32_16x16x32_bf16 v[212:215], v[244:247], v[228:231], v[212:215]
v_mfma_f32_16x16x32_bf16 v[200:203], v[244:247], v[234:237], v[200:203]
v_mfma_f32_16x16x32_bf16 v[204:207], v[244:247], v[238:241], v[204:207]
v_mfma_f32_16x16x32_bf16 v[216:219], v[244:247], v[232:235], v[216:219]
v_mfma_f32_16x16x32_bf16 v[220:223], v[244:247], v[236:239], v[220:223]
s_waitcnt lgkmcnt(4)
v_mfma_f32_16x16x32_bf16 v[128:131], v[24:27], a[0:3], 0
buffer_load_dwordx4 v5, s[16:19], s6 offen offset:1024 lds
ds_read_b64_tr_b16 v[120:121], v8 offset:4096
v_mfma_f32_16x16x32_bf16 v[136:139], v[24:27], a[4:7], 0
ds_read_b64_tr_b16 v[122:123], v8 offset:6144
v_mfma_f32_16x16x32_bf16 v[132:135], v[28:31], a[0:3], 0
ds_read_b64_tr_b16 v[124:125], v9 offset:4096
v_mfma_f32_16x16x32_bf16 v[140:143], v[28:31], a[4:7], 0
ds_read_b64_tr_b16 v[126:127], v9 offset:6144
v_mfma_f32_16x16x32_bf16 v[144:147], v[32:35], a[0:3], 0
buffer_load_dwordx4 v[244:247], v1, s[8:11], s33 offen offset:2048 sc1
ds_read_b64_tr_b16 v[24:25], v6 offset:8192
v_mfma_f32_16x16x32_bf16 v[152:155], v[32:35], a[4:7], 0
ds_read_b64_tr_b16 v[26:27], v6 offset:10240
v_mul_f32 v192, v192, |v192|
v_mfma_f32_16x16x32_bf16 v[148:151], v[36:39], a[0:3], 0
ds_read_b64_tr_b16 v[28:29], v7 offset:8192
v_mul_f32 v193, v193, |v193|
v_mfma_f32_16x16x32_bf16 v[156:159], v[36:39], a[4:7], 0
ds_read_b64_tr_b16 v[30:31], v7 offset:10240
v_mul_f32 v194, v194, |v194|
s_waitcnt lgkmcnt(4)
v_mfma_f32_16x16x32_bf16 v[128:131], v[40:43], a[8:11], v[128:131]
ds_read_b64_tr_b16 v[32:33], v8 offset:8192
s_add_u32 m0, s30, 98304
v_mfma_f32_16x16x32_bf16 v[136:139], v[40:43], a[12:15], v[136:139]
ds_read_b64_tr_b16 v[34:35], v8 offset:10240
s_add_u32 s6, s35, 1106176
v_mul_f32 v195, v195, |v195|
v_mfma_f32_16x16x32_bf16 v[132:135], v[44:47], a[8:11], v[132:135]
buffer_load_dwordx4 v4, s[16:19], s6 offen offset:0 lds
ds_read_b64_tr_b16 v[36:37], v9 offset:8192
v_mfma_f32_16x16x32_bf16 v[140:143], v[44:47], a[12:15], v[140:143]
ds_read_b64_tr_b16 v[38:39], v9 offset:10240
v_mul_f32 v196, v196, |v196|
v_mfma_f32_16x16x32_bf16 v[144:147], v[120:123], a[8:11], v[144:147]
ds_read_b64_tr_b16 v[40:41], v6 offset:12288
v_mul_f32 v197, v197, |v197|
v_mfma_f32_16x16x32_bf16 v[152:155], v[120:123], a[12:15], v[152:155]
ds_read_b64_tr_b16 v[42:43], v6 offset:14336
v_mul_f32 v198, v198, |v198|
v_mul_f32 v199, v199, |v199|
v_mfma_f32_16x16x32_bf16 v[148:151], v[124:127], a[8:11], v[148:151]
ds_read_b64_tr_b16 v[44:45], v7 offset:12288
v_cvt_pk_bf16_f32 v192, v192, v193
v_mfma_f32_16x16x32_bf16 v[156:159], v[124:127], a[12:15], v[156:159]
ds_read_b64_tr_b16 v[46:47], v7 offset:14336
v_cvt_pk_bf16_f32 v193, v194, v195
s_waitcnt lgkmcnt(4)
v_mfma_f32_16x16x32_bf16 v[128:131], v[24:27], a[16:19], v[128:131]
buffer_load_dwordx4 v5, s[16:19], s6 offen offset:1024 lds
ds_read_b64_tr_b16 v[120:121], v8 offset:12288
v_mfma_f32_16x16x32_bf16 v[136:139], v[24:27], a[20:23], v[136:139]
ds_read_b64_tr_b16 v[122:123], v8 offset:14336
v_cvt_pk_bf16_f32 v194, v196, v197
v_mfma_f32_16x16x32_bf16 v[132:135], v[28:31], a[16:19], v[132:135]
ds_read_b64_tr_b16 v[124:125], v9 offset:12288
v_cvt_pk_bf16_f32 v195, v198, v199
v_mfma_f32_16x16x32_bf16 v[140:143], v[28:31], a[20:23], v[140:143]
ds_read_b64_tr_b16 v[126:127], v9 offset:14336
v_pk_max_i16 v64, v192, 0
v_pk_max_i16 v65, v193, 0
v_mfma_f32_16x16x32_bf16 v[144:147], v[32:35], a[16:19], v[144:147]
ds_read_b64_tr_b16 v[24:25], v6 offset:16384
s_add_u32 m0, s30, 106496
v_mfma_f32_16x16x32_bf16 v[152:155], v[32:35], a[20:23], v[152:155]
ds_read_b64_tr_b16 v[26:27], v6 offset:18432
s_add_u32 s6, s35, 1179904
v_pk_max_i16 v66, v194, 0
v_mfma_f32_16x16x32_bf16 v[148:151], v[36:39], a[16:19], v[148:151]
buffer_load_dwordx4 v4, s[16:19], s6 offen offset:0 lds
ds_read_b64_tr_b16 v[28:29], v7 offset:16384
v_mfma_f32_16x16x32_bf16 v[156:159], v[36:39], a[20:23], v[156:159]
ds_read_b64_tr_b16 v[30:31], v7 offset:18432
s_waitcnt lgkmcnt(4)
v_mfma_f32_16x16x32_bf16 v[128:131], v[40:43], a[24:27], v[128:131]
ds_read_b64_tr_b16 v[32:33], v8 offset:16384
v_pk_max_i16 v67, v195, 0
v_mfma_f32_16x16x32_bf16 v[136:139], v[40:43], a[28:31], v[136:139]
ds_read_b64_tr_b16 v[34:35], v8 offset:18432
v_mul_f32 v200, v200, |v200|
v_mul_f32 v201, v201, |v201|
v_mfma_f32_16x16x32_bf16 v[132:135], v[44:47], a[24:27], v[132:135]
ds_read_b64_tr_b16 v[36:37], v9 offset:16384
s_add_u32 s51, s47, 16384
v_mfma_f32_16x16x32_bf16 v[140:143], v[44:47], a[28:31], v[140:143]
ds_read_b64_tr_b16 v[38:39], v9 offset:18432
v_mul_f32 v202, v202, |v202|
v_mul_f32 v203, v203, |v203|
v_mfma_f32_16x16x32_bf16 v[144:147], v[120:123], a[24:27], v[144:147]
buffer_store_dwordx4 v[64:67], v1, s[8:11], s51 offen offset:0 sc1
ds_read_b64_tr_b16 v[40:41], v6 offset:20480
v_mfma_f32_16x16x32_bf16 v[152:155], v[120:123], a[28:31], v[152:155]
ds_read_b64_tr_b16 v[42:43], v6 offset:22528
v_mul_f32 v204, v204, |v204|
v_mfma_f32_16x16x32_bf16 v[148:151], v[124:127], a[24:27], v[148:151]
ds_read_b64_tr_b16 v[44:45], v7 offset:20480
v_mul_f32 v205, v205, |v205|
v_mfma_f32_16x16x32_bf16 v[156:159], v[124:127], a[28:31], v[156:159]
ds_read_b64_tr_b16 v[46:47], v7 offset:22528
v_mul_f32 v206, v206, |v206|
s_waitcnt lgkmcnt(4)
v_mfma_f32_16x16x32_bf16 v[128:131], v[24:27], a[32:35], v[128:131]
ds_read_b64_tr_b16 v[120:121], v8 offset:20480
v_mul_f32 v207, v207, |v207|
v_mfma_f32_16x16x32_bf16 v[136:139], v[24:27], a[36:39], v[136:139]
ds_read_b64_tr_b16 v[122:123], v8 offset:22528
v_cvt_pk_bf16_f32 v200, v200, v201
v_cvt_pk_bf16_f32 v201, v202, v203
v_mfma_f32_16x16x32_bf16 v[132:135], v[28:31], a[32:35], v[132:135]
buffer_load_dwordx4 v5, s[16:19], s6 offen offset:1024 lds
ds_read_b64_tr_b16 v[124:125], v9 offset:20480
v_mfma_f32_16x16x32_bf16 v[140:143], v[28:31], a[36:39], v[140:143]
ds_read_b64_tr_b16 v[126:127], v9 offset:22528
v_cvt_pk_bf16_f32 v202, v204, v205
v_mfma_f32_16x16x32_bf16 v[144:147], v[32:35], a[32:35], v[144:147]
v_mfma_f32_16x16x32_bf16 v[152:155], v[32:35], a[36:39], v[152:155]
s_waitcnt vmcnt(22)
s_barrier
ds_read_b64_tr_b16 v[24:25], v6 offset:24576
ds_read_b64_tr_b16 v[26:27], v6 offset:26624
s_add_u32 m0, s30, 114688
s_add_u32 s6, s35, 1253632
v_mfma_f32_16x16x32_bf16 v[148:151], v[36:39], a[32:35], v[148:151]
buffer_load_dwordx4 v4, s[16:19], s6 offen offset:0 lds
ds_read_b64_tr_b16 v[28:29], v7 offset:24576
v_mfma_f32_16x16x32_bf16 v[156:159], v[36:39], a[36:39], v[156:159]
ds_read_b64_tr_b16 v[30:31], v7 offset:26624
s_waitcnt lgkmcnt(4)
v_mfma_f32_16x16x32_bf16 v[128:131], v[40:43], a[40:43], v[128:131]
ds_read_b64_tr_b16 v[32:33], v8 offset:24576
v_cvt_pk_bf16_f32 v203, v206, v207
v_mfma_f32_16x16x32_bf16 v[136:139], v[40:43], a[44:47], v[136:139]
ds_read_b64_tr_b16 v[34:35], v8 offset:26624
v_pk_max_i16 v68, v200, 0
v_pk_max_i16 v69, v201, 0
v_mfma_f32_16x16x32_bf16 v[132:135], v[44:47], a[40:43], v[132:135]
buffer_load_dwordx4 v5, s[16:19], s6 offen offset:1024 lds
ds_read_b64_tr_b16 v[36:37], v9 offset:24576
v_mfma_f32_16x16x32_bf16 v[140:143], v[44:47], a[44:47], v[140:143]
ds_read_b64_tr_b16 v[38:39], v9 offset:26624
v_pk_max_i16 v70, v202, 0
v_mfma_f32_16x16x32_bf16 v[144:147], v[120:123], a[40:43], v[144:147]
ds_read_b64_tr_b16 v[40:41], v6 offset:28672
v_pk_max_i16 v71, v203, 0
v_mfma_f32_16x16x32_bf16 v[152:155], v[120:123], a[44:47], v[152:155]
ds_read_b64_tr_b16 v[42:43], v6 offset:30720
v_mul_f32 v208, v208, |v208|
v_mul_f32 v209, v209, |v209|
v_mfma_f32_16x16x32_bf16 v[148:151], v[124:127], a[40:43], v[148:151]
ds_read_b64_tr_b16 v[44:45], v7 offset:28672
v_mul_f32 v210, v210, |v210|
v_mfma_f32_16x16x32_bf16 v[156:159], v[124:127], a[44:47], v[156:159]
ds_read_b64_tr_b16 v[46:47], v7 offset:30720
v_mul_f32 v211, v211, |v211|
s_waitcnt lgkmcnt(4)
v_mfma_f32_16x16x32_bf16 v[128:131], v[24:27], a[48:51], v[128:131]
buffer_store_dwordx4 v[68:71], v1, s[8:11], s51 offen offset:1024 sc1
ds_read_b64_tr_b16 v[120:121], v8 offset:28672
v_mfma_f32_16x16x32_bf16 v[136:139], v[24:27], a[52:55], v[136:139]
ds_read_b64_tr_b16 v[122:123], v8 offset:30720
v_mul_f32 v212, v212, |v212|
v_mfma_f32_16x16x32_bf16 v[132:135], v[28:31], a[48:51], v[132:135]
ds_read_b64_tr_b16 v[124:125], v9 offset:28672
v_mul_f32 v213, v213, |v213|
v_mfma_f32_16x16x32_bf16 v[140:143], v[28:31], a[52:55], v[140:143]
ds_read_b64_tr_b16 v[126:127], v9 offset:30720
v_mul_f32 v214, v214, |v214|
v_mul_f32 v215, v215, |v215|
v_mfma_f32_16x16x32_bf16 v[144:147], v[32:35], a[48:51], v[144:147]
ds_read_b64_tr_b16 v[24:25], v6 offset:32768
s_add_u32 m0, s30, 122880
v_mfma_f32_16x16x32_bf16 v[152:155], v[32:35], a[52:55], v[152:155]
ds_read_b64_tr_b16 v[26:27], v6 offset:34816
s_add_u32 s6, s54, 1105920
v_cvt_pk_bf16_f32 v208, v208, v209
v_mfma_f32_16x16x32_bf16 v[148:151], v[36:39], a[48:51], v[148:151]
buffer_load_dwordx4 v4, s[16:19], s6 offen offset:0 lds
ds_read_b64_tr_b16 v[28:29], v7 offset:32768
v_mfma_f32_16x16x32_bf16 v[156:159], v[36:39], a[52:55], v[156:159]
ds_read_b64_tr_b16 v[30:31], v7 offset:34816
s_waitcnt lgkmcnt(4)
v_mfma_f32_16x16x32_bf16 v[128:131], v[40:43], a[56:59], v[128:131]
ds_read_b64_tr_b16 v[32:33], v8 offset:32768
v_cvt_pk_bf16_f32 v209, v210, v211
v_mfma_f32_16x16x32_bf16 v[136:139], v[40:43], a[60:63], v[136:139]
ds_read_b64_tr_b16 v[34:35], v8 offset:34816
v_cvt_pk_bf16_f32 v210, v212, v213
v_cvt_pk_bf16_f32 v211, v214, v215
v_mfma_f32_16x16x32_bf16 v[132:135], v[44:47], a[56:59], v[132:135]
ds_read_b64_tr_b16 v[36:37], v9 offset:32768
v_pk_max_i16 v72, v208, 0
v_mfma_f32_16x16x32_bf16 v[140:143], v[44:47], a[60:63], v[140:143]
ds_read_b64_tr_b16 v[38:39], v9 offset:34816
v_pk_max_i16 v73, v209, 0
v_pk_max_i16 v74, v210, 0
v_mfma_f32_16x16x32_bf16 v[144:147], v[120:123], a[56:59], v[144:147]
buffer_load_dwordx4 v5, s[16:19], s6 offen offset:1024 lds
ds_read_b64_tr_b16 v[40:41], v6 offset:36864
v_mfma_f32_16x16x32_bf16 v[152:155], v[120:123], a[60:63], v[152:155]
ds_read_b64_tr_b16 v[42:43], v6 offset:38912
v_pk_max_i16 v75, v211, 0
v_mfma_f32_16x16x32_bf16 v[148:151], v[124:127], a[56:59], v[148:151]
ds_read_b64_tr_b16 v[44:45], v7 offset:36864
v_mul_f32 v216, v216, |v216|
v_mfma_f32_16x16x32_bf16 v[156:159], v[124:127], a[60:63], v[156:159]
ds_read_b64_tr_b16 v[46:47], v7 offset:38912
v_mul_f32 v217, v217, |v217|
s_waitcnt lgkmcnt(4)
v_mfma_f32_16x16x32_bf16 v[128:131], v[24:27], a[64:67], v[128:131]
buffer_store_dwordx4 v[72:75], v1, s[8:11], s51 offen offset:2048 sc1
ds_read_b64_tr_b16 v[120:121], v8 offset:36864
v_mfma_f32_16x16x32_bf16 v[136:139], v[24:27], a[68:71], v[136:139]
ds_read_b64_tr_b16 v[122:123], v8 offset:38912
v_mul_f32 v218, v218, |v218|
v_mfma_f32_16x16x32_bf16 v[132:135], v[28:31], a[64:67], v[132:135]
ds_read_b64_tr_b16 v[124:125], v9 offset:36864
v_mul_f32 v219, v219, |v219|
v_mfma_f32_16x16x32_bf16 v[140:143], v[28:31], a[68:71], v[140:143]
ds_read_b64_tr_b16 v[126:127], v9 offset:38912
v_mul_f32 v220, v220, |v220|
v_mul_f32 v221, v221, |v221|
v_mfma_f32_16x16x32_bf16 v[144:147], v[32:35], a[64:67], v[144:147]
ds_read_b64_tr_b16 v[24:25], v6 offset:40960
s_add_u32 m0, s30, 131072
v_mfma_f32_16x16x32_bf16 v[152:155], v[32:35], a[68:71], v[152:155]
ds_read_b64_tr_b16 v[26:27], v6 offset:43008
s_add_u32 s6, s54, 1179648
v_mul_f32 v222, v222, |v222|
v_mfma_f32_16x16x32_bf16 v[148:151], v[36:39], a[64:67], v[148:151]
buffer_load_dwordx4 v4, s[16:19], s6 offen offset:0 lds
ds_read_b64_tr_b16 v[28:29], v7 offset:40960
v_mfma_f32_16x16x32_bf16 v[156:159], v[36:39], a[68:71], v[156:159]
ds_read_b64_tr_b16 v[30:31], v7 offset:43008
s_waitcnt lgkmcnt(4)
v_mfma_f32_16x16x32_bf16 v[128:131], v[40:43], a[72:75], v[128:131]
ds_read_b64_tr_b16 v[32:33], v8 offset:40960
v_mul_f32 v223, v223, |v223|
v_mfma_f32_16x16x32_bf16 v[136:139], v[40:43], a[76:79], v[136:139]
ds_read_b64_tr_b16 v[34:35], v8 offset:43008
v_cvt_pk_bf16_f32 v216, v216, v217
v_cvt_pk_bf16_f32 v217, v218, v219
v_mfma_f32_16x16x32_bf16 v[132:135], v[44:47], a[72:75], v[132:135]
ds_read_b64_tr_b16 v[36:37], v9 offset:40960
v_cvt_pk_bf16_f32 v218, v220, v221
v_mfma_f32_16x16x32_bf16 v[140:143], v[44:47], a[76:79], v[140:143]
ds_read_b64_tr_b16 v[38:39], v9 offset:43008
v_cvt_pk_bf16_f32 v219, v222, v223
v_pk_max_i16 v76, v216, 0
v_mfma_f32_16x16x32_bf16 v[144:147], v[120:123], a[72:75], v[144:147]
v_mfma_f32_16x16x32_bf16 v[152:155], v[120:123], a[76:79], v[152:155]
s_waitcnt vmcnt(18)
buffer_store_dword v15, off, s[8:11], s37 offset:128 sc1
ds_read_b64_tr_b16 v[40:41], v6 offset:45056
ds_read_b64_tr_b16 v[42:43], v6 offset:47104
v_mfma_f32_16x16x32_bf16 v[148:151], v[124:127], a[72:75], v[148:151]
ds_read_b64_tr_b16 v[44:45], v7 offset:45056
v_pk_max_i16 v77, v217, 0
v_mfma_f32_16x16x32_bf16 v[156:159], v[124:127], a[76:79], v[156:159]
ds_read_b64_tr_b16 v[46:47], v7 offset:47104
v_pk_max_i16 v78, v218, 0
s_waitcnt lgkmcnt(4)
v_mfma_f32_16x16x32_bf16 v[128:131], v[24:27], a[80:83], v[128:131]
ds_read_b64_tr_b16 v[120:121], v8 offset:45056
v_mfma_f32_16x16x32_bf16 v[136:139], v[24:27], a[84:87], v[136:139]
ds_read_b64_tr_b16 v[122:123], v8 offset:47104
v_pk_max_i16 v79, v219, 0
v_mfma_f32_16x16x32_bf16 v[132:135], v[28:31], a[80:83], v[132:135]
buffer_load_dwordx4 v5, s[16:19], s6 offen offset:1024 lds
ds_read_b64_tr_b16 v[124:125], v9 offset:45056
v_mfma_f32_16x16x32_bf16 v[140:143], v[28:31], a[84:87], v[140:143]
ds_read_b64_tr_b16 v[126:127], v9 offset:47104
v_mfma_f32_16x16x32_bf16 v[144:147], v[32:35], a[80:83], v[144:147]
v_mfma_f32_16x16x32_bf16 v[152:155], v[32:35], a[84:87], v[152:155]
s_barrier
buffer_store_dwordx4 v[76:79], v1, s[8:11], s51 offen offset:3072 sc1
v_add_u32 v6, 49152, v6
ds_read_b64_tr_b16 v[24:25], v6 offset:0
ds_read_b64_tr_b16 v[26:27], v6 offset:2048
v_mfma_f32_16x16x32_bf16 v[148:151], v[36:39], a[80:83], v[148:151]
v_add_u32 v7, 49152, v7
ds_read_b64_tr_b16 v[28:29], v7 offset:0
s_add_u32 m0, s30, 139264
v_mfma_f32_16x16x32_bf16 v[156:159], v[36:39], a[84:87], v[156:159]
ds_read_b64_tr_b16 v[30:31], v7 offset:2048
s_add_u32 s6, s54, 1253376
s_waitcnt lgkmcnt(4)
v_mfma_f32_16x16x32_bf16 v[128:131], v[40:43], a[88:91], v[128:131]
buffer_load_dwordx4 v4, s[16:19], s6 offen offset:0 lds
v_add_u32 v8, 49152, v8
ds_read_b64_tr_b16 v[32:33], v8 offset:0
v_mfma_f32_16x16x32_bf16 v[136:139], v[40:43], a[92:95], v[136:139]
ds_read_b64_tr_b16 v[34:35], v8 offset:2048
v_mfma_f32_16x16x32_bf16 v[132:135], v[44:47], a[88:91], v[132:135]
v_add_u32 v9, 49152, v9
ds_read_b64_tr_b16 v[36:37], v9 offset:0
v_mfma_f32_16x16x32_bf16 v[140:143], v[44:47], a[92:95], v[140:143]
ds_read_b64_tr_b16 v[38:39], v9 offset:2048
v_mfma_f32_16x16x32_bf16 v[144:147], v[120:123], a[88:91], v[144:147]
buffer_load_dwordx4 v5, s[16:19], s6 offen offset:1024 lds
ds_read_b64_tr_b16 v[40:41], v6 offset:4096
v_mfma_f32_16x16x32_bf16 v[152:155], v[120:123], a[92:95], v[152:155]
ds_read_b64_tr_b16 v[42:43], v6 offset:6144
v_mfma_f32_16x16x32_bf16 v[148:151], v[124:127], a[88:91], v[148:151]
ds_read_b64_tr_b16 v[44:45], v7 offset:4096
v_mfma_f32_16x16x32_bf16 v[156:159], v[124:127], a[92:95], v[156:159]
ds_read_b64_tr_b16 v[46:47], v7 offset:6144
s_waitcnt lgkmcnt(4)
v_mfma_f32_16x16x32_bf16 v[128:131], v[24:27], a[96:99], v[128:131]
ds_read_b64_tr_b16 v[120:121], v8 offset:4096
s_add_u32 m0, s30, 0
v_mfma_f32_16x16x32_bf16 v[136:139], v[24:27], a[100:103], v[136:139]
ds_read_b64_tr_b16 v[122:123], v8 offset:6144
s_add_u32 s6, s55, 0
v_mfma_f32_16x16x32_bf16 v[132:135], v[28:31], a[96:99], v[132:135]
buffer_load_dwordx4 v4, s[16:19], s6 offen offset:0 lds
ds_read_b64_tr_b16 v[124:125], v9 offset:4096
v_mfma_f32_16x16x32_bf16 v[140:143], v[28:31], a[100:103], v[140:143]
ds_read_b64_tr_b16 v[126:127], v9 offset:6144
v_mfma_f32_16x16x32_bf16 v[144:147], v[32:35], a[96:99], v[144:147]
ds_read_b64_tr_b16 v[24:25], v6 offset:8192
v_mfma_f32_16x16x32_bf16 v[152:155], v[32:35], a[100:103], v[152:155]
ds_read_b64_tr_b16 v[26:27], v6 offset:10240
v_mfma_f32_16x16x32_bf16 v[148:151], v[36:39], a[96:99], v[148:151]
ds_read_b64_tr_b16 v[28:29], v7 offset:8192
v_mfma_f32_16x16x32_bf16 v[156:159], v[36:39], a[100:103], v[156:159]
ds_read_b64_tr_b16 v[30:31], v7 offset:10240
s_waitcnt lgkmcnt(4)
v_mfma_f32_16x16x32_bf16 v[128:131], v[40:43], a[104:107], v[128:131]
buffer_load_dwordx4 v5, s[16:19], s6 offen offset:1024 lds
ds_read_b64_tr_b16 v[32:33], v8 offset:8192
v_mfma_f32_16x16x32_bf16 v[136:139], v[40:43], a[108:111], v[136:139]
ds_read_b64_tr_b16 v[34:35], v8 offset:10240
v_mfma_f32_16x16x32_bf16 v[132:135], v[44:47], a[104:107], v[132:135]
ds_read_b64_tr_b16 v[36:37], v9 offset:8192
v_mfma_f32_16x16x32_bf16 v[140:143], v[44:47], a[108:111], v[140:143]
ds_read_b64_tr_b16 v[38:39], v9 offset:10240
v_mfma_f32_16x16x32_bf16 v[144:147], v[120:123], a[104:107], v[144:147]
ds_read_b64_tr_b16 v[40:41], v6 offset:12288
s_add_u32 m0, s30, 8192
v_mfma_f32_16x16x32_bf16 v[152:155], v[120:123], a[108:111], v[152:155]
ds_read_b64_tr_b16 v[42:43], v6 offset:14336
s_add_u32 s6, s55, 368640
v_mfma_f32_16x16x32_bf16 v[148:151], v[124:127], a[104:107], v[148:151]
buffer_load_dwordx4 v4, s[16:19], s6 offen offset:0 lds
ds_read_b64_tr_b16 v[44:45], v7 offset:12288
v_mfma_f32_16x16x32_bf16 v[156:159], v[124:127], a[108:111], v[156:159]
ds_read_b64_tr_b16 v[46:47], v7 offset:14336
s_waitcnt lgkmcnt(4)
v_mfma_f32_16x16x32_bf16 v[128:131], v[24:27], a[112:115], v[128:131]
ds_read_b64_tr_b16 v[120:121], v8 offset:12288
v_mfma_f32_16x16x32_bf16 v[136:139], v[24:27], a[116:119], v[136:139]
ds_read_b64_tr_b16 v[122:123], v8 offset:14336
v_mfma_f32_16x16x32_bf16 v[132:135], v[28:31], a[112:115], v[132:135]
ds_read_b64_tr_b16 v[124:125], v9 offset:12288
v_mfma_f32_16x16x32_bf16 v[140:143], v[28:31], a[116:119], v[140:143]
ds_read_b64_tr_b16 v[126:127], v9 offset:14336
v_mfma_f32_16x16x32_bf16 v[144:147], v[32:35], a[112:115], v[144:147]
buffer_load_dwordx4 v5, s[16:19], s6 offen offset:1024 lds
ds_read_b64_tr_b16 v[24:25], v6 offset:16384
v_mfma_f32_16x16x32_bf16 v[152:155], v[32:35], a[116:119], v[152:155]
ds_read_b64_tr_b16 v[26:27], v6 offset:18432
v_mfma_f32_16x16x32_bf16 v[148:151], v[36:39], a[112:115], v[148:151]
ds_read_b64_tr_b16 v[28:29], v7 offset:16384
v_mfma_f32_16x16x32_bf16 v[156:159], v[36:39], a[116:119], v[156:159]
ds_read_b64_tr_b16 v[30:31], v7 offset:18432
s_waitcnt lgkmcnt(4)
v_mfma_f32_16x16x32_bf16 v[128:131], v[40:43], a[120:123], v[128:131]
ds_read_b64_tr_b16 v[32:33], v8 offset:16384
s_add_u32 m0, s30, 16384
v_mfma_f32_16x16x32_bf16 v[136:139], v[40:43], a[124:127], v[136:139]
ds_read_b64_tr_b16 v[34:35], v8 offset:18432
s_add_u32 s6, s55, 737280
v_mfma_f32_16x16x32_bf16 v[132:135], v[44:47], a[120:123], v[132:135]
buffer_load_dwordx4 v4, s[16:19], s6 offen offset:0 lds
ds_read_b64_tr_b16 v[36:37], v9 offset:16384
v_mfma_f32_16x16x32_bf16 v[140:143], v[44:47], a[124:127], v[140:143]
ds_read_b64_tr_b16 v[38:39], v9 offset:18432
v_mfma_f32_16x16x32_bf16 v[144:147], v[120:123], a[120:123], v[144:147]
ds_read_b64_tr_b16 v[40:41], v6 offset:20480
v_mfma_f32_16x16x32_bf16 v[152:155], v[120:123], a[124:127], v[152:155]
ds_read_b64_tr_b16 v[42:43], v6 offset:22528
v_mfma_f32_16x16x32_bf16 v[148:151], v[124:127], a[120:123], v[148:151]
ds_read_b64_tr_b16 v[44:45], v7 offset:20480
v_mfma_f32_16x16x32_bf16 v[156:159], v[124:127], a[124:127], v[156:159]
ds_read_b64_tr_b16 v[46:47], v7 offset:22528
s_waitcnt lgkmcnt(4)
v_mfma_f32_16x16x32_bf16 v[128:131], v[24:27], a[128:131], v[128:131]
buffer_load_dwordx4 v5, s[16:19], s6 offen offset:1024 lds
ds_read_b64_tr_b16 v[120:121], v8 offset:20480
v_mfma_f32_16x16x32_bf16 v[136:139], v[24:27], a[132:135], v[136:139]
ds_read_b64_tr_b16 v[122:123], v8 offset:22528
v_mfma_f32_16x16x32_bf16 v[132:135], v[28:31], a[128:131], v[132:135]
ds_read_b64_tr_b16 v[124:125], v9 offset:20480
v_mfma_f32_16x16x32_bf16 v[140:143], v[28:31], a[132:135], v[140:143]
ds_read_b64_tr_b16 v[126:127], v9 offset:22528
v_mfma_f32_16x16x32_bf16 v[144:147], v[32:35], a[128:131], v[144:147]
v_mfma_f32_16x16x32_bf16 v[152:155], v[32:35], a[132:135], v[152:155]
s_waitcnt vmcnt(24)
s_barrier
ds_read_b64_tr_b16 v[24:25], v10 offset:24576
ds_read_b64_tr_b16 v[26:27], v10 offset:26624
s_add_u32 m0, s30, 24576
s_add_u32 s6, s35, 256
v_mfma_f32_16x16x32_bf16 v[148:151], v[36:39], a[128:131], v[148:151]
buffer_load_dwordx4 v4, s[16:19], s6 offen offset:0 lds
ds_read_b64_tr_b16 v[28:29], v11 offset:24576
v_mfma_f32_16x16x32_bf16 v[156:159], v[36:39], a[132:135], v[156:159]
ds_read_b64_tr_b16 v[30:31], v11 offset:26624
s_waitcnt lgkmcnt(4)
v_mfma_f32_16x16x32_bf16 v[128:131], v[40:43], a[136:139], v[128:131]
ds_read_b64_tr_b16 v[32:33], v12 offset:24576
v_mfma_f32_16x16x32_bf16 v[136:139], v[40:43], a[140:143], v[136:139]
ds_read_b64_tr_b16 v[34:35], v12 offset:26624
v_mfma_f32_16x16x32_bf16 v[132:135], v[44:47], a[136:139], v[132:135]
ds_read_b64_tr_b16 v[36:37], v13 offset:24576
v_mfma_f32_16x16x32_bf16 v[140:143], v[44:47], a[140:143], v[140:143]
ds_read_b64_tr_b16 v[38:39], v13 offset:26624
v_mfma_f32_16x16x32_bf16 v[144:147], v[120:123], a[136:139], v[144:147]
buffer_load_dwordx4 v5, s[16:19], s6 offen offset:1024 lds
ds_read_b64_tr_b16 v[40:41], v10 offset:28672
v_mfma_f32_16x16x32_bf16 v[152:155], v[120:123], a[140:143], v[152:155]
ds_read_b64_tr_b16 v[42:43], v10 offset:30720
v_mfma_f32_16x16x32_bf16 v[148:151], v[124:127], a[136:139], v[148:151]
ds_read_b64_tr_b16 v[44:45], v11 offset:28672
v_mfma_f32_16x16x32_bf16 v[156:159], v[124:127], a[140:143], v[156:159]
ds_read_b64_tr_b16 v[46:47], v11 offset:30720
s_waitcnt vmcnt(25)
v_mfma_f32_16x16x32_bf16 v[128:131], v[244:247], v[226:229], v[128:131]
v_mfma_f32_16x16x32_bf16 v[132:135], v[244:247], v[230:233], v[132:135]
v_mfma_f32_16x16x32_bf16 v[144:147], v[244:247], v[224:227], v[144:147]
v_mfma_f32_16x16x32_bf16 v[148:151], v[244:247], v[228:231], v[148:151]
v_mfma_f32_16x16x32_bf16 v[136:139], v[244:247], v[234:237], v[136:139]
v_mfma_f32_16x16x32_bf16 v[140:143], v[244:247], v[238:241], v[140:143]
v_mfma_f32_16x16x32_bf16 v[152:155], v[244:247], v[232:235], v[152:155]
v_mfma_f32_16x16x32_bf16 v[156:159], v[244:247], v[236:239], v[156:159]
s_waitcnt lgkmcnt(4)
v_mfma_f32_16x16x32_bf16 v[192:195], v[24:27], v[48:51], 0
ds_read_b64_tr_b16 v[120:121], v12 offset:28672
s_add_u32 m0, s30, 32768
v_mfma_f32_16x16x32_bf16 v[200:203], v[24:27], v[52:55], 0
ds_read_b64_tr_b16 v[122:123], v12 offset:30720
s_add_u32 s6, s35, 368896
v_mfma_f32_16x16x32_bf16 v[196:199], v[28:31], v[48:51], 0
buffer_load_dwordx4 v4, s[16:19], s6 offen offset:0 lds
ds_read_b64_tr_b16 v[124:125], v13 offset:28672
v_mfma_f32_16x16x32_bf16 v[204:207], v[28:31], v[52:55], 0
ds_read_b64_tr_b16 v[126:127], v13 offset:30720
v_mfma_f32_16x16x32_bf16 v[208:211], v[32:35], v[48:51], 0
ds_read_b64_tr_b16 v[24:25], v10 offset:32768
v_mul_f32 v128, v128, |v128|
v_mul_f32 v129, v129, |v129|
v_mfma_f32_16x16x32_bf16 v[216:219], v[32:35], v[52:55], 0
ds_read_b64_tr_b16 v[26:27], v10 offset:34816
v_mul_f32 v130, v130, |v130|
v_mul_f32 v131, v131, |v131|
v_mfma_f32_16x16x32_bf16 v[212:215], v[36:39], v[48:51], 0
ds_read_b64_tr_b16 v[28:29], v11 offset:32768
v_mul_f32 v132, v132, |v132|
v_mul_f32 v133, v133, |v133|
v_mfma_f32_16x16x32_bf16 v[220:223], v[36:39], v[52:55], 0
ds_read_b64_tr_b16 v[30:31], v11 offset:34816
v_mul_f32 v134, v134, |v134|
s_waitcnt lgkmcnt(4)
v_mfma_f32_16x16x32_bf16 v[192:195], v[40:43], v[56:59], v[192:195]
buffer_load_dwordx4 v5, s[16:19], s6 offen offset:1024 lds
ds_read_b64_tr_b16 v[32:33], v12 offset:32768
v_mfma_f32_16x16x32_bf16 v[200:203], v[40:43], v[60:63], v[200:203]
ds_read_b64_tr_b16 v[34:35], v12 offset:34816
v_mul_f32 v135, v135, |v135|
v_cvt_pk_bf16_f32 v128, v128, v129
v_mfma_f32_16x16x32_bf16 v[196:199], v[44:47], v[56:59], v[196:199]
ds_read_b64_tr_b16 v[36:37], v13 offset:32768
v_cvt_pk_bf16_f32 v129, v130, v131
v_cvt_pk_bf16_f32 v130, v132, v133
v_mfma_f32_16x16x32_bf16 v[204:207], v[44:47], v[60:63], v[204:207]
ds_read_b64_tr_b16 v[38:39], v13 offset:34816
v_cvt_pk_bf16_f32 v131, v134, v135
v_pk_max_i16 v80, v128, 0
v_mfma_f32_16x16x32_bf16 v[208:211], v[120:123], v[56:59], v[208:211]
ds_read_b64_tr_b16 v[40:41], v10 offset:36864
s_add_u32 m0, s30, 40960
s_add_u32 s6, s35, 737536
v_mfma_f32_16x16x32_bf16 v[216:219], v[120:123], v[60:63], v[216:219]
ds_read_b64_tr_b16 v[42:43], v10 offset:38912
v_pk_max_i16 v81, v129, 0
v_pk_max_i16 v82, v130, 0
v_mfma_f32_16x16x32_bf16 v[212:215], v[124:127], v[56:59], v[212:215]
buffer_load_dwordx4 v4, s[16:19], s6 offen offset:0 lds
ds_read_b64_tr_b16 v[44:45], v11 offset:36864
v_mfma_f32_16x16x32_bf16 v[220:223], v[124:127], v[60:63], v[220:223]
ds_read_b64_tr_b16 v[46:47], v11 offset:38912
v_pk_max_i16 v83, v131, 0
s_waitcnt lgkmcnt(4)
v_mfma_f32_16x16x32_bf16 v[192:195], v[24:27], v[64:67], v[192:195]
s_branch PGC_3
.p2align 12
PSC_3:
s_setpc_b64 s[62:63]
PGC_3:
ds_read_b64_tr_b16 v[120:121], v12 offset:36864
s_add_u32 s51, s47, 32768
v_mul_f32 v136, v136, |v136|
v_mfma_f32_16x16x32_bf16 v[200:203], v[24:27], v[68:71], v[200:203]
ds_read_b64_tr_b16 v[122:123], v12 offset:38912
v_mul_f32 v137, v137, |v137|
v_mul_f32 v138, v138, |v138|
v_mfma_f32_16x16x32_bf16 v[196:199], v[28:31], v[64:67], v[196:199]
buffer_store_dwordx4 v[80:83], v1, s[8:11], s51 offen offset:0 sc1
ds_read_b64_tr_b16 v[124:125], v13 offset:36864
v_mfma_f32_16x16x32_bf16 v[204:207], v[28:31], v[68:71], v[204:207]
ds_read_b64_tr_b16 v[126:127], v13 offset:38912
v_mul_f32 v139, v139, |v139|
v_mul_f32 v140, v140, |v140|
v_mfma_f32_16x16x32_bf16 v[208:211], v[32:35], v[64:67], v[208:211]
ds_read_b64_tr_b16 v[24:25], v10 offset:40960
v_mul_f32 v141, v141, |v141|
v_mul_f32 v142, v142, |v142|
v_mfma_f32_16x16x32_bf16 v[216:219], v[32:35], v[68:71], v[216:219]
ds_read_b64_tr_b16 v[26:27], v10 offset:43008
v_mul_f32 v143, v143, |v143|
v_cvt_pk_bf16_f32 v136, v136, v137
v_mfma_f32_16x16x32_bf16 v[212:215], v[36:39], v[64:67], v[212:215]
ds_read_b64_tr_b16 v[28:29], v11 offset:40960
v_cvt_pk_bf16_f32 v137, v138, v139
v_cvt_pk_bf16_f32 v138, v140, v141
v_mfma_f32_16x16x32_bf16 v[220:223], v[36:39], v[68:71], v[220:223]
ds_read_b64_tr_b16 v[30:31], v11 offset:43008
v_cvt_pk_bf16_f32 v139, v142, v143
s_waitcnt lgkmcnt(4)
v_mfma_f32_16x16x32_bf16 v[192:195], v[40:43], v[72:75], v[192:195]
buffer_load_dwordx4 v5, s[16:19], s6 offen offset:1024 lds
ds_read_b64_tr_b16 v[32:33], v12 offset:40960
v_mfma_f32_16x16x32_bf16 v[200:203], v[40:43], v[76:79], v[200:203]
ds_read_b64_tr_b16 v[34:35], v12 offset:43008
v_pk_max_i16 v84, v136, 0
v_pk_max_i16 v85, v137, 0
v_mfma_f32_16x16x32_bf16 v[196:199], v[44:47], v[72:75], v[196:199]
ds_read_b64_tr_b16 v[36:37], v13 offset:40960
v_pk_max_i16 v86, v138, 0
v_pk_max_i16 v87, v139, 0
v_mfma_f32_16x16x32_bf16 v[204:207], v[44:47], v[76:79], v[204:207]
ds_read_b64_tr_b16 v[38:39], v13 offset:43008
v_mul_f32 v144, v144, |v144|
v_mul_f32 v145, v145, |v145|
v_mfma_f32_16x16x32_bf16 v[208:211], v[120:123], v[72:75], v[208:211]
ds_read_b64_tr_b16 v[40:41], v10 offset:45056
v_mul_f32 v146, v146, |v146|
v_mul_f32 v147, v147, |v147|
v_mfma_f32_16x16x32_bf16 v[216:219], v[120:123], v[76:79], v[216:219]
ds_read_b64_tr_b16 v[42:43], v10 offset:47104
v_mul_f32 v148, v148, |v148|
v_mul_f32 v149, v149, |v149|
v_mfma_f32_16x16x32_bf16 v[212:215], v[124:127], v[72:75], v[212:215]
ds_read_b64_tr_b16 v[44:45], v11 offset:45056
v_mul_f32 v150, v150, |v150|
v_mul_f32 v151, v151, |v151|
v_cvt_pk_bf16_f32 v144, v144, v145
v_cvt_pk_bf16_f32 v145, v146, v147
v_cvt_pk_bf16_f32 v146, v148, v149
v_cvt_pk_bf16_f32 v147, v150, v151
v_pk_max_i16 v88, v144, 0
v_pk_max_i16 v89, v145, 0
v_pk_max_i16 v90, v146, 0
v_pk_max_i16 v91, v147, 0
v_mul_f32 v152, v152, |v152|
v_mul_f32 v153, v153, |v153|
v_mul_f32 v154, v154, |v154|
v_mfma_f32_16x16x32_bf16 v[220:223], v[124:127], v[76:79], v[220:223]
ds_read_b64_tr_b16 v[46:47], v11 offset:47104
v_mul_f32 v155, v155, |v155|
v_mul_f32 v156, v156, |v156|
v_mul_f32 v157, v157, |v157|
v_mul_f32 v158, v158, |v158|
v_mul_f32 v159, v159, |v159|
v_cvt_pk_bf16_f32 v152, v152, v153
v_cvt_pk_bf16_f32 v153, v154, v155
v_cvt_pk_bf16_f32 v154, v156, v157
v_cvt_pk_bf16_f32 v155, v158, v159
v_pk_max_i16 v92, v152, 0
v_pk_max_i16 v93, v153, 0
v_pk_max_i16 v94, v154, 0
v_pk_max_i16 v95, v155, 0
s_waitcnt lgkmcnt(4)
v_mfma_f32_16x16x32_bf16 v[192:195], v[24:27], v[80:83], v[192:195]
ds_read_b64_tr_b16 v[120:121], v12 offset:45056
v_mfma_f32_16x16x32_bf16 v[200:203], v[24:27], v[84:87], v[200:203]
ds_read_b64_tr_b16 v[122:123], v12 offset:47104
v_mfma_f32_16x16x32_bf16 v[196:199], v[28:31], v[80:83], v[196:199]
buffer_store_dwordx4 v[84:87], v1, s[8:11], s51 offen offset:1024 sc1
ds_read_b64_tr_b16 v[124:125], v13 offset:45056
v_mfma_f32_16x16x32_bf16 v[204:207], v[28:31], v[84:87], v[204:207]
ds_read_b64_tr_b16 v[126:127], v13 offset:47104
v_mfma_f32_16x16x32_bf16 v[208:211], v[32:35], v[80:83], v[208:211]
v_mfma_f32_16x16x32_bf16 v[216:219], v[32:35], v[84:87], v[216:219]
s_waitcnt vmcnt(24)
s_barrier
v_xor_b32 v6, s43, v6
v_add_u32 v6, 49152, v6
ds_read_b64_tr_b16 v[24:25], v6 offset:0
ds_read_b64_tr_b16 v[26:27], v6 offset:2048
v_mfma_f32_16x16x32_bf16 v[212:215], v[36:39], v[80:83], v[212:215]
v_xor_b32 v7, s43, v7
v_add_u32 v7, 49152, v7
ds_read_b64_tr_b16 v[28:29], v7 offset:0
v_mfma_f32_16x16x32_bf16 v[220:223], v[36:39], v[84:87], v[220:223]
ds_read_b64_tr_b16 v[30:31], v7 offset:2048
s_waitcnt lgkmcnt(4)
v_mfma_f32_16x16x32_bf16 v[192:195], v[40:43], v[88:91], v[192:195]
v_mfma_f32_16x16x32_bf16 v[200:203], v[40:43], v[92:95], v[200:203]
s_waitcnt vmcnt(16)
buffer_store_dword v15, off, s[8:11], s37 offset:256 sc1
v_xor_b32 v8, s43, v8
v_add_u32 v8, 49152, v8
ds_read_b64_tr_b16 v[32:33], v8 offset:0
ds_read_b64_tr_b16 v[34:35], v8 offset:2048
v_mfma_f32_16x16x32_bf16 v[196:199], v[44:47], v[88:91], v[196:199]
v_xor_b32 v9, s43, v9
v_add_u32 v9, 49152, v9
ds_read_b64_tr_b16 v[36:37], v9 offset:0
v_mfma_f32_16x16x32_bf16 v[204:207], v[44:47], v[92:95], v[204:207]
ds_read_b64_tr_b16 v[38:39], v9 offset:2048
v_mfma_f32_16x16x32_bf16 v[208:211], v[120:123], v[88:91], v[208:211]
ds_read_b64_tr_b16 v[40:41], v6 offset:4096
s_load_dwordx4 s[56:59], s[8:9], s36 offset:128 glc
v_mfma_f32_16x16x32_bf16 v[216:219], v[120:123], v[92:95], v[216:219]
ds_read_b64_tr_b16 v[42:43], v6 offset:6144
s_add_u32 m0, s30, 49152
s_add_u32 s6, s54, 0
v_mfma_f32_16x16x32_bf16 v[212:215], v[124:127], v[88:91], v[212:215]
buffer_load_dwordx4 v4, s[16:19], s6 offen offset:0 lds
ds_read_b64_tr_b16 v[44:45], v7 offset:4096
v_mfma_f32_16x16x32_bf16 v[220:223], v[124:127], v[92:95], v[220:223]
ds_read_b64_tr_b16 v[46:47], v7 offset:6144
s_waitcnt lgkmcnt(4)
v_mfma_f32_16x16x32_bf16 v[224:227], v[24:27], v[48:51], 0
ds_read_b64_tr_b16 v[120:121], v8 offset:4096
v_mfma_f32_16x16x32_bf16 v[228:231], v[24:27], v[52:55], 0
ds_read_b64_tr_b16 v[122:123], v8 offset:6144
buffer_store_dwordx4 v[88:91], v1, s[8:11], s51 offen offset:2048 sc1
v_mfma_f32_16x16x32_bf16 v[232:235], v[28:31], v[48:51], 0
ds_read_b64_tr_b16 v[124:125], v9 offset:4096
v_mfma_f32_16x16x32_bf16 v[236:239], v[28:31], v[52:55], 0
ds_read_b64_tr_b16 v[126:127], v9 offset:6144
v_mfma_f32_16x16x32_bf16 v[240:243], v[32:35], v[48:51], 0
ds_read_b64_tr_b16 v[24:25], v6 offset:8192
v_mfma_f32_16x16x32_bf16 v[244:247], v[32:35], v[52:55], 0
ds_read_b64_tr_b16 v[26:27], v6 offset:10240
v_mfma_f32_16x16x32_bf16 v[248:251], v[36:39], v[48:51], 0
ds_read_b64_tr_b16 v[28:29], v7 offset:8192
v_mfma_f32_16x16x32_bf16 v[252:255], v[36:39], v[52:55], 0
ds_read_b64_tr_b16 v[30:31], v7 offset:10240
s_waitcnt lgkmcnt(4)
v_mfma_f32_16x16x32_bf16 v[224:227], v[40:43], v[56:59], v[224:227]
buffer_load_dwordx4 v5, s[16:19], s6 offen offset:1024 lds
ds_read_b64_tr_b16 v[32:33], v8 offset:8192
v_mfma_f32_16x16x32_bf16 v[228:231], v[40:43], v[60:63], v[228:231]
ds_read_b64_tr_b16 v[34:35], v8 offset:10240
v_mfma_f32_16x16x32_bf16 v[232:235], v[44:47], v[56:59], v[232:235]
ds_read_b64_tr_b16 v[36:37], v9 offset:8192
v_mfma_f32_16x16x32_bf16 v[236:239], v[44:47], v[60:63], v[236:239]
ds_read_b64_tr_b16 v[38:39], v9 offset:10240
v_mfma_f32_16x16x32_bf16 v[240:243], v[120:123], v[56:59], v[240:243]
ds_read_b64_tr_b16 v[40:41], v6 offset:12288
s_add_u32 m0, s30, 57344
v_mfma_f32_16x16x32_bf16 v[244:247], v[120:123], v[60:63], v[244:247]
ds_read_b64_tr_b16 v[42:43], v6 offset:14336
s_add_u32 s6, s54, 368640
v_mfma_f32_16x16x32_bf16 v[248:251], v[124:127], v[56:59], v[248:251]
buffer_load_dwordx4 v4, s[16:19], s6 offen offset:0 lds
ds_read_b64_tr_b16 v[44:45], v7 offset:12288
v_mfma_f32_16x16x32_bf16 v[252:255], v[124:127], v[60:63], v[252:255]
ds_read_b64_tr_b16 v[46:47], v7 offset:14336
s_waitcnt lgkmcnt(4)
v_mfma_f32_16x16x32_bf16 v[224:227], v[24:27], v[64:67], v[224:227]
ds_read_b64_tr_b16 v[120:121], v8 offset:12288
v_mfma_f32_16x16x32_bf16 v[228:231], v[24:27], v[68:71], v[228:231]
ds_read_b64_tr_b16 v[122:123], v8 offset:14336
buffer_store_dwordx4 v[92:95], v1, s[8:11], s51 offen offset:3072 sc1
v_mfma_f32_16x16x32_bf16 v[232:235], v[28:31], v[64:67], v[232:235]
ds_read_b64_tr_b16 v[124:125], v9 offset:12288
v_mfma_f32_16x16x32_bf16 v[236:239], v[28:31], v[68:71], v[236:239]
ds_read_b64_tr_b16 v[126:127], v9 offset:14336
v_mfma_f32_16x16x32_bf16 v[240:243], v[32:35], v[64:67], v[240:243]
ds_read_b64_tr_b16 v[24:25], v6 offset:16384
v_mfma_f32_16x16x32_bf16 v[244:247], v[32:35], v[68:71], v[244:247]
ds_read_b64_tr_b16 v[26:27], v6 offset:18432
v_mfma_f32_16x16x32_bf16 v[248:251], v[36:39], v[64:67], v[248:251]
ds_read_b64_tr_b16 v[28:29], v7 offset:16384
v_mfma_f32_16x16x32_bf16 v[252:255], v[36:39], v[68:71], v[252:255]
ds_read_b64_tr_b16 v[30:31], v7 offset:18432
s_waitcnt lgkmcnt(4)
v_mfma_f32_16x16x32_bf16 v[224:227], v[40:43], v[72:75], v[224:227]
buffer_load_dwordx4 v5, s[16:19], s6 offen offset:1024 lds
ds_read_b64_tr_b16 v[32:33], v8 offset:16384
v_mfma_f32_16x16x32_bf16 v[228:231], v[40:43], v[76:79], v[228:231]
ds_read_b64_tr_b16 v[34:35], v8 offset:18432
v_mfma_f32_16x16x32_bf16 v[232:235], v[44:47], v[72:75], v[232:235]
ds_read_b64_tr_b16 v[36:37], v9 offset:16384
v_mfma_f32_16x16x32_bf16 v[236:239], v[44:47], v[76:79], v[236:239]
ds_read_b64_tr_b16 v[38:39], v9 offset:18432
v_mfma_f32_16x16x32_bf16 v[240:243], v[120:123], v[72:75], v[240:243]
ds_read_b64_tr_b16 v[40:41], v6 offset:20480
s_add_u32 m0, s30, 65536
v_mfma_f32_16x16x32_bf16 v[244:247], v[120:123], v[76:79], v[244:247]
ds_read_b64_tr_b16 v[42:43], v6 offset:22528
s_add_u32 s6, s54, 737280
v_mfma_f32_16x16x32_bf16 v[248:251], v[124:127], v[72:75], v[248:251]
buffer_load_dwordx4 v4, s[16:19], s6 offen offset:0 lds
ds_read_b64_tr_b16 v[44:45], v7 offset:20480
v_mfma_f32_16x16x32_bf16 v[252:255], v[124:127], v[76:79], v[252:255]
ds_read_b64_tr_b16 v[46:47], v7 offset:22528
s_waitcnt lgkmcnt(0)
v_mfma_f32_16x16x32_bf16 v[224:227], v[24:27], v[80:83], v[224:227]
ds_read_b64_tr_b16 v[120:121], v8 offset:20480
s_xor_b64 s[56:57], s[56:57], s[0:1]
s_xor_b32 s58, s58, s0
s_or_b32 s57, s57, s58
v_mfma_f32_16x16x32_bf16 v[228:231], v[24:27], v[84:87], v[228:231]
ds_read_b64_tr_b16 v[122:123], v8 offset:22528
s_or_b32 s56, s56, s57
s_cbranch_scc1 K3C_slow1
K3C_back1:
s_add_u32 s7, s34, 0
v_mfma_f32_16x16x32_bf16 v[232:235], v[28:31], v[80:83], v[232:235]
buffer_load_dwordx4 a[144:147], v1, s[8:11], s7 offen offset:0 sc1
ds_read_b64_tr_b16 v[124:125], v9 offset:20480
v_mfma_f32_16x16x32_bf16 v[236:239], v[28:31], v[84:87], v[236:239]
ds_read_b64_tr_b16 v[126:127], v9 offset:22528
v_mfma_f32_16x16x32_bf16 v[240:243], v[32:35], v[80:83], v[240:243]
v_mfma_f32_16x16x32_bf16 v[244:247], v[32:35], v[84:87], v[244:247]
s_waitcnt vmcnt(23)
s_barrier
v_add_u32 v10, 49152, v10
ds_read_b64_tr_b16 v[24:25], v10 offset:24576
ds_read_b64_tr_b16 v[26:27], v10 offset:26624
v_mfma_f32_16x16x32_bf16 v[248:251], v[36:39], v[80:83], v[248:251]
buffer_load_dwordx4 a[148:151], v1, s[8:11], s7 offen offset:1024 sc1
v_add_u32 v11, 49152, v11
ds_read_b64_tr_b16 v[28:29], v11 offset:24576
v_mfma_f32_16x16x32_bf16 v[252:255], v[36:39], v[84:87], v[252:255]
ds_read_b64_tr_b16 v[30:31], v11 offset:26624
s_waitcnt lgkmcnt(4)
v_mfma_f32_16x16x32_bf16 v[224:227], v[40:43], v[88:91], v[224:227]
v_add_u32 v12, 49152, v12
ds_read_b64_tr_b16 v[32:33], v12 offset:24576
v_mfma_f32_16x16x32_bf16 v[228:231], v[40:43], v[92:95], v[228:231]
ds_read_b64_tr_b16 v[34:35], v12 offset:26624
v_mfma_f32_16x16x32_bf16 v[232:235], v[44:47], v[88:91], v[232:235]
buffer_load_dwordx4 a[152:155], v1, s[8:11], s7 offen offset:2048 sc1
v_add_u32 v13, 49152, v13
ds_read_b64_tr_b16 v[36:37], v13 offset:24576
v_mfma_f32_16x16x32_bf16 v[236:239], v[44:47], v[92:95], v[236:239]
ds_read_b64_tr_b16 v[38:39], v13 offset:26624
v_mfma_f32_16x16x32_bf16 v[240:243], v[120:123], v[88:91], v[240:243]
ds_read_b64_tr_b16 v[40:41], v10 offset:28672
v_mfma_f32_16x16x32_bf16 v[244:247], v[120:123], v[92:95], v[244:247]
ds_read_b64_tr_b16 v[42:43], v10 offset:30720
v_mfma_f32_16x16x32_bf16 v[248:251], v[124:127], v[88:91], v[248:251]
buffer_load_dwordx4 a[156:159], v1, s[8:11], s7 offen offset:3072 sc1
ds_read_b64_tr_b16 v[44:45], v11 offset:28672
v_mfma_f32_16x16x32_bf16 v[252:255], v[124:127], v[92:95], v[252:255]
ds_read_b64_tr_b16 v[46:47], v11 offset:30720
s_waitcnt lgkmcnt(4)
v_mfma_f32_16x16x32_bf16 v[160:163], v[24:27], v[48:51], 0
ds_read_b64_tr_b16 v[120:121], v12 offset:28672
v_mfma_f32_16x16x32_bf16 v[168:171], v[24:27], v[52:55], 0
ds_read_b64_tr_b16 v[122:123], v12 offset:30720
s_add_u32 s7, s34, 98304
v_mfma_f32_16x16x32_bf16 v[164:167], v[28:31], v[48:51], 0
buffer_load_dwordx4 a[160:163], v1, s[8:11], s7 offen offset:0 sc1
ds_read_b64_tr_b16 v[124:125], v13 offset:28672
v_mfma_f32_16x16x32_bf16 v[172:175], v[28:31], v[52:55], 0
ds_read_b64_tr_b16 v[126:127], v13 offset:30720
v_mfma_f32_16x16x32_bf16 v[176:179], v[32:35], v[48:51], 0
ds_read_b64_tr_b16 v[24:25], v10 offset:32768
v_mfma_f32_16x16x32_bf16 v[184:187], v[32:35], v[52:55], 0
ds_read_b64_tr_b16 v[26:27], v10 offset:34816
v_mfma_f32_16x16x32_bf16 v[180:183], v[36:39], v[48:51], 0
buffer_load_dwordx4 a[164:167], v1, s[8:11], s7 offen offset:1024 sc1
ds_read_b64_tr_b16 v[28:29], v11 offset:32768
v_mfma_f32_16x16x32_bf16 v[188:191], v[36:39], v[52:55], 0
ds_read_b64_tr_b16 v[30:31], v11 offset:34816
s_waitcnt lgkmcnt(4)
v_mfma_f32_16x16x32_bf16 v[160:163], v[40:43], v[56:59], v[160:163]
ds_read_b64_tr_b16 v[32:33], v12 offset:32768
v_mfma_f32_16x16x32_bf16 v[168:171], v[40:43], v[60:63], v[168:171]
ds_read_b64_tr_b16 v[34:35], v12 offset:34816
v_mfma_f32_16x16x32_bf16 v[164:167], v[44:47], v[56:59], v[164:167]
buffer_load_dwordx4 a[168:171], v1, s[8:11], s7 offen offset:2048 sc1
ds_read_b64_tr_b16 v[36:37], v13 offset:32768
v_mfma_f32_16x16x32_bf16 v[172:175], v[44:47], v[60:63], v[172:175]
ds_read_b64_tr_b16 v[38:39], v13 offset:34816
v_mfma_f32_16x16x32_bf16 v[176:179], v[120:123], v[56:59], v[176:179]
ds_read_b64_tr_b16 v[40:41], v10 offset:36864
v_mfma_f32_16x16x32_bf16 v[184:187], v[120:123], v[60:63], v[184:187]
ds_read_b64_tr_b16 v[42:43], v10 offset:38912
v_mfma_f32_16x16x32_bf16 v[180:183], v[124:127], v[56:59], v[180:183]
buffer_load_dwordx4 a[172:175], v1, s[8:11], s7 offen offset:3072 sc1
ds_read_b64_tr_b16 v[44:45], v11 offset:36864
v_mfma_f32_16x16x32_bf16 v[188:191], v[124:127], v[60:63], v[188:191]
ds_read_b64_tr_b16 v[46:47], v11 offset:38912
s_waitcnt lgkmcnt(4)
v_mfma_f32_16x16x32_bf16 v[160:163], v[24:27], v[64:67], v[160:163]
ds_read_b64_tr_b16 v[120:121], v12 offset:36864
v_mfma_f32_16x16x32_bf16 v[168:171], v[24:27], v[68:71], v[168:171]
ds_read_b64_tr_b16 v[122:123], v12 offset:38912
s_add_u32 s7, s34, 196608
v_mfma_f32_16x16x32_bf16 v[164:167], v[28:31], v[64:67], v[164:167]
buffer_load_dwordx4 a[176:179], v1, s[8:11], s7 offen offset:0 sc1
ds_read_b64_tr_b16 v[124:125], v13 offset:36864
v_mfma_f32_16x16x32_bf16 v[172:175], v[28:31], v[68:71], v[172:175]
ds_read_b64_tr_b16 v[126:127], v13 offset:38912
v_mfma_f32_16x16x32_bf16 v[176:179], v[32:35], v[64:67], v[176:179]
ds_read_b64_tr_b16 v[24:25], v10 offset:40960
v_mfma_f32_16x16x32_bf16 v[184:187], v[32:35], v[68:71], v[184:187]
ds_read_b64_tr_b16 v[26:27], v10 offset:43008
v_mfma_f32_16x16x32_bf16 v[180:183], v[36:39], v[64:67], v[180:183]
buffer_load_dwordx4 a[180:183], v1, s[8:11], s7 offen offset:1024 sc1
ds_read_b64_tr_b16 v[28:29], v11 offset:40960
v_mfma_f32_16x16x32_bf16 v[188:191], v[36:39], v[68:71], v[188:191]
ds_read_b64_tr_b16 v[30:31], v11 offset:43008
s_waitcnt lgkmcnt(4)
v_mfma_f32_16x16x32_bf16 v[160:163], v[40:43], v[72:75], v[160:163]
ds_read_b64_tr_b16 v[32:33], v12 offset:40960
v_mfma_f32_16x16x32_bf16 v[168:171], v[40:43], v[76:79], v[168:171]
ds_read_b64_tr_b16 v[34:35], v12 offset:43008
v_mfma_f32_16x16x32_bf16 v[164:167], v[44:47], v[72:75], v[164:167]
buffer_load_dwordx4 a[184:187], v1, s[8:11], s7 offen offset:2048 sc1
ds_read_b64_tr_b16 v[36:37], v13 offset:40960
v_mfma_f32_16x16x32_bf16 v[172:175], v[44:47], v[76:79], v[172:175]
ds_read_b64_tr_b16 v[38:39], v13 offset:43008
v_mfma_f32_16x16x32_bf16 v[176:179], v[120:123], v[72:75], v[176:179]
ds_read_b64_tr_b16 v[40:41], v10 offset:45056
v_mfma_f32_16x16x32_bf16 v[184:187], v[120:123], v[76:79], v[184:187]
ds_read_b64_tr_b16 v[42:43], v10 offset:47104
v_mfma_f32_16x16x32_bf16 v[180:183], v[124:127], v[72:75], v[180:183]
ds_read_b64_tr_b16 v[44:45], v11 offset:45056
v_mfma_f32_16x16x32_bf16 v[188:191], v[124:127], v[76:79], v[188:191]
ds_read_b64_tr_b16 v[46:47], v11 offset:47104
s_waitcnt lgkmcnt(4)
v_mfma_f32_16x16x32_bf16 v[160:163], v[24:27], v[80:83], v[160:163]
ds_read_b64_tr_b16 v[120:121], v12 offset:45056
v_mfma_f32_16x16x32_bf16 v[168:171], v[24:27], v[84:87], v[168:171]
ds_read_b64_tr_b16 v[122:123], v12 offset:47104
v_mfma_f32_16x16x32_bf16 v[164:167], v[28:31], v[80:83], v[164:167]
ds_read_b64_tr_b16 v[124:125], v13 offset:45056
v_mfma_f32_16x16x32_bf16 v[172:175], v[28:31], v[84:87], v[172:175]
ds_read_b64_tr_b16 v[126:127], v13 offset:47104
v_mfma_f32_16x16x32_bf16 v[176:179], v[32:35], v[80:83], v[176:179]
v_mfma_f32_16x16x32_bf16 v[184:187], v[32:35], v[84:87], v[184:187]
s_waitcnt vmcnt(27)
s_barrier
v_add_u32 v10, 4294868992, v10
ds_read_b64_tr_b16 v[24:25], v10 offset:0
ds_read_b64_tr_b16 v[26:27], v10 offset:2048
v_mfma_f32_16x16x32_bf16 v[180:183], v[36:39], v[80:83], v[180:183]
buffer_load_dwordx4 a[188:191], v1, s[8:11], s7 offen offset:3072 sc1
v_add_u32 v11, 4294868992, v11
ds_read_b64_tr_b16 v[28:29], v11 offset:0
v_mfma_f32_16x16x32_bf16 v[188:191], v[36:39], v[84:87], v[188:191]
ds_read_b64_tr_b16 v[30:31], v11 offset:2048
s_waitcnt lgkmcnt(4)
v_mfma_f32_16x16x32_bf16 v[160:163], v[40:43], v[88:91], v[160:163]
v_add_u32 v12, 4294868992, v12
ds_read_b64_tr_b16 v[32:33], v12 offset:0
v_mfma_f32_16x16x32_bf16 v[168:171], v[40:43], v[92:95], v[168:171]
ds_read_b64_tr_b16 v[34:35], v12 offset:2048
v_mfma_f32_16x16x32_bf16 v[164:167], v[44:47], v[88:91], v[164:167]
buffer_load_dwordx4 v5, s[16:19], s6 offen offset:1024 lds
v_add_u32 v13, 4294868992, v13
ds_read_b64_tr_b16 v[36:37], v13 offset:0
v_mfma_f32_16x16x32_bf16 v[172:175], v[44:47], v[92:95], v[172:175]
ds_read_b64_tr_b16 v[38:39], v13 offset:2048
v_mfma_f32_16x16x32_bf16 v[176:179], v[120:123], v[88:91], v[176:179]
ds_read_b64_tr_b16 v[40:41], v10 offset:4096
s_add_u32 m0, s30, 73728
v_mfma_f32_16x16x32_bf16 v[184:187], v[120:123], v[92:95], v[184:187]
ds_read_b64_tr_b16 v[42:43], v10 offset:6144
s_add_u32 s6, s55, 73728
v_mfma_f32_16x16x32_bf16 v[180:183], v[124:127], v[88:91], v[180:183]
buffer_load_dwordx4 v4, s[16:19], s6 offen offset:0 lds
ds_read_b64_tr_b16 v[44:45], v11 offset:4096
v_mfma_f32_16x16x32_bf16 v[188:191], v[124:127], v[92:95], v[188:191]
ds_read_b64_tr_b16 v[46:47], v11 offset:6144
s_waitcnt vmcnt(12)
s_waitcnt lgkmcnt(4)
v_mfma_f32_16x16x32_bf16 v[192:195], v[24:27], a[144:147], v[192:195]
ds_read_b64_tr_b16 v[120:121], v12 offset:4096
v_lshrrev_b32 v158, 4, v0
v_mfma_f32_16x16x32_bf16 v[200:203], v[24:27], a[148:151], v[200:203]
ds_read_b64_tr_b16 v[122:123], v12 offset:6144
v_lshl_add_u32 v20, v158, 3, s28
v_lshl_add_u32 v21, v158, 3, s31
v_mfma_f32_16x16x32_bf16 v[196:199], v[28:31], a[144:147], v[196:199]
buffer_load_dwordx4 v5, s[16:19], s6 offen offset:1024 lds
ds_read_b64_tr_b16 v[124:125], v13 offset:4096
v_mfma_f32_16x16x32_bf16 v[204:207], v[28:31], a[148:151], v[204:207]
ds_read_b64_tr_b16 v[126:127], v13 offset:6144
v_and_b32 v2, 31, v0
v_mfma_f32_16x16x32_bf16 v[208:211], v[32:35], a[144:147], v[208:211]
ds_read_b64_tr_b16 v[24:25], v10 offset:8192
s_add_u32 m0, s30, 81920
v_mfma_f32_16x16x32_bf16 v[216:219], v[32:35], a[148:151], v[216:219]
ds_read_b64_tr_b16 v[26:27], v10 offset:10240
s_add_u32 s6, s55, 442368
v_mul_u32_u24 v2, 1152, v2
v_mfma_f32_16x16x32_bf16 v[212:215], v[36:39], a[144:147], v[212:215]
buffer_load_dwordx4 v4, s[16:19], s6 offen offset:0 lds
ds_read_b64_tr_b16 v[28:29], v11 offset:8192
v_mfma_f32_16x16x32_bf16 v[220:223], v[36:39], a[148:151], v[220:223]
ds_read_b64_tr_b16 v[30:31], v11 offset:10240
s_waitcnt vmcnt(12)
s_waitcnt lgkmcnt(4)
v_mfma_f32_16x16x32_bf16 v[192:195], v[40:43], a[152:155], v[192:195]
ds_read_b64_tr_b16 v[32:33], v12 offset:8192
s_load_dwordx4 s[56:59], s[8:9], s36 offset:256 glc
v_mfma_f32_16x16x32_bf16 v[200:203], v[40:43], a[156:159], v[200:203]
ds_read_b64_tr_b16 v[34:35], v12 offset:10240
v_lshrrev_b32 v22, 5, v0
v_lshl_add_u32 v2, v22, 4, v2
v_mfma_f32_16x16x32_bf16 v[196:199], v[44:47], a[152:155], v[196:199]
buffer_load_dwordx4 v5, s[16:19], s6 offen offset:1024 lds
ds_read_b64_tr_b16 v[36:37], v13 offset:8192
v_mfma_f32_16x16x32_bf16 v[204:207], v[44:47], a[156:159], v[204:207]
ds_read_b64_tr_b16 v[38:39], v13 offset:10240
v_bfe_u32 v152, v0, 2, 2
v_mfma_f32_16x16x32_bf16 v[208:211], v[120:123], a[152:155], v[208:211]
ds_read_b64_tr_b16 v[40:41], v10 offset:12288
s_add_u32 m0, s30, 90112
v_mfma_f32_16x16x32_bf16 v[216:219], v[120:123], a[156:159], v[216:219]
ds_read_b64_tr_b16 v[42:43], v10 offset:14336
s_add_u32 s6, s55, 811008
v_xor_b32 v158, v152, v158
v_mfma_f32_16x16x32_bf16 v[212:215], v[124:127], a[152:155], v[212:215]
buffer_load_dwordx4 v4, s[16:19], s6 offen offset:0 lds
ds_read_b64_tr_b16 v[44:45], v11 offset:12288
v_mfma_f32_16x16x32_bf16 v[220:223], v[124:127], a[156:159], v[220:223]
ds_read_b64_tr_b16 v[46:47], v11 offset:14336
s_waitcnt vmcnt(12)
s_waitcnt lgkmcnt(4)
v_mfma_f32_16x16x32_bf16 v[192:195], v[24:27], a[160:163], v[192:195]
ds_read_b64_tr_b16 v[120:121], v12 offset:12288
v_add_u32 v158, -1, v158
v_mfma_f32_16x16x32_bf16 v[200:203], v[24:27], a[164:167], v[200:203]
ds_read_b64_tr_b16 v[122:123], v12 offset:14336
v_ashrrev_i32 v158, 31, v158
v_and_b32 v152, 1, v0
v_mfma_f32_16x16x32_bf16 v[196:199], v[28:31], a[160:163], v[196:199]
buffer_load_dwordx4 v5, s[16:19], s6 offen offset:1024 lds
ds_read_b64_tr_b16 v[124:125], v13 offset:12288
v_mfma_f32_16x16x32_bf16 v[204:207], v[28:31], a[164:167], v[204:207]
ds_read_b64_tr_b16 v[126:127], v13 offset:14336
v_lshlrev_b32 v152, 4, v152
v_mfma_f32_16x16x32_bf16 v[208:211], v[32:35], a[160:163], v[208:211]
ds_read_b64_tr_b16 v[24:25], v10 offset:16384
v_mov_b32 v153, 0x3f80
v_mfma_f32_16x16x32_bf16 v[216:219], v[32:35], a[164:167], v[216:219]
ds_read_b64_tr_b16 v[26:27], v10 offset:18432
v_lshlrev_b32 v152, v152, v153
v_and_b32 v158, v158, v152
v_mfma_f32_16x16x32_bf16 v[212:215], v[36:39], a[160:163], v[212:215]
buffer_store_dword v15, off, s[8:11], s37 offset:384 sc1
ds_read_b64_tr_b16 v[28:29], v11 offset:16384
v_mfma_f32_16x16x32_bf16 v[220:223], v[36:39], a[164:167], v[220:223]
ds_read_b64_tr_b16 v[30:31], v11 offset:18432
s_waitcnt vmcnt(12)
s_waitcnt lgkmcnt(4)
v_mfma_f32_16x16x32_bf16 v[192:195], v[40:43], a[168:171], v[192:195]
ds_read_b64_tr_b16 v[32:33], v12 offset:16384
s_add_u32 m0, s30, 98304
v_mfma_f32_16x16x32_bf16 v[200:203], v[40:43], a[172:175], v[200:203]
ds_read_b64_tr_b16 v[34:35], v12 offset:18432
s_add_u32 s6, s35, 73984
v_bfe_i32 v152, v0, 1, 1
v_mfma_f32_16x16x32_bf16 v[196:199], v[44:47], a[168:171], v[196:199]
buffer_load_dwordx4 v4, s[16:19], s6 offen offset:0 lds
ds_read_b64_tr_b16 v[36:37], v13 offset:16384
v_mfma_f32_16x16x32_bf16 v[204:207], v[44:47], a[172:175], v[204:207]
ds_read_b64_tr_b16 v[38:39], v13 offset:18432
v_and_b32 v155, v152, v158
v_mfma_f32_16x16x32_bf16 v[208:211], v[120:123], a[168:171], v[208:211]
ds_read_b64_tr_b16 v[40:41], v10 offset:20480
v_xor_b32 v154, v155, v158
v_mfma_f32_16x16x32_bf16 v[216:219], v[120:123], a[172:175], v[216:219]
ds_read_b64_tr_b16 v[42:43], v10 offset:22528
v_mov_b32 v152, 0
v_mov_b32 v153, 0
v_mfma_f32_16x16x32_bf16 v[212:215], v[124:127], a[168:171], v[212:215]
buffer_load_dwordx4 v5, s[16:19], s6 offen offset:1024 lds
ds_read_b64_tr_b16 v[44:45], v11 offset:20480
v_mfma_f32_16x16x32_bf16 v[220:223], v[124:127], a[172:175], v[220:223]
ds_read_b64_tr_b16 v[46:47], v11 offset:22528
s_waitcnt vmcnt(12)
s_waitcnt lgkmcnt(4)
v_mfma_f32_16x16x32_bf16 v[192:195], v[24:27], a[176:179], v[192:195]
ds_read_b64_tr_b16 v[120:121], v12 offset:20480
v_mov_b32 v156, 0
v_mfma_f32_16x16x32_bf16 v[200:203], v[24:27], a[180:183], v[200:203]
ds_read_b64_tr_b16 v[122:123], v12 offset:22528
v_mov_b32 v157, 0
v_mfma_f32_16x16x32_bf16 v[196:199], v[28:31], a[176:179], v[196:199]
ds_read_b64_tr_b16 v[124:125], v13 offset:20480
v_mfma_f32_16x16x32_bf16 v[204:207], v[28:31], a[180:183], v[204:207]
ds_read_b64_tr_b16 v[126:127], v13 offset:22528
v_mfma_f32_16x16x32_bf16 v[208:211], v[32:35], a[176:179], v[208:211]
v_mfma_f32_16x16x32_bf16 v[216:219], v[32:35], a[180:183], v[216:219]
s_barrier
v_add_u32 v6, 4294868992, v6
ds_read_b64_tr_b16 v[24:25], v6 offset:24576
ds_read_b64_tr_b16 v[26:27], v6 offset:26624
s_add_u32 m0, s30, 106496
s_add_u32 s6, s35, 442624
v_mfma_f32_16x16x32_bf16 v[212:215], v[36:39], a[176:179], v[212:215]
buffer_load_dwordx4 v4, s[16:19], s6 offen offset:0 lds
v_add_u32 v7, 4294868992, v7
ds_read_b64_tr_b16 v[28:29], v7 offset:24576
v_mfma_f32_16x16x32_bf16 v[220:223], v[36:39], a[180:183], v[220:223]
ds_read_b64_tr_b16 v[30:31], v7 offset:26624
s_waitcnt vmcnt(11)
s_waitcnt lgkmcnt(0)
v_mfma_f32_16x16x32_bf16 v[192:195], v[40:43], a[184:187], v[192:195]
v_add_u32 v8, 4294868992, v8
ds_read_b64_tr_b16 v[32:33], v8 offset:24576
s_xor_b64 s[56:57], s[56:57], s[0:1]
s_xor_b32 s58, s58, s0
s_or_b32 s57, s57, s58
v_mfma_f32_16x16x32_bf16 v[200:203], v[40:43], a[188:191], v[200:203]
s_branch PGC_4
.p2align 12
PSC_4:
s_setpc_b64 s[62:63]
PGC_4:
ds_read_b64_tr_b16 v[34:35], v8 offset:26624
s_or_b32 s56, s56, s57
s_cbranch_scc1 K3C_slow2
K3C_back2:
s_add_u32 s7, s34, 16384
v_mfma_f32_16x16x32_bf16 v[196:199], v[44:47], a[184:187], v[196:199]
buffer_load_dwordx4 a[192:195], v1, s[8:11], s7 offen offset:0 sc1
v_add_u32 v9, 4294868992, v9
ds_read_b64_tr_b16 v[36:37], v9 offset:24576
v_mfma_f32_16x16x32_bf16 v[204:207], v[44:47], a[188:191], v[204:207]
ds_read_b64_tr_b16 v[38:39], v9 offset:26624
v_mfma_f32_16x16x32_bf16 v[208:211], v[120:123], a[184:187], v[208:211]
ds_read_b64_tr_b16 v[40:41], v6 offset:28672
v_mfma_f32_16x16x32_bf16 v[216:219], v[120:123], a[188:191], v[216:219]
ds_read_b64_tr_b16 v[42:43], v6 offset:30720
v_mfma_f32_16x16x32_bf16 v[212:215], v[124:127], a[184:187], v[212:215]
buffer_load_dwordx4 a[196:199], v1, s[8:11], s7 offen offset:1024 sc1
ds_read_b64_tr_b16 v[44:45], v7 offset:28672
v_mfma_f32_16x16x32_bf16 v[220:223], v[124:127], a[188:191], v[220:223]
ds_read_b64_tr_b16 v[46:47], v7 offset:30720
s_waitcnt lgkmcnt(4)
v_mfma_f32_16x16x32_bf16 v[224:227], v[24:27], a[144:147], v[224:227]
ds_read_b64_tr_b16 v[120:121], v8 offset:28672
v_mfma_f32_16x16x32_bf16 v[228:231], v[24:27], a[148:151], v[228:231]
ds_read_b64_tr_b16 v[122:123], v8 offset:30720
v_mfma_f32_16x16x32_bf16 v[232:235], v[28:31], a[144:147], v[232:235]
buffer_load_dwordx4 a[200:203], v1, s[8:11], s7 offen offset:2048 sc1
ds_read_b64_tr_b16 v[124:125], v9 offset:28672
v_mfma_f32_16x16x32_bf16 v[236:239], v[28:31], a[148:151], v[236:239]
ds_read_b64_tr_b16 v[126:127], v9 offset:30720
v_mfma_f32_16x16x32_bf16 v[240:243], v[32:35], a[144:147], v[240:243]
ds_read_b64_tr_b16 v[24:25], v6 offset:32768
v_mfma_f32_16x16x32_bf16 v[244:247], v[32:35], a[148:151], v[244:247]
ds_read_b64_tr_b16 v[26:27], v6 offset:34816
v_mfma_f32_16x16x32_bf16 v[248:251], v[36:39], a[144:147], v[248:251]
buffer_load_dwordx4 a[204:207], v1, s[8:11], s7 offen offset:3072 sc1
ds_read_b64_tr_b16 v[28:29], v7 offset:32768
v_mfma_f32_16x16x32_bf16 v[252:255], v[36:39], a[148:151], v[252:255]
ds_read_b64_tr_b16 v[30:31], v7 offset:34816
s_waitcnt lgkmcnt(4)
v_mfma_f32_16x16x32_bf16 v[224:227], v[40:43], a[152:155], v[224:227]
ds_read_b64_tr_b16 v[32:33], v8 offset:32768
v_mfma_f32_16x16x32_bf16 v[228:231], v[40:43], a[156:159], v[228:231]
ds_read_b64_tr_b16 v[34:35], v8 offset:34816
s_add_u32 s7, s34, 114688
v_mfma_f32_16x16x32_bf16 v[232:235], v[44:47], a[152:155], v[232:235]
buffer_load_dwordx4 a[208:211], v1, s[8:11], s7 offen offset:0 sc1
ds_read_b64_tr_b16 v[36:37], v9 offset:32768
v_mfma_f32_16x16x32_bf16 v[236:239], v[44:47], a[156:159], v[236:239]
ds_read_b64_tr_b16 v[38:39], v9 offset:34816
v_mfma_f32_16x16x32_bf16 v[240:243], v[120:123], a[152:155], v[240:243]
ds_read_b64_tr_b16 v[40:41], v6 offset:36864
v_mfma_f32_16x16x32_bf16 v[244:247], v[120:123], a[156:159], v[244:247]
ds_read_b64_tr_b16 v[42:43], v6 offset:38912
v_mfma_f32_16x16x32_bf16 v[248:251], v[124:127], a[152:155], v[248:251]
buffer_load_dwordx4 a[212:215], v1, s[8:11], s7 offen offset:1024 sc1
ds_read_b64_tr_b16 v[44:45], v7 offset:36864
v_mfma_f32_16x16x32_bf16 v[252:255], v[124:127], a[156:159], v[252:255]
ds_read_b64_tr_b16 v[46:47], v7 offset:38912
s_waitcnt lgkmcnt(4)
v_mfma_f32_16x16x32_bf16 v[224:227], v[24:27], a[160:163], v[224:227]
ds_read_b64_tr_b16 v[120:121], v8 offset:36864
v_mfma_f32_16x16x32_bf16 v[228:231], v[24:27], a[164:167], v[228:231]
ds_read_b64_tr_b16 v[122:123], v8 offset:38912
v_mfma_f32_16x16x32_bf16 v[232:235], v[28:31], a[160:163], v[232:235]
buffer_load_dwordx4 a[216:219], v1, s[8:11], s7 offen offset:2048 sc1
ds_read_b64_tr_b16 v[124:125], v9 offset:36864
v_mfma_f32_16x16x32_bf16 v[236:239], v[28:31], a[164:167], v[236:239]
ds_read_b64_tr_b16 v[126:127], v9 offset:38912
v_mfma_f32_16x16x32_bf16 v[240:243], v[32:35], a[160:163], v[240:243]
ds_read_b64_tr_b16 v[24:25], v6 offset:40960
v_mfma_f32_16x16x32_bf16 v[244:247], v[32:35], a[164:167], v[244:247]
ds_read_b64_tr_b16 v[26:27], v6 offset:43008
v_mfma_f32_16x16x32_bf16 v[248:251], v[36:39], a[160:163], v[248:251]
buffer_load_dwordx4 a[220:223], v1, s[8:11], s7 offen offset:3072 sc1
ds_read_b64_tr_b16 v[28:29], v7 offset:40960
v_mfma_f32_16x16x32_bf16 v[252:255], v[36:39], a[164:167], v[252:255]
ds_read_b64_tr_b16 v[30:31], v7 offset:43008
s_waitcnt lgkmcnt(4)
v_mfma_f32_16x16x32_bf16 v[224:227], v[40:43], a[168:171], v[224:227]
ds_read_b64_tr_b16 v[32:33], v8 offset:40960
v_mfma_f32_16x16x32_bf16 v[228:231], v[40:43], a[172:175], v[228:231]
ds_read_b64_tr_b16 v[34:35], v8 offset:43008
s_add_u32 s7, s34, 212992
v_mfma_f32_16x16x32_bf16 v[232:235], v[44:47], a[168:171], v[232:235]
buffer_load_dwordx4 a[224:227], v1, s[8:11], s7 offen offset:0 sc1
ds_read_b64_tr_b16 v[36:37], v9 offset:40960
v_mfma_f32_16x16x32_bf16 v[236:239], v[44:47], a[172:175], v[236:239]
ds_read_b64_tr_b16 v[38:39], v9 offset:43008
v_mfma_f32_16x16x32_bf16 v[240:243], v[120:123], a[168:171], v[240:243]
ds_read_b64_tr_b16 v[40:41], v6 offset:45056
v_mfma_f32_16x16x32_bf16 v[244:247], v[120:123], a[172:175], v[244:247]
ds_read_b64_tr_b16 v[42:43], v6 offset:47104
v_mfma_f32_16x16x32_bf16 v[248:251], v[124:127], a[168:171], v[248:251]
buffer_load_dwordx4 a[228:231], v1, s[8:11], s7 offen offset:1024 sc1
ds_read_b64_tr_b16 v[44:45], v7 offset:45056
v_mfma_f32_16x16x32_bf16 v[252:255], v[124:127], a[172:175], v[252:255]
ds_read_b64_tr_b16 v[46:47], v7 offset:47104
s_waitcnt lgkmcnt(4)
v_mfma_f32_16x16x32_bf16 v[224:227], v[24:27], a[176:179], v[224:227]
ds_read_b64_tr_b16 v[120:121], v8 offset:45056
v_mfma_f32_16x16x32_bf16 v[228:231], v[24:27], a[180:183], v[228:231]
ds_read_b64_tr_b16 v[122:123], v8 offset:47104
v_mfma_f32_16x16x32_bf16 v[232:235], v[28:31], a[176:179], v[232:235]
buffer_load_dwordx4 v5, s[16:19], s6 offen offset:1024 lds
ds_read_b64_tr_b16 v[124:125], v9 offset:45056
v_mfma_f32_16x16x32_bf16 v[236:239], v[28:31], a[180:183], v[236:239]
ds_read_b64_tr_b16 v[126:127], v9 offset:47104
v_mfma_f32_16x16x32_bf16 v[240:243], v[32:35], a[176:179], v[240:243]
v_mfma_f32_16x16x32_bf16 v[244:247], v[32:35], a[180:183], v[244:247]
s_waitcnt vmcnt(21)
s_barrier
v_add_u32 v10, 49152, v10
ds_read_b64_tr_b16 v[24:25], v10 offset:0
ds_read_b64_tr_b16 v[26:27], v10 offset:2048
v_mfma_f32_16x16x32_bf16 v[248:251], v[36:39], a[176:179], v[248:251]
v_add_u32 v11, 49152, v11
ds_read_b64_tr_b16 v[28:29], v11 offset:0
v_mfma_f32_16x16x32_bf16 v[252:255], v[36:39], a[180:183], v[252:255]
ds_read_b64_tr_b16 v[30:31], v11 offset:2048
s_waitcnt lgkmcnt(4)
v_mfma_f32_16x16x32_bf16 v[224:227], v[40:43], a[184:187], v[224:227]
v_add_u32 v12, 49152, v12
ds_read_b64_tr_b16 v[32:33], v12 offset:0
v_mfma_f32_16x16x32_bf16 v[228:231], v[40:43], a[188:191], v[228:231]
ds_read_b64_tr_b16 v[34:35], v12 offset:2048
v_mfma_f32_16x16x32_bf16 v[232:235], v[44:47], a[184:187], v[232:235]
v_add_u32 v13, 49152, v13
ds_read_b64_tr_b16 v[36:37], v13 offset:0
v_mfma_f32_16x16x32_bf16 v[236:239], v[44:47], a[188:191], v[236:239]
ds_read_b64_tr_b16 v[38:39], v13 offset:2048
v_mfma_f32_16x16x32_bf16 v[240:243], v[120:123], a[184:187], v[240:243]
ds_read_b64_tr_b16 v[40:41], v10 offset:4096
s_add_u32 m0, s30, 114688
v_mfma_f32_16x16x32_bf16 v[244:247], v[120:123], a[188:191], v[244:247]
ds_read_b64_tr_b16 v[42:43], v10 offset:6144
s_add_u32 s6, s35, 811264
v_mfma_f32_16x16x32_bf16 v[248:251], v[124:127], a[184:187], v[248:251]
buffer_load_dwordx4 v4, s[16:19], s6 offen offset:0 lds
ds_read_b64_tr_b16 v[44:45], v11 offset:4096
v_mfma_f32_16x16x32_bf16 v[252:255], v[124:127], a[188:191], v[252:255]
ds_read_b64_tr_b16 v[46:47], v11 offset:6144
s_waitcnt lgkmcnt(4)
v_mfma_f32_16x16x32_bf16 v[160:163], v[24:27], a[144:147], v[160:163]
ds_read_b64_tr_b16 v[120:121], v12 offset:4096
v_mfma_f32_16x16x32_bf16 v[168:171], v[24:27], a[148:151], v[168:171]
ds_read_b64_tr_b16 v[122:123], v12 offset:6144
v_mfma_f32_16x16x32_bf16 v[164:167], v[28:31], a[144:147], v[164:167]
buffer_load_dwordx4 v5, s[16:19], s6 offen offset:1024 lds
ds_read_b64_tr_b16 v[124:125], v13 offset:4096
v_mfma_f32_16x16x32_bf16 v[172:175], v[28:31], a[148:151], v[172:175]
ds_read_b64_tr_b16 v[126:127], v13 offset:6144
v_mfma_f32_16x16x32_bf16 v[176:179], v[32:35], a[144:147], v[176:179]
ds_read_b64_tr_b16 v[24:25], v10 offset:8192
v_mfma_f32_16x16x32_bf16 v[184:187], v[32:35], a[148:151], v[184:187]
ds_read_b64_tr_b16 v[26:27], v10 offset:10240
v_mfma_f32_16x16x32_bf16 v[180:183], v[36:39], a[144:147], v[180:183]
buffer_load_dwordx4 a[232:235], v1, s[8:11], s7 offen offset:2048 sc1
ds_read_b64_tr_b16 v[28:29], v11 offset:8192
v_mfma_f32_16x16x32_bf16 v[188:191], v[36:39], a[148:151], v[188:191]
ds_read_b64_tr_b16 v[30:31], v11 offset:10240
s_waitcnt lgkmcnt(4)
v_mfma_f32_16x16x32_bf16 v[160:163], v[40:43], a[152:155], v[160:163]
ds_read_b64_tr_b16 v[32:33], v12 offset:8192
v_mfma_f32_16x16x32_bf16 v[168:171], v[40:43], a[156:159], v[168:171]
ds_read_b64_tr_b16 v[34:35], v12 offset:10240
v_mfma_f32_16x16x32_bf16 v[164:167], v[44:47], a[152:155], v[164:167]
buffer_load_dwordx4 a[236:239], v1, s[8:11], s7 offen offset:3072 sc1
ds_read_b64_tr_b16 v[36:37], v13 offset:8192
v_mfma_f32_16x16x32_bf16 v[172:175], v[44:47], a[156:159], v[172:175]
ds_read_b64_tr_b16 v[38:39], v13 offset:10240
v_mfma_f32_16x16x32_bf16 v[176:179], v[120:123], a[152:155], v[176:179]
ds_read_b64_tr_b16 v[40:41], v10 offset:12288
s_add_u32 m0, s30, 122880
v_mfma_f32_16x16x32_bf16 v[184:187], v[120:123], a[156:159], v[184:187]
ds_read_b64_tr_b16 v[42:43], v10 offset:14336
s_add_u32 s6, s55, 147456
v_mfma_f32_16x16x32_bf16 v[180:183], v[124:127], a[152:155], v[180:183]
buffer_load_dwordx4 v4, s[16:19], s6 offen offset:0 lds
ds_read_b64_tr_b16 v[44:45], v11 offset:12288
v_mfma_f32_16x16x32_bf16 v[188:191], v[124:127], a[156:159], v[188:191]
ds_read_b64_tr_b16 v[46:47], v11 offset:14336
s_waitcnt lgkmcnt(4)
v_mfma_f32_16x16x32_bf16 v[160:163], v[24:27], a[160:163], v[160:163]
ds_read_b64_tr_b16 v[120:121], v12 offset:12288
v_mfma_f32_16x16x32_bf16 v[168:171], v[24:27], a[164:167], v[168:171]
ds_read_b64_tr_b16 v[122:123], v12 offset:14336
v_mfma_f32_16x16x32_bf16 v[164:167], v[28:31], a[160:163], v[164:167]
buffer_load_dwordx4 v5, s[16:19], s6 offen offset:1024 lds
ds_read_b64_tr_b16 v[124:125], v13 offset:12288
v_mfma_f32_16x16x32_bf16 v[172:175], v[28:31], a[164:167], v[172:175]
ds_read_b64_tr_b16 v[126:127], v13 offset:14336
v_mfma_f32_16x16x32_bf16 v[176:179], v[32:35], a[160:163], v[176:179]
ds_read_b64_tr_b16 v[24:25], v10 offset:16384
s_add_u32 m0, s30, 131072
v_mfma_f32_16x16x32_bf16 v[184:187], v[32:35], a[164:167], v[184:187]
ds_read_b64_tr_b16 v[26:27], v10 offset:18432
s_add_u32 s6, s55, 516096
v_mfma_f32_16x16x32_bf16 v[180:183], v[36:39], a[160:163], v[180:183]
buffer_load_dwordx4 v4, s[16:19], s6 offen offset:0 lds
ds_read_b64_tr_b16 v[28:29], v11 offset:16384
v_mfma_f32_16x16x32_bf16 v[188:191], v[36:39], a[164:167], v[188:191]
ds_read_b64_tr_b16 v[30:31], v11 offset:18432
s_waitcnt lgkmcnt(4)
v_mfma_f32_16x16x32_bf16 v[160:163], v[40:43], a[168:171], v[160:163]
ds_read_b64_tr_b16 v[32:33], v12 offset:16384
v_mfma_f32_16x16x32_bf16 v[168:171], v[40:43], a[172:175], v[168:171]
ds_read_b64_tr_b16 v[34:35], v12 offset:18432
v_mfma_f32_16x16x32_bf16 v[164:167], v[44:47], a[168:171], v[164:167]
buffer_load_dwordx4 v5, s[16:19], s6 offen offset:1024 lds
ds_read_b64_tr_b16 v[36:37], v13 offset:16384
v_mfma_f32_16x16x32_bf16 v[172:175], v[44:47], a[172:175], v[172:175]
ds_read_b64_tr_b16 v[38:39], v13 offset:18432
v_mfma_f32_16x16x32_bf16 v[176:179], v[120:123], a[168:171], v[176:179]
ds_read_b64_tr_b16 v[40:41], v10 offset:20480
s_add_u32 m0, s30, 139264
v_mfma_f32_16x16x32_bf16 v[184:187], v[120:123], a[172:175], v[184:187]
ds_read_b64_tr_b16 v[42:43], v10 offset:22528
s_add_u32 s6, s55, 884736
v_mfma_f32_16x16x32_bf16 v[180:183], v[124:127], a[168:171], v[180:183]
buffer_load_dwordx4 v4, s[16:19], s6 offen offset:0 lds
ds_read_b64_tr_b16 v[44:45], v11 offset:20480
v_mfma_f32_16x16x32_bf16 v[188:191], v[124:127], a[172:175], v[188:191]
ds_read_b64_tr_b16 v[46:47], v11 offset:22528
s_waitcnt lgkmcnt(4)
v_mfma_f32_16x16x32_bf16 v[160:163], v[24:27], a[176:179], v[160:163]
ds_read_b64_tr_b16 v[120:121], v12 offset:20480
v_mfma_f32_16x16x32_bf16 v[168:171], v[24:27], a[180:183], v[168:171]
ds_read_b64_tr_b16 v[122:123], v12 offset:22528
v_mfma_f32_16x16x32_bf16 v[164:167], v[28:31], a[176:179], v[164:167]
buffer_load_dwordx4 v5, s[16:19], s6 offen offset:1024 lds
ds_read_b64_tr_b16 v[124:125], v13 offset:20480
v_mfma_f32_16x16x32_bf16 v[172:175], v[28:31], a[180:183], v[172:175]
ds_read_b64_tr_b16 v[126:127], v13 offset:22528
v_mfma_f32_16x16x32_bf16 v[176:179], v[32:35], a[176:179], v[176:179]
v_mfma_f32_16x16x32_bf16 v[184:187], v[32:35], a[180:183], v[184:187]
s_waitcnt vmcnt(25)
s_barrier
ds_read_b64_tr_b16 v[24:25], v10 offset:24576
ds_read_b64_tr_b16 v[26:27], v10 offset:26624
s_add_u32 m0, s30, 0
s_add_u32 s6, s35, 147712
v_mfma_f32_16x16x32_bf16 v[180:183], v[36:39], a[176:179], v[180:183]
buffer_load_dwordx4 v4, s[16:19], s6 offen offset:0 lds
ds_read_b64_tr_b16 v[28:29], v11 offset:24576
v_mfma_f32_16x16x32_bf16 v[188:191], v[36:39], a[180:183], v[188:191]
ds_read_b64_tr_b16 v[30:31], v11 offset:26624
s_waitcnt lgkmcnt(4)
v_mfma_f32_16x16x32_bf16 v[160:163], v[40:43], a[184:187], v[160:163]
ds_read_b64_tr_b16 v[32:33], v12 offset:24576
v_mfma_f32_16x16x32_bf16 v[168:171], v[40:43], a[188:191], v[168:171]
ds_read_b64_tr_b16 v[34:35], v12 offset:26624
v_mfma_f32_16x16x32_bf16 v[164:167], v[44:47], a[184:187], v[164:167]
buffer_load_dwordx4 v5, s[16:19], s6 offen offset:1024 lds
ds_read_b64_tr_b16 v[36:37], v13 offset:24576
v_mfma_f32_16x16x32_bf16 v[172:175], v[44:47], a[188:191], v[172:175]
ds_read_b64_tr_b16 v[38:39], v13 offset:26624
v_mfma_f32_16x16x32_bf16 v[176:179], v[120:123], a[184:187], v[176:179]
ds_read_b64_tr_b16 v[40:41], v10 offset:28672
s_add_u32 m0, s30, 8192
v_mfma_f32_16x16x32_bf16 v[184:187], v[120:123], a[188:191], v[184:187]
ds_read_b64_tr_b16 v[42:43], v10 offset:30720
s_add_u32 s6, s35, 516352
v_mfma_f32_16x16x32_bf16 v[180:183], v[124:127], a[184:187], v[180:183]
buffer_load_dwordx4 v4, s[16:19], s6 offen offset:0 lds
ds_read_b64_tr_b16 v[44:45], v11 offset:28672
v_mfma_f32_16x16x32_bf16 v[188:191], v[124:127], a[188:191], v[188:191]
ds_read_b64_tr_b16 v[46:47], v11 offset:30720
s_waitcnt vmcnt(22)
s_waitcnt lgkmcnt(4)
v_mfma_f32_16x16x32_bf16 v[192:195], v[24:27], a[192:195], v[192:195]
ds_read_b64_tr_b16 v[120:121], v12 offset:28672
v_mfma_f32_16x16x32_bf16 v[200:203], v[24:27], a[196:199], v[200:203]
ds_read_b64_tr_b16 v[122:123], v12 offset:30720
v_mfma_f32_16x16x32_bf16 v[196:199], v[28:31], a[192:195], v[196:199]
ds_read_b64_tr_b16 v[124:125], v13 offset:28672
v_mfma_f32_16x16x32_bf16 v[204:207], v[28:31], a[196:199], v[204:207]
ds_read_b64_tr_b16 v[126:127], v13 offset:30720
v_mfma_f32_16x16x32_bf16 v[208:211], v[32:35], a[192:195], v[208:211]
ds_read_b64_tr_b16 v[24:25], v10 offset:32768
v_mfma_f32_16x16x32_bf16 v[216:219], v[32:35], a[196:199], v[216:219]
ds_read_b64_tr_b16 v[26:27], v10 offset:34816
v_mfma_f32_16x16x32_bf16 v[212:215], v[36:39], a[192:195], v[212:215]
ds_read_b64_tr_b16 v[28:29], v11 offset:32768
v_mfma_f32_16x16x32_bf16 v[220:223], v[36:39], a[196:199], v[220:223]
ds_read_b64_tr_b16 v[30:31], v11 offset:34816
s_waitcnt vmcnt(20)
s_waitcnt lgkmcnt(4)
v_mfma_f32_16x16x32_bf16 v[192:195], v[40:43], a[200:203], v[192:195]
ds_read_b64_tr_b16 v[32:33], v12 offset:32768
v_mfma_f32_16x16x32_bf16 v[200:203], v[40:43], a[204:207], v[200:203]
ds_read_b64_tr_b16 v[34:35], v12 offset:34816
v_mfma_f32_16x16x32_bf16 v[196:199], v[44:47], a[200:203], v[196:199]
buffer_load_dwordx4 v5, s[16:19], s6 offen offset:1024 lds
ds_read_b64_tr_b16 v[36:37], v13 offset:32768
v_mfma_f32_16x16x32_bf16 v[204:207], v[44:47], a[204:207], v[204:207]
ds_read_b64_tr_b16 v[38:39], v13 offset:34816
v_mfma_f32_16x16x32_bf16 v[208:211], v[120:123], a[200:203], v[208:211]
ds_read_b64_tr_b16 v[40:41], v10 offset:36864
s_add_u32 m0, s30, 16384
v_mfma_f32_16x16x32_bf16 v[216:219], v[120:123], a[204:207], v[216:219]
ds_read_b64_tr_b16 v[42:43], v10 offset:38912
s_add_u32 s6, s35, 884992
v_mfma_f32_16x16x32_bf16 v[212:215], v[124:127], a[200:203], v[212:215]
buffer_load_dwordx4 v4, s[16:19], s6 offen offset:0 lds
ds_read_b64_tr_b16 v[44:45], v11 offset:36864
s_load_dwordx4 s[56:59], s[8:9], s36 offset:384 glc
v_mfma_f32_16x16x32_bf16 v[220:223], v[124:127], a[204:207], v[220:223]
ds_read_b64_tr_b16 v[46:47], v11 offset:38912
s_waitcnt vmcnt(20)
s_waitcnt lgkmcnt(4)
v_mfma_f32_16x16x32_bf16 v[192:195], v[24:27], a[208:211], v[192:195]
ds_read_b64_tr_b16 v[120:121], v12 offset:36864
v_mfma_f32_16x16x32_bf16 v[200:203], v[24:27], a[212:215], v[200:203]
ds_read_b64_tr_b16 v[122:123], v12 offset:38912
v_mfma_f32_16x16x32_bf16 v[196:199], v[28:31], a[208:211], v[196:199]
buffer_load_dwordx4 v5, s[16:19], s6 offen offset:1024 lds
ds_read_b64_tr_b16 v[124:125], v13 offset:36864
v_mfma_f32_16x16x32_bf16 v[204:207], v[28:31], a[212:215], v[204:207]
ds_read_b64_tr_b16 v[126:127], v13 offset:38912
v_mfma_f32_16x16x32_bf16 v[208:211], v[32:35], a[208:211], v[208:211]
ds_read_b64_tr_b16 v[24:25], v10 offset:40960
s_add_u32 m0, s30, 24576
v_mfma_f32_16x16x32_bf16 v[216:219], v[32:35], a[212:215], v[216:219]
ds_read_b64_tr_b16 v[26:27], v10 offset:43008
s_add_u32 s6, s54, 73728
v_mfma_f32_16x16x32_bf16 v[212:215], v[36:39], a[208:211], v[212:215]
buffer_load_dwordx4 v4, s[16:19], s6 offen offset:0 lds
ds_read_b64_tr_b16 v[28:29], v11 offset:40960
v_mfma_f32_16x16x32_bf16 v[220:223], v[36:39], a[212:215], v[220:223]
ds_read_b64_tr_b16 v[30:31], v11 offset:43008
s_waitcnt vmcnt(20)
s_waitcnt lgkmcnt(4)
v_mfma_f32_16x16x32_bf16 v[192:195], v[40:43], a[216:219], v[192:195]
ds_read_b64_tr_b16 v[32:33], v12 offset:40960
v_mfma_f32_16x16x32_bf16 v[200:203], v[40:43], a[220:223], v[200:203]
ds_read_b64_tr_b16 v[34:35], v12 offset:43008
v_mfma_f32_16x16x32_bf16 v[196:199], v[44:47], a[216:219], v[196:199]
buffer_load_dwordx4 v5, s[16:19], s6 offen offset:1024 lds
ds_read_b64_tr_b16 v[36:37], v13 offset:40960
v_mfma_f32_16x16x32_bf16 v[204:207], v[44:47], a[220:223], v[204:207]
ds_read_b64_tr_b16 v[38:39], v13 offset:43008
v_mfma_f32_16x16x32_bf16 v[208:211], v[120:123], a[216:219], v[208:211]
ds_read_b64_tr_b16 v[40:41], v10 offset:45056
s_add_u32 m0, s30, 32768
v_mfma_f32_16x16x32_bf16 v[216:219], v[120:123], a[220:223], v[216:219]
ds_read_b64_tr_b16 v[42:43], v10 offset:47104
s_add_u32 s6, s54, 442368
v_mfma_f32_16x16x32_bf16 v[212:215], v[124:127], a[216:219], v[212:215]
buffer_load_dwordx4 v4, s[16:19], s6 offen offset:0 lds
ds_read_b64_tr_b16 v[44:45], v11 offset:45056
v_mfma_f32_16x16x32_bf16 v[220:223], v[124:127], a[220:223], v[220:223]
ds_read_b64_tr_b16 v[46:47], v11 offset:47104
s_waitcnt vmcnt(20)
s_waitcnt lgkmcnt(4)
v_mfma_f32_16x16x32_bf16 v[192:195], v[24:27], a[224:227], v[192:195]
ds_read_b64_tr_b16 v[120:121], v12 offset:45056
v_mfma_f32_16x16x32_bf16 v[200:203], v[24:27], a[228:231], v[200:203]
ds_read_b64_tr_b16 v[122:123], v12 offset:47104
v_mfma_f32_16x16x32_bf16 v[196:199], v[28:31], a[224:227], v[196:199]
buffer_load_dwordx4 v5, s[16:19], s6 offen offset:1024 lds
ds_read_b64_tr_b16 v[124:125], v13 offset:45056
v_mfma_f32_16x16x32_bf16 v[204:207], v[28:31], a[228:231], v[204:207]
ds_read_b64_tr_b16 v[126:127], v13 offset:47104
v_mfma_f32_16x16x32_bf16 v[208:211], v[32:35], a[224:227], v[208:211]
v_mfma_f32_16x16x32_bf16 v[216:219], v[32:35], a[228:231], v[216:219]
s_waitcnt vmcnt(18)
s_barrier
v_add_u32 v6, 98304, v6
ds_read_b64_tr_b16 v[24:25], v6 offset:0
ds_read_b64_tr_b16 v[26:27], v6 offset:2048
s_add_u32 m0, s30, 40960
s_add_u32 s6, s54, 811008
v_mfma_f32_16x16x32_bf16 v[212:215], v[36:39], a[224:227], v[212:215]
buffer_load_dwordx4 v4, s[16:19], s6 offen offset:0 lds
v_add_u32 v7, 98304, v7
ds_read_b64_tr_b16 v[28:29], v7 offset:0
v_mfma_f32_16x16x32_bf16 v[220:223], v[36:39], a[228:231], v[220:223]
ds_read_b64_tr_b16 v[30:31], v7 offset:2048
s_waitcnt vmcnt(17)
s_waitcnt lgkmcnt(4)
v_mfma_f32_16x16x32_bf16 v[192:195], v[40:43], a[232:235], v[192:195]
v_add_u32 v8, 98304, v8
ds_read_b64_tr_b16 v[32:33], v8 offset:0
v_mfma_f32_16x16x32_bf16 v[200:203], v[40:43], a[236:239], v[200:203]
ds_read_b64_tr_b16 v[34:35], v8 offset:2048
v_mfma_f32_16x16x32_bf16 v[196:199], v[44:47], a[232:235], v[196:199]
buffer_load_dwordx4 v5, s[16:19], s6 offen offset:1024 lds
v_add_u32 v9, 98304, v9
ds_read_b64_tr_b16 v[36:37], v9 offset:0
v_mfma_f32_16x16x32_bf16 v[204:207], v[44:47], a[236:239], v[204:207]
ds_read_b64_tr_b16 v[38:39], v9 offset:2048
v_mfma_f32_16x16x32_bf16 v[208:211], v[120:123], a[232:235], v[208:211]
ds_read_b64_tr_b16 v[40:41], v6 offset:4096
v_mfma_f32_16x16x32_bf16 v[216:219], v[120:123], a[236:239], v[216:219]
ds_read_b64_tr_b16 v[42:43], v6 offset:6144
v_mfma_f32_16x16x32_bf16 v[212:215], v[124:127], a[232:235], v[212:215]
buffer_load_dwordx4 v[128:131], v1, s[8:11], s25 offen offset:0 sc1
ds_read_b64_tr_b16 v[44:45], v7 offset:4096
v_mfma_f32_16x16x32_bf16 v[220:223], v[124:127], a[236:239], v[220:223]
ds_read_b64_tr_b16 v[46:47], v7 offset:6144
s_waitcnt lgkmcnt(0)
v_mfma_f32_16x16x32_bf16 v[224:227], v[24:27], a[192:195], v[224:227]
ds_read_b64_tr_b16 v[120:121], v8 offset:4096
s_xor_b64 s[56:57], s[56:57], s[0:1]
s_xor_b32 s58, s58, s0
s_or_b32 s57, s57, s58
v_mfma_f32_16x16x32_bf16 v[228:231], v[24:27], a[196:199], v[228:231]
ds_read_b64_tr_b16 v[122:123], v8 offset:6144
s_or_b32 s56, s56, s57
s_cbranch_scc1 K3C_slow3
K3C_back3:
s_add_u32 s7, s34, 32768
v_mfma_f32_16x16x32_bf16 v[232:235], v[28:31], a[192:195], v[232:235]
buffer_load_dwordx4 a[240:243], v1, s[8:11], s7 offen offset:0 sc1
ds_read_b64_tr_b16 v[124:125], v9 offset:4096
v_mfma_f32_16x16x32_bf16 v[236:239], v[28:31], a[196:199], v[236:239]
ds_read_b64_tr_b16 v[126:127], v9 offset:6144
v_mfma_f32_16x16x32_bf16 v[240:243], v[32:35], a[192:195], v[240:243]
ds_read_b64_tr_b16 v[24:25], v6 offset:8192
v_mfma_f32_16x16x32_bf16 v[244:247], v[32:35], a[196:199], v[244:247]
ds_read_b64_tr_b16 v[26:27], v6 offset:10240
v_mfma_f32_16x16x32_bf16 v[248:251], v[36:39], a[192:195], v[248:251]
buffer_load_dwordx4 a[244:247], v1, s[8:11], s7 offen offset:1024 sc1
ds_read_b64_tr_b16 v[28:29], v7 offset:8192
v_mfma_f32_16x16x32_bf16 v[252:255], v[36:39], a[196:199], v[252:255]
ds_read_b64_tr_b16 v[30:31], v7 offset:10240
s_waitcnt lgkmcnt(4)
v_mfma_f32_16x16x32_bf16 v[224:227], v[40:43], a[200:203], v[224:227]
ds_read_b64_tr_b16 v[32:33], v8 offset:8192
v_mfma_f32_16x16x32_bf16 v[228:231], v[40:43], a[204:207], v[228:231]
ds_read_b64_tr_b16 v[34:35], v8 offset:10240
v_mfma_f32_16x16x32_bf16 v[232:235], v[44:47], a[200:203], v[232:235]
buffer_load_dwordx4 a[248:251], v1, s[8:11], s7 offen offset:2048 sc1
ds_read_b64_tr_b16 v[36:37], v9 offset:8192
v_mfma_f32_16x16x32_bf16 v[236:239], v[44:47], a[204:207], v[236:239]
ds_read_b64_tr_b16 v[38:39], v9 offset:10240
v_mfma_f32_16x16x32_bf16 v[240:243], v[120:123], a[200:203], v[240:243]
ds_read_b64_tr_b16 v[40:41], v6 offset:12288
v_mfma_f32_16x16x32_bf16 v[244:247], v[120:123], a[204:207], v[244:247]
ds_read_b64_tr_b16 v[42:43], v6 offset:14336
v_mfma_f32_16x16x32_bf16 v[248:251], v[124:127], a[200:203], v[248:251]
buffer_load_dwordx4 a[252:255], v1, s[8:11], s7 offen offset:3072 sc1
ds_read_b64_tr_b16 v[44:45], v7 offset:12288
v_mfma_f32_16x16x32_bf16 v[252:255], v[124:127], a[204:207], v[252:255]
ds_read_b64_tr_b16 v[46:47], v7 offset:14336
s_waitcnt lgkmcnt(4)
v_mfma_f32_16x16x32_bf16 v[224:227], v[24:27], a[208:211], v[224:227]
ds_read_b64_tr_b16 v[120:121], v8 offset:12288
v_mfma_f32_16x16x32_bf16 v[228:231], v[24:27], a[212:215], v[228:231]
ds_read_b64_tr_b16 v[122:123], v8 offset:14336
s_add_u32 s7, s34, 131072
v_mfma_f32_16x16x32_bf16 v[232:235], v[28:31], a[208:211], v[232:235]
buffer_load_dwordx4 a[0:3], v1, s[8:11], s7 offen offset:0 sc1
ds_read_b64_tr_b16 v[124:125], v9 offset:12288
v_mfma_f32_16x16x32_bf16 v[236:239], v[28:31], a[212:215], v[236:239]
ds_read_b64_tr_b16 v[126:127], v9 offset:14336
v_mfma_f32_16x16x32_bf16 v[240:243], v[32:35], a[208:211], v[240:243]
ds_read_b64_tr_b16 v[24:25], v6 offset:16384
v_mfma_f32_16x16x32_bf16 v[244:247], v[32:35], a[212:215], v[244:247]
ds_read_b64_tr_b16 v[26:27], v6 offset:18432
v_mfma_f32_16x16x32_bf16 v[248:251], v[36:39], a[208:211], v[248:251]
buffer_load_dwordx4 a[4:7], v1, s[8:11], s7 offen offset:1024 sc1
ds_read_b64_tr_b16 v[28:29], v7 offset:16384
v_mfma_f32_16x16x32_bf16 v[252:255], v[36:39], a[212:215], v[252:255]
ds_read_b64_tr_b16 v[30:31], v7 offset:18432
s_waitcnt lgkmcnt(4)
v_mfma_f32_16x16x32_bf16 v[224:227], v[40:43], a[216:219], v[224:227]
ds_read_b64_tr_b16 v[32:33], v8 offset:16384
v_mfma_f32_16x16x32_bf16 v[228:231], v[40:43], a[220:223], v[228:231]
ds_read_b64_tr_b16 v[34:35], v8 offset:18432
v_mfma_f32_16x16x32_bf16 v[232:235], v[44:47], a[216:219], v[232:235]
buffer_load_dwordx4 a[8:11], v1, s[8:11], s7 offen offset:2048 sc1
ds_read_b64_tr_b16 v[36:37], v9 offset:16384
v_mfma_f32_16x16x32_bf16 v[236:239], v[44:47], a[220:223], v[236:239]
ds_read_b64_tr_b16 v[38:39], v9 offset:18432
v_mfma_f32_16x16x32_bf16 v[240:243], v[120:123], a[216:219], v[240:243]
ds_read_b64_tr_b16 v[40:41], v6 offset:20480
v_mfma_f32_16x16x32_bf16 v[244:247], v[120:123], a[220:223], v[244:247]
ds_read_b64_tr_b16 v[42:43], v6 offset:22528
v_mfma_f32_16x16x32_bf16 v[248:251], v[124:127], a[216:219], v[248:251]
buffer_load_dwordx4 a[12:15], v1, s[8:11], s7 offen offset:3072 sc1
ds_read_b64_tr_b16 v[44:45], v7 offset:20480
v_mfma_f32_16x16x32_bf16 v[252:255], v[124:127], a[220:223], v[252:255]
ds_read_b64_tr_b16 v[46:47], v7 offset:22528
s_waitcnt lgkmcnt(4)
v_mfma_f32_16x16x32_bf16 v[224:227], v[24:27], a[224:227], v[224:227]
ds_read_b64_tr_b16 v[120:121], v8 offset:20480
v_mfma_f32_16x16x32_bf16 v[228:231], v[24:27], a[228:231], v[228:231]
ds_read_b64_tr_b16 v[122:123], v8 offset:22528
s_add_u32 s7, s34, 229376
v_mfma_f32_16x16x32_bf16 v[232:235], v[28:31], a[224:227], v[232:235]
buffer_load_dwordx4 a[16:19], v1, s[8:11], s7 offen offset:0 sc1
ds_read_b64_tr_b16 v[124:125], v9 offset:20480
v_mfma_f32_16x16x32_bf16 v[236:239], v[28:31], a[228:231], v[236:239]
ds_read_b64_tr_b16 v[126:127], v9 offset:22528
v_mfma_f32_16x16x32_bf16 v[240:243], v[32:35], a[224:227], v[240:243]
v_mfma_f32_16x16x32_bf16 v[244:247], v[32:35], a[228:231], v[244:247]
s_waitcnt vmcnt(22)
s_barrier
v_add_u32 v10, 49152, v10
ds_read_b64_tr_b16 v[24:25], v10 offset:24576
ds_read_b64_tr_b16 v[26:27], v10 offset:26624
v_mfma_f32_16x16x32_bf16 v[248:251], v[36:39], a[224:227], v[248:251]
buffer_load_dwordx4 a[20:23], v1, s[8:11], s7 offen offset:1024 sc1
v_add_u32 v11, 49152, v11
ds_read_b64_tr_b16 v[28:29], v11 offset:24576
v_mfma_f32_16x16x32_bf16 v[252:255], v[36:39], a[228:231], v[252:255]
ds_read_b64_tr_b16 v[30:31], v11 offset:26624
s_waitcnt lgkmcnt(4)
v_mfma_f32_16x16x32_bf16 v[224:227], v[40:43], a[232:235], v[224:227]
v_add_u32 v12, 49152, v12
ds_read_b64_tr_b16 v[32:33], v12 offset:24576
v_mfma_f32_16x16x32_bf16 v[228:231], v[40:43], a[236:239], v[228:231]
ds_read_b64_tr_b16 v[34:35], v12 offset:26624
v_mfma_f32_16x16x32_bf16 v[232:235], v[44:47], a[232:235], v[232:235]
v_add_u32 v13, 49152, v13
s_branch PGC_5
.p2align 12
PSC_5:
s_setpc_b64 s[62:63]
PGC_5:
ds_read_b64_tr_b16 v[36:37], v13 offset:24576
v_mfma_f32_16x16x32_bf16 v[236:239], v[44:47], a[236:239], v[236:239]
ds_read_b64_tr_b16 v[38:39], v13 offset:26624
v_mfma_f32_16x16x32_bf16 v[240:243], v[120:123], a[232:235], v[240:243]
ds_read_b64_tr_b16 v[40:41], v10 offset:28672
v_mfma_f32_16x16x32_bf16 v[244:247], v[120:123], a[236:239], v[244:247]
ds_read_b64_tr_b16 v[42:43], v10 offset:30720
v_mfma_f32_16x16x32_bf16 v[248:251], v[124:127], a[232:235], v[248:251]
ds_read_b64_tr_b16 v[44:45], v11 offset:28672
v_mfma_f32_16x16x32_bf16 v[252:255], v[124:127], a[236:239], v[252:255]
ds_read_b64_tr_b16 v[46:47], v11 offset:30720
s_waitcnt vmcnt(8)
s_waitcnt lgkmcnt(4)
v_mfma_f32_16x16x32_bf16 v[192:195], v[24:27], a[240:243], v[192:195]
ds_read_b64_tr_b16 v[120:121], v12 offset:28672
v_mfma_f32_16x16x32_bf16 v[200:203], v[24:27], a[244:247], v[200:203]
ds_read_b64_tr_b16 v[122:123], v12 offset:30720
v_mfma_f32_16x16x32_bf16 v[196:199], v[28:31], a[240:243], v[196:199]
buffer_load_dwordx4 a[24:27], v1, s[8:11], s7 offen offset:2048 sc1
ds_read_b64_tr_b16 v[124:125], v13 offset:28672
v_mfma_f32_16x16x32_bf16 v[204:207], v[28:31], a[244:247], v[204:207]
ds_read_b64_tr_b16 v[126:127], v13 offset:30720
v_mfma_f32_16x16x32_bf16 v[208:211], v[32:35], a[240:243], v[208:211]
buffer_load_dwordx4 a[28:31], v1, s[8:11], s7 offen offset:3072 sc1
ds_read_b64_tr_b16 v[24:25], v10 offset:32768
v_mfma_f32_16x16x32_bf16 v[216:219], v[32:35], a[244:247], v[216:219]
ds_read_b64_tr_b16 v[26:27], v10 offset:34816
v_mfma_f32_16x16x32_bf16 v[212:215], v[36:39], a[240:243], v[212:215]
ds_read_b64_tr_b16 v[28:29], v11 offset:32768
v_mfma_f32_16x16x32_bf16 v[220:223], v[36:39], a[244:247], v[220:223]
ds_read_b64_tr_b16 v[30:31], v11 offset:34816
s_waitcnt vmcnt(8)
s_waitcnt lgkmcnt(4)
v_mfma_f32_16x16x32_bf16 v[192:195], v[40:43], a[248:251], v[192:195]
global_load_dwordx2 v[140:141], v20, s[4:5] offset:0
ds_read_b64_tr_b16 v[32:33], v12 offset:32768
v_mfma_f32_16x16x32_bf16 v[200:203], v[40:43], a[252:255], v[200:203]
ds_read_b64_tr_b16 v[34:35], v12 offset:34816
v_mfma_f32_16x16x32_bf16 v[196:199], v[44:47], a[248:251], v[196:199]
ds_read_b64_tr_b16 v[36:37], v13 offset:32768
v_mfma_f32_16x16x32_bf16 v[204:207], v[44:47], a[252:255], v[204:207]
ds_read_b64_tr_b16 v[38:39], v13 offset:34816
v_mfma_f32_16x16x32_bf16 v[208:211], v[120:123], a[248:251], v[208:211]
buffer_load_dwordx4 v[132:135], v1, s[8:11], s25 offen offset:1024 sc1
ds_read_b64_tr_b16 v[40:41], v10 offset:36864
v_mfma_f32_16x16x32_bf16 v[216:219], v[120:123], a[252:255], v[216:219]
ds_read_b64_tr_b16 v[42:43], v10 offset:38912
v_mfma_f32_16x16x32_bf16 v[212:215], v[124:127], a[248:251], v[212:215]
ds_read_b64_tr_b16 v[44:45], v11 offset:36864
v_mfma_f32_16x16x32_bf16 v[220:223], v[124:127], a[252:255], v[220:223]
ds_read_b64_tr_b16 v[46:47], v11 offset:38912
s_waitcnt vmcnt(8)
s_waitcnt lgkmcnt(4)
v_mfma_f32_16x16x32_bf16 v[192:195], v[24:27], a[0:3], v[192:195]
global_load_dwordx2 v[142:143], v20, s[4:5] offset:32
ds_read_b64_tr_b16 v[120:121], v12 offset:36864
v_mfma_f32_16x16x32_bf16 v[200:203], v[24:27], a[4:7], v[200:203]
ds_read_b64_tr_b16 v[122:123], v12 offset:38912
v_mfma_f32_16x16x32_bf16 v[196:199], v[28:31], a[0:3], v[196:199]
ds_read_b64_tr_b16 v[124:125], v13 offset:36864
v_mfma_f32_16x16x32_bf16 v[204:207], v[28:31], a[4:7], v[204:207]
ds_read_b64_tr_b16 v[126:127], v13 offset:38912
v_mfma_f32_16x16x32_bf16 v[208:211], v[32:35], a[0:3], v[208:211]
buffer_load_dwordx4 v[136:139], v1, s[8:11], s26 offen offset:0 sc1
ds_read_b64_tr_b16 v[24:25], v10 offset:40960
v_mfma_f32_16x16x32_bf16 v[216:219], v[32:35], a[4:7], v[216:219]
ds_read_b64_tr_b16 v[26:27], v10 offset:43008
v_mfma_f32_16x16x32_bf16 v[212:215], v[36:39], a[0:3], v[212:215]
ds_read_b64_tr_b16 v[28:29], v11 offset:40960
v_mfma_f32_16x16x32_bf16 v[220:223], v[36:39], a[4:7], v[220:223]
ds_read_b64_tr_b16 v[30:31], v11 offset:43008
s_waitcnt vmcnt(8)
s_waitcnt lgkmcnt(4)
v_mfma_f32_16x16x32_bf16 v[192:195], v[40:43], a[8:11], v[192:195]
global_load_dwordx2 v[144:145], v21, s[4:5] offset:0
ds_read_b64_tr_b16 v[32:33], v12 offset:40960
v_mfma_f32_16x16x32_bf16 v[200:203], v[40:43], a[12:15], v[200:203]
ds_read_b64_tr_b16 v[34:35], v12 offset:43008
v_mfma_f32_16x16x32_bf16 v[196:199], v[44:47], a[8:11], v[196:199]
ds_read_b64_tr_b16 v[36:37], v13 offset:40960
s_add_u32 m0, s30, 49152
v_mfma_f32_16x16x32_bf16 v[204:207], v[44:47], a[12:15], v[204:207]
ds_read_b64_tr_b16 v[38:39], v13 offset:43008
s_add_u32 s6, s55, 221184
v_mfma_f32_16x16x32_bf16 v[208:211], v[120:123], a[8:11], v[208:211]
buffer_load_dwordx4 v4, s[16:19], s6 offen offset:0 lds
ds_read_b64_tr_b16 v[40:41], v10 offset:45056
v_mfma_f32_16x16x32_bf16 v[216:219], v[120:123], a[12:15], v[216:219]
ds_read_b64_tr_b16 v[42:43], v10 offset:47104
v_mfma_f32_16x16x32_bf16 v[212:215], v[124:127], a[8:11], v[212:215]
ds_read_b64_tr_b16 v[44:45], v11 offset:45056
v_mfma_f32_16x16x32_bf16 v[220:223], v[124:127], a[12:15], v[220:223]
ds_read_b64_tr_b16 v[46:47], v11 offset:47104
s_waitcnt vmcnt(8)
s_waitcnt lgkmcnt(4)
v_mfma_f32_16x16x32_bf16 v[192:195], v[24:27], a[16:19], v[192:195]
buffer_load_dwordx4 v5, s[16:19], s6 offen offset:1024 lds
ds_read_b64_tr_b16 v[120:121], v12 offset:45056
v_mfma_f32_16x16x32_bf16 v[200:203], v[24:27], a[20:23], v[200:203]
ds_read_b64_tr_b16 v[122:123], v12 offset:47104
v_mfma_f32_16x16x32_bf16 v[196:199], v[28:31], a[16:19], v[196:199]
ds_read_b64_tr_b16 v[124:125], v13 offset:45056
s_add_u32 m0, s30, 57344
v_mfma_f32_16x16x32_bf16 v[204:207], v[28:31], a[20:23], v[204:207]
ds_read_b64_tr_b16 v[126:127], v13 offset:47104
s_add_u32 s6, s55, 589824
v_mfma_f32_16x16x32_bf16 v[208:211], v[32:35], a[16:19], v[208:211]
v_mfma_f32_16x16x32_bf16 v[216:219], v[32:35], a[20:23], v[216:219]
s_barrier
buffer_load_dwordx4 v4, s[16:19], s6 offen offset:0 lds
v_add_u32 v6, 4294868992, v6
ds_read_b64_tr_b16 v[24:25], v6 offset:0
ds_read_b64_tr_b16 v[26:27], v6 offset:2048
v_mfma_f32_16x16x32_bf16 v[212:215], v[36:39], a[16:19], v[212:215]
v_add_u32 v7, 4294868992, v7
ds_read_b64_tr_b16 v[28:29], v7 offset:0
v_mfma_f32_16x16x32_bf16 v[220:223], v[36:39], a[20:23], v[220:223]
ds_read_b64_tr_b16 v[30:31], v7 offset:2048
s_waitcnt vmcnt(8)
s_waitcnt lgkmcnt(4)
v_mfma_f32_16x16x32_bf16 v[192:195], v[40:43], a[24:27], v[192:195]
buffer_load_dwordx4 v5, s[16:19], s6 offen offset:1024 lds
v_add_u32 v8, 4294868992, v8
ds_read_b64_tr_b16 v[32:33], v8 offset:0
v_mfma_f32_16x16x32_bf16 v[200:203], v[40:43], a[28:31], v[200:203]
ds_read_b64_tr_b16 v[34:35], v8 offset:2048
v_mfma_f32_16x16x32_bf16 v[196:199], v[44:47], a[24:27], v[196:199]
v_add_u32 v9, 4294868992, v9
ds_read_b64_tr_b16 v[36:37], v9 offset:0
v_mfma_f32_16x16x32_bf16 v[204:207], v[44:47], a[28:31], v[204:207]
ds_read_b64_tr_b16 v[38:39], v9 offset:2048
s_add_u32 m0, s30, 65536
s_add_u32 s6, s55, 958464
v_mfma_f32_16x16x32_bf16 v[208:211], v[120:123], a[24:27], v[208:211]
buffer_load_dwordx4 v4, s[16:19], s6 offen offset:0 lds
ds_read_b64_tr_b16 v[40:41], v6 offset:4096
v_mfma_f32_16x16x32_bf16 v[216:219], v[120:123], a[28:31], v[216:219]
ds_read_b64_tr_b16 v[42:43], v6 offset:6144
v_mfma_f32_16x16x32_bf16 v[212:215], v[124:127], a[24:27], v[212:215]
ds_read_b64_tr_b16 v[44:45], v7 offset:4096
s_load_dwordx4 s[56:59], s[8:9], s36 offset:512 glc
v_mfma_f32_16x16x32_bf16 v[220:223], v[124:127], a[28:31], v[220:223]
ds_read_b64_tr_b16 v[46:47], v7 offset:6144
s_waitcnt lgkmcnt(4)
v_mfma_f32_16x16x32_bf16 v[224:227], v[24:27], a[240:243], v[224:227]
buffer_load_dwordx4 v5, s[16:19], s6 offen offset:1024 lds
ds_read_b64_tr_b16 v[120:121], v8 offset:4096
v_mfma_f32_16x16x32_bf16 v[228:231], v[24:27], a[244:247], v[228:231]
ds_read_b64_tr_b16 v[122:123], v8 offset:6144
v_mfma_f32_16x16x32_bf16 v[232:235], v[28:31], a[240:243], v[232:235]
ds_read_b64_tr_b16 v[124:125], v9 offset:4096
v_mfma_f32_16x16x32_bf16 v[236:239], v[28:31], a[244:247], v[236:239]
ds_read_b64_tr_b16 v[126:127], v9 offset:6144
v_mfma_f32_16x16x32_bf16 v[240:243], v[32:35], a[240:243], v[240:243]
ds_read_b64_tr_b16 v[24:25], v6 offset:8192
s_add_u32 m0, s30, 73728
v_mfma_f32_16x16x32_bf16 v[244:247], v[32:35], a[244:247], v[244:247]
ds_read_b64_tr_b16 v[26:27], v6 offset:10240
s_add_u32 s6, s35, 221440
v_mfma_f32_16x16x32_bf16 v[248:251], v[36:39], a[240:243], v[248:251]
buffer_load_dwordx4 v4, s[16:19], s6 offen offset:0 lds
ds_read_b64_tr_b16 v[28:29], v7 offset:8192
v_mfma_f32_16x16x32_bf16 v[252:255], v[36:39], a[244:247], v[252:255]
ds_read_b64_tr_b16 v[30:31], v7 offset:10240
s_waitcnt lgkmcnt(4)
v_mfma_f32_16x16x32_bf16 v[224:227], v[40:43], a[248:251], v[224:227]
ds_read_b64_tr_b16 v[32:33], v8 offset:8192
v_mfma_f32_16x16x32_bf16 v[228:231], v[40:43], a[252:255], v[228:231]
ds_read_b64_tr_b16 v[34:35], v8 offset:10240
v_mfma_f32_16x16x32_bf16 v[232:235], v[44:47], a[248:251], v[232:235]
buffer_load_dwordx4 v5, s[16:19], s6 offen offset:1024 lds
ds_read_b64_tr_b16 v[36:37], v9 offset:8192
v_mfma_f32_16x16x32_bf16 v[236:239], v[44:47], a[252:255], v[236:239]
ds_read_b64_tr_b16 v[38:39], v9 offset:10240
v_mfma_f32_16x16x32_bf16 v[240:243], v[120:123], a[248:251], v[240:243]
ds_read_b64_tr_b16 v[40:41], v6 offset:12288
s_add_u32 m0, s30, 81920
v_mfma_f32_16x16x32_bf16 v[244:247], v[120:123], a[252:255], v[244:247]
ds_read_b64_tr_b16 v[42:43], v6 offset:14336
s_add_u32 s6, s35, 590080
v_mfma_f32_16x16x32_bf16 v[248:251], v[124:127], a[248:251], v[248:251]
buffer_load_dwordx4 v4, s[16:19], s6 offen offset:0 lds
ds_read_b64_tr_b16 v[44:45], v7 offset:12288
v_mfma_f32_16x16x32_bf16 v[252:255], v[124:127], a[252:255], v[252:255]
ds_read_b64_tr_b16 v[46:47], v7 offset:14336
s_waitcnt lgkmcnt(4)
v_mfma_f32_16x16x32_bf16 v[224:227], v[24:27], a[0:3], v[224:227]
ds_read_b64_tr_b16 v[120:121], v8 offset:12288
v_mfma_f32_16x16x32_bf16 v[228:231], v[24:27], a[4:7], v[228:231]
ds_read_b64_tr_b16 v[122:123], v8 offset:14336
v_mfma_f32_16x16x32_bf16 v[232:235], v[28:31], a[0:3], v[232:235]
buffer_load_dwordx4 v5, s[16:19], s6 offen offset:1024 lds
ds_read_b64_tr_b16 v[124:125], v9 offset:12288
v_mfma_f32_16x16x32_bf16 v[236:239], v[28:31], a[4:7], v[236:239]
ds_read_b64_tr_b16 v[126:127], v9 offset:14336
v_mfma_f32_16x16x32_bf16 v[240:243], v[32:35], a[0:3], v[240:243]
ds_read_b64_tr_b16 v[24:25], v6 offset:16384
s_add_u32 m0, s30, 90112
v_mfma_f32_16x16x32_bf16 v[244:247], v[32:35], a[4:7], v[244:247]
ds_read_b64_tr_b16 v[26:27], v6 offset:18432
s_add_u32 s6, s35, 958720
v_mfma_f32_16x16x32_bf16 v[248:251], v[36:39], a[0:3], v[248:251]
buffer_load_dwordx4 v4, s[16:19], s6 offen offset:0 lds
ds_read_b64_tr_b16 v[28:29], v7 offset:16384
v_mfma_f32_16x16x32_bf16 v[252:255], v[36:39], a[4:7], v[252:255]
ds_read_b64_tr_b16 v[30:31], v7 offset:18432
s_waitcnt lgkmcnt(4)
v_mfma_f32_16x16x32_bf16 v[224:227], v[40:43], a[8:11], v[224:227]
ds_read_b64_tr_b16 v[32:33], v8 offset:16384
v_mfma_f32_16x16x32_bf16 v[228:231], v[40:43], a[12:15], v[228:231]
ds_read_b64_tr_b16 v[34:35], v8 offset:18432
v_mfma_f32_16x16x32_bf16 v[232:235], v[44:47], a[8:11], v[232:235]
buffer_load_dwordx4 v5, s[16:19], s6 offen offset:1024 lds
ds_read_b64_tr_b16 v[36:37], v9 offset:16384
v_mfma_f32_16x16x32_bf16 v[236:239], v[44:47], a[12:15], v[236:239]
ds_read_b64_tr_b16 v[38:39], v9 offset:18432
v_mfma_f32_16x16x32_bf16 v[240:243], v[120:123], a[8:11], v[240:243]
ds_read_b64_tr_b16 v[40:41], v6 offset:20480
v_mfma_f32_16x16x32_bf16 v[244:247], v[120:123], a[12:15], v[244:247]
ds_read_b64_tr_b16 v[42:43], v6 offset:22528
v_mfma_f32_16x16x32_bf16 v[248:251], v[124:127], a[8:11], v[248:251]
ds_read_b64_tr_b16 v[44:45], v7 offset:20480
s_add_u32 m0, s30, 98304
v_mfma_f32_16x16x32_bf16 v[252:255], v[124:127], a[12:15], v[252:255]
ds_read_b64_tr_b16 v[46:47], v7 offset:22528
s_add_u32 s6, s55, 294912
s_waitcnt lgkmcnt(0)
v_mfma_f32_16x16x32_bf16 v[224:227], v[24:27], a[16:19], v[224:227]
buffer_load_dwordx4 v4, s[16:19], s6 offen offset:0 lds
ds_read_b64_tr_b16 v[120:121], v8 offset:20480
s_xor_b64 s[56:57], s[56:57], s[0:1]
s_xor_b32 s58, s58, s0
v_mfma_f32_16x16x32_bf16 v[228:231], v[24:27], a[20:23], v[228:231]
ds_read_b64_tr_b16 v[122:123], v8 offset:22528
s_or_b32 s57, s57, s58
s_or_b32 s56, s56, s57
s_cbranch_scc1 K3C_slow4
K3C_back4:
v_mfma_f32_16x16x32_bf16 v[232:235], v[28:31], a[16:19], v[232:235]
ds_read_b64_tr_b16 v[124:125], v9 offset:20480
v_mfma_f32_16x16x32_bf16 v[236:239], v[28:31], a[20:23], v[236:239]
ds_read_b64_tr_b16 v[126:127], v9 offset:22528
s_add_u32 s7, s34, 49152
v_mfma_f32_16x16x32_bf16 v[240:243], v[32:35], a[16:19], v[240:243]
v_mfma_f32_16x16x32_bf16 v[244:247], v[32:35], a[20:23], v[244:247]
s_barrier
buffer_load_dwordx4 a[32:35], v1, s[8:11], s7 offen offset:0 sc1
v_add_u32 v10, 4294868992, v10
ds_read_b64_tr_b16 v[24:25], v10 offset:24576
ds_read_b64_tr_b16 v[26:27], v10 offset:26624
v_mfma_f32_16x16x32_bf16 v[248:251], v[36:39], a[16:19], v[248:251]
v_add_u32 v11, 4294868992, v11
ds_read_b64_tr_b16 v[28:29], v11 offset:24576
v_mfma_f32_16x16x32_bf16 v[252:255], v[36:39], a[20:23], v[252:255]
ds_read_b64_tr_b16 v[30:31], v11 offset:26624
s_waitcnt lgkmcnt(4)
v_mfma_f32_16x16x32_bf16 v[224:227], v[40:43], a[24:27], v[224:227]
buffer_load_dwordx4 a[36:39], v1, s[8:11], s7 offen offset:1024 sc1
v_add_u32 v12, 4294868992, v12
ds_read_b64_tr_b16 v[32:33], v12 offset:24576
v_mfma_f32_16x16x32_bf16 v[228:231], v[40:43], a[28:31], v[228:231]
ds_read_b64_tr_b16 v[34:35], v12 offset:26624
v_mfma_f32_16x16x32_bf16 v[232:235], v[44:47], a[24:27], v[232:235]
v_add_u32 v13, 4294868992, v13
ds_read_b64_tr_b16 v[36:37], v13 offset:24576
v_mfma_f32_16x16x32_bf16 v[236:239], v[44:47], a[28:31], v[236:239]
ds_read_b64_tr_b16 v[38:39], v13 offset:26624
v_mfma_f32_16x16x32_bf16 v[240:243], v[120:123], a[24:27], v[240:243]
buffer_load_dwordx4 a[40:43], v1, s[8:11], s7 offen offset:2048 sc1
ds_read_b64_tr_b16 v[40:41], v10 offset:28672
v_mfma_f32_16x16x32_bf16 v[244:247], v[120:123], a[28:31], v[244:247]
ds_read_b64_tr_b16 v[42:43], v10 offset:30720
v_mfma_f32_16x16x32_bf16 v[248:251], v[124:127], a[24:27], v[248:251]
ds_read_b64_tr_b16 v[44:45], v11 offset:28672
v_mfma_f32_16x16x32_bf16 v[252:255], v[124:127], a[28:31], v[252:255]
ds_read_b64_tr_b16 v[46:47], v11 offset:30720
s_waitcnt lgkmcnt(4)
v_mfma_f32_16x16x32_bf16 v[160:163], v[24:27], a[192:195], v[160:163]
buffer_load_dwordx4 a[44:47], v1, s[8:11], s7 offen offset:3072 sc1
ds_read_b64_tr_b16 v[120:121], v12 offset:28672
v_mfma_f32_16x16x32_bf16 v[168:171], v[24:27], a[196:199], v[168:171]
ds_read_b64_tr_b16 v[122:123], v12 offset:30720
s_waitcnt vmcnt(17)
v_mfma_f32_16x16x32_bf16 v[164:167], v[28:31], a[192:195], v[164:167]
ds_read_b64_tr_b16 v[124:125], v13 offset:28672
s_add_u32 s7, s34, 147456
v_mfma_f32_16x16x32_bf16 v[172:175], v[28:31], a[196:199], v[172:175]
ds_read_b64_tr_b16 v[126:127], v13 offset:30720
v_lshlrev_b32 v96, 16, v128
v_and_b32 v97, s39, v128
v_mfma_f32_16x16x32_bf16 v[176:179], v[32:35], a[192:195], v[176:179]
buffer_load_dwordx4 a[48:51], v1, s[8:11], s7 offen offset:0 sc1
ds_read_b64_tr_b16 v[24:25], v10 offset:32768
v_mfma_f32_16x16x32_bf16 v[184:187], v[32:35], a[196:199], v[184:187]
ds_read_b64_tr_b16 v[26:27], v10 offset:34816
v_lshlrev_b32 v98, 16, v129
v_mfma_f32_16x16x32_bf16 v[180:183], v[36:39], a[192:195], v[180:183]
ds_read_b64_tr_b16 v[28:29], v11 offset:32768
v_and_b32 v99, s39, v129
v_mfma_f32_16x16x32_bf16 v[188:191], v[36:39], a[196:199], v[188:191]
ds_read_b64_tr_b16 v[30:31], v11 offset:34816
v_lshlrev_b32 v100, 16, v130
s_waitcnt lgkmcnt(4)
v_mfma_f32_16x16x32_bf16 v[160:163], v[40:43], a[200:203], v[160:163]
buffer_load_dwordx4 a[52:55], v1, s[8:11], s7 offen offset:1024 sc1
ds_read_b64_tr_b16 v[32:33], v12 offset:32768
v_mfma_f32_16x16x32_bf16 v[168:171], v[40:43], a[204:207], v[168:171]
ds_read_b64_tr_b16 v[34:35], v12 offset:34816
v_and_b32 v101, s39, v130
v_mfma_f32_16x16x32_bf16 v[164:167], v[44:47], a[200:203], v[164:167]
ds_read_b64_tr_b16 v[36:37], v13 offset:32768
v_lshlrev_b32 v102, 16, v131
v_mfma_f32_16x16x32_bf16 v[172:175], v[44:47], a[204:207], v[172:175]
ds_read_b64_tr_b16 v[38:39], v13 offset:34816
v_and_b32 v103, s39, v131
v_lshlrev_b32 v104, 16, v132
v_mfma_f32_16x16x32_bf16 v[176:179], v[120:123], a[200:203], v[176:179]
buffer_load_dwordx4 a[56:59], v1, s[8:11], s7 offen offset:2048 sc1
ds_read_b64_tr_b16 v[40:41], v10 offset:36864
v_mfma_f32_16x16x32_bf16 v[184:187], v[120:123], a[204:207], v[184:187]
ds_read_b64_tr_b16 v[42:43], v10 offset:38912
v_and_b32 v105, s39, v132
v_mfma_f32_16x16x32_bf16 v[180:183], v[124:127], a[200:203], v[180:183]
ds_read_b64_tr_b16 v[44:45], v11 offset:36864
v_lshlrev_b32 v106, 16, v133
v_mfma_f32_16x16x32_bf16 v[188:191], v[124:127], a[204:207], v[188:191]
ds_read_b64_tr_b16 v[46:47], v11 offset:38912
v_and_b32 v107, s39, v133
s_waitcnt lgkmcnt(4)
v_mfma_f32_16x16x32_bf16 v[160:163], v[24:27], a[208:211], v[160:163]
buffer_load_dwordx4 a[60:63], v1, s[8:11], s7 offen offset:3072 sc1
ds_read_b64_tr_b16 v[120:121], v12 offset:36864
v_mfma_f32_16x16x32_bf16 v[168:171], v[24:27], a[212:215], v[168:171]
ds_read_b64_tr_b16 v[122:123], v12 offset:38912
v_lshlrev_b32 v108, 16, v134
v_mfma_f32_16x16x32_bf16 v[164:167], v[28:31], a[208:211], v[164:167]
ds_read_b64_tr_b16 v[124:125], v13 offset:36864
s_add_u32 s7, s34, 245760
v_mfma_f32_16x16x32_bf16 v[172:175], v[28:31], a[212:215], v[172:175]
ds_read_b64_tr_b16 v[126:127], v13 offset:38912
v_and_b32 v109, s39, v134
v_lshlrev_b32 v110, 16, v135
v_mfma_f32_16x16x32_bf16 v[176:179], v[32:35], a[208:211], v[176:179]
buffer_load_dwordx4 a[64:67], v1, s[8:11], s7 offen offset:0 sc1
ds_read_b64_tr_b16 v[24:25], v10 offset:40960
v_mfma_f32_16x16x32_bf16 v[184:187], v[32:35], a[212:215], v[184:187]
ds_read_b64_tr_b16 v[26:27], v10 offset:43008
v_and_b32 v111, s39, v135
v_mfma_f32_16x16x32_bf16 v[180:183], v[36:39], a[208:211], v[180:183]
ds_read_b64_tr_b16 v[28:29], v11 offset:40960
v_lshlrev_b32 v112, 16, v136
v_mfma_f32_16x16x32_bf16 v[188:191], v[36:39], a[212:215], v[188:191]
ds_read_b64_tr_b16 v[30:31], v11 offset:43008
v_and_b32 v113, s39, v136
s_waitcnt lgkmcnt(4)
v_mfma_f32_16x16x32_bf16 v[160:163], v[40:43], a[216:219], v[160:163]
buffer_load_dwordx4 a[68:71], v1, s[8:11], s7 offen offset:1024 sc1
ds_read_b64_tr_b16 v[32:33], v12 offset:40960
v_mfma_f32_16x16x32_bf16 v[168:171], v[40:43], a[220:223], v[168:171]
ds_read_b64_tr_b16 v[34:35], v12 offset:43008
v_lshlrev_b32 v114, 16, v137
v_mfma_f32_16x16x32_bf16 v[164:167], v[44:47], a[216:219], v[164:167]
ds_read_b64_tr_b16 v[36:37], v13 offset:40960
v_and_b32 v115, s39, v137
v_mfma_f32_16x16x32_bf16 v[172:175], v[44:47], a[220:223], v[172:175]
ds_read_b64_tr_b16 v[38:39], v13 offset:43008
v_lshlrev_b32 v116, 16, v138
v_and_b32 v117, s39, v138
v_mfma_f32_16x16x32_bf16 v[176:179], v[120:123], a[216:219], v[176:179]
buffer_load_dwordx4 a[72:75], v1, s[8:11], s7 offen offset:2048 sc1
ds_read_b64_tr_b16 v[40:41], v10 offset:45056
v_mfma_f32_16x16x32_bf16 v[184:187], v[120:123], a[220:223], v[184:187]
ds_read_b64_tr_b16 v[42:43], v10 offset:47104
v_lshlrev_b32 v118, 16, v139
v_mfma_f32_16x16x32_bf16 v[180:183], v[124:127], a[216:219], v[180:183]
ds_read_b64_tr_b16 v[44:45], v11 offset:45056
v_and_b32 v119, s39, v139
v_mfma_f32_16x16x32_bf16 v[188:191], v[124:127], a[220:223], v[188:191]
ds_read_b64_tr_b16 v[46:47], v11 offset:47104
v_lshlrev_b32 v128, 16, v140
s_waitcnt lgkmcnt(4)
v_mfma_f32_16x16x32_bf16 v[160:163], v[24:27], a[224:227], v[160:163]
buffer_load_dwordx4 a[76:79], v1, s[8:11], s7 offen offset:3072 sc1
ds_read_b64_tr_b16 v[120:121], v12 offset:45056
v_mfma_f32_16x16x32_bf16 v[168:171], v[24:27], a[228:231], v[168:171]
ds_read_b64_tr_b16 v[122:123], v12 offset:47104
v_and_b32 v129, s39, v140
v_mfma_f32_16x16x32_bf16 v[164:167], v[28:31], a[224:227], v[164:167]
ds_read_b64_tr_b16 v[124:125], v13 offset:45056
v_lshlrev_b32 v130, 16, v141
v_mfma_f32_16x16x32_bf16 v[172:175], v[28:31], a[228:231], v[172:175]
ds_read_b64_tr_b16 v[126:127], v13 offset:47104
v_and_b32 v131, s39, v141
v_add_f32 v96, v96, v128
v_mfma_f32_16x16x32_bf16 v[176:179], v[32:35], a[224:227], v[176:179]
v_mfma_f32_16x16x32_bf16 v[184:187], v[32:35], a[228:231], v[184:187]
s_waitcnt vmcnt(19)
s_barrier
buffer_load_dwordx4 v5, s[16:19], s6 offen offset:1024 lds
v_add_u32 v10, 49152, v10
ds_read_b64_tr_b16 v[24:25], v10 offset:0
ds_read_b64_tr_b16 v[26:27], v10 offset:2048
v_mfma_f32_16x16x32_bf16 v[180:183], v[36:39], a[224:227], v[180:183]
v_add_u32 v11, 49152, v11
ds_read_b64_tr_b16 v[28:29], v11 offset:0
s_add_u32 m0, s30, 106496
v_mfma_f32_16x16x32_bf16 v[188:191], v[36:39], a[228:231], v[188:191]
ds_read_b64_tr_b16 v[30:31], v11 offset:2048
s_add_u32 s6, s55, 663552
s_waitcnt lgkmcnt(4)
v_mfma_f32_16x16x32_bf16 v[160:163], v[40:43], a[232:235], v[160:163]
buffer_load_dwordx4 v4, s[16:19], s6 offen offset:0 lds
v_add_u32 v12, 49152, v12
ds_read_b64_tr_b16 v[32:33], v12 offset:0
v_mfma_f32_16x16x32_bf16 v[168:171], v[40:43], a[236:239], v[168:171]
ds_read_b64_tr_b16 v[34:35], v12 offset:2048
v_mfma_f32_16x16x32_bf16 v[164:167], v[44:47], a[232:235], v[164:167]
v_add_u32 v13, 49152, v13
ds_read_b64_tr_b16 v[36:37], v13 offset:0
v_mfma_f32_16x16x32_bf16 v[172:175], v[44:47], a[236:239], v[172:175]
ds_read_b64_tr_b16 v[38:39], v13 offset:2048
v_add_f32 v97, v97, v129
v_add_f32 v98, v98, v130
v_mfma_f32_16x16x32_bf16 v[176:179], v[120:123], a[232:235], v[176:179]
buffer_load_dwordx4 v5, s[16:19], s6 offen offset:1024 lds
ds_read_b64_tr_b16 v[40:41], v10 offset:4096
v_mfma_f32_16x16x32_bf16 v[184:187], v[120:123], a[236:239], v[184:187]
ds_read_b64_tr_b16 v[42:43], v10 offset:6144
v_add_f32 v99, v99, v131
v_mfma_f32_16x16x32_bf16 v[180:183], v[124:127], a[232:235], v[180:183]
ds_read_b64_tr_b16 v[44:45], v11 offset:4096
s_add_u32 m0, s30, 114688
s_add_u32 s6, s55, 1032192
v_mfma_f32_16x16x32_bf16 v[188:191], v[124:127], a[236:239], v[188:191]
ds_read_b64_tr_b16 v[46:47], v11 offset:6144
s_waitcnt vmcnt(13)
s_waitcnt lgkmcnt(4)
v_mfma_f32_16x16x32_bf16 v[192:195], v[24:27], a[32:35], v[192:195]
buffer_load_dwordx4 v4, s[16:19], s6 offen offset:0 lds
ds_read_b64_tr_b16 v[120:121], v12 offset:4096
v_mfma_f32_16x16x32_bf16 v[200:203], v[24:27], a[36:39], v[200:203]
ds_read_b64_tr_b16 v[122:123], v12 offset:6144
v_add_f32 v100, v100, v128
v_mfma_f32_16x16x32_bf16 v[196:199], v[28:31], a[32:35], v[196:199]
ds_read_b64_tr_b16 v[124:125], v13 offset:4096
v_add_f32 v101, v101, v129
v_mfma_f32_16x16x32_bf16 v[204:207], v[28:31], a[36:39], v[204:207]
ds_read_b64_tr_b16 v[126:127], v13 offset:6144
v_add_f32 v102, v102, v130
v_add_f32 v103, v103, v131
v_mfma_f32_16x16x32_bf16 v[208:211], v[32:35], a[32:35], v[208:211]
buffer_load_dwordx4 v5, s[16:19], s6 offen offset:1024 lds
ds_read_b64_tr_b16 v[24:25], v10 offset:8192
v_mfma_f32_16x16x32_bf16 v[216:219], v[32:35], a[36:39], v[216:219]
ds_read_b64_tr_b16 v[26:27], v10 offset:10240
v_lshlrev_b32 v132, 16, v142
v_mfma_f32_16x16x32_bf16 v[212:215], v[36:39], a[32:35], v[212:215]
ds_read_b64_tr_b16 v[28:29], v11 offset:8192
s_add_u32 s7, s34, 65536
v_and_b32 v133, s39, v142
v_mfma_f32_16x16x32_bf16 v[220:223], v[36:39], a[36:39], v[220:223]
ds_read_b64_tr_b16 v[30:31], v11 offset:10240
s_waitcnt vmcnt(13)
s_waitcnt lgkmcnt(4)
v_mfma_f32_16x16x32_bf16 v[192:195], v[40:43], a[40:43], v[192:195]
buffer_load_dwordx4 v[48:51], v1, s[8:11], s7 offen offset:0 sc1
ds_read_b64_tr_b16 v[32:33], v12 offset:8192
v_mfma_f32_16x16x32_bf16 v[200:203], v[40:43], a[44:47], v[200:203]
ds_read_b64_tr_b16 v[34:35], v12 offset:10240
v_lshlrev_b32 v134, 16, v143
v_mfma_f32_16x16x32_bf16 v[196:199], v[44:47], a[40:43], v[196:199]
ds_read_b64_tr_b16 v[36:37], v13 offset:8192
v_and_b32 v135, s39, v143
v_mfma_f32_16x16x32_bf16 v[204:207], v[44:47], a[44:47], v[204:207]
ds_read_b64_tr_b16 v[38:39], v13 offset:10240
v_add_f32 v104, v104, v132
v_add_f32 v105, v105, v133
v_mfma_f32_16x16x32_bf16 v[208:211], v[120:123], a[40:43], v[208:211]
buffer_load_dwordx4 v[52:55], v1, s[8:11], s7 offen offset:1024 sc1
ds_read_b64_tr_b16 v[40:41], v10 offset:12288
v_mfma_f32_16x16x32_bf16 v[216:219], v[120:123], a[44:47], v[216:219]
ds_read_b64_tr_b16 v[42:43], v10 offset:14336
v_add_f32 v106, v106, v134
v_mfma_f32_16x16x32_bf16 v[212:215], v[124:127], a[40:43], v[212:215]
ds_read_b64_tr_b16 v[44:45], v11 offset:12288
v_add_f32 v107, v107, v135
v_add_f32 v108, v108, v132
v_mfma_f32_16x16x32_bf16 v[220:223], v[124:127], a[44:47], v[220:223]
ds_read_b64_tr_b16 v[46:47], v11 offset:14336
s_waitcnt vmcnt(13)
s_waitcnt lgkmcnt(4)
v_mfma_f32_16x16x32_bf16 v[192:195], v[24:27], a[48:51], v[192:195]
buffer_load_dwordx4 v[56:59], v1, s[8:11], s7 offen offset:2048 sc1
ds_read_b64_tr_b16 v[120:121], v12 offset:12288
v_mfma_f32_16x16x32_bf16 v[200:203], v[24:27], a[52:55], v[200:203]
ds_read_b64_tr_b16 v[122:123], v12 offset:14336
v_add_f32 v109, v109, v133
v_mfma_f32_16x16x32_bf16 v[196:199], v[28:31], a[48:51], v[196:199]
ds_read_b64_tr_b16 v[124:125], v13 offset:12288
v_add_f32 v110, v110, v134
v_mfma_f32_16x16x32_bf16 v[204:207], v[28:31], a[52:55], v[204:207]
ds_read_b64_tr_b16 v[126:127], v13 offset:14336
v_add_f32 v111, v111, v135
v_lshlrev_b32 v136, 16, v144
v_mfma_f32_16x16x32_bf16 v[208:211], v[32:35], a[48:51], v[208:211]
buffer_load_dwordx4 v[60:63], v1, s[8:11], s7 offen offset:3072 sc1
ds_read_b64_tr_b16 v[24:25], v10 offset:16384
v_mfma_f32_16x16x32_bf16 v[216:219], v[32:35], a[52:55], v[216:219]
ds_read_b64_tr_b16 v[26:27], v10 offset:18432
v_and_b32 v137, s39, v144
v_mfma_f32_16x16x32_bf16 v[212:215], v[36:39], a[48:51], v[212:215]
ds_read_b64_tr_b16 v[28:29], v11 offset:16384
v_lshlrev_b32 v138, 16, v145
v_and_b32 v139, s39, v145
v_mfma_f32_16x16x32_bf16 v[220:223], v[36:39], a[52:55], v[220:223]
ds_read_b64_tr_b16 v[30:31], v11 offset:18432
s_waitcnt vmcnt(13)
s_waitcnt lgkmcnt(4)
v_mfma_f32_16x16x32_bf16 v[192:195], v[40:43], a[56:59], v[192:195]
buffer_load_dword v20, v19, s[8:11], s7 offen sc1
ds_read_b64_tr_b16 v[32:33], v12 offset:16384
v_mfma_f32_16x16x32_bf16 v[200:203], v[40:43], a[60:63], v[200:203]
ds_read_b64_tr_b16 v[34:35], v12 offset:18432
v_add_f32 v112, v112, v136
v_mfma_f32_16x16x32_bf16 v[196:199], v[44:47], a[56:59], v[196:199]
ds_read_b64_tr_b16 v[36:37], v13 offset:16384
s_add_u32 s7, s34, 163840
v_mfma_f32_16x16x32_bf16 v[204:207], v[44:47], a[60:63], v[204:207]
ds_read_b64_tr_b16 v[38:39], v13 offset:18432
v_add_f32 v113, v113, v137
v_add_f32 v114, v114, v138
v_mfma_f32_16x16x32_bf16 v[208:211], v[120:123], a[56:59], v[208:211]
buffer_load_dwordx4 v[64:67], v1, s[8:11], s7 offen offset:0 sc1
ds_read_b64_tr_b16 v[40:41], v10 offset:20480
v_mfma_f32_16x16x32_bf16 v[216:219], v[120:123], a[60:63], v[216:219]
ds_read_b64_tr_b16 v[42:43], v10 offset:22528
v_add_f32 v115, v115, v139
v_mfma_f32_16x16x32_bf16 v[212:215], v[124:127], a[56:59], v[212:215]
ds_read_b64_tr_b16 v[44:45], v11 offset:20480
v_add_f32 v116, v116, v136
v_add_f32 v117, v117, v137
v_mfma_f32_16x16x32_bf16 v[220:223], v[124:127], a[60:63], v[220:223]
ds_read_b64_tr_b16 v[46:47], v11 offset:22528
s_waitcnt vmcnt(13)
s_waitcnt lgkmcnt(4)
v_mfma_f32_16x16x32_bf16 v[192:195], v[24:27], a[64:67], v[192:195]
buffer_load_dwordx4 v[68:71], v1, s[8:11], s7 offen offset:1024 sc1
s_branch PGC_6
.p2align 12
PSC_6:
s_setpc_b64 s[62:63]
PGC_6:
ds_read_b64_tr_b16 v[120:121], v12 offset:20480
v_mfma_f32_16x16x32_bf16 v[200:203], v[24:27], a[68:71], v[200:203]
ds_read_b64_tr_b16 v[122:123], v12 offset:22528
v_add_f32 v118, v118, v138
v_mfma_f32_16x16x32_bf16 v[196:199], v[28:31], a[64:67], v[196:199]
ds_read_b64_tr_b16 v[124:125], v13 offset:20480
v_mfma_f32_16x16x32_bf16 v[204:207], v[28:31], a[68:71], v[204:207]
ds_read_b64_tr_b16 v[126:127], v13 offset:22528
v_add_f32 v119, v119, v139
v_mfma_f32_16x16x32_bf16 v[208:211], v[32:35], a[64:67], v[208:211]
v_mfma_f32_16x16x32_bf16 v[216:219], v[32:35], a[68:71], v[216:219]
s_barrier
buffer_load_dwordx4 v[72:75], v1, s[8:11], s7 offen offset:2048 sc1
v_add_u32 v6, 49152, v6
ds_read_b64_tr_b16 v[24:25], v6 offset:24576
ds_read_b64_tr_b16 v[26:27], v6 offset:26624
v_mfma_f32_16x16x32_bf16 v[212:215], v[36:39], a[64:67], v[212:215]
v_add_u32 v7, 49152, v7
ds_read_b64_tr_b16 v[28:29], v7 offset:24576
v_mfma_f32_16x16x32_bf16 v[220:223], v[36:39], a[68:71], v[220:223]
ds_read_b64_tr_b16 v[30:31], v7 offset:26624
s_waitcnt vmcnt(13)
s_waitcnt lgkmcnt(4)
v_mfma_f32_16x16x32_bf16 v[192:195], v[40:43], a[72:75], v[192:195]
buffer_load_dwordx4 v[76:79], v1, s[8:11], s7 offen offset:3072 sc1
v_add_u32 v8, 49152, v8
ds_read_b64_tr_b16 v[32:33], v8 offset:24576
v_mfma_f32_16x16x32_bf16 v[200:203], v[40:43], a[76:79], v[200:203]
ds_read_b64_tr_b16 v[34:35], v8 offset:26624
v_mfma_f32_16x16x32_bf16 v[196:199], v[44:47], a[72:75], v[196:199]
v_add_u32 v9, 49152, v9
ds_read_b64_tr_b16 v[36:37], v9 offset:24576
v_mfma_f32_16x16x32_bf16 v[204:207], v[44:47], a[76:79], v[204:207]
ds_read_b64_tr_b16 v[38:39], v9 offset:26624
v_mfma_f32_16x16x32_bf16 v[208:211], v[120:123], a[72:75], v[208:211]
buffer_load_dword v21, v19, s[8:11], s7 offen sc1
ds_read_b64_tr_b16 v[40:41], v6 offset:28672
v_mfma_f32_16x16x32_bf16 v[216:219], v[120:123], a[76:79], v[216:219]
ds_read_b64_tr_b16 v[42:43], v6 offset:30720
v_mfma_f32_16x16x32_bf16 v[212:215], v[124:127], a[72:75], v[212:215]
ds_read_b64_tr_b16 v[44:45], v7 offset:28672
s_add_u32 s7, s34, 262144
v_mfma_f32_16x16x32_bf16 v[220:223], v[124:127], a[76:79], v[220:223]
ds_read_b64_tr_b16 v[46:47], v7 offset:30720
s_waitcnt lgkmcnt(4)
v_mfma_f32_16x16x32_bf16 v[224:227], v[24:27], a[32:35], v[224:227]
buffer_load_dwordx4 v[80:83], v1, s[8:11], s7 offen offset:0 sc1
ds_read_b64_tr_b16 v[120:121], v8 offset:28672
v_mfma_f32_16x16x32_bf16 v[228:231], v[24:27], a[36:39], v[228:231]
ds_read_b64_tr_b16 v[122:123], v8 offset:30720
v_mfma_f32_16x16x32_bf16 v[232:235], v[28:31], a[32:35], v[232:235]
ds_read_b64_tr_b16 v[124:125], v9 offset:28672
v_mfma_f32_16x16x32_bf16 v[236:239], v[28:31], a[36:39], v[236:239]
ds_read_b64_tr_b16 v[126:127], v9 offset:30720
s_barrier
v_mfma_f32_16x16x32_bf16 v[240:243], v[32:35], a[32:35], v[240:243]
buffer_load_dwordx4 v[84:87], v1, s[8:11], s7 offen offset:1024 sc1
ds_read_b64_tr_b16 v[24:25], v6 offset:32768
v_mfma_f32_16x16x32_bf16 v[244:247], v[32:35], a[36:39], v[244:247]
ds_read_b64_tr_b16 v[26:27], v6 offset:34816
v_mfma_f32_16x16x32_bf16 v[248:251], v[36:39], a[32:35], v[248:251]
ds_read_b64_tr_b16 v[28:29], v7 offset:32768
v_mfma_f32_16x16x32_bf16 v[252:255], v[36:39], a[36:39], v[252:255]
ds_read_b64_tr_b16 v[30:31], v7 offset:34816
s_waitcnt lgkmcnt(4)
v_mfma_f32_16x16x32_bf16 v[224:227], v[40:43], a[40:43], v[224:227]
buffer_load_dwordx4 v[88:91], v1, s[8:11], s7 offen offset:2048 sc1
ds_read_b64_tr_b16 v[32:33], v8 offset:32768
v_mfma_f32_16x16x32_bf16 v[228:231], v[40:43], a[44:47], v[228:231]
ds_read_b64_tr_b16 v[34:35], v8 offset:34816
v_mfma_f32_16x16x32_bf16 v[232:235], v[44:47], a[40:43], v[232:235]
ds_read_b64_tr_b16 v[36:37], v9 offset:32768
v_mfma_f32_16x16x32_bf16 v[236:239], v[44:47], a[44:47], v[236:239]
ds_read_b64_tr_b16 v[38:39], v9 offset:34816
v_mfma_f32_16x16x32_bf16 v[240:243], v[120:123], a[40:43], v[240:243]
buffer_load_dwordx4 v[92:95], v1, s[8:11], s7 offen offset:3072 sc1
ds_read_b64_tr_b16 v[40:41], v6 offset:36864
v_mfma_f32_16x16x32_bf16 v[244:247], v[120:123], a[44:47], v[244:247]
ds_read_b64_tr_b16 v[42:43], v6 offset:38912
v_mfma_f32_16x16x32_bf16 v[248:251], v[124:127], a[40:43], v[248:251]
ds_read_b64_tr_b16 v[44:45], v7 offset:36864
v_mfma_f32_16x16x32_bf16 v[252:255], v[124:127], a[44:47], v[252:255]
ds_read_b64_tr_b16 v[46:47], v7 offset:38912
s_waitcnt lgkmcnt(4)
v_mfma_f32_16x16x32_bf16 v[224:227], v[24:27], a[48:51], v[224:227]
buffer_load_dword v22, v19, s[8:11], s7 offen sc1
ds_read_b64_tr_b16 v[120:121], v8 offset:36864
v_mfma_f32_16x16x32_bf16 v[228:231], v[24:27], a[52:55], v[228:231]
ds_read_b64_tr_b16 v[122:123], v8 offset:38912
v_mfma_f32_16x16x32_bf16 v[232:235], v[28:31], a[48:51], v[232:235]
ds_read_b64_tr_b16 v[124:125], v9 offset:36864
s_add_u32 m0, s30, 122880
v_mfma_f32_16x16x32_bf16 v[236:239], v[28:31], a[52:55], v[236:239]
ds_read_b64_tr_b16 v[126:127], v9 offset:38912
s_add_u32 s6, s35, 295168
v_mfma_f32_16x16x32_bf16 v[240:243], v[32:35], a[48:51], v[240:243]
buffer_load_dwordx4 v4, s[16:19], s6 offen offset:0 lds
ds_read_b64_tr_b16 v[24:25], v6 offset:40960
v_mfma_f32_16x16x32_bf16 v[244:247], v[32:35], a[52:55], v[244:247]
ds_read_b64_tr_b16 v[26:27], v6 offset:43008
v_mfma_f32_16x16x32_bf16 v[248:251], v[36:39], a[48:51], v[248:251]
ds_read_b64_tr_b16 v[28:29], v7 offset:40960
v_mfma_f32_16x16x32_bf16 v[252:255], v[36:39], a[52:55], v[252:255]
ds_read_b64_tr_b16 v[30:31], v7 offset:43008
s_waitcnt lgkmcnt(4)
v_mfma_f32_16x16x32_bf16 v[224:227], v[40:43], a[56:59], v[224:227]
buffer_load_dwordx4 v5, s[16:19], s6 offen offset:1024 lds
ds_read_b64_tr_b16 v[32:33], v8 offset:40960
v_mfma_f32_16x16x32_bf16 v[228:231], v[40:43], a[60:63], v[228:231]
ds_read_b64_tr_b16 v[34:35], v8 offset:43008
v_mfma_f32_16x16x32_bf16 v[232:235], v[44:47], a[56:59], v[232:235]
ds_read_b64_tr_b16 v[36:37], v9 offset:40960
s_add_u32 m0, s30, 131072
v_mfma_f32_16x16x32_bf16 v[236:239], v[44:47], a[60:63], v[236:239]
ds_read_b64_tr_b16 v[38:39], v9 offset:43008
s_add_u32 s6, s35, 663808
v_mfma_f32_16x16x32_bf16 v[240:243], v[120:123], a[56:59], v[240:243]
buffer_load_dwordx4 v4, s[16:19], s6 offen offset:0 lds
ds_read_b64_tr_b16 v[40:41], v6 offset:45056
v_mfma_f32_16x16x32_bf16 v[244:247], v[120:123], a[60:63], v[244:247]
ds_read_b64_tr_b16 v[42:43], v6 offset:47104
v_mfma_f32_16x16x32_bf16 v[248:251], v[124:127], a[56:59], v[248:251]
ds_read_b64_tr_b16 v[44:45], v7 offset:45056
v_mfma_f32_16x16x32_bf16 v[252:255], v[124:127], a[60:63], v[252:255]
ds_read_b64_tr_b16 v[46:47], v7 offset:47104
s_waitcnt lgkmcnt(4)
v_mfma_f32_16x16x32_bf16 v[224:227], v[24:27], a[64:67], v[224:227]
buffer_load_dwordx4 v5, s[16:19], s6 offen offset:1024 lds
ds_read_b64_tr_b16 v[120:121], v8 offset:45056
v_mfma_f32_16x16x32_bf16 v[228:231], v[24:27], a[68:71], v[228:231]
ds_read_b64_tr_b16 v[122:123], v8 offset:47104
v_mfma_f32_16x16x32_bf16 v[232:235], v[28:31], a[64:67], v[232:235]
ds_read_b64_tr_b16 v[124:125], v9 offset:45056
s_add_u32 m0, s30, 139264
v_mfma_f32_16x16x32_bf16 v[236:239], v[28:31], a[68:71], v[236:239]
ds_read_b64_tr_b16 v[126:127], v9 offset:47104
s_add_u32 s6, s35, 1032448
s_waitcnt vmcnt(14)
v_mfma_f32_16x16x32_bf16 v[240:243], v[32:35], a[64:67], v[240:243]
v_mfma_f32_16x16x32_bf16 v[244:247], v[32:35], a[68:71], v[244:247]
s_barrier
buffer_load_dwordx4 v4, s[16:19], s6 offen offset:0 lds
v_add_u32 v10, 49152, v10
ds_read_b64_tr_b16 v[24:25], v10 offset:0
ds_read_b64_tr_b16 v[26:27], v10 offset:2048
v_bitop3_b32 v20, v20, v48, v49 bitop3:0x96
v_bitop3_b32 v20, v20, v50, v51 bitop3:0x96
v_bitop3_b32 v20, v20, v52, v53 bitop3:0x96
v_mfma_f32_16x16x32_bf16 v[248:251], v[36:39], a[64:67], v[248:251]
v_add_u32 v11, 49152, v11
ds_read_b64_tr_b16 v[28:29], v11 offset:0
v_bitop3_b32 v20, v20, v54, v55 bitop3:0x96
v_mfma_f32_16x16x32_bf16 v[252:255], v[36:39], a[68:71], v[252:255]
ds_read_b64_tr_b16 v[30:31], v11 offset:2048
v_bitop3_b32 v20, v20, v56, v57 bitop3:0x96
v_bitop3_b32 v20, v20, v58, v59 bitop3:0x96
s_waitcnt lgkmcnt(4)
v_mfma_f32_16x16x32_bf16 v[224:227], v[40:43], a[72:75], v[224:227]
buffer_load_dwordx4 v5, s[16:19], s6 offen offset:1024 lds
v_add_u32 v12, 49152, v12
ds_read_b64_tr_b16 v[32:33], v12 offset:0
v_mfma_f32_16x16x32_bf16 v[228:231], v[40:43], a[76:79], v[228:231]
ds_read_b64_tr_b16 v[34:35], v12 offset:2048
v_bitop3_b32 v20, v20, v60, v61 bitop3:0x96
v_bitop3_b32 v20, v20, v62, v63 bitop3:0x96
v_cmp_ne_u32 s[56:57], s52, v20
v_mfma_f32_16x16x32_bf16 v[232:235], v[44:47], a[72:75], v[232:235]
v_add_u32 v13, 49152, v13
ds_read_b64_tr_b16 v[36:37], v13 offset:0
s_cmp_lg_u64 s[56:57], 0
v_mfma_f32_16x16x32_bf16 v[236:239], v[44:47], a[76:79], v[236:239]
ds_read_b64_tr_b16 v[38:39], v13 offset:2048
s_cbranch_scc1 K3C_dr0
K3C_dk0:
s_add_u32 m0, s30, 0
s_add_u32 s6, s54, 147456
v_mfma_f32_16x16x32_bf16 v[240:243], v[120:123], a[72:75], v[240:243]
buffer_load_dwordx4 v4, s[16:19], s6 offen offset:0 lds
ds_read_b64_tr_b16 v[40:41], v10 offset:4096
v_mfma_f32_16x16x32_bf16 v[244:247], v[120:123], a[76:79], v[244:247]
ds_read_b64_tr_b16 v[42:43], v10 offset:6144
v_mfma_f32_16x16x32_bf16 v[248:251], v[124:127], a[72:75], v[248:251]
ds_read_b64_tr_b16 v[44:45], v11 offset:4096
v_mfma_f32_16x16x32_bf16 v[252:255], v[124:127], a[76:79], v[252:255]
ds_read_b64_tr_b16 v[46:47], v11 offset:6144
s_waitcnt lgkmcnt(4)
v_mfma_f32_16x16x32_bf16 v[192:195], v[24:27], v[48:51], v[192:195]
buffer_load_dwordx4 v5, s[16:19], s6 offen offset:1024 lds
ds_read_b64_tr_b16 v[120:121], v12 offset:4096
v_mfma_f32_16x16x32_bf16 v[200:203], v[24:27], v[52:55], v[200:203]
ds_read_b64_tr_b16 v[122:123], v12 offset:6144
v_mfma_f32_16x16x32_bf16 v[196:199], v[28:31], v[48:51], v[196:199]
ds_read_b64_tr_b16 v[124:125], v13 offset:4096
s_add_u32 m0, s30, 8192
v_mfma_f32_16x16x32_bf16 v[204:207], v[28:31], v[52:55], v[204:207]
ds_read_b64_tr_b16 v[126:127], v13 offset:6144
s_add_u32 s6, s54, 516096
s_waitcnt vmcnt(13)
v_mfma_f32_16x16x32_bf16 v[208:211], v[32:35], v[48:51], v[208:211]
buffer_load_dwordx4 v4, s[16:19], s6 offen offset:0 lds
ds_read_b64_tr_b16 v[24:25], v10 offset:8192
v_bitop3_b32 v21, v21, v64, v65 bitop3:0x96
v_mfma_f32_16x16x32_bf16 v[216:219], v[32:35], v[52:55], v[216:219]
ds_read_b64_tr_b16 v[26:27], v10 offset:10240
v_bitop3_b32 v21, v21, v66, v67 bitop3:0x96
v_bitop3_b32 v21, v21, v68, v69 bitop3:0x96
v_mfma_f32_16x16x32_bf16 v[212:215], v[36:39], v[48:51], v[212:215]
ds_read_b64_tr_b16 v[28:29], v11 offset:8192
v_bitop3_b32 v21, v21, v70, v71 bitop3:0x96
v_bitop3_b32 v21, v21, v72, v73 bitop3:0x96
v_bitop3_b32 v21, v21, v74, v75 bitop3:0x96
v_bitop3_b32 v21, v21, v76, v77 bitop3:0x96
v_bitop3_b32 v21, v21, v78, v79 bitop3:0x96
v_mfma_f32_16x16x32_bf16 v[220:223], v[36:39], v[52:55], v[220:223]
ds_read_b64_tr_b16 v[30:31], v11 offset:10240
v_cmp_ne_u32 s[56:57], s52, v21
s_cmp_lg_u64 s[56:57], 0
s_cbranch_scc1 K3C_dr1
K3C_dk1:
s_waitcnt lgkmcnt(4)
v_mfma_f32_16x16x32_bf16 v[192:195], v[40:43], v[56:59], v[192:195]
buffer_load_dwordx4 v5, s[16:19], s6 offen offset:1024 lds
ds_read_b64_tr_b16 v[32:33], v12 offset:8192
v_mfma_f32_16x16x32_bf16 v[200:203], v[40:43], v[60:63], v[200:203]
ds_read_b64_tr_b16 v[34:35], v12 offset:10240
v_mfma_f32_16x16x32_bf16 v[196:199], v[44:47], v[56:59], v[196:199]
ds_read_b64_tr_b16 v[36:37], v13 offset:8192
s_add_u32 m0, s30, 16384
v_mfma_f32_16x16x32_bf16 v[204:207], v[44:47], v[60:63], v[204:207]
ds_read_b64_tr_b16 v[38:39], v13 offset:10240
s_add_u32 s6, s54, 884736
v_mfma_f32_16x16x32_bf16 v[208:211], v[120:123], v[56:59], v[208:211]
buffer_load_dwordx4 v4, s[16:19], s6 offen offset:0 lds
ds_read_b64_tr_b16 v[40:41], v10 offset:12288
v_mfma_f32_16x16x32_bf16 v[216:219], v[120:123], v[60:63], v[216:219]
ds_read_b64_tr_b16 v[42:43], v10 offset:14336
v_mfma_f32_16x16x32_bf16 v[212:215], v[124:127], v[56:59], v[212:215]
ds_read_b64_tr_b16 v[44:45], v11 offset:12288
v_mfma_f32_16x16x32_bf16 v[220:223], v[124:127], v[60:63], v[220:223]
ds_read_b64_tr_b16 v[46:47], v11 offset:14336
s_waitcnt lgkmcnt(4)
v_mfma_f32_16x16x32_bf16 v[192:195], v[24:27], v[64:67], v[192:195]
buffer_load_dwordx4 v5, s[16:19], s6 offen offset:1024 lds
ds_read_b64_tr_b16 v[120:121], v12 offset:12288
v_mfma_f32_16x16x32_bf16 v[200:203], v[24:27], v[68:71], v[200:203]
ds_read_b64_tr_b16 v[122:123], v12 offset:14336
v_mfma_f32_16x16x32_bf16 v[196:199], v[28:31], v[64:67], v[196:199]
ds_read_b64_tr_b16 v[124:125], v13 offset:12288
s_add_u32 m0, s30, 24576
v_mfma_f32_16x16x32_bf16 v[204:207], v[28:31], v[68:71], v[204:207]
ds_read_b64_tr_b16 v[126:127], v13 offset:14336
s_add_u32 s6, s54, 221184
s_waitcnt vmcnt(12)
v_mfma_f32_16x16x32_bf16 v[208:211], v[32:35], v[64:67], v[208:211]
buffer_load_dwordx4 v4, s[16:19], s6 offen offset:0 lds
ds_read_b64_tr_b16 v[24:25], v10 offset:16384
v_bitop3_b32 v22, v22, v80, v81 bitop3:0x96
v_mfma_f32_16x16x32_bf16 v[216:219], v[32:35], v[68:71], v[216:219]
ds_read_b64_tr_b16 v[26:27], v10 offset:18432
v_bitop3_b32 v22, v22, v82, v83 bitop3:0x96
v_bitop3_b32 v22, v22, v84, v85 bitop3:0x96
v_mfma_f32_16x16x32_bf16 v[212:215], v[36:39], v[64:67], v[212:215]
ds_read_b64_tr_b16 v[28:29], v11 offset:16384
v_bitop3_b32 v22, v22, v86, v87 bitop3:0x96
v_bitop3_b32 v22, v22, v88, v89 bitop3:0x96
v_bitop3_b32 v22, v22, v90, v91 bitop3:0x96
v_bitop3_b32 v22, v22, v92, v93 bitop3:0x96
v_bitop3_b32 v22, v22, v94, v95 bitop3:0x96
v_mfma_f32_16x16x32_bf16 v[220:223], v[36:39], v[68:71], v[220:223]
ds_read_b64_tr_b16 v[30:31], v11 offset:18432
v_cmp_ne_u32 s[56:57], s52, v22
s_cmp_lg_u64 s[56:57], 0
s_cbranch_scc1 K3C_dr2
K3C_dk2:
s_waitcnt lgkmcnt(4)
v_mfma_f32_16x16x32_bf16 v[192:195], v[40:43], v[72:75], v[192:195]
buffer_load_dwordx4 v5, s[16:19], s6 offen offset:1024 lds
ds_read_b64_tr_b16 v[32:33], v12 offset:16384
v_mfma_f32_16x16x32_bf16 v[200:203], v[40:43], v[76:79], v[200:203]
ds_read_b64_tr_b16 v[34:35], v12 offset:18432
v_mfma_f32_16x16x32_bf16 v[196:199], v[44:47], v[72:75], v[196:199]
ds_read_b64_tr_b16 v[36:37], v13 offset:16384
s_add_u32 m0, s30, 32768
v_mfma_f32_16x16x32_bf16 v[204:207], v[44:47], v[76:79], v[204:207]
ds_read_b64_tr_b16 v[38:39], v13 offset:18432
s_add_u32 s6, s54, 589824
v_mfma_f32_16x16x32_bf16 v[208:211], v[120:123], v[72:75], v[208:211]
buffer_load_dwordx4 v4, s[16:19], s6 offen offset:0 lds
ds_read_b64_tr_b16 v[40:41], v10 offset:20480
v_mfma_f32_16x16x32_bf16 v[216:219], v[120:123], v[76:79], v[216:219]
ds_read_b64_tr_b16 v[42:43], v10 offset:22528
v_mfma_f32_16x16x32_bf16 v[212:215], v[124:127], v[72:75], v[212:215]
ds_read_b64_tr_b16 v[44:45], v11 offset:20480
v_mfma_f32_16x16x32_bf16 v[220:223], v[124:127], v[76:79], v[220:223]
ds_read_b64_tr_b16 v[46:47], v11 offset:22528
s_waitcnt lgkmcnt(4)
v_mfma_f32_16x16x32_bf16 v[192:195], v[24:27], v[80:83], v[192:195]
buffer_load_dwordx4 v5, s[16:19], s6 offen offset:1024 lds
ds_read_b64_tr_b16 v[120:121], v12 offset:20480
v_mfma_f32_16x16x32_bf16 v[200:203], v[24:27], v[84:87], v[200:203]
ds_read_b64_tr_b16 v[122:123], v12 offset:22528
v_mfma_f32_16x16x32_bf16 v[196:199], v[28:31], v[80:83], v[196:199]
ds_read_b64_tr_b16 v[124:125], v13 offset:20480
s_add_u32 m0, s30, 40960
v_mfma_f32_16x16x32_bf16 v[204:207], v[28:31], v[84:87], v[204:207]
ds_read_b64_tr_b16 v[126:127], v13 offset:22528
s_add_u32 s6, s54, 958464
v_mfma_f32_16x16x32_bf16 v[208:211], v[32:35], v[80:83], v[208:211]
v_mfma_f32_16x16x32_bf16 v[216:219], v[32:35], v[84:87], v[216:219]
s_waitcnt vmcnt(10)
s_barrier
buffer_load_dwordx4 v4, s[16:19], s6 offen offset:0 lds
v_add_u32 v6, 49152, v6
ds_read_b64_tr_b16 v[24:25], v6 offset:24576
ds_read_b64_tr_b16 v[26:27], v6 offset:26624
v_mfma_f32_16x16x32_bf16 v[212:215], v[36:39], v[80:83], v[212:215]
v_add_u32 v7, 49152, v7
ds_read_b64_tr_b16 v[28:29], v7 offset:24576
v_mfma_f32_16x16x32_bf16 v[220:223], v[36:39], v[84:87], v[220:223]
ds_read_b64_tr_b16 v[30:31], v7 offset:26624
s_waitcnt lgkmcnt(4)
v_mfma_f32_16x16x32_bf16 v[192:195], v[40:43], v[88:91], v[192:195]
buffer_load_dwordx4 v5, s[16:19], s6 offen offset:1024 lds
v_add_u32 v8, 49152, v8
ds_read_b64_tr_b16 v[32:33], v8 offset:24576
v_mfma_f32_16x16x32_bf16 v[200:203], v[40:43], v[92:95], v[200:203]
ds_read_b64_tr_b16 v[34:35], v8 offset:26624
v_mfma_f32_16x16x32_bf16 v[196:199], v[44:47], v[88:91], v[196:199]
v_add_u32 v9, 49152, v9
ds_read_b64_tr_b16 v[36:37], v9 offset:24576
v_mfma_f32_16x16x32_bf16 v[204:207], v[44:47], v[92:95], v[204:207]
ds_read_b64_tr_b16 v[38:39], v9 offset:26624
s_add_u32 m0, s30, 49152
s_add_u32 s6, s54, 294912
v_mfma_f32_16x16x32_bf16 v[208:211], v[120:123], v[88:91], v[208:211]
buffer_load_dwordx4 v4, s[16:19], s6 offen offset:0 lds
ds_read_b64_tr_b16 v[40:41], v6 offset:28672
v_mfma_f32_16x16x32_bf16 v[216:219], v[120:123], v[92:95], v[216:219]
ds_read_b64_tr_b16 v[42:43], v6 offset:30720
v_mfma_f32_16x16x32_bf16 v[212:215], v[124:127], v[88:91], v[212:215]
ds_read_b64_tr_b16 v[44:45], v7 offset:28672
v_mfma_f32_16x16x32_bf16 v[220:223], v[124:127], v[92:95], v[220:223]
ds_read_b64_tr_b16 v[46:47], v7 offset:30720
s_waitcnt lgkmcnt(4)
v_mfma_f32_16x16x32_bf16 v[224:227], v[24:27], v[48:51], v[224:227]
buffer_load_dwordx4 v5, s[16:19], s6 offen offset:1024 lds
ds_read_b64_tr_b16 v[120:121], v8 offset:28672
v_mfma_f32_16x16x32_bf16 v[228:231], v[24:27], v[52:55], v[228:231]
ds_read_b64_tr_b16 v[122:123], v8 offset:30720
v_cvt_pk_bf16_f32 v192, v192, v193
v_cvt_pk_bf16_f32 v193, v194, v195
v_mfma_f32_16x16x32_bf16 v[232:235], v[28:31], v[48:51], v[232:235]
ds_read_b64_tr_b16 v[124:125], v9 offset:28672
s_add_u32 m0, s30, 57344
s_add_u32 s6, s54, 663552
v_mfma_f32_16x16x32_bf16 v[236:239], v[28:31], v[52:55], v[236:239]
ds_read_b64_tr_b16 v[126:127], v9 offset:30720
v_cvt_pk_bf16_f32 v194, v196, v197
v_cvt_pk_bf16_f32 v195, v198, v199
v_mfma_f32_16x16x32_bf16 v[240:243], v[32:35], v[48:51], v[240:243]
buffer_load_dwordx4 v4, s[16:19], s6 offen offset:0 lds
ds_read_b64_tr_b16 v[24:25], v6 offset:32768
v_mfma_f32_16x16x32_bf16 v[244:247], v[32:35], v[52:55], v[244:247]
ds_read_b64_tr_b16 v[26:27], v6 offset:34816
v_mfma_f32_16x16x32_bf16 v[248:251], v[36:39], v[48:51], v[248:251]
ds_read_b64_tr_b16 v[28:29], v7 offset:32768
v_mfma_f32_16x16x32_bf16 v[252:255], v[36:39], v[52:55], v[252:255]
ds_read_b64_tr_b16 v[30:31], v7 offset:34816
s_waitcnt lgkmcnt(4)
v_mfma_f32_16x16x32_bf16 v[224:227], v[40:43], v[56:59], v[224:227]
buffer_load_dwordx4 v5, s[16:19], s6 offen offset:1024 lds
ds_read_b64_tr_b16 v[32:33], v8 offset:32768
v_mfma_f32_16x16x32_bf16 v[228:231], v[40:43], v[60:63], v[228:231]
ds_read_b64_tr_b16 v[34:35], v8 offset:34816
v_mfma_f32_16x16x32_bf16 v[232:235], v[44:47], v[56:59], v[232:235]
ds_read_b64_tr_b16 v[36:37], v9 offset:32768
s_add_u32 m0, s30, 65536
v_mfma_f32_16x16x32_bf16 v[236:239], v[44:47], v[60:63], v[236:239]
ds_read_b64_tr_b16 v[38:39], v9 offset:34816
s_add_u32 s6, s54, 1032192
v_mfma_f32_16x16x32_bf16 v[240:243], v[120:123], v[56:59], v[240:243]
buffer_load_dwordx4 v4, s[16:19], s6 offen offset:0 lds
ds_read_b64_tr_b16 v[40:41], v6 offset:36864
v_mfma_f32_16x16x32_bf16 v[244:247], v[120:123], v[60:63], v[244:247]
ds_read_b64_tr_b16 v[42:43], v6 offset:38912
v_mfma_f32_16x16x32_bf16 v[248:251], v[124:127], v[56:59], v[248:251]
ds_read_b64_tr_b16 v[44:45], v7 offset:36864
v_mfma_f32_16x16x32_bf16 v[252:255], v[124:127], v[60:63], v[252:255]
ds_read_b64_tr_b16 v[46:47], v7 offset:38912
s_waitcnt lgkmcnt(4)
v_mfma_f32_16x16x32_bf16 v[224:227], v[24:27], v[64:67], v[224:227]
buffer_load_dwordx4 v5, s[16:19], s6 offen offset:1024 lds
ds_read_b64_tr_b16 v[120:121], v8 offset:36864
v_mfma_f32_16x16x32_bf16 v[228:231], v[24:27], v[68:71], v[228:231]
ds_read_b64_tr_b16 v[122:123], v8 offset:38912
v_mfma_f32_16x16x32_bf16 v[232:235], v[28:31], v[64:67], v[232:235]
buffer_store_dwordx4 v[192:195], v1, s[8:11], s65 offen offset:0 sc1
ds_read_b64_tr_b16 v[124:125], v9 offset:36864
v_mfma_f32_16x16x32_bf16 v[236:239], v[28:31], v[68:71], v[236:239]
ds_read_b64_tr_b16 v[126:127], v9 offset:38912
v_bitop3_b32 v21, v15, v192, v193 bitop3:0x96
v_bitop3_b32 v21, v21, v194, v195 bitop3:0x96
v_mfma_f32_16x16x32_bf16 v[240:243], v[32:35], v[64:67], v[240:243]
ds_read_b64_tr_b16 v[24:25], v6 offset:40960
v_cvt_pk_bf16_f32 v200, v200, v201
v_cvt_pk_bf16_f32 v201, v202, v203
v_mfma_f32_16x16x32_bf16 v[244:247], v[32:35], v[68:71], v[244:247]
ds_read_b64_tr_b16 v[26:27], v6 offset:43008
v_cvt_pk_bf16_f32 v202, v204, v205
v_cvt_pk_bf16_f32 v203, v206, v207
v_mfma_f32_16x16x32_bf16 v[248:251], v[36:39], v[64:67], v[248:251]
buffer_store_dwordx4 v[200:203], v1, s[8:11], s65 offen offset:1024 sc1
ds_read_b64_tr_b16 v[28:29], v7 offset:40960
v_mfma_f32_16x16x32_bf16 v[252:255], v[36:39], v[68:71], v[252:255]
ds_read_b64_tr_b16 v[30:31], v7 offset:43008
v_bitop3_b32 v21, v21, v200, v201 bitop3:0x96
s_waitcnt lgkmcnt(4)
v_mfma_f32_16x16x32_bf16 v[224:227], v[40:43], v[72:75], v[224:227]
ds_read_b64_tr_b16 v[32:33], v8 offset:40960
v_bitop3_b32 v21, v21, v202, v203 bitop3:0x96
v_cvt_pk_bf16_f32 v208, v208, v209
v_mfma_f32_16x16x32_bf16 v[228:231], v[40:43], v[76:79], v[228:231]
ds_read_b64_tr_b16 v[34:35], v8 offset:43008
v_cvt_pk_bf16_f32 v209, v210, v211
v_cvt_pk_bf16_f32 v210, v212, v213
v_mfma_f32_16x16x32_bf16 v[232:235], v[44:47], v[72:75], v[232:235]
ds_read_b64_tr_b16 v[36:37], v9 offset:40960
v_mfma_f32_16x16x32_bf16 v[236:239], v[44:47], v[76:79], v[236:239]
ds_read_b64_tr_b16 v[38:39], v9 offset:43008
v_cvt_pk_bf16_f32 v211, v214, v215
v_mfma_f32_16x16x32_bf16 v[240:243], v[120:123], v[72:75], v[240:243]
buffer_store_dwordx4 v[208:211], v1, s[8:11], s66 offen offset:0 sc1
ds_read_b64_tr_b16 v[40:41], v6 offset:45056
v_mfma_f32_16x16x32_bf16 v[244:247], v[120:123], v[76:79], v[244:247]
ds_read_b64_tr_b16 v[42:43], v6 offset:47104
v_bitop3_b32 v22, v15, v208, v209 bitop3:0x96
v_bitop3_b32 v22, v22, v210, v211 bitop3:0x96
v_mfma_f32_16x16x32_bf16 v[248:251], v[124:127], v[72:75], v[248:251]
ds_read_b64_tr_b16 v[44:45], v7 offset:45056
v_cvt_pk_bf16_f32 v216, v216, v217
v_cvt_pk_bf16_f32 v217, v218, v219
v_mfma_f32_16x16x32_bf16 v[252:255], v[124:127], v[76:79], v[252:255]
ds_read_b64_tr_b16 v[46:47], v7 offset:47104
v_cvt_pk_bf16_f32 v218, v220, v221
s_waitcnt lgkmcnt(4)
v_mfma_f32_16x16x32_bf16 v[224:227], v[24:27], v[80:83], v[224:227]
ds_read_b64_tr_b16 v[120:121], v8 offset:45056
v_mfma_f32_16x16x32_bf16 v[228:231], v[24:27], v[84:87], v[228:231]
ds_read_b64_tr_b16 v[122:123], v8 offset:47104
v_cvt_pk_bf16_f32 v219, v222, v223
v_mfma_f32_16x16x32_bf16 v[232:235], v[28:31], v[80:83], v[232:235]
buffer_store_dwordx4 v[216:219], v1, s[8:11], s66 offen offset:1024 sc1
ds_read_b64_tr_b16 v[124:125], v9 offset:45056
v_mfma_f32_16x16x32_bf16 v[236:239], v[28:31], v[84:87], v[236:239]
ds_read_b64_tr_b16 v[126:127], v9 offset:47104
v_bitop3_b32 v22, v22, v216, v217 bitop3:0x96
v_bitop3_b32 v22, v22, v218, v219 bitop3:0x96
v_mfma_f32_16x16x32_bf16 v[240:243], v[32:35], v[80:83], v[240:243]
v_mfma_f32_16x16x32_bf16 v[244:247], v[32:35], v[84:87], v[244:247]
s_waitcnt vmcnt(16)
s_barrier
v_add_u32 v12, 4294868992, v12
ds_read_b64_tr_b16 v[24:25], v12 offset:0
ds_read_b64_tr_b16 v[26:27], v12 offset:2048
v_mfma_f32_16x16x32_bf16 v[248:251], v[36:39], v[80:83], v[248:251]
v_add_u32 v13, 4294868992, v13
ds_read_b64_tr_b16 v[28:29], v13 offset:0
v_mfma_f32_16x16x32_bf16 v[252:255], v[36:39], v[84:87], v[252:255]
ds_read_b64_tr_b16 v[30:31], v13 offset:2048
s_waitcnt lgkmcnt(4)
v_mfma_f32_16x16x32_bf16 v[224:227], v[40:43], v[88:91], v[224:227]
ds_read_b64_tr_b16 v[32:33], v12 offset:4096
v_mfma_f32_16x16x32_bf16 v[228:231], v[40:43], v[92:95], v[228:231]
ds_read_b64_tr_b16 v[34:35], v12 offset:6144
v_mfma_f32_16x16x32_bf16 v[232:235], v[44:47], v[88:91], v[232:235]
ds_read_b64_tr_b16 v[36:37], v13 offset:4096
v_mfma_f32_16x16x32_bf16 v[236:239], v[44:47], v[92:95], v[236:239]
ds_read_b64_tr_b16 v[38:39], v13 offset:6144
v_mfma_f32_16x16x32_bf16 v[240:243], v[120:123], v[88:91], v[240:243]
ds_read_b64_tr_b16 v[40:41], v12 offset:8192
v_mfma_f32_16x16x32_bf16 v[244:247], v[120:123], v[92:95], v[244:247]
ds_read_b64_tr_b16 v[42:43], v12 offset:10240
v_mfma_f32_16x16x32_bf16 v[248:251], v[124:127], v[88:91], v[248:251]
ds_read_b64_tr_b16 v[44:45], v13 offset:8192
v_mfma_f32_16x16x32_bf16 v[252:255], v[124:127], v[92:95], v[252:255]
ds_read_b64_tr_b16 v[46:47], v13 offset:10240
s_waitcnt lgkmcnt(4)
v_mfma_f32_16x16x32_bf16 v[176:179], v[24:27], a[240:243], v[176:179]
ds_read_b64_tr_b16 v[120:121], v12 offset:12288
v_cvt_pk_bf16_f32 v232, v232, v233
v_cvt_pk_bf16_f32 v233, v234, v235
v_mfma_f32_16x16x32_bf16 v[184:187], v[24:27], a[244:247], v[184:187]
ds_read_b64_tr_b16 v[122:123], v12 offset:14336
v_cvt_pk_bf16_f32 v234, v236, v237
v_cvt_pk_bf16_f32 v235, v238, v239
v_mfma_f32_16x16x32_bf16 v[180:183], v[28:31], a[240:243], v[180:183]
buffer_store_dwordx4 v[232:235], v1, s[8:11], s64 offen offset:2048 sc1
ds_read_b64_tr_b16 v[124:125], v13 offset:12288
v_mfma_f32_16x16x32_bf16 v[188:191], v[28:31], a[244:247], v[188:191]
ds_read_b64_tr_b16 v[126:127], v13 offset:14336
v_bitop3_b32 v20, v15, v232, v233 bitop3:0x96
v_bitop3_b32 v20, v20, v234, v235 bitop3:0x96
v_mfma_f32_16x16x32_bf16 v[176:179], v[32:35], a[248:251], v[176:179]
ds_read_b64_tr_b16 v[24:25], v12 offset:16384
v_cvt_pk_bf16_f32 v240, v240, v241
v_cvt_pk_bf16_f32 v241, v242, v243
v_mfma_f32_16x16x32_bf16 v[184:187], v[32:35], a[252:255], v[184:187]
ds_read_b64_tr_b16 v[26:27], v12 offset:18432
v_cvt_pk_bf16_f32 v242, v244, v245
v_cvt_pk_bf16_f32 v243, v246, v247
v_mfma_f32_16x16x32_bf16 v[180:183], v[36:39], a[248:251], v[180:183]
buffer_store_dwordx4 v[240:243], v1, s[8:11], s65 offen offset:2048 sc1
ds_read_b64_tr_b16 v[28:29], v13 offset:16384
v_mfma_f32_16x16x32_bf16 v[188:191], v[36:39], a[252:255], v[188:191]
ds_read_b64_tr_b16 v[30:31], v13 offset:18432
v_bitop3_b32 v21, v21, v240, v241 bitop3:0x96
s_waitcnt lgkmcnt(4)
v_mfma_f32_16x16x32_bf16 v[176:179], v[40:43], a[0:3], v[176:179]
s_branch PGC_7
.p2align 12
PSC_7:
s_setpc_b64 s[62:63]
PGC_7:
ds_read_b64_tr_b16 v[32:33], v12 offset:20480
v_mfma_f32_16x16x32_bf16 v[184:187], v[40:43], a[4:7], v[184:187]
ds_read_b64_tr_b16 v[34:35], v12 offset:22528
v_bitop3_b32 v21, v21, v242, v243 bitop3:0x96
v_mfma_f32_16x16x32_bf16 v[180:183], v[44:47], a[0:3], v[180:183]
buffer_store_dword v21, v17, s[8:11], s65 offen offset:3072 sc1
ds_read_b64_tr_b16 v[36:37], v13 offset:20480
v_mfma_f32_16x16x32_bf16 v[188:191], v[44:47], a[4:7], v[188:191]
ds_read_b64_tr_b16 v[38:39], v13 offset:22528
v_cvt_pk_bf16_f32 v248, v248, v249
v_cvt_pk_bf16_f32 v249, v250, v251
v_mfma_f32_16x16x32_bf16 v[176:179], v[120:123], a[8:11], v[176:179]
v_mfma_f32_16x16x32_bf16 v[184:187], v[120:123], a[12:15], v[184:187]
s_waitcnt vmcnt(13)
s_barrier
ds_read_b64_tr_b16 v[40:41], v12 offset:24576
ds_read_b64_tr_b16 v[42:43], v12 offset:26624
v_cvt_pk_bf16_f32 v250, v252, v253
v_mfma_f32_16x16x32_bf16 v[180:183], v[124:127], a[8:11], v[180:183]
ds_read_b64_tr_b16 v[44:45], v13 offset:24576
v_cvt_pk_bf16_f32 v251, v254, v255
v_mfma_f32_16x16x32_bf16 v[188:191], v[124:127], a[12:15], v[188:191]
ds_read_b64_tr_b16 v[46:47], v13 offset:26624
s_waitcnt lgkmcnt(4)
v_mfma_f32_16x16x32_bf16 v[176:179], v[24:27], a[16:19], v[176:179]
buffer_store_dwordx4 v[248:251], v1, s[8:11], s66 offen offset:2048 sc1
ds_read_b64_tr_b16 v[120:121], v12 offset:28672
v_mfma_f32_16x16x32_bf16 v[184:187], v[24:27], a[20:23], v[184:187]
ds_read_b64_tr_b16 v[122:123], v12 offset:30720
v_bitop3_b32 v22, v22, v248, v249 bitop3:0x96
v_bitop3_b32 v22, v22, v250, v251 bitop3:0x96
v_mfma_f32_16x16x32_bf16 v[180:183], v[28:31], a[16:19], v[180:183]
buffer_store_dword v22, v17, s[8:11], s66 offen offset:3072 sc1
ds_read_b64_tr_b16 v[124:125], v13 offset:28672
v_mfma_f32_16x16x32_bf16 v[188:191], v[28:31], a[20:23], v[188:191]
ds_read_b64_tr_b16 v[126:127], v13 offset:30720
v_mfma_f32_16x16x32_bf16 v[176:179], v[32:35], a[24:27], v[176:179]
ds_read_b64_tr_b16 v[24:25], v12 offset:32768
v_mfma_f32_16x16x32_bf16 v[184:187], v[32:35], a[28:31], v[184:187]
ds_read_b64_tr_b16 v[26:27], v12 offset:34816
v_mfma_f32_16x16x32_bf16 v[180:183], v[36:39], a[24:27], v[180:183]
ds_read_b64_tr_b16 v[28:29], v13 offset:32768
v_mfma_f32_16x16x32_bf16 v[188:191], v[36:39], a[28:31], v[188:191]
ds_read_b64_tr_b16 v[30:31], v13 offset:34816
s_waitcnt lgkmcnt(4)
v_mfma_f32_16x16x32_bf16 v[176:179], v[40:43], a[32:35], v[176:179]
ds_read_b64_tr_b16 v[32:33], v12 offset:36864
v_mfma_f32_16x16x32_bf16 v[184:187], v[40:43], a[36:39], v[184:187]
ds_read_b64_tr_b16 v[34:35], v12 offset:38912
v_mfma_f32_16x16x32_bf16 v[180:183], v[44:47], a[32:35], v[180:183]
ds_read_b64_tr_b16 v[36:37], v13 offset:36864
v_mfma_f32_16x16x32_bf16 v[188:191], v[44:47], a[36:39], v[188:191]
ds_read_b64_tr_b16 v[38:39], v13 offset:38912
v_mfma_f32_16x16x32_bf16 v[176:179], v[120:123], a[40:43], v[176:179]
ds_read_b64_tr_b16 v[40:41], v12 offset:40960
v_mfma_f32_16x16x32_bf16 v[184:187], v[120:123], a[44:47], v[184:187]
ds_read_b64_tr_b16 v[42:43], v12 offset:43008
v_mfma_f32_16x16x32_bf16 v[180:183], v[124:127], a[40:43], v[180:183]
ds_read_b64_tr_b16 v[44:45], v13 offset:40960
v_mfma_f32_16x16x32_bf16 v[188:191], v[124:127], a[44:47], v[188:191]
ds_read_b64_tr_b16 v[46:47], v13 offset:43008
s_waitcnt lgkmcnt(4)
v_mfma_f32_16x16x32_bf16 v[176:179], v[24:27], a[48:51], v[176:179]
ds_read_b64_tr_b16 v[120:121], v12 offset:45056
v_mfma_f32_16x16x32_bf16 v[184:187], v[24:27], a[52:55], v[184:187]
ds_read_b64_tr_b16 v[122:123], v12 offset:47104
v_mfma_f32_16x16x32_bf16 v[180:183], v[28:31], a[48:51], v[180:183]
ds_read_b64_tr_b16 v[124:125], v13 offset:45056
v_mfma_f32_16x16x32_bf16 v[188:191], v[28:31], a[52:55], v[188:191]
ds_read_b64_tr_b16 v[126:127], v13 offset:47104
v_mfma_f32_16x16x32_bf16 v[176:179], v[32:35], a[56:59], v[176:179]
v_mfma_f32_16x16x32_bf16 v[184:187], v[32:35], a[60:63], v[184:187]
s_waitcnt vmcnt(9)
s_barrier
v_add_u32 v12, 49152, v12
ds_read_b64_tr_b16 v[24:25], v12 offset:0
ds_read_b64_tr_b16 v[26:27], v12 offset:2048
v_mfma_f32_16x16x32_bf16 v[180:183], v[36:39], a[56:59], v[180:183]
v_add_u32 v13, 49152, v13
ds_read_b64_tr_b16 v[28:29], v13 offset:0
v_mfma_f32_16x16x32_bf16 v[188:191], v[36:39], a[60:63], v[188:191]
ds_read_b64_tr_b16 v[30:31], v13 offset:2048
s_waitcnt lgkmcnt(4)
v_mfma_f32_16x16x32_bf16 v[176:179], v[40:43], a[64:67], v[176:179]
ds_read_b64_tr_b16 v[32:33], v12 offset:4096
v_mfma_f32_16x16x32_bf16 v[184:187], v[40:43], a[68:71], v[184:187]
ds_read_b64_tr_b16 v[34:35], v12 offset:6144
v_mfma_f32_16x16x32_bf16 v[180:183], v[44:47], a[64:67], v[180:183]
ds_read_b64_tr_b16 v[36:37], v13 offset:4096
v_mfma_f32_16x16x32_bf16 v[188:191], v[44:47], a[68:71], v[188:191]
ds_read_b64_tr_b16 v[38:39], v13 offset:6144
v_mfma_f32_16x16x32_bf16 v[176:179], v[120:123], a[72:75], v[176:179]
ds_read_b64_tr_b16 v[40:41], v12 offset:8192
v_mfma_f32_16x16x32_bf16 v[184:187], v[120:123], a[76:79], v[184:187]
ds_read_b64_tr_b16 v[42:43], v12 offset:10240
v_mfma_f32_16x16x32_bf16 v[180:183], v[124:127], a[72:75], v[180:183]
ds_read_b64_tr_b16 v[44:45], v13 offset:8192
v_mfma_f32_16x16x32_bf16 v[188:191], v[124:127], a[76:79], v[188:191]
ds_read_b64_tr_b16 v[46:47], v13 offset:10240
s_waitcnt lgkmcnt(4)
v_mfma_f32_16x16x32_bf16 v[176:179], v[24:27], v[48:51], v[176:179]
ds_read_b64_tr_b16 v[120:121], v12 offset:12288
v_mfma_f32_16x16x32_bf16 v[184:187], v[24:27], v[52:55], v[184:187]
ds_read_b64_tr_b16 v[122:123], v12 offset:14336
v_mfma_f32_16x16x32_bf16 v[180:183], v[28:31], v[48:51], v[180:183]
ds_read_b64_tr_b16 v[124:125], v13 offset:12288
v_mfma_f32_16x16x32_bf16 v[188:191], v[28:31], v[52:55], v[188:191]
ds_read_b64_tr_b16 v[126:127], v13 offset:14336
v_mfma_f32_16x16x32_bf16 v[176:179], v[32:35], v[56:59], v[176:179]
ds_read_b64_tr_b16 v[24:25], v12 offset:16384
v_mfma_f32_16x16x32_bf16 v[184:187], v[32:35], v[60:63], v[184:187]
ds_read_b64_tr_b16 v[26:27], v12 offset:18432
v_mfma_f32_16x16x32_bf16 v[180:183], v[36:39], v[56:59], v[180:183]
ds_read_b64_tr_b16 v[28:29], v13 offset:16384
v_mfma_f32_16x16x32_bf16 v[188:191], v[36:39], v[60:63], v[188:191]
ds_read_b64_tr_b16 v[30:31], v13 offset:18432
s_waitcnt lgkmcnt(4)
v_mfma_f32_16x16x32_bf16 v[176:179], v[40:43], v[64:67], v[176:179]
ds_read_b64_tr_b16 v[32:33], v12 offset:20480
v_mfma_f32_16x16x32_bf16 v[184:187], v[40:43], v[68:71], v[184:187]
ds_read_b64_tr_b16 v[34:35], v12 offset:22528
v_mfma_f32_16x16x32_bf16 v[180:183], v[44:47], v[64:67], v[180:183]
ds_read_b64_tr_b16 v[36:37], v13 offset:20480
v_mfma_f32_16x16x32_bf16 v[188:191], v[44:47], v[68:71], v[188:191]
ds_read_b64_tr_b16 v[38:39], v13 offset:22528
v_mfma_f32_16x16x32_bf16 v[176:179], v[120:123], v[72:75], v[176:179]
v_add_u32 v10, 4294868992, v10
ds_read_b64_tr_b16 v[40:41], v10 offset:0
v_mfma_f32_16x16x32_bf16 v[184:187], v[120:123], v[76:79], v[184:187]
ds_read_b64_tr_b16 v[42:43], v10 offset:2048
v_mfma_f32_16x16x32_bf16 v[180:183], v[124:127], v[72:75], v[180:183]
v_add_u32 v11, 4294868992, v11
ds_read_b64_tr_b16 v[44:45], v11 offset:0
v_mfma_f32_16x16x32_bf16 v[188:191], v[124:127], v[76:79], v[188:191]
ds_read_b64_tr_b16 v[46:47], v11 offset:2048
s_waitcnt lgkmcnt(4)
v_mfma_f32_16x16x32_bf16 v[176:179], v[24:27], v[80:83], v[176:179]
ds_read_b64_tr_b16 v[120:121], v10 offset:4096
v_mfma_f32_16x16x32_bf16 v[184:187], v[24:27], v[84:87], v[184:187]
ds_read_b64_tr_b16 v[122:123], v10 offset:6144
v_mfma_f32_16x16x32_bf16 v[180:183], v[28:31], v[80:83], v[180:183]
buffer_load_dwordx4 v[192:195], v1, s[8:11], s68 offen offset:0 sc1
ds_read_b64_tr_b16 v[124:125], v11 offset:4096
v_mfma_f32_16x16x32_bf16 v[188:191], v[28:31], v[84:87], v[188:191]
ds_read_b64_tr_b16 v[126:127], v11 offset:6144
v_mfma_f32_16x16x32_bf16 v[176:179], v[32:35], v[88:91], v[176:179]
ds_read_b64_tr_b16 v[24:25], v10 offset:8192
v_mfma_f32_16x16x32_bf16 v[184:187], v[32:35], v[92:95], v[184:187]
ds_read_b64_tr_b16 v[26:27], v10 offset:10240
v_mfma_f32_16x16x32_bf16 v[180:183], v[36:39], v[88:91], v[180:183]
ds_read_b64_tr_b16 v[28:29], v11 offset:8192
v_mfma_f32_16x16x32_bf16 v[188:191], v[36:39], v[92:95], v[188:191]
ds_read_b64_tr_b16 v[30:31], v11 offset:10240
s_waitcnt lgkmcnt(4)
v_mfma_f32_16x16x32_bf16 v[160:163], v[40:43], a[240:243], v[160:163]
buffer_load_dwordx4 v[196:199], v1, s[8:11], s68 offen offset:1024 sc1
ds_read_b64_tr_b16 v[32:33], v10 offset:12288
v_mfma_f32_16x16x32_bf16 v[168:171], v[40:43], a[244:247], v[168:171]
ds_read_b64_tr_b16 v[34:35], v10 offset:14336
v_mfma_f32_16x16x32_bf16 v[164:167], v[44:47], a[240:243], v[164:167]
ds_read_b64_tr_b16 v[36:37], v11 offset:12288
v_mfma_f32_16x16x32_bf16 v[172:175], v[44:47], a[244:247], v[172:175]
ds_read_b64_tr_b16 v[38:39], v11 offset:14336
v_mfma_f32_16x16x32_bf16 v[160:163], v[120:123], a[248:251], v[160:163]
ds_read_b64_tr_b16 v[40:41], v10 offset:16384
v_cvt_pk_bf16_f32 v176, v176, v177
v_cvt_pk_bf16_f32 v177, v178, v179
v_mfma_f32_16x16x32_bf16 v[168:171], v[120:123], a[252:255], v[168:171]
ds_read_b64_tr_b16 v[42:43], v10 offset:18432
v_cvt_pk_bf16_f32 v178, v180, v181
v_cvt_pk_bf16_f32 v179, v182, v183
v_mfma_f32_16x16x32_bf16 v[164:167], v[124:127], a[248:251], v[164:167]
buffer_store_dwordx4 v[176:179], v1, s[8:11], s64 offen offset:0 sc1
ds_read_b64_tr_b16 v[44:45], v11 offset:16384
v_mfma_f32_16x16x32_bf16 v[172:175], v[124:127], a[252:255], v[172:175]
ds_read_b64_tr_b16 v[46:47], v11 offset:18432
v_bitop3_b32 v20, v20, v176, v177 bitop3:0x96
s_waitcnt lgkmcnt(4)
v_mfma_f32_16x16x32_bf16 v[160:163], v[24:27], a[0:3], v[160:163]
ds_read_b64_tr_b16 v[120:121], v10 offset:20480
v_bitop3_b32 v20, v20, v178, v179 bitop3:0x96
v_cvt_pk_bf16_f32 v184, v184, v185
v_mfma_f32_16x16x32_bf16 v[168:171], v[24:27], a[4:7], v[168:171]
ds_read_b64_tr_b16 v[122:123], v10 offset:22528
v_cvt_pk_bf16_f32 v185, v186, v187
v_cvt_pk_bf16_f32 v186, v188, v189
v_mfma_f32_16x16x32_bf16 v[164:167], v[28:31], a[0:3], v[164:167]
ds_read_b64_tr_b16 v[124:125], v11 offset:20480
v_mfma_f32_16x16x32_bf16 v[172:175], v[28:31], a[4:7], v[172:175]
ds_read_b64_tr_b16 v[126:127], v11 offset:22528
v_cvt_pk_bf16_f32 v187, v190, v191
v_mfma_f32_16x16x32_bf16 v[160:163], v[32:35], a[8:11], v[160:163]
buffer_store_dwordx4 v[184:187], v1, s[8:11], s64 offen offset:1024 sc1
ds_read_b64_tr_b16 v[24:25], v10 offset:24576
v_mfma_f32_16x16x32_bf16 v[168:171], v[32:35], a[12:15], v[168:171]
ds_read_b64_tr_b16 v[26:27], v10 offset:26624
v_bitop3_b32 v20, v20, v184, v185 bitop3:0x96
v_bitop3_b32 v20, v20, v186, v187 bitop3:0x96
v_mfma_f32_16x16x32_bf16 v[164:167], v[36:39], a[8:11], v[164:167]
buffer_store_dword v20, v17, s[8:11], s64 offen offset:3072 sc1
ds_read_b64_tr_b16 v[28:29], v11 offset:24576
v_mfma_f32_16x16x32_bf16 v[172:175], v[36:39], a[12:15], v[172:175]
ds_read_b64_tr_b16 v[30:31], v11 offset:26624
s_waitcnt lgkmcnt(4)
v_mfma_f32_16x16x32_bf16 v[160:163], v[40:43], a[16:19], v[160:163]
ds_read_b64_tr_b16 v[32:33], v10 offset:28672
v_mfma_f32_16x16x32_bf16 v[168:171], v[40:43], a[20:23], v[168:171]
ds_read_b64_tr_b16 v[34:35], v10 offset:30720
v_mfma_f32_16x16x32_bf16 v[164:167], v[44:47], a[16:19], v[164:167]
ds_read_b64_tr_b16 v[36:37], v11 offset:28672
v_mfma_f32_16x16x32_bf16 v[172:175], v[44:47], a[20:23], v[172:175]
ds_read_b64_tr_b16 v[38:39], v11 offset:30720
v_mfma_f32_16x16x32_bf16 v[160:163], v[120:123], a[24:27], v[160:163]
buffer_load_dwordx4 v[200:203], v1, s[8:11], s68 offen offset:2048 sc1
ds_read_b64_tr_b16 v[40:41], v10 offset:32768
v_mfma_f32_16x16x32_bf16 v[168:171], v[120:123], a[28:31], v[168:171]
ds_read_b64_tr_b16 v[42:43], v10 offset:34816
v_mfma_f32_16x16x32_bf16 v[164:167], v[124:127], a[24:27], v[164:167]
ds_read_b64_tr_b16 v[44:45], v11 offset:32768
v_mfma_f32_16x16x32_bf16 v[172:175], v[124:127], a[28:31], v[172:175]
ds_read_b64_tr_b16 v[46:47], v11 offset:34816
s_waitcnt lgkmcnt(4)
v_mfma_f32_16x16x32_bf16 v[160:163], v[24:27], a[32:35], v[160:163]
ds_read_b64_tr_b16 v[120:121], v10 offset:36864
v_mfma_f32_16x16x32_bf16 v[168:171], v[24:27], a[36:39], v[168:171]
ds_read_b64_tr_b16 v[122:123], v10 offset:38912
v_mfma_f32_16x16x32_bf16 v[164:167], v[28:31], a[32:35], v[164:167]
buffer_load_dword v204, v17, s[8:11], s68 offen offset:3072 sc1
ds_read_b64_tr_b16 v[124:125], v11 offset:36864
v_mfma_f32_16x16x32_bf16 v[172:175], v[28:31], a[36:39], v[172:175]
ds_read_b64_tr_b16 v[126:127], v11 offset:38912
v_mfma_f32_16x16x32_bf16 v[160:163], v[32:35], a[40:43], v[160:163]
ds_read_b64_tr_b16 v[24:25], v10 offset:40960
v_mfma_f32_16x16x32_bf16 v[168:171], v[32:35], a[44:47], v[168:171]
ds_read_b64_tr_b16 v[26:27], v10 offset:43008
v_mfma_f32_16x16x32_bf16 v[164:167], v[36:39], a[40:43], v[164:167]
ds_read_b64_tr_b16 v[28:29], v11 offset:40960
v_mfma_f32_16x16x32_bf16 v[172:175], v[36:39], a[44:47], v[172:175]
ds_read_b64_tr_b16 v[30:31], v11 offset:43008
s_waitcnt lgkmcnt(4)
v_mfma_f32_16x16x32_bf16 v[160:163], v[40:43], a[48:51], v[160:163]
buffer_load_dwordx4 v[208:211], v1, s[8:11], s69 offen offset:0 sc1
ds_read_b64_tr_b16 v[32:33], v10 offset:45056
v_mfma_f32_16x16x32_bf16 v[168:171], v[40:43], a[52:55], v[168:171]
ds_read_b64_tr_b16 v[34:35], v10 offset:47104
v_mfma_f32_16x16x32_bf16 v[164:167], v[44:47], a[48:51], v[164:167]
ds_read_b64_tr_b16 v[36:37], v11 offset:45056
v_mfma_f32_16x16x32_bf16 v[172:175], v[44:47], a[52:55], v[172:175]
ds_read_b64_tr_b16 v[38:39], v11 offset:47104
v_mfma_f32_16x16x32_bf16 v[160:163], v[120:123], a[56:59], v[160:163]
buffer_load_dwordx4 v[212:215], v1, s[8:11], s69 offen offset:1024 sc1
v_add_u32 v10, 49152, v10
ds_read_b64_tr_b16 v[40:41], v10 offset:0
v_mfma_f32_16x16x32_bf16 v[168:171], v[120:123], a[60:63], v[168:171]
ds_read_b64_tr_b16 v[42:43], v10 offset:2048
v_mfma_f32_16x16x32_bf16 v[164:167], v[124:127], a[56:59], v[164:167]
v_add_u32 v11, 49152, v11
ds_read_b64_tr_b16 v[44:45], v11 offset:0
v_mfma_f32_16x16x32_bf16 v[172:175], v[124:127], a[60:63], v[172:175]
ds_read_b64_tr_b16 v[46:47], v11 offset:2048
s_waitcnt lgkmcnt(4)
v_mfma_f32_16x16x32_bf16 v[160:163], v[24:27], a[64:67], v[160:163]
buffer_load_dwordx4 v[216:219], v1, s[8:11], s69 offen offset:2048 sc1
ds_read_b64_tr_b16 v[120:121], v10 offset:4096
v_mfma_f32_16x16x32_bf16 v[168:171], v[24:27], a[68:71], v[168:171]
ds_read_b64_tr_b16 v[122:123], v10 offset:6144
v_mfma_f32_16x16x32_bf16 v[164:167], v[28:31], a[64:67], v[164:167]
ds_read_b64_tr_b16 v[124:125], v11 offset:4096
v_mfma_f32_16x16x32_bf16 v[172:175], v[28:31], a[68:71], v[172:175]
ds_read_b64_tr_b16 v[126:127], v11 offset:6144
v_mfma_f32_16x16x32_bf16 v[160:163], v[32:35], a[72:75], v[160:163]
buffer_load_dword v220, v17, s[8:11], s69 offen offset:3072 sc1
ds_read_b64_tr_b16 v[24:25], v10 offset:8192
v_mfma_f32_16x16x32_bf16 v[168:171], v[32:35], a[76:79], v[168:171]
ds_read_b64_tr_b16 v[26:27], v10 offset:10240
v_mfma_f32_16x16x32_bf16 v[164:167], v[36:39], a[72:75], v[164:167]
ds_read_b64_tr_b16 v[28:29], v11 offset:8192
v_mfma_f32_16x16x32_bf16 v[172:175], v[36:39], a[76:79], v[172:175]
ds_read_b64_tr_b16 v[30:31], v11 offset:10240
s_waitcnt lgkmcnt(4)
v_mfma_f32_16x16x32_bf16 v[160:163], v[40:43], v[48:51], v[160:163]
ds_read_b64_tr_b16 v[32:33], v10 offset:12288
v_mfma_f32_16x16x32_bf16 v[168:171], v[40:43], v[52:55], v[168:171]
ds_read_b64_tr_b16 v[34:35], v10 offset:14336
v_mfma_f32_16x16x32_bf16 v[164:167], v[44:47], v[48:51], v[164:167]
ds_read_b64_tr_b16 v[36:37], v11 offset:12288
v_mfma_f32_16x16x32_bf16 v[172:175], v[44:47], v[52:55], v[172:175]
ds_read_b64_tr_b16 v[38:39], v11 offset:14336
v_mfma_f32_16x16x32_bf16 v[160:163], v[120:123], v[56:59], v[160:163]
ds_read_b64_tr_b16 v[40:41], v10 offset:16384
v_mfma_f32_16x16x32_bf16 v[168:171], v[120:123], v[60:63], v[168:171]
ds_read_b64_tr_b16 v[42:43], v10 offset:18432
v_mfma_f32_16x16x32_bf16 v[164:167], v[124:127], v[56:59], v[164:167]
buffer_load_dwordx4 v[176:179], v1, s[8:11], s67 offen offset:0 sc1
ds_read_b64_tr_b16 v[44:45], v11 offset:16384
v_mfma_f32_16x16x32_bf16 v[172:175], v[124:127], v[60:63], v[172:175]
ds_read_b64_tr_b16 v[46:47], v11 offset:18432
s_waitcnt lgkmcnt(4)
v_mfma_f32_16x16x32_bf16 v[160:163], v[24:27], v[64:67], v[160:163]
ds_read_b64_tr_b16 v[120:121], v10 offset:20480
v_mfma_f32_16x16x32_bf16 v[168:171], v[24:27], v[68:71], v[168:171]
ds_read_b64_tr_b16 v[122:123], v10 offset:22528
v_mfma_f32_16x16x32_bf16 v[164:167], v[28:31], v[64:67], v[164:167]
buffer_load_dwordx4 v[180:183], v1, s[8:11], s67 offen offset:1024 sc1
ds_read_b64_tr_b16 v[124:125], v11 offset:20480
v_mfma_f32_16x16x32_bf16 v[172:175], v[28:31], v[68:71], v[172:175]
ds_read_b64_tr_b16 v[126:127], v11 offset:22528
v_mfma_f32_16x16x32_bf16 v[160:163], v[32:35], v[72:75], v[160:163]
v_mfma_f32_16x16x32_bf16 v[168:171], v[32:35], v[76:79], v[168:171]
v_mfma_f32_16x16x32_bf16 v[164:167], v[36:39], v[72:75], v[164:167]
buffer_load_dwordx4 v[184:187], v1, s[8:11], s67 offen offset:2048 sc1
v_mfma_f32_16x16x32_bf16 v[172:175], v[36:39], v[76:79], v[172:175]
s_waitcnt lgkmcnt(0)
v_mfma_f32_16x16x32_bf16 v[160:163], v[40:43], v[80:83], v[160:163]
v_mfma_f32_16x16x32_bf16 v[168:171], v[40:43], v[84:87], v[168:171]
v_mfma_f32_16x16x32_bf16 v[164:167], v[44:47], v[80:83], v[164:167]
buffer_load_dword v188, v17, s[8:11], s67 offen offset:3072 sc1
v_mfma_f32_16x16x32_bf16 v[172:175], v[44:47], v[84:87], v[172:175]
v_mfma_f32_16x16x32_bf16 v[160:163], v[120:123], v[88:91], v[160:163]
v_mfma_f32_16x16x32_bf16 v[168:171], v[120:123], v[92:95], v[168:171]
v_mfma_f32_16x16x32_bf16 v[164:167], v[124:127], v[88:91], v[164:167]
v_mfma_f32_16x16x32_bf16 v[172:175], v[124:127], v[92:95], v[172:175]
s_mov_b32 s51, 0
s_waitcnt vmcnt(8)
K3C_chk2:
v_bitop3_b32 v205, v192, v193, v194 bitop3:0x96
v_bitop3_b32 v204, v204, v195, v196 bitop3:0x96
v_bitop3_b32 v205, v205, v197, v198 bitop3:0x96
v_bitop3_b32 v204, v204, v200, v201 bitop3:0x96
v_bitop3_b32 v205, v205, v202, v203 bitop3:0x96
v_bitop3_b32 v204, v204, v205, v199 bitop3:0x96
v_cmp_ne_u32 vcc, s52, v204
s_cbranch_vccnz K3C_rt2
K3C_go2:
v_mfma_f32_16x16x32_bf16 v[224:227], v[154:157], v[200:203], v[224:227]
v_mfma_f32_16x16x32_bf16 v[228:231], v[152:155], v[200:203], v[228:231]
v_mfma_f32_16x16x32_bf16 v[160:163], v[154:157], v[192:195], v[160:163]
v_mfma_f32_16x16x32_bf16 v[164:167], v[152:155], v[192:195], v[164:167]
v_mfma_f32_16x16x32_bf16 v[168:171], v[154:157], v[196:199], v[168:171]
v_mfma_f32_16x16x32_bf16 v[172:175], v[152:155], v[196:199], v[172:175]
s_waitcnt vmcnt(4)
K3C_chk3:
v_bitop3_b32 v221, v208, v209, v210 bitop3:0x96
v_bitop3_b32 v220, v220, v211, v212 bitop3:0x96
v_bitop3_b32 v221, v221, v213, v214 bitop3:0x96
v_bitop3_b32 v220, v220, v216, v217 bitop3:0x96
v_bitop3_b32 v221, v221, v218, v219 bitop3:0x96
v_bitop3_b32 v220, v220, v221, v215 bitop3:0x96
v_cmp_ne_u32 vcc, s52, v220
s_cbranch_vccnz K3C_rt3
K3C_go3:
v_mfma_f32_16x16x32_bf16 v[224:227], v[154:157], v[216:219], v[224:227]
v_mfma_f32_16x16x32_bf16 v[228:231], v[152:155], v[216:219], v[228:231]
v_mfma_f32_16x16x32_bf16 v[160:163], v[154:157], v[208:211], v[160:163]
v_mfma_f32_16x16x32_bf16 v[164:167], v[152:155], v[208:211], v[164:167]
v_mfma_f32_16x16x32_bf16 v[168:171], v[154:157], v[212:215], v[168:171]
v_mfma_f32_16x16x32_bf16 v[172:175], v[152:155], v[212:215], v[172:175]
s_waitcnt vmcnt(0)
K3C_chk1:
v_bitop3_b32 v189, v176, v177, v178 bitop3:0x96
v_bitop3_b32 v188, v188, v179, v180 bitop3:0x96
v_bitop3_b32 v189, v189, v181, v182 bitop3:0x96
v_bitop3_b32 v188, v188, v184, v185 bitop3:0x96
v_bitop3_b32 v189, v189, v186, v187 bitop3:0x96
v_bitop3_b32 v188, v188, v189, v183 bitop3:0x96
v_cmp_ne_u32 vcc, s52, v188
s_cbranch_vccnz K3C_rt1
K3C_go1:
v_mfma_f32_16x16x32_bf16 v[224:227], v[154:157], v[184:187], v[224:227]
v_mfma_f32_16x16x32_bf16 v[228:231], v[152:155], v[184:187], v[228:231]
v_mfma_f32_16x16x32_bf16 v[160:163], v[154:157], v[176:179], v[160:163]
v_mfma_f32_16x16x32_bf16 v[164:167], v[152:155], v[176:179], v[164:167]
v_mfma_f32_16x16x32_bf16 v[168:171], v[154:157], v[180:183], v[168:171]
v_mfma_f32_16x16x32_bf16 v[172:175], v[152:155], v[180:183], v[172:175]
s_nop 2
v_fma_f32 v224, v224, v18, v112
v_fma_f32 v225, v225, v18, v113
v_fma_f32 v226, v226, v18, v114
v_fma_f32 v227, v227, v18, v115
v_fma_f32 v228, v228, v16, v116
v_fma_f32 v229, v229, v16, v117
v_fma_f32 v230, v230, v16, v118
v_fma_f32 v231, v231, v16, v119
v_cvt_pk_bf16_f32 v136, v224, v225
v_cvt_pk_bf16_f32 v137, v226, v227
v_cvt_pk_bf16_f32 v138, v228, v229
v_cvt_pk_bf16_f32 v139, v230, v231
s_nop 0
v_permlane16_swap_b32 v136, v138
v_permlane16_swap_b32 v137, v139
buffer_store_dwordx4 v[136:139], v2, s[20:23], s46 offen offset:0
v_fma_f32 v160, v160, v18, v96
v_fma_f32 v161, v161, v18, v97
v_fma_f32 v162, v162, v18, v98
v_fma_f32 v163, v163, v18, v99
v_fma_f32 v168, v168, v16, v100
v_fma_f32 v169, v169, v16, v101
v_fma_f32 v170, v170, v16, v102
v_fma_f32 v171, v171, v16, v103
v_cvt_pk_bf16_f32 v128, v160, v161
v_cvt_pk_bf16_f32 v129, v162, v163
v_cvt_pk_bf16_f32 v130, v168, v169
v_cvt_pk_bf16_f32 v131, v170, v171
s_nop 0
v_permlane16_swap_b32 v128, v130
v_permlane16_swap_b32 v129, v131
buffer_store_dwordx4 v[128:131], v2, s[20:23], s38 offen offset:0
v_fma_f32 v164, v164, v18, v104
v_fma_f32 v165, v165, v18, v105
v_fma_f32 v166, v166, v18, v106
v_fma_f32 v167, v167, v18, v107
v_fma_f32 v172, v172, v16, v108
v_fma_f32 v173, v173, v16, v109
v_fma_f32 v174, v174, v16, v110
v_fma_f32 v175, v175, v16, v111
v_cvt_pk_bf16_f32 v132, v164, v165
v_cvt_pk_bf16_f32 v133, v166, v167
v_cvt_pk_bf16_f32 v134, v172, v173
v_cvt_pk_bf16_f32 v135, v174, v175
s_nop 0
v_permlane16_swap_b32 v132, v134
v_permlane16_swap_b32 v133, v135
buffer_store_dwordx4 v[132:135], v2, s[20:23], s38 offen offset:32
s_endpgm
K3C_rt1:
s_add_u32 s51, s51, 1
s_cmp_gt_u32 s51, 20000
s_cbranch_scc1 K3C_go1
buffer_load_dwordx4 v[176:179], v1, s[8:11], s67 offen offset:0 sc1
buffer_load_dwordx4 v[180:183], v1, s[8:11], s67 offen offset:1024 sc1
buffer_load_dwordx4 v[184:187], v1, s[8:11], s67 offen offset:2048 sc1
buffer_load_dword v188, v17, s[8:11], s67 offen offset:3072 sc1
s_waitcnt vmcnt(0)
s_branch K3C_chk1
K3C_rt2:
s_add_u32 s51, s51, 1
s_cmp_gt_u32 s51, 20000
s_cbranch_scc1 K3C_go2
buffer_load_dwordx4 v[192:195], v1, s[8:11], s68 offen offset:0 sc1
buffer_load_dwordx4 v[196:199], v1, s[8:11], s68 offen offset:1024 sc1
buffer_load_dwordx4 v[200:203], v1, s[8:11], s68 offen offset:2048 sc1
buffer_load_dword v204, v17, s[8:11], s68 offen offset:3072 sc1
s_waitcnt vmcnt(0)
s_branch K3C_chk2
K3C_rt3:
s_add_u32 s51, s51, 1
s_cmp_gt_u32 s51, 20000
s_cbranch_scc1 K3C_go3
buffer_load_dwordx4 v[208:211], v1, s[8:11], s69 offen offset:0 sc1
buffer_load_dwordx4 v[212:215], v1, s[8:11], s69 offen offset:1024 sc1
buffer_load_dwordx4 v[216:219], v1, s[8:11], s69 offen offset:2048 sc1
buffer_load_dword v220, v17, s[8:11], s69 offen offset:3072 sc1
s_waitcnt vmcnt(0)
s_branch K3C_chk3
K3C_dr0:
s_mov_b32 s59, 0
s_add_u32 s53, s53, 10000
s_add_u32 s58, s34, 65536
K3C_dl0:
buffer_load_dwordx4 v[48:51], v1, s[8:11], s58 offen offset:0 sc1
buffer_load_dwordx4 v[52:55], v1, s[8:11], s58 offen offset:1024 sc1
buffer_load_dwordx4 v[56:59], v1, s[8:11], s58 offen offset:2048 sc1
buffer_load_dwordx4 v[60:63], v1, s[8:11], s58 offen offset:3072 sc1
buffer_load_dword v20, v19, s[8:11], s58 offen sc1
s_add_u32 s59, s59, 1
s_waitcnt vmcnt(0)
v_bitop3_b32 v20, v20, v48, v49 bitop3:0x96
v_bitop3_b32 v20, v20, v50, v51 bitop3:0x96
v_bitop3_b32 v20, v20, v52, v53 bitop3:0x96
v_bitop3_b32 v20, v20, v54, v55 bitop3:0x96
v_bitop3_b32 v20, v20, v56, v57 bitop3:0x96
v_bitop3_b32 v20, v20, v58, v59 bitop3:0x96
v_bitop3_b32 v20, v20, v60, v61 bitop3:0x96
v_bitop3_b32 v20, v20, v62, v63 bitop3:0x96
v_cmp_ne_u32 s[56:57], s52, v20
s_cmp_gt_u32 s59, 20000
s_cbranch_scc1 K3C_dk0
s_cmp_lg_u64 s[56:57], 0
s_cbranch_scc1 K3C_dl0
s_branch K3C_dk0
K3C_dr1:
s_mov_b32 s59, 0
s_add_u32 s53, s53, 10000
s_add_u32 s58, s34, 163840
K3C_dl1:
buffer_load_dwordx4 v[64:67], v1, s[8:11], s58 offen offset:0 sc1
buffer_load_dwordx4 v[68:71], v1, s[8:11], s58 offen offset:1024 sc1
buffer_load_dwordx4 v[72:75], v1, s[8:11], s58 offen offset:2048 sc1
buffer_load_dwordx4 v[76:79], v1, s[8:11], s58 offen offset:3072 sc1
buffer_load_dword v21, v19, s[8:11], s58 offen sc1
s_add_u32 s59, s59, 1
s_waitcnt vmcnt(0)
v_bitop3_b32 v21, v21, v64, v65 bitop3:0x96
v_bitop3_b32 v21, v21, v66, v67 bitop3:0x96
v_bitop3_b32 v21, v21, v68, v69 bitop3:0x96
v_bitop3_b32 v21, v21, v70, v71 bitop3:0x96
v_bitop3_b32 v21, v21, v72, v73 bitop3:0x96
v_bitop3_b32 v21, v21, v74, v75 bitop3:0x96
v_bitop3_b32 v21, v21, v76, v77 bitop3:0x96
v_bitop3_b32 v21, v21, v78, v79 bitop3:0x96
v_cmp_ne_u32 s[56:57], s52, v21
s_cmp_gt_u32 s59, 20000
s_cbranch_scc1 K3C_dk1
s_cmp_lg_u64 s[56:57], 0
s_cbranch_scc1 K3C_dl1
s_branch K3C_dk1
K3C_dr2:
s_mov_b32 s59, 0
s_add_u32 s53, s53, 10000
s_add_u32 s58, s34, 262144
K3C_dl2:
buffer_load_dwordx4 v[80:83], v1, s[8:11], s58 offen offset:0 sc1
buffer_load_dwordx4 v[84:87], v1, s[8:11], s58 offen offset:1024 sc1
buffer_load_dwordx4 v[88:91], v1, s[8:11], s58 offen offset:2048 sc1
buffer_load_dwordx4 v[92:95], v1, s[8:11], s58 offen offset:3072 sc1
buffer_load_dword v22, v19, s[8:11], s58 offen sc1
s_add_u32 s59, s59, 1
s_waitcnt vmcnt(0)
v_bitop3_b32 v22, v22, v80, v81 bitop3:0x96
v_bitop3_b32 v22, v22, v82, v83 bitop3:0x96
v_bitop3_b32 v22, v22, v84, v85 bitop3:0x96
v_bitop3_b32 v22, v22, v86, v87 bitop3:0x96
v_bitop3_b32 v22, v22, v88, v89 bitop3:0x96
v_bitop3_b32 v22, v22, v90, v91 bitop3:0x96
v_bitop3_b32 v22, v22, v92, v93 bitop3:0x96
v_bitop3_b32 v22, v22, v94, v95 bitop3:0x96
v_cmp_ne_u32 s[56:57], s52, v22
s_cmp_gt_u32 s59, 20000
s_cbranch_scc1 K3C_dk2
s_cmp_lg_u64 s[56:57], 0
s_cbranch_scc1 K3C_dl2
s_branch K3C_dk2
K3C_slow1:
s_mov_b32 s58, 0
s_add_u32 s53, s53, 1
K3C_sl1:
buffer_load_dword v14, v17, s[8:11], s36 offen offset:128 sc1
s_add_u32 s58, s58, 1
s_waitcnt vmcnt(0)
v_cmp_ne_u32 s[56:57], s52, v14
s_cmp_gt_u32 s58, 20000
s_cbranch_scc1 K3C_back1
s_and_b32 s56, s56, 7
s_cbranch_scc1 K3C_sl1
s_branch K3C_back1
K3C_slow2:
s_mov_b32 s58, 0
s_add_u32 s53, s53, 10
K3C_sl2:
buffer_load_dword v14, v17, s[8:11], s36 offen offset:256 sc1
s_add_u32 s58, s58, 1
s_waitcnt vmcnt(0)
v_cmp_ne_u32 s[56:57], s52, v14
s_cmp_gt_u32 s58, 20000
s_cbranch_scc1 K3C_back2
s_and_b32 s56, s56, 7
s_cbranch_scc1 K3C_sl2
s_branch K3C_back2
K3C_slow3:
s_mov_b32 s58, 0
s_add_u32 s53, s53, 100
K3C_sl3:
buffer_load_dword v14, v17, s[8:11], s36 offen offset:384 sc1
s_add_u32 s58, s58, 1
s_waitcnt vmcnt(0)
v_cmp_ne_u32 s[56:57], s52, v14
s_cmp_gt_u32 s58, 20000
s_cbranch_scc1 K3C_back3
s_and_b32 s56, s56, 7
s_cbranch_scc1 K3C_sl3
s_branch K3C_back3
K3C_slow4:
s_mov_b32 s58, 0
s_add_u32 s53, s53, 1000
K3C_sl4:
buffer_load_dword v14, v17, s[8:11], s36 offen offset:512 sc1
s_add_u32 s58, s58, 1
s_waitcnt vmcnt(0)
v_cmp_ne_u32 s[56:57], s52, v14
s_cmp_gt_u32 s58, 20000
s_cbranch_scc1 K3C_back4
s_and_b32 s56, s56, 7
s_cbranch_scc1 K3C_sl4
s_branch K3C_back4
K3_end:
s_endpgm
.fill 8192, 4, 0xbf810000
.section .rodata,"a"
.p2align 6
.amdhsa_kernel sequential_preLN__ssm_conv_s4d__dense_activation_squared_relu__prompt_kernel
  .amdhsa_next_free_vgpr 512
  .amdhsa_next_free_sgpr 102
  .amdhsa_accum_offset 256
  .amdhsa_group_segment_fixed_size 0
  .amdhsa_kernarg_size 120
  .amdhsa_user_sgpr_count 2
  .amdhsa_user_sgpr_kernarg_segment_ptr 1
  .amdhsa_system_sgpr_workgroup_id_x 1
  .amdhsa_float_denorm_mode_32 3
.end_amdhsa_kernel
```
